```python
import torch

def _softmax(x, axis=-1):
    return torch.softmax(x, dim=axis)
def _gelu(x):
    return torch.nn.functional.gelu(x, approximate="tanh")
def _silu(x):
    return torch.nn.functional.silu(x)
def _sigmoid(x):
    return torch.sigmoid(x)
def _layernorm(x, axis=-1, eps=1e-5):
    m = x.mean(dim=axis, keepdim=True)
    v = x.var(dim=axis, keepdim=True, unbiased=False)
    return (x - m) / torch.sqrt(v + eps)
def _scatter_add(tgt, idx, src, axis=0):
    return tgt.clone().index_add_(axis, idx, src)
def _segment_sum(src, seg, n):
    out = torch.zeros((n,) + src.shape[1:], dtype=src.dtype)
    return out.index_add_(0, seg, src)
def _pad(x, pw):
    flat = tuple(v for pair in reversed(pw) for v in pair)
    return torch.nn.functional.pad(x, flat)

kernel_name = 'recurrent_scan__ssm_conv_s5__mixer_s_mlp__prompt'

def setup_inputs():

    _w = (lambda a: (lambda t: t.to(torch.bfloat16) if t.is_floating_point() else t)(torch.as_tensor(a)))
    def _A_setup():
        B, S, D = 1, 2048, 640
        P = D
        Lambda_re = -0.5 * (lambda _x: torch.exp(torch.as_tensor(_x)))((lambda *s: torch.randn(*s, dtype=torch.bfloat16) * 0.2)(P))
        Lambda_im = (lambda *s: torch.randn(*s, dtype=torch.bfloat16) * 0.4)(P) * 1.0
        B_re = (lambda *s: torch.randn(*s, dtype=torch.bfloat16) * 0.2)(P, D) * (D ** -0.5)
        B_im = (lambda *s: torch.randn(*s, dtype=torch.bfloat16) * 0.2)(P, D) * (D ** -0.5)
        C_re = (lambda *s: torch.randn(*s, dtype=torch.bfloat16) * 0.2)(D, P) * (P ** -0.5)
        C_im = (lambda *s: torch.randn(*s, dtype=torch.bfloat16) * 0.2)(D, P) * (P ** -0.5)
        log_dt = (lambda *s: torch.randn(*s, dtype=torch.bfloat16) * 0.2)(P) * 0.3 - 2.0
        Dskip = (lambda *s: torch.randn(*s, dtype=torch.bfloat16) * 0.05)(D)
        return {
            "x": _w((lambda *s: torch.randn(*s, dtype=torch.bfloat16) * 0.05)(B, S, D)),
            "Lambda_re": _w(Lambda_re),
            "Lambda_im": _w(Lambda_im),
            "B_re": _w(B_re),
            "B_im": _w(B_im),
            "C_re": _w(C_re),
            "C_im": _w(C_im),
            "log_dt": _w(log_dt),
            "Dskip": _w(Dskip),
        }
    _A_in = _A_setup()

    def _B_setup():
        B, S, D, F = 1, 2048, 640, 1536
        return {
            "x":  _w((lambda *s: torch.randn(*s, dtype=torch.bfloat16) * 0.05)(B, S, D)),
            "w1": _w((lambda *s: torch.randn(*s, dtype=torch.bfloat16) * 3.2)(D, D) * (D ** -0.5)),
            "w2": _w((lambda *s: torch.randn(*s, dtype=torch.bfloat16) * 3.2)(D, D) * (D ** -0.5)),
            "w3": _w((lambda *s: torch.randn(*s, dtype=torch.bfloat16) * 3.2)(D, F) * (D ** -0.5)),
            "w4": _w((lambda *s: torch.randn(*s, dtype=torch.bfloat16) * 1.6)(F, D) * (F ** -0.5)),
        }
    _B_in = _B_setup()

    return {
        "A_x": _A_in["x"],
        "A_Lambda_re": _A_in["Lambda_re"],
        "A_Lambda_im": _A_in["Lambda_im"],
        "A_B_re": _A_in["B_re"],
        "A_B_im": _A_in["B_im"],
        "A_C_re": _A_in["C_re"],
        "A_C_im": _A_in["C_im"],
        "A_log_dt": _A_in["log_dt"],
        "A_Dskip": _A_in["Dskip"],
        "B_x": _B_in["x"],
        "B_w1": _B_in["w1"],
        "B_w2": _B_in["w2"],
        "B_w3": _B_in["w3"],
        "B_w4": _B_in["w4"],
    }

def reference(A_x, A_Lambda_re, A_Lambda_im, A_B_re, A_B_im, A_C_re, A_C_im, A_log_dt, A_Dskip, B_x, B_w1, B_w2, B_w3, B_w4):
    def _A_ref(x, Lambda_re, Lambda_im, B_re, B_im, C_re, C_im, log_dt, Dskip):
        Bsz, L, H = x.shape
        Lam = Lambda_re + 1j * Lambda_im
        Bmat = B_re + 1j * B_im
        Cmat = C_re + 1j * C_im
        dt = torch.exp(log_dt)
        Lam_bar = torch.exp(dt * Lam)
        B_bar = ((Lam_bar - 1.0) / Lam)[:, None] * Bmat
        Bu = torch.einsum("bld,pd->blp", x + 0j, B_bar)
        h = torch.zeros_like(Bu[:, 0, :])
        hs = []
        for t in range(L):
            h = Lam_bar[None, :] * h + Bu[:, t, :]
            hs.append(h)
        hseq = torch.stack(hs, 1)
        y = 2.0 * torch.einsum("blp,dp->bld", hseq, Cmat).real + x * Dskip[None, None, :]
        return y

    def _B_ref(x, w1, w2, w3, w4):
        B, S, D = x.shape
        h = _gelu(_layernorm(x, axis=-1) @ w1)
        c = D // 4
        g0 = _pad(h[:, :, 0*c:1*c], ((0, 0), (1, 0), (0, 0)))[:, :S, :]
        g1 = _pad(h[:, :, 1*c:2*c], ((0, 0), (0, 1), (0, 0)))[:, 1:, :]
        g2 = _pad(h[:, :, 2*c:3*c], ((0, 0), (2, 0), (0, 0)))[:, :S, :]
        g3 = _pad(h[:, :, 3*c:   ], ((0, 0), (0, 2), (0, 0)))[:, 2:, :]
        hs = torch.concatenate([g0, g1, g2, g3], axis=-1) @ w2
        x1 = x + hs
        h2 = _gelu(_layernorm(x1, axis=-1) @ w3) @ w4
        return x1 + h2

    x = A_x
    xn = _layernorm(x, axis=-1)
    s = _A_ref(xn, A_Lambda_re, A_Lambda_im, A_B_re, A_B_im, A_C_re, A_C_im, A_log_dt, A_Dskip)
    g = _silu(_B_ref(xn, B_w1, B_w2, B_w3, B_w4))
    return x + s * g
```

```asm
; @launch grid=(256,1,1) block=(512,1,1) lds=163840
.amdgcn_target "amdgcn-amd-amdhsa--gfx950"
.text
.globl recurrent_scan__ssm_conv_s5__mixer_s_mlp__prompt_kernel
.p2align 8
.type recurrent_scan__ssm_conv_s5__mixer_s_mlp__prompt_kernel,@function
recurrent_scan__ssm_conv_s5__mixer_s_mlp__prompt_kernel:
    s_cmp_ge_u32 s2, 256
    s_cbranch_scc1 recurrent_scan__ssm_conv_s5__mixer_s_mlp__prompt_kernel_done
    s_load_dwordx16 s[8:23], s[0:1], 0
    s_load_dwordx16 s[24:39], s[0:1], 64
    s_load_dwordx2 s[40:41], s[0:1], 128
    v_and_b32 v1, 63, v0
    v_lshrrev_b32 v2, 6, v0
    s_nop 0
    v_readfirstlane_b32 s3, v2
    s_memrealtime s[96:97]
    v_lshrrev_b32 v10, 5, v1
    s_lshl_b32 s4, s2, 3
    s_lshl_b32 s5, s3, 1
    s_add_u32 s4, s4, s5
    v_add_u32 v10, s4, v10
    v_mul_u32_u24 v10, 1280, v10
    v_and_b32 v11, 31, v1
    v_lshl_add_u32 v2, v11, 3, v10
    s_waitcnt lgkmcnt(0)
    s_mov_b32 s48, s8
    s_mov_b32 s49, s9
    s_mov_b32 s50, 2621440
    s_mov_b32 s51, 0x20000
    s_cmp_ge_u32 s3, 4
    s_cbranch_scc1 m_nox
    buffer_load_dwordx2 v[16:17], v2, s[48:51], 0 offen offset:0
    buffer_load_dwordx2 v[18:19], v2, s[48:51], 0 offen offset:256
    buffer_load_dwordx2 v[20:21], v2, s[48:51], 0 offen offset:512
    buffer_load_dwordx2 v[22:23], v2, s[48:51], 0 offen offset:768
    buffer_load_dwordx2 v[24:25], v2, s[48:51], 0 offen offset:1024
m_nox:
    s_mov_b32 s95, -1
    s_cmp_lg_u32 s3, 7
    s_cbranch_scc1 m_nocpf
    s_getpc_b64 s[92:93]
L_cpf32:
    s_sub_u32 s92, s92, (L_cpf32-recurrent_scan__ssm_conv_s5__mixer_s_mlp__prompt_kernel)
    s_subb_u32 s93, s93, 0
    v_lshlrev_b32 v250, 7, v1
    v_min_u32 v251, (recurrent_scan__ssm_conv_s5__mixer_s_mlp__prompt_kernel_end-recurrent_scan__ssm_conv_s5__mixer_s_mlp__prompt_kernel-4), v250
    global_load_dword v252, v251, s[92:93]
    v_add_u32 v250, 8192, v250
    v_min_u32 v251, (recurrent_scan__ssm_conv_s5__mixer_s_mlp__prompt_kernel_end-recurrent_scan__ssm_conv_s5__mixer_s_mlp__prompt_kernel-4), v250
    global_load_dword v253, v251, s[92:93]
    v_add_u32 v250, 8192, v250
    v_min_u32 v251, (recurrent_scan__ssm_conv_s5__mixer_s_mlp__prompt_kernel_end-recurrent_scan__ssm_conv_s5__mixer_s_mlp__prompt_kernel-4), v250
    global_load_dword v252, v251, s[92:93]
    v_add_u32 v250, 8192, v250
    v_min_u32 v251, (recurrent_scan__ssm_conv_s5__mixer_s_mlp__prompt_kernel_end-recurrent_scan__ssm_conv_s5__mixer_s_mlp__prompt_kernel-4), v250
    global_load_dword v253, v251, s[92:93]
    v_add_u32 v250, 8192, v250
    v_min_u32 v251, (recurrent_scan__ssm_conv_s5__mixer_s_mlp__prompt_kernel_end-recurrent_scan__ssm_conv_s5__mixer_s_mlp__prompt_kernel-4), v250
    global_load_dword v252, v251, s[92:93]
    v_add_u32 v250, 8192, v250
    v_min_u32 v251, (recurrent_scan__ssm_conv_s5__mixer_s_mlp__prompt_kernel_end-recurrent_scan__ssm_conv_s5__mixer_s_mlp__prompt_kernel-4), v250
    global_load_dword v253, v251, s[92:93]
    v_add_u32 v250, 8192, v250
    v_min_u32 v251, (recurrent_scan__ssm_conv_s5__mixer_s_mlp__prompt_kernel_end-recurrent_scan__ssm_conv_s5__mixer_s_mlp__prompt_kernel-4), v250
    global_load_dword v252, v251, s[92:93]
    v_add_u32 v250, 8192, v250
    v_min_u32 v251, (recurrent_scan__ssm_conv_s5__mixer_s_mlp__prompt_kernel_end-recurrent_scan__ssm_conv_s5__mixer_s_mlp__prompt_kernel-4), v250
    global_load_dword v253, v251, s[92:93]
    v_add_u32 v250, 8192, v250
    v_min_u32 v251, (recurrent_scan__ssm_conv_s5__mixer_s_mlp__prompt_kernel_end-recurrent_scan__ssm_conv_s5__mixer_s_mlp__prompt_kernel-4), v250
    global_load_dword v252, v251, s[92:93]
    v_add_u32 v250, 8192, v250
    v_min_u32 v251, (recurrent_scan__ssm_conv_s5__mixer_s_mlp__prompt_kernel_end-recurrent_scan__ssm_conv_s5__mixer_s_mlp__prompt_kernel-4), v250
    global_load_dword v253, v251, s[92:93]
m_nocpf:
    s_sub_u32 s96, s96, 2000
    s_subb_u32 s97, s97, 0
    s_and_b32 s4, s2, 7
    s_lshr_b32 s5, s2, 3
    s_lshl_b32 s6, s4, 1
    s_and_b32 s7, s5, 1
    s_add_u32 s44, s6, s7
    s_lshr_b32 s45, s5, 1
    s_mov_b32 s46, s5
    s_waitcnt lgkmcnt(0)
    s_cmp_ge_u32 s3, 4
    s_cbranch_scc1 m1_loaders
    s_mov_b32 s52, s40
    s_mov_b32 s53, s41
    s_mov_b32 s54, 2621440
    s_mov_b32 s55, 0x20000
    s_add_u32 s56, s40, 2621440
    s_addc_u32 s57, s41, 0
    s_mov_b32 s58, 2621440
    s_mov_b32 s59, 0x20000
    s_add_u32 s60, s40, 5242880
    s_addc_u32 s61, s41, 0
    s_mov_b32 s62, 2626560
    s_mov_b32 s63, 0x20000
    s_cmp_eq_u32 s2, 0
    s_cselect_b32 s64, 0, 1
    s_cmp_eq_u32 s2, 255
    s_cselect_b32 s64, 2624000, s64
    s_cmp_eq_u32 s64, 1
    s_cbranch_scc1 m_nopad
    v_mov_b32 v8, 0
    v_mov_b32 v9, 0
    v_mov_b32 v10, 0
    v_mov_b32 v11, 0
    v_lshlrev_b32 v12, 4, v0
    v_cmp_gt_u32 vcc, 160, v0
    s_nop 1
    s_and_saveexec_b64 s[66:67], vcc
    s_cbranch_execz m_pad_done
    buffer_store_dwordx4 v[8:11], v12, s[60:63], s64 offen sc1
m_pad_done:
    s_mov_b64 exec, s[66:67]
m_nopad:
    s_mov_b32 s68, 0x3f803f80
    s_mov_b32 s69, 0xffff0000
    s_waitcnt vmcnt(0)
    v_mov_b32 v40, 0
    v_mov_b32 v41, 0
    v_mov_b32 v42, 0
    v_mov_b32 v43, 0
    v_dot2c_f32_bf16 v40, s68, v16
    v_dot2c_f32_bf16 v42, v16, v16
    v_dot2c_f32_bf16 v41, s68, v17
    v_dot2c_f32_bf16 v43, v17, v17
    v_dot2c_f32_bf16 v40, s68, v18
    v_dot2c_f32_bf16 v42, v18, v18
    v_dot2c_f32_bf16 v41, s68, v19
    v_dot2c_f32_bf16 v43, v19, v19
    v_dot2c_f32_bf16 v40, s68, v20
    v_dot2c_f32_bf16 v42, v20, v20
    v_dot2c_f32_bf16 v41, s68, v21
    v_dot2c_f32_bf16 v43, v21, v21
    v_dot2c_f32_bf16 v40, s68, v22
    v_dot2c_f32_bf16 v42, v22, v22
    v_dot2c_f32_bf16 v41, s68, v23
    v_dot2c_f32_bf16 v43, v23, v23
    v_dot2c_f32_bf16 v40, s68, v24
    v_dot2c_f32_bf16 v42, v24, v24
    v_dot2c_f32_bf16 v41, s68, v25
    v_dot2c_f32_bf16 v43, v25, v25
    s_nop 1
    v_add_f32 v40, v40, v41
    v_add_f32 v42, v42, v43
    s_nop 0
    v_add_f32_dpp v40, v40, v40 row_ror:8 row_mask:0xf bank_mask:0xf
    s_nop 1
    v_add_f32_dpp v40, v40, v40 row_ror:4 row_mask:0xf bank_mask:0xf
    s_nop 1
    v_add_f32_dpp v40, v40, v40 row_ror:2 row_mask:0xf bank_mask:0xf
    s_nop 1
    v_add_f32_dpp v40, v40, v40 row_ror:1 row_mask:0xf bank_mask:0xf
    v_mov_b32 v44, v40
    s_nop 1
    v_permlane16_swap_b32 v40, v44
    v_add_f32 v40, v40, v44
    v_add_f32_dpp v42, v42, v42 row_ror:8 row_mask:0xf bank_mask:0xf
    s_nop 1
    v_add_f32_dpp v42, v42, v42 row_ror:4 row_mask:0xf bank_mask:0xf
    s_nop 1
    v_add_f32_dpp v42, v42, v42 row_ror:2 row_mask:0xf bank_mask:0xf
    s_nop 1
    v_add_f32_dpp v42, v42, v42 row_ror:1 row_mask:0xf bank_mask:0xf
    v_mov_b32 v45, v42
    s_nop 1
    v_permlane16_swap_b32 v42, v45
    v_add_f32 v42, v42, v45
    v_mul_f32 v48, 0x3acccccd, v40
    v_mul_f32 v49, 0x3acccccd, v42
    v_fma_f32 v49, -v48, v48, v49
    v_max_f32 v49, 0, v49
    v_cvt_pk_bf16_f32 v50, v48, v48
    v_lshlrev_b32 v50, 16, v50
    v_cvt_pk_bf16_f32 v53, v49, v49
    v_lshlrev_b32 v53, 16, v53
    v_add_f32 v53, 0x3727c5ac, v53
    v_cvt_pk_bf16_f32 v53, v53, v53
    v_lshlrev_b32 v53, 16, v53
    v_sqrt_f32 v53, v53
    s_nop 0
    v_cvt_pk_bf16_f32 v51, v53, v53
    v_lshlrev_b32 v51, 16, v51
    v_rcp_f32 v52, v51
    s_nop 0
    v_mov_b32 v46, v52
    v_mov_b32 v47, v50
    v_lshlrev_b32 v56, 16, v16
    v_and_b32 v57, s69, v16
    v_lshlrev_b32 v58, 16, v17
    v_and_b32 v59, s69, v17
    v_lshlrev_b32 v60, 16, v18
    v_and_b32 v61, s69, v18
    v_lshlrev_b32 v62, 16, v19
    v_and_b32 v63, s69, v19
    v_lshlrev_b32 v64, 16, v20
    v_and_b32 v65, s69, v20
    v_lshlrev_b32 v66, 16, v21
    v_and_b32 v67, s69, v21
    v_lshlrev_b32 v68, 16, v22
    v_and_b32 v69, s69, v22
    v_lshlrev_b32 v70, 16, v23
    v_and_b32 v71, s69, v23
    v_lshlrev_b32 v72, 16, v24
    v_and_b32 v73, s69, v24
    v_lshlrev_b32 v74, 16, v25
    v_and_b32 v75, s69, v25
    v_pk_add_f32 v[56:57], v[56:57], v[46:47] op_sel:[0,1] op_sel_hi:[1,1] neg_lo:[0,1] neg_hi:[0,1]
    v_pk_add_f32 v[58:59], v[58:59], v[46:47] op_sel:[0,1] op_sel_hi:[1,1] neg_lo:[0,1] neg_hi:[0,1]
    v_pk_add_f32 v[60:61], v[60:61], v[46:47] op_sel:[0,1] op_sel_hi:[1,1] neg_lo:[0,1] neg_hi:[0,1]
    v_pk_add_f32 v[62:63], v[62:63], v[46:47] op_sel:[0,1] op_sel_hi:[1,1] neg_lo:[0,1] neg_hi:[0,1]
    v_pk_add_f32 v[64:65], v[64:65], v[46:47] op_sel:[0,1] op_sel_hi:[1,1] neg_lo:[0,1] neg_hi:[0,1]
    v_pk_add_f32 v[66:67], v[66:67], v[46:47] op_sel:[0,1] op_sel_hi:[1,1] neg_lo:[0,1] neg_hi:[0,1]
    v_pk_add_f32 v[68:69], v[68:69], v[46:47] op_sel:[0,1] op_sel_hi:[1,1] neg_lo:[0,1] neg_hi:[0,1]
    v_pk_add_f32 v[70:71], v[70:71], v[46:47] op_sel:[0,1] op_sel_hi:[1,1] neg_lo:[0,1] neg_hi:[0,1]
    v_pk_add_f32 v[72:73], v[72:73], v[46:47] op_sel:[0,1] op_sel_hi:[1,1] neg_lo:[0,1] neg_hi:[0,1]
    v_pk_add_f32 v[74:75], v[74:75], v[46:47] op_sel:[0,1] op_sel_hi:[1,1] neg_lo:[0,1] neg_hi:[0,1]
    v_cvt_pk_bf16_f32 v16, v56, v57
    v_cvt_pk_bf16_f32 v17, v58, v59
    v_cvt_pk_bf16_f32 v18, v60, v61
    v_cvt_pk_bf16_f32 v19, v62, v63
    v_cvt_pk_bf16_f32 v20, v64, v65
    v_cvt_pk_bf16_f32 v21, v66, v67
    v_cvt_pk_bf16_f32 v22, v68, v69
    v_cvt_pk_bf16_f32 v23, v70, v71
    v_cvt_pk_bf16_f32 v24, v72, v73
    v_cvt_pk_bf16_f32 v25, v74, v75
    v_lshlrev_b32 v56, 16, v16
    v_and_b32 v57, s69, v16
    v_lshlrev_b32 v58, 16, v17
    v_and_b32 v59, s69, v17
    v_lshlrev_b32 v60, 16, v18
    v_and_b32 v61, s69, v18
    v_lshlrev_b32 v62, 16, v19
    v_and_b32 v63, s69, v19
    v_lshlrev_b32 v64, 16, v20
    v_and_b32 v65, s69, v20
    v_lshlrev_b32 v66, 16, v21
    v_and_b32 v67, s69, v21
    v_lshlrev_b32 v68, 16, v22
    v_and_b32 v69, s69, v22
    v_lshlrev_b32 v70, 16, v23
    v_and_b32 v71, s69, v23
    v_lshlrev_b32 v72, 16, v24
    v_and_b32 v73, s69, v24
    v_lshlrev_b32 v74, 16, v25
    v_and_b32 v75, s69, v25
    v_pk_mul_f32 v[56:57], v[56:57], v[46:47] op_sel_hi:[1,0]
    v_pk_mul_f32 v[58:59], v[58:59], v[46:47] op_sel_hi:[1,0]
    v_pk_mul_f32 v[60:61], v[60:61], v[46:47] op_sel_hi:[1,0]
    v_pk_mul_f32 v[62:63], v[62:63], v[46:47] op_sel_hi:[1,0]
    v_pk_mul_f32 v[64:65], v[64:65], v[46:47] op_sel_hi:[1,0]
    v_pk_mul_f32 v[66:67], v[66:67], v[46:47] op_sel_hi:[1,0]
    v_pk_mul_f32 v[68:69], v[68:69], v[46:47] op_sel_hi:[1,0]
    v_pk_mul_f32 v[70:71], v[70:71], v[46:47] op_sel_hi:[1,0]
    v_pk_mul_f32 v[72:73], v[72:73], v[46:47] op_sel_hi:[1,0]
    v_pk_mul_f32 v[74:75], v[74:75], v[46:47] op_sel_hi:[1,0]
    v_cvt_pk_bf16_f32 v16, v56, v57
    v_cvt_pk_bf16_f32 v17, v58, v59
    v_cvt_pk_bf16_f32 v18, v60, v61
    v_cvt_pk_bf16_f32 v19, v62, v63
    v_cvt_pk_bf16_f32 v20, v64, v65
    v_cvt_pk_bf16_f32 v21, v66, v67
    v_cvt_pk_bf16_f32 v22, v68, v69
    v_cvt_pk_bf16_f32 v23, v70, v71
    v_cvt_pk_bf16_f32 v24, v72, v73
    v_cvt_pk_bf16_f32 v25, v74, v75
    v_and_b32 v30, 1, v1
    v_cmp_eq_u32 s[70:71], 1, v30
    v_lshlrev_b32 v31, 3, v30
    v_sub_u32 v31, v2, v31
    v_lshl_add_u32 v31, v30, 8, v31
    v_cndmask_b32 v110, v18, v16, s[70:71]
    v_cndmask_b32 v112, v16, v18, s[70:71]
    v_cndmask_b32 v111, v19, v17, s[70:71]
    v_cndmask_b32 v113, v17, v19, s[70:71]
    v_mov_b32_dpp v114, v110 quad_perm:[1,0,3,2] row_mask:0xf bank_mask:0xf
    v_mov_b32_dpp v115, v111 quad_perm:[1,0,3,2] row_mask:0xf bank_mask:0xf
    v_cndmask_b32 v100, v112, v114, s[70:71]
    v_cndmask_b32 v102, v114, v112, s[70:71]
    v_cndmask_b32 v101, v113, v115, s[70:71]
    v_cndmask_b32 v103, v115, v113, s[70:71]
    buffer_store_dwordx4 v[100:103], v31, s[52:55], 0 offen offset:0 sc1
    v_cndmask_b32 v110, v22, v20, s[70:71]
    v_cndmask_b32 v112, v20, v22, s[70:71]
    v_cndmask_b32 v111, v23, v21, s[70:71]
    v_cndmask_b32 v113, v21, v23, s[70:71]
    v_mov_b32_dpp v114, v110 quad_perm:[1,0,3,2] row_mask:0xf bank_mask:0xf
    v_mov_b32_dpp v115, v111 quad_perm:[1,0,3,2] row_mask:0xf bank_mask:0xf
    v_cndmask_b32 v104, v112, v114, s[70:71]
    v_cndmask_b32 v106, v114, v112, s[70:71]
    v_cndmask_b32 v105, v113, v115, s[70:71]
    v_cndmask_b32 v107, v115, v113, s[70:71]
    buffer_store_dwordx4 v[104:107], v31, s[52:55], 0 offen offset:512 sc1
    buffer_store_dwordx2 v[24:25], v2, s[52:55], 0 offen offset:1024 sc1
    v_mov_b32 v40, 0
    v_mov_b32 v41, 0
    v_mov_b32 v42, 0
    v_mov_b32 v43, 0
    v_dot2c_f32_bf16 v40, s68, v16
    v_dot2c_f32_bf16 v42, v16, v16
    v_dot2c_f32_bf16 v41, s68, v17
    v_dot2c_f32_bf16 v43, v17, v17
    v_dot2c_f32_bf16 v40, s68, v18
    v_dot2c_f32_bf16 v42, v18, v18
    v_dot2c_f32_bf16 v41, s68, v19
    v_dot2c_f32_bf16 v43, v19, v19
    v_dot2c_f32_bf16 v40, s68, v20
    v_dot2c_f32_bf16 v42, v20, v20
    v_dot2c_f32_bf16 v41, s68, v21
    v_dot2c_f32_bf16 v43, v21, v21
    v_dot2c_f32_bf16 v40, s68, v22
    v_dot2c_f32_bf16 v42, v22, v22
    v_dot2c_f32_bf16 v41, s68, v23
    v_dot2c_f32_bf16 v43, v23, v23
    v_dot2c_f32_bf16 v40, s68, v24
    v_dot2c_f32_bf16 v42, v24, v24
    v_dot2c_f32_bf16 v41, s68, v25
    v_dot2c_f32_bf16 v43, v25, v25
    s_nop 1
    v_add_f32 v40, v40, v41
    v_add_f32 v42, v42, v43
    s_nop 0
    v_add_f32_dpp v40, v40, v40 row_ror:8 row_mask:0xf bank_mask:0xf
    s_nop 1
    v_add_f32_dpp v40, v40, v40 row_ror:4 row_mask:0xf bank_mask:0xf
    s_nop 1
    v_add_f32_dpp v40, v40, v40 row_ror:2 row_mask:0xf bank_mask:0xf
    s_nop 1
    v_add_f32_dpp v40, v40, v40 row_ror:1 row_mask:0xf bank_mask:0xf
    v_mov_b32 v44, v40
    s_nop 1
    v_permlane16_swap_b32 v40, v44
    v_add_f32 v40, v40, v44
    v_add_f32_dpp v42, v42, v42 row_ror:8 row_mask:0xf bank_mask:0xf
    s_nop 1
    v_add_f32_dpp v42, v42, v42 row_ror:4 row_mask:0xf bank_mask:0xf
    s_nop 1
    v_add_f32_dpp v42, v42, v42 row_ror:2 row_mask:0xf bank_mask:0xf
    s_nop 1
    v_add_f32_dpp v42, v42, v42 row_ror:1 row_mask:0xf bank_mask:0xf
    v_mov_b32 v45, v42
    s_nop 1
    v_permlane16_swap_b32 v42, v45
    v_add_f32 v42, v42, v45
    v_mul_f32 v48, 0x3acccccd, v40
    v_mul_f32 v49, 0x3acccccd, v42
    v_fma_f32 v49, -v48, v48, v49
    v_max_f32 v49, 0, v49
    v_cvt_pk_bf16_f32 v50, v48, v48
    v_lshlrev_b32 v50, 16, v50
    v_cvt_pk_bf16_f32 v53, v49, v49
    v_lshlrev_b32 v53, 16, v53
    v_add_f32 v53, 0x3727c5ac, v53
    v_cvt_pk_bf16_f32 v53, v53, v53
    v_lshlrev_b32 v53, 16, v53
    v_sqrt_f32 v53, v53
    s_nop 0
    v_cvt_pk_bf16_f32 v51, v53, v53
    v_lshlrev_b32 v51, 16, v51
    v_rcp_f32 v52, v51
    s_nop 0
    v_mov_b32 v46, v52
    v_mov_b32 v47, v50
    v_lshlrev_b32 v56, 16, v16
    v_and_b32 v57, s69, v16
    v_lshlrev_b32 v58, 16, v17
    v_and_b32 v59, s69, v17
    v_lshlrev_b32 v60, 16, v18
    v_and_b32 v61, s69, v18
    v_lshlrev_b32 v62, 16, v19
    v_and_b32 v63, s69, v19
    v_lshlrev_b32 v64, 16, v20
    v_and_b32 v65, s69, v20
    v_lshlrev_b32 v66, 16, v21
    v_and_b32 v67, s69, v21
    v_lshlrev_b32 v68, 16, v22
    v_and_b32 v69, s69, v22
    v_lshlrev_b32 v70, 16, v23
    v_and_b32 v71, s69, v23
    v_lshlrev_b32 v72, 16, v24
    v_and_b32 v73, s69, v24
    v_lshlrev_b32 v74, 16, v25
    v_and_b32 v75, s69, v25
    v_pk_add_f32 v[56:57], v[56:57], v[46:47] op_sel:[0,1] op_sel_hi:[1,1] neg_lo:[0,1] neg_hi:[0,1]
    v_pk_add_f32 v[58:59], v[58:59], v[46:47] op_sel:[0,1] op_sel_hi:[1,1] neg_lo:[0,1] neg_hi:[0,1]
    v_pk_add_f32 v[60:61], v[60:61], v[46:47] op_sel:[0,1] op_sel_hi:[1,1] neg_lo:[0,1] neg_hi:[0,1]
    v_pk_add_f32 v[62:63], v[62:63], v[46:47] op_sel:[0,1] op_sel_hi:[1,1] neg_lo:[0,1] neg_hi:[0,1]
    v_pk_add_f32 v[64:65], v[64:65], v[46:47] op_sel:[0,1] op_sel_hi:[1,1] neg_lo:[0,1] neg_hi:[0,1]
    v_pk_add_f32 v[66:67], v[66:67], v[46:47] op_sel:[0,1] op_sel_hi:[1,1] neg_lo:[0,1] neg_hi:[0,1]
    v_pk_add_f32 v[68:69], v[68:69], v[46:47] op_sel:[0,1] op_sel_hi:[1,1] neg_lo:[0,1] neg_hi:[0,1]
    v_pk_add_f32 v[70:71], v[70:71], v[46:47] op_sel:[0,1] op_sel_hi:[1,1] neg_lo:[0,1] neg_hi:[0,1]
    v_pk_add_f32 v[72:73], v[72:73], v[46:47] op_sel:[0,1] op_sel_hi:[1,1] neg_lo:[0,1] neg_hi:[0,1]
    v_pk_add_f32 v[74:75], v[74:75], v[46:47] op_sel:[0,1] op_sel_hi:[1,1] neg_lo:[0,1] neg_hi:[0,1]
    v_cvt_pk_bf16_f32 v16, v56, v57
    v_cvt_pk_bf16_f32 v17, v58, v59
    v_cvt_pk_bf16_f32 v18, v60, v61
    v_cvt_pk_bf16_f32 v19, v62, v63
    v_cvt_pk_bf16_f32 v20, v64, v65
    v_cvt_pk_bf16_f32 v21, v66, v67
    v_cvt_pk_bf16_f32 v22, v68, v69
    v_cvt_pk_bf16_f32 v23, v70, v71
    v_cvt_pk_bf16_f32 v24, v72, v73
    v_cvt_pk_bf16_f32 v25, v74, v75
    v_lshlrev_b32 v56, 16, v16
    v_and_b32 v57, s69, v16
    v_lshlrev_b32 v58, 16, v17
    v_and_b32 v59, s69, v17
    v_lshlrev_b32 v60, 16, v18
    v_and_b32 v61, s69, v18
    v_lshlrev_b32 v62, 16, v19
    v_and_b32 v63, s69, v19
    v_lshlrev_b32 v64, 16, v20
    v_and_b32 v65, s69, v20
    v_lshlrev_b32 v66, 16, v21
    v_and_b32 v67, s69, v21
    v_lshlrev_b32 v68, 16, v22
    v_and_b32 v69, s69, v22
    v_lshlrev_b32 v70, 16, v23
    v_and_b32 v71, s69, v23
    v_lshlrev_b32 v72, 16, v24
    v_and_b32 v73, s69, v24
    v_lshlrev_b32 v74, 16, v25
    v_and_b32 v75, s69, v25
    v_pk_mul_f32 v[56:57], v[56:57], v[46:47] op_sel_hi:[1,0]
    v_pk_mul_f32 v[58:59], v[58:59], v[46:47] op_sel_hi:[1,0]
    v_pk_mul_f32 v[60:61], v[60:61], v[46:47] op_sel_hi:[1,0]
    v_pk_mul_f32 v[62:63], v[62:63], v[46:47] op_sel_hi:[1,0]
    v_pk_mul_f32 v[64:65], v[64:65], v[46:47] op_sel_hi:[1,0]
    v_pk_mul_f32 v[66:67], v[66:67], v[46:47] op_sel_hi:[1,0]
    v_pk_mul_f32 v[68:69], v[68:69], v[46:47] op_sel_hi:[1,0]
    v_pk_mul_f32 v[70:71], v[70:71], v[46:47] op_sel_hi:[1,0]
    v_pk_mul_f32 v[72:73], v[72:73], v[46:47] op_sel_hi:[1,0]
    v_pk_mul_f32 v[74:75], v[74:75], v[46:47] op_sel_hi:[1,0]
    v_cvt_pk_bf16_f32 v16, v56, v57
    v_cvt_pk_bf16_f32 v17, v58, v59
    v_cvt_pk_bf16_f32 v18, v60, v61
    v_cvt_pk_bf16_f32 v19, v62, v63
    v_cvt_pk_bf16_f32 v20, v64, v65
    v_cvt_pk_bf16_f32 v21, v66, v67
    v_cvt_pk_bf16_f32 v22, v68, v69
    v_cvt_pk_bf16_f32 v23, v70, v71
    v_cvt_pk_bf16_f32 v24, v72, v73
    v_cvt_pk_bf16_f32 v25, v74, v75
    v_cndmask_b32 v110, v18, v16, s[70:71]
    v_cndmask_b32 v112, v16, v18, s[70:71]
    v_cndmask_b32 v111, v19, v17, s[70:71]
    v_cndmask_b32 v113, v17, v19, s[70:71]
    v_mov_b32_dpp v114, v110 quad_perm:[1,0,3,2] row_mask:0xf bank_mask:0xf
    v_mov_b32_dpp v115, v111 quad_perm:[1,0,3,2] row_mask:0xf bank_mask:0xf
    v_cndmask_b32 v100, v112, v114, s[70:71]
    v_cndmask_b32 v102, v114, v112, s[70:71]
    v_cndmask_b32 v101, v113, v115, s[70:71]
    v_cndmask_b32 v103, v115, v113, s[70:71]
    buffer_store_dwordx4 v[100:103], v31, s[56:59], 0 offen offset:0 sc1
    v_cndmask_b32 v110, v22, v20, s[70:71]
    v_cndmask_b32 v112, v20, v22, s[70:71]
    v_cndmask_b32 v111, v23, v21, s[70:71]
    v_cndmask_b32 v113, v21, v23, s[70:71]
    v_mov_b32_dpp v114, v110 quad_perm:[1,0,3,2] row_mask:0xf bank_mask:0xf
    v_mov_b32_dpp v115, v111 quad_perm:[1,0,3,2] row_mask:0xf bank_mask:0xf
    v_cndmask_b32 v104, v112, v114, s[70:71]
    v_cndmask_b32 v106, v114, v112, s[70:71]
    v_cndmask_b32 v105, v113, v115, s[70:71]
    v_cndmask_b32 v107, v115, v113, s[70:71]
    buffer_store_dwordx4 v[104:107], v31, s[56:59], 0 offen offset:512 sc1
    buffer_store_dwordx2 v[24:25], v2, s[56:59], 0 offen offset:1024 sc1
    s_lshr_b32 s4, s2, 4
    s_add_u32 s4, s4, 0
    s_lshl_b32 s4, s4, 7
    s_and_b32 s5, s2, 15
    s_lshl_b32 s5, s5, 3
    s_add_u32 s95, s4, s5
    s_add_u32 s84, s40, 34656256
    s_addc_u32 s85, s41, 0
    s_mov_b32 s86, 22528
    s_mov_b32 s87, 0x20000
    s_add_u32 s88, s96, 2000
    s_addc_u32 s89, s97, 0
    v_mov_b32 v22, s88
    v_mov_b32 v23, s89
    v_mov_b32 v20, s95
    s_waitcnt vmcnt(0) lgkmcnt(0)
    s_barrier
    s_cmp_lg_u32 s3, 0
    s_cbranch_scc1 pb1
    s_cmp_eq_u32 s95, -1
    s_cbranch_scc1 pb1
    s_mov_b64 s[90:91], exec
    s_mov_b64 exec, 1
    buffer_store_dwordx2 v[22:23], v20, s[84:87], 0 offen sc1
    s_mov_b64 exec, s[90:91]
pb1:
    s_cmp_eq_u32 s3, 0
    s_cbranch_scc1 w3p2
    s_mul_i32 s78, s2, 3
    s_add_u32 s78, s78, s3
    s_sub_u32 s78, s78, 1
    v_lshlrev_b32 v250, 7, v1
    s_mov_b32 s80, s32
    s_mov_b32 s81, s33
    s_mov_b32 s82, 1966080
    s_mov_b32 s83, 0x20000
    s_mul_i32 s84, s78, 2560
    v_cmp_gt_u32 vcc, 20, v1
    s_nop 1
    s_and_saveexec_b64 s[86:87], vcc
    s_add_u32 s85, s84, 0
    buffer_load_dword v251, v250, s[80:83], s85 offen
    s_mov_b64 exec, s[86:87]
w3p2:
    s_cmp_ge_u32 s46, 30
    s_cbranch_scc1 m1_idle_c
    s_cmp_ge_u32 s46, 20
    s_cbranch_scc1 m1_u_c
    s_and_b32 s4, s2, 7
    s_lshr_b32 s5, s2, 3
    s_lshl_b32 s6, s4, 2
    s_and_b32 s7, s5, 3
    s_add_u32 s44, s6, s7
    s_lshr_b32 s45, s5, 2
    s_add_u32 s88, s44, 16
    s_lshl_b32 s88, s88, 7
    s_lshl_b32 s89, s45, 3
    s_add_u32 s95, s88, s89
    s_add_u32 s64, s40, 5242880
    s_addc_u32 s65, s41, 0
    s_mov_b32 s66, 2626560
    s_mov_b32 s67, 0x20000
    s_mov_b32 s70, 0xc0135761
    s_mov_b32 s71, 0xc0135761
    s_mov_b32 s72, 0xbdd2d3e8
    s_mov_b32 s73, 0xbdd2d3e8
    s_mov_b32 s74, 0xffff0000
    v_mov_b32 v196, s70
    v_mov_b32 v197, s70
    v_lshrrev_b32 v7, 4, v1
    s_lshl_b32 s60, s3, 3
    v_add_u32 v7, s60, v7
    v_and_b32 v11, 15, v1
    v_lshlrev_b32 v4, 8, v7
    v_lshl_add_u32 v4, v11, 4, v4
    v_add_u32 v12, 0, v7
    v_and_b32 v13, 15, v12
    v_xor_b32 v13, v13, v11
    v_mul_u32_u24 v12, 1280, v12
    v_lshl_add_u32 v5, v13, 4, v12
    v_add_u32 v12, 4, v7
    v_and_b32 v13, 15, v12
    v_xor_b32 v13, v13, v11
    v_mul_u32_u24 v12, 1280, v12
    v_lshl_add_u32 v6, v13, 4, v12
    s_lshl_b32 s61, s44, 6
    s_add_u32 s61, s61, 2
    s_mul_i32 s61, s61, 1280
    s_lshl_b32 s62, s45, 8
    s_add_u32 s75, s61, s62
    s_and_b32 s4, s3, 1
    s_lshr_b32 s5, s3, 1
    s_lshl_b32 s42, s5, 12
    v_and_b32 v10, 31, v1
    v_lshlrev_b32 v10, 7, v10
    v_lshrrev_b32 v11, 5, v1
    v_bfe_u32 v12, v1, 1, 3
    v_xor_b32 v11, v11, v12
    v_add_u32 v10, s42, v10
    v_xor_b32 v12, 0, v11
    v_lshl_add_u32 v208, v12, 4, v10
    v_xor_b32 v12, 2, v11
    v_lshl_add_u32 v209, v12, 4, v10
    v_xor_b32 v12, 4, v11
    v_lshl_add_u32 v210, v12, 4, v10
    v_xor_b32 v12, 6, v11
    v_lshl_add_u32 v211, v12, 4, v10
    v_lshrrev_b32 v10, 5, v1
    v_lshlrev_b32 v10, 3, v10
    v_bfe_u32 v11, v1, 2, 2
    v_add_u32 v10, v10, v11
    v_lshlrev_b32 v10, 7, v10
    v_bfe_u32 v11, v1, 3, 1
    v_lshlrev_b32 v11, 6, v11
    v_or_b32 v10, v10, v11
    v_bfe_u32 v11, v1, 4, 1
    v_lshlrev_b32 v11, 5, v11
    v_or_b32 v10, v10, v11
    v_bfe_u32 v11, v1, 1, 1
    v_lshlrev_b32 v11, 4, v11
    v_or_b32 v10, v10, v11
    v_and_b32 v11, 1, v1
    v_lshlrev_b32 v11, 3, v11
    v_or_b32 v224, v10, v11
    s_lshl_b32 s42, s4, 13
    s_add_u32 s42, s42, 8192
    v_add_u32 v224, s42, v224
    v_xor_b32 v225, 64, v224
    s_lshl_b32 s60, s5, 5
    s_lshl_b32 s62, s4, 3
    v_and_b32 v10, 31, v1
    v_add_u32 v10, s60, v10
    v_and_b32 v13, 15, v10
    v_mul_u32_u24 v12, 256, v10
    v_lshrrev_b32 v10, 5, v1
    v_lshl_add_u32 v12, v10, 3, v12
    s_add_u32 s42, s62, 0
    v_xor_b32 v14, s42, v13
    v_lshl_add_u32 v184, v14, 4, v12
    s_add_u32 s42, s62, 1
    v_xor_b32 v14, s42, v13
    v_lshl_add_u32 v185, v14, 4, v12
    s_add_u32 s42, s62, 2
    v_xor_b32 v14, s42, v13
    v_lshl_add_u32 v186, v14, 4, v12
    s_add_u32 s42, s62, 3
    v_xor_b32 v14, s42, v13
    v_lshl_add_u32 v187, v14, 4, v12
    s_add_u32 s42, s62, 4
    v_xor_b32 v14, s42, v13
    v_lshl_add_u32 v188, v14, 4, v12
    s_add_u32 s42, s62, 5
    v_xor_b32 v14, s42, v13
    v_lshl_add_u32 v189, v14, 4, v12
    s_add_u32 s42, s62, 6
    v_xor_b32 v14, s42, v13
    v_lshl_add_u32 v190, v14, 4, v12
    s_add_u32 s42, s62, 7
    v_xor_b32 v14, s42, v13
    v_lshl_add_u32 v191, v14, 4, v12
    s_cmp_lg_u32 s3, 0
    s_cbranch_scc1 dw3
    s_add_u32 s84, s40, 34656256
    s_addc_u32 s85, s41, 0
    s_mov_b32 s86, 22528
    s_mov_b32 s87, 0x20000
    s_lshr_b32 s90, s44, 1
    s_add_u32 s90, s90, 0
    s_lshl_b32 s90, s90, 7
    s_and_b32 s91, s44, 1
    s_lshl_b32 s91, s91, 6
    s_add_u32 s90, s90, s91
    v_lshlrev_b32 v236, 3, v1
    v_add_u32 v236, s90, v236
    v_cmp_gt_u32 vcc, 8, v1
    s_nop 1
    s_and_saveexec_b64 s[88:89], vcc
    s_cbranch_execz pd5
    v_mov_b32 v240, s96
    v_mov_b32 v241, s97
    s_mov_b32 s90, 0
pl4:
    buffer_load_dwordx2 v[238:239], v236, s[84:87], 0 offen sc1
    s_waitcnt vmcnt(0)
    v_sub_co_u32 v238, vcc, v238, v240
    s_nop 1
    v_subb_co_u32 v239, vcc, v239, v241, vcc
    v_cmp_eq_u32 s[92:93], 0, v239
    s_mov_b32 s91, 16777216
    v_cmp_gt_u32 vcc, s91, v238
    s_nop 1
    s_and_b64 vcc, vcc, s[92:93]
    s_cmp_eq_u64 vcc, exec
    s_cbranch_scc1 pd5
    s_add_u32 s90, s90, 1
    s_cmp_lt_u32 s90, 262144
    s_cbranch_scc1 pl4
pd5:
    s_mov_b64 exec, s[88:89]
dw3:
    s_barrier
    v_add_u32 v212, 73728, v208
    v_add_u32 v213, 73728, v209
    v_add_u32 v214, 73728, v210
    v_add_u32 v215, 73728, v211
    v_add_u32 v226, 73728, v224
    v_add_u32 v227, 73728, v225
    s_barrier
    ds_read_b128 v[48:51], v208 offset:0
    ds_read_b64_tr_b16 v[52:53], v224 offset:0
    ds_read_b64_tr_b16 v[54:55], v224 offset:512
    ds_read_b64_tr_b16 v[56:57], v225 offset:0
    ds_read_b64_tr_b16 v[58:59], v225 offset:512
    ds_read_b128 v[60:63], v209 offset:0
    ds_read_b64_tr_b16 v[64:65], v224 offset:2048
    ds_read_b64_tr_b16 v[66:67], v224 offset:2560
    ds_read_b64_tr_b16 v[68:69], v225 offset:2048
    ds_read_b64_tr_b16 v[70:71], v225 offset:2560
    ds_read_b128 v[72:75], v210 offset:0
    ds_read_b64_tr_b16 v[76:77], v224 offset:4096
    ds_read_b64_tr_b16 v[78:79], v224 offset:4608
    ds_read_b64_tr_b16 v[80:81], v225 offset:4096
    ds_read_b64_tr_b16 v[82:83], v225 offset:4608
    s_waitcnt lgkmcnt(10)
    v_mfma_f32_32x32x16_bf16 v[16:31], v[52:55], v[48:51], 0
    ds_read_b128 v[84:87], v211 offset:0
    ds_read_b64_tr_b16 v[88:89], v224 offset:6144
    ds_read_b64_tr_b16 v[90:91], v224 offset:6656
    v_mfma_f32_32x32x16_bf16 v[32:47], v[56:59], v[48:51], 0
    ds_read_b64_tr_b16 v[92:93], v225 offset:6144
    ds_read_b64_tr_b16 v[94:95], v225 offset:6656
    s_waitcnt lgkmcnt(10)
    s_barrier
    v_mfma_f32_32x32x16_bf16 v[16:31], v[64:67], v[60:63], v[16:31]
    ds_read_b128 v[48:51], v208 offset:24576
    ds_read_b64_tr_b16 v[52:53], v224 offset:24576
    ds_read_b64_tr_b16 v[54:55], v224 offset:25088
    v_mfma_f32_32x32x16_bf16 v[32:47], v[68:71], v[60:63], v[32:47]
    ds_read_b64_tr_b16 v[56:57], v225 offset:24576
    ds_read_b64_tr_b16 v[58:59], v225 offset:25088
    s_waitcnt lgkmcnt(10)
    v_mfma_f32_32x32x16_bf16 v[16:31], v[76:79], v[72:75], v[16:31]
    ds_read_b128 v[60:63], v209 offset:24576
    ds_read_b64_tr_b16 v[64:65], v224 offset:26624
    ds_read_b64_tr_b16 v[66:67], v224 offset:27136
    v_mfma_f32_32x32x16_bf16 v[32:47], v[80:83], v[72:75], v[32:47]
    ds_read_b64_tr_b16 v[68:69], v225 offset:26624
    ds_read_b64_tr_b16 v[70:71], v225 offset:27136
    s_waitcnt lgkmcnt(10)
    v_mfma_f32_32x32x16_bf16 v[16:31], v[88:91], v[84:87], v[16:31]
    ds_read_b128 v[72:75], v210 offset:24576
    ds_read_b64_tr_b16 v[76:77], v224 offset:28672
    ds_read_b64_tr_b16 v[78:79], v224 offset:29184
    v_mfma_f32_32x32x16_bf16 v[32:47], v[92:95], v[84:87], v[32:47]
    ds_read_b64_tr_b16 v[80:81], v225 offset:28672
    ds_read_b64_tr_b16 v[82:83], v225 offset:29184
    s_waitcnt lgkmcnt(10)
    v_mfma_f32_32x32x16_bf16 v[16:31], v[52:55], v[48:51], v[16:31]
    ds_read_b128 v[84:87], v211 offset:24576
    ds_read_b64_tr_b16 v[88:89], v224 offset:30720
    ds_read_b64_tr_b16 v[90:91], v224 offset:31232
    v_mfma_f32_32x32x16_bf16 v[32:47], v[56:59], v[48:51], v[32:47]
    ds_read_b64_tr_b16 v[92:93], v225 offset:30720
    ds_read_b64_tr_b16 v[94:95], v225 offset:31232
    s_waitcnt lgkmcnt(10)
    s_barrier
    v_mfma_f32_32x32x16_bf16 v[16:31], v[64:67], v[60:63], v[16:31]
    ds_read_b128 v[48:51], v208 offset:49152
    ds_read_b64_tr_b16 v[52:53], v224 offset:49152
    ds_read_b64_tr_b16 v[54:55], v224 offset:49664
    v_mfma_f32_32x32x16_bf16 v[32:47], v[68:71], v[60:63], v[32:47]
    ds_read_b64_tr_b16 v[56:57], v225 offset:49152
    ds_read_b64_tr_b16 v[58:59], v225 offset:49664
    s_waitcnt lgkmcnt(10)
    v_mfma_f32_32x32x16_bf16 v[16:31], v[76:79], v[72:75], v[16:31]
    ds_read_b128 v[60:63], v209 offset:49152
    ds_read_b64_tr_b16 v[64:65], v224 offset:51200
    ds_read_b64_tr_b16 v[66:67], v224 offset:51712
    v_mfma_f32_32x32x16_bf16 v[32:47], v[80:83], v[72:75], v[32:47]
    ds_read_b64_tr_b16 v[68:69], v225 offset:51200
    ds_read_b64_tr_b16 v[70:71], v225 offset:51712
    s_waitcnt lgkmcnt(10)
    v_mfma_f32_32x32x16_bf16 v[16:31], v[88:91], v[84:87], v[16:31]
    ds_read_b128 v[72:75], v210 offset:49152
    ds_read_b64_tr_b16 v[76:77], v224 offset:53248
    ds_read_b64_tr_b16 v[78:79], v224 offset:53760
    v_mfma_f32_32x32x16_bf16 v[32:47], v[92:95], v[84:87], v[32:47]
    ds_read_b64_tr_b16 v[80:81], v225 offset:53248
    ds_read_b64_tr_b16 v[82:83], v225 offset:53760
    s_waitcnt lgkmcnt(10)
    v_mfma_f32_32x32x16_bf16 v[16:31], v[52:55], v[48:51], v[16:31]
    ds_read_b128 v[84:87], v211 offset:49152
    ds_read_b64_tr_b16 v[88:89], v224 offset:55296
    ds_read_b64_tr_b16 v[90:91], v224 offset:55808
    v_mfma_f32_32x32x16_bf16 v[32:47], v[56:59], v[48:51], v[32:47]
    ds_read_b64_tr_b16 v[92:93], v225 offset:55296
    ds_read_b64_tr_b16 v[94:95], v225 offset:55808
    s_waitcnt lgkmcnt(10)
    s_barrier
    v_mfma_f32_32x32x16_bf16 v[16:31], v[64:67], v[60:63], v[16:31]
    ds_read_b128 v[48:51], v212 offset:0
    ds_read_b64_tr_b16 v[52:53], v226 offset:0
    ds_read_b64_tr_b16 v[54:55], v226 offset:512
    v_mfma_f32_32x32x16_bf16 v[32:47], v[68:71], v[60:63], v[32:47]
    ds_read_b64_tr_b16 v[56:57], v227 offset:0
    ds_read_b64_tr_b16 v[58:59], v227 offset:512
    s_waitcnt lgkmcnt(10)
    v_mfma_f32_32x32x16_bf16 v[16:31], v[76:79], v[72:75], v[16:31]
    ds_read_b128 v[60:63], v213 offset:0
    ds_read_b64_tr_b16 v[64:65], v226 offset:2048
    ds_read_b64_tr_b16 v[66:67], v226 offset:2560
    v_mfma_f32_32x32x16_bf16 v[32:47], v[80:83], v[72:75], v[32:47]
    ds_read_b64_tr_b16 v[68:69], v227 offset:2048
    ds_read_b64_tr_b16 v[70:71], v227 offset:2560
    s_waitcnt lgkmcnt(10)
    v_mfma_f32_32x32x16_bf16 v[16:31], v[88:91], v[84:87], v[16:31]
    ds_read_b128 v[72:75], v214 offset:0
    ds_read_b64_tr_b16 v[76:77], v226 offset:4096
    ds_read_b64_tr_b16 v[78:79], v226 offset:4608
    v_mfma_f32_32x32x16_bf16 v[32:47], v[92:95], v[84:87], v[32:47]
    ds_read_b64_tr_b16 v[80:81], v227 offset:4096
    ds_read_b64_tr_b16 v[82:83], v227 offset:4608
    s_waitcnt lgkmcnt(10)
    v_mfma_f32_32x32x16_bf16 v[16:31], v[52:55], v[48:51], v[16:31]
    ds_read_b128 v[84:87], v215 offset:0
    ds_read_b64_tr_b16 v[88:89], v226 offset:6144
    ds_read_b64_tr_b16 v[90:91], v226 offset:6656
    v_mfma_f32_32x32x16_bf16 v[32:47], v[56:59], v[48:51], v[32:47]
    ds_read_b64_tr_b16 v[92:93], v227 offset:6144
    ds_read_b64_tr_b16 v[94:95], v227 offset:6656
    s_waitcnt lgkmcnt(10)
    s_barrier
    v_mfma_f32_32x32x16_bf16 v[16:31], v[64:67], v[60:63], v[16:31]
    ds_read_b128 v[48:51], v212 offset:24576
    ds_read_b64_tr_b16 v[52:53], v226 offset:24576
    ds_read_b64_tr_b16 v[54:55], v226 offset:25088
    v_mfma_f32_32x32x16_bf16 v[32:47], v[68:71], v[60:63], v[32:47]
    ds_read_b64_tr_b16 v[56:57], v227 offset:24576
    ds_read_b64_tr_b16 v[58:59], v227 offset:25088
    s_waitcnt lgkmcnt(10)
    v_mfma_f32_32x32x16_bf16 v[16:31], v[76:79], v[72:75], v[16:31]
    ds_read_b128 v[60:63], v213 offset:24576
    ds_read_b64_tr_b16 v[64:65], v226 offset:26624
    ds_read_b64_tr_b16 v[66:67], v226 offset:27136
    v_mfma_f32_32x32x16_bf16 v[32:47], v[80:83], v[72:75], v[32:47]
    ds_read_b64_tr_b16 v[68:69], v227 offset:26624
    ds_read_b64_tr_b16 v[70:71], v227 offset:27136
    s_waitcnt lgkmcnt(10)
    v_mfma_f32_32x32x16_bf16 v[16:31], v[88:91], v[84:87], v[16:31]
    ds_read_b128 v[72:75], v214 offset:24576
    ds_read_b64_tr_b16 v[76:77], v226 offset:28672
    ds_read_b64_tr_b16 v[78:79], v226 offset:29184
    v_mfma_f32_32x32x16_bf16 v[32:47], v[92:95], v[84:87], v[32:47]
    ds_read_b64_tr_b16 v[80:81], v227 offset:28672
    ds_read_b64_tr_b16 v[82:83], v227 offset:29184
    s_waitcnt lgkmcnt(10)
    v_mfma_f32_32x32x16_bf16 v[16:31], v[52:55], v[48:51], v[16:31]
    ds_read_b128 v[84:87], v215 offset:24576
    ds_read_b64_tr_b16 v[88:89], v226 offset:30720
    ds_read_b64_tr_b16 v[90:91], v226 offset:31232
    v_mfma_f32_32x32x16_bf16 v[32:47], v[56:59], v[48:51], v[32:47]
    ds_read_b64_tr_b16 v[92:93], v227 offset:30720
    ds_read_b64_tr_b16 v[94:95], v227 offset:31232
    s_waitcnt lgkmcnt(10)
    s_barrier
    v_mfma_f32_32x32x16_bf16 v[16:31], v[64:67], v[60:63], v[16:31]
    ds_read_b128 v[48:51], v212 offset:49152
    ds_read_b64_tr_b16 v[52:53], v226 offset:49152
    ds_read_b64_tr_b16 v[54:55], v226 offset:49664
    v_mfma_f32_32x32x16_bf16 v[32:47], v[68:71], v[60:63], v[32:47]
    ds_read_b64_tr_b16 v[56:57], v227 offset:49152
    ds_read_b64_tr_b16 v[58:59], v227 offset:49664
    s_waitcnt lgkmcnt(10)
    v_mfma_f32_32x32x16_bf16 v[16:31], v[76:79], v[72:75], v[16:31]
    ds_read_b128 v[60:63], v213 offset:49152
    ds_read_b64_tr_b16 v[64:65], v226 offset:51200
    ds_read_b64_tr_b16 v[66:67], v226 offset:51712
    v_mfma_f32_32x32x16_bf16 v[32:47], v[80:83], v[72:75], v[32:47]
    ds_read_b64_tr_b16 v[68:69], v227 offset:51200
    ds_read_b64_tr_b16 v[70:71], v227 offset:51712
    s_waitcnt lgkmcnt(10)
    v_mfma_f32_32x32x16_bf16 v[16:31], v[88:91], v[84:87], v[16:31]
    ds_read_b128 v[72:75], v214 offset:49152
    ds_read_b64_tr_b16 v[76:77], v226 offset:53248
    ds_read_b64_tr_b16 v[78:79], v226 offset:53760
    v_mfma_f32_32x32x16_bf16 v[32:47], v[92:95], v[84:87], v[32:47]
    ds_read_b64_tr_b16 v[80:81], v227 offset:53248
    ds_read_b64_tr_b16 v[82:83], v227 offset:53760
    s_waitcnt lgkmcnt(10)
    v_mfma_f32_32x32x16_bf16 v[16:31], v[52:55], v[48:51], v[16:31]
    ds_read_b128 v[84:87], v215 offset:49152
    ds_read_b64_tr_b16 v[88:89], v226 offset:55296
    ds_read_b64_tr_b16 v[90:91], v226 offset:55808
    v_mfma_f32_32x32x16_bf16 v[32:47], v[56:59], v[48:51], v[32:47]
    ds_read_b64_tr_b16 v[92:93], v227 offset:55296
    ds_read_b64_tr_b16 v[94:95], v227 offset:55808
    s_waitcnt lgkmcnt(10)
    s_barrier
    v_mfma_f32_32x32x16_bf16 v[16:31], v[64:67], v[60:63], v[16:31]
    ds_read_b128 v[48:51], v208 offset:0
    ds_read_b64_tr_b16 v[52:53], v224 offset:0
    ds_read_b64_tr_b16 v[54:55], v224 offset:512
    v_mfma_f32_32x32x16_bf16 v[32:47], v[68:71], v[60:63], v[32:47]
    ds_read_b64_tr_b16 v[56:57], v225 offset:0
    ds_read_b64_tr_b16 v[58:59], v225 offset:512
    s_waitcnt lgkmcnt(10)
    v_mfma_f32_32x32x16_bf16 v[16:31], v[76:79], v[72:75], v[16:31]
    ds_read_b128 v[60:63], v209 offset:0
    ds_read_b64_tr_b16 v[64:65], v224 offset:2048
    ds_read_b64_tr_b16 v[66:67], v224 offset:2560
    v_mfma_f32_32x32x16_bf16 v[32:47], v[80:83], v[72:75], v[32:47]
    ds_read_b64_tr_b16 v[68:69], v225 offset:2048
    ds_read_b64_tr_b16 v[70:71], v225 offset:2560
    s_waitcnt lgkmcnt(10)
    v_mfma_f32_32x32x16_bf16 v[16:31], v[88:91], v[84:87], v[16:31]
    ds_read_b128 v[72:75], v210 offset:0
    ds_read_b64_tr_b16 v[76:77], v224 offset:4096
    ds_read_b64_tr_b16 v[78:79], v224 offset:4608
    v_mfma_f32_32x32x16_bf16 v[32:47], v[92:95], v[84:87], v[32:47]
    ds_read_b64_tr_b16 v[80:81], v225 offset:4096
    ds_read_b64_tr_b16 v[82:83], v225 offset:4608
    s_waitcnt lgkmcnt(10)
    v_mfma_f32_32x32x16_bf16 v[16:31], v[52:55], v[48:51], v[16:31]
    ds_read_b128 v[84:87], v211 offset:0
    ds_read_b64_tr_b16 v[88:89], v224 offset:6144
    ds_read_b64_tr_b16 v[90:91], v224 offset:6656
    v_mfma_f32_32x32x16_bf16 v[32:47], v[56:59], v[48:51], v[32:47]
    ds_read_b64_tr_b16 v[92:93], v225 offset:6144
    ds_read_b64_tr_b16 v[94:95], v225 offset:6656
    s_waitcnt lgkmcnt(10)
    s_barrier
    v_mfma_f32_32x32x16_bf16 v[16:31], v[64:67], v[60:63], v[16:31]
    ds_read_b128 v[48:51], v208 offset:24576
    ds_read_b64_tr_b16 v[52:53], v224 offset:24576
    ds_read_b64_tr_b16 v[54:55], v224 offset:25088
    v_mfma_f32_32x32x16_bf16 v[32:47], v[68:71], v[60:63], v[32:47]
    ds_read_b64_tr_b16 v[56:57], v225 offset:24576
    ds_read_b64_tr_b16 v[58:59], v225 offset:25088
    s_waitcnt lgkmcnt(10)
    v_mfma_f32_32x32x16_bf16 v[16:31], v[76:79], v[72:75], v[16:31]
    ds_read_b128 v[60:63], v209 offset:24576
    ds_read_b64_tr_b16 v[64:65], v224 offset:26624
    ds_read_b64_tr_b16 v[66:67], v224 offset:27136
    v_mfma_f32_32x32x16_bf16 v[32:47], v[80:83], v[72:75], v[32:47]
    ds_read_b64_tr_b16 v[68:69], v225 offset:26624
    ds_read_b64_tr_b16 v[70:71], v225 offset:27136
    s_waitcnt lgkmcnt(10)
    v_mfma_f32_32x32x16_bf16 v[16:31], v[88:91], v[84:87], v[16:31]
    ds_read_b128 v[72:75], v210 offset:24576
    ds_read_b64_tr_b16 v[76:77], v224 offset:28672
    ds_read_b64_tr_b16 v[78:79], v224 offset:29184
    v_mfma_f32_32x32x16_bf16 v[32:47], v[92:95], v[84:87], v[32:47]
    ds_read_b64_tr_b16 v[80:81], v225 offset:28672
    ds_read_b64_tr_b16 v[82:83], v225 offset:29184
    s_waitcnt lgkmcnt(10)
    v_mfma_f32_32x32x16_bf16 v[16:31], v[52:55], v[48:51], v[16:31]
    ds_read_b128 v[84:87], v211 offset:24576
    ds_read_b64_tr_b16 v[88:89], v224 offset:30720
    ds_read_b64_tr_b16 v[90:91], v224 offset:31232
    v_mfma_f32_32x32x16_bf16 v[32:47], v[56:59], v[48:51], v[32:47]
    ds_read_b64_tr_b16 v[92:93], v225 offset:30720
    ds_read_b64_tr_b16 v[94:95], v225 offset:31232
    s_waitcnt lgkmcnt(10)
    s_barrier
    v_mfma_f32_32x32x16_bf16 v[16:31], v[64:67], v[60:63], v[16:31]
    ds_read_b128 v[48:51], v208 offset:49152
    ds_read_b64_tr_b16 v[52:53], v224 offset:49152
    ds_read_b64_tr_b16 v[54:55], v224 offset:49664
    v_mfma_f32_32x32x16_bf16 v[32:47], v[68:71], v[60:63], v[32:47]
    ds_read_b64_tr_b16 v[56:57], v225 offset:49152
    ds_read_b64_tr_b16 v[58:59], v225 offset:49664
    s_waitcnt lgkmcnt(10)
    v_mfma_f32_32x32x16_bf16 v[16:31], v[76:79], v[72:75], v[16:31]
    ds_read_b128 v[60:63], v209 offset:49152
    ds_read_b64_tr_b16 v[64:65], v224 offset:51200
    ds_read_b64_tr_b16 v[66:67], v224 offset:51712
    v_mfma_f32_32x32x16_bf16 v[32:47], v[80:83], v[72:75], v[32:47]
    ds_read_b64_tr_b16 v[68:69], v225 offset:51200
    ds_read_b64_tr_b16 v[70:71], v225 offset:51712
    s_waitcnt lgkmcnt(10)
    v_mfma_f32_32x32x16_bf16 v[16:31], v[88:91], v[84:87], v[16:31]
    ds_read_b128 v[72:75], v210 offset:49152
    ds_read_b64_tr_b16 v[76:77], v224 offset:53248
    ds_read_b64_tr_b16 v[78:79], v224 offset:53760
    v_mfma_f32_32x32x16_bf16 v[32:47], v[92:95], v[84:87], v[32:47]
    ds_read_b64_tr_b16 v[80:81], v225 offset:53248
    ds_read_b64_tr_b16 v[82:83], v225 offset:53760
    s_waitcnt lgkmcnt(10)
    v_mfma_f32_32x32x16_bf16 v[16:31], v[52:55], v[48:51], v[16:31]
    ds_read_b128 v[84:87], v211 offset:49152
    ds_read_b64_tr_b16 v[88:89], v224 offset:55296
    ds_read_b64_tr_b16 v[90:91], v224 offset:55808
    v_mfma_f32_32x32x16_bf16 v[32:47], v[56:59], v[48:51], v[32:47]
    ds_read_b64_tr_b16 v[92:93], v225 offset:55296
    ds_read_b64_tr_b16 v[94:95], v225 offset:55808
    s_waitcnt lgkmcnt(10)
    s_barrier
    v_mfma_f32_32x32x16_bf16 v[16:31], v[64:67], v[60:63], v[16:31]
    ds_read_b128 v[48:51], v212 offset:0
    ds_read_b64_tr_b16 v[52:53], v226 offset:0
    ds_read_b64_tr_b16 v[54:55], v226 offset:512
    v_mfma_f32_32x32x16_bf16 v[32:47], v[68:71], v[60:63], v[32:47]
    ds_read_b64_tr_b16 v[56:57], v227 offset:0
    ds_read_b64_tr_b16 v[58:59], v227 offset:512
    s_waitcnt lgkmcnt(10)
    v_mfma_f32_32x32x16_bf16 v[16:31], v[76:79], v[72:75], v[16:31]
    ds_read_b128 v[60:63], v213 offset:0
    ds_read_b64_tr_b16 v[64:65], v226 offset:2048
    ds_read_b64_tr_b16 v[66:67], v226 offset:2560
    v_mfma_f32_32x32x16_bf16 v[32:47], v[80:83], v[72:75], v[32:47]
    ds_read_b64_tr_b16 v[68:69], v227 offset:2048
    ds_read_b64_tr_b16 v[70:71], v227 offset:2560
    s_waitcnt lgkmcnt(10)
    v_mfma_f32_32x32x16_bf16 v[16:31], v[88:91], v[84:87], v[16:31]
    ds_read_b128 v[72:75], v214 offset:0
    ds_read_b64_tr_b16 v[76:77], v226 offset:4096
    ds_read_b64_tr_b16 v[78:79], v226 offset:4608
    v_mfma_f32_32x32x16_bf16 v[32:47], v[92:95], v[84:87], v[32:47]
    ds_read_b64_tr_b16 v[80:81], v227 offset:4096
    ds_read_b64_tr_b16 v[82:83], v227 offset:4608
    s_waitcnt lgkmcnt(10)
    v_mfma_f32_32x32x16_bf16 v[16:31], v[52:55], v[48:51], v[16:31]
    ds_read_b128 v[84:87], v215 offset:0
    ds_read_b64_tr_b16 v[88:89], v226 offset:6144
    ds_read_b64_tr_b16 v[90:91], v226 offset:6656
    v_mfma_f32_32x32x16_bf16 v[32:47], v[56:59], v[48:51], v[32:47]
    ds_read_b64_tr_b16 v[92:93], v227 offset:6144
    ds_read_b64_tr_b16 v[94:95], v227 offset:6656
    s_waitcnt lgkmcnt(10)
    v_mfma_f32_32x32x16_bf16 v[16:31], v[64:67], v[60:63], v[16:31]
    v_mfma_f32_32x32x16_bf16 v[32:47], v[68:71], v[60:63], v[32:47]
    s_waitcnt lgkmcnt(5)
    v_mfma_f32_32x32x16_bf16 v[16:31], v[76:79], v[72:75], v[16:31]
    v_mfma_f32_32x32x16_bf16 v[32:47], v[80:83], v[72:75], v[32:47]
    s_waitcnt lgkmcnt(0)
    v_mfma_f32_32x32x16_bf16 v[16:31], v[88:91], v[84:87], v[16:31]
    v_mfma_f32_32x32x16_bf16 v[32:47], v[92:95], v[84:87], v[32:47]
    s_nop 10
    v_cvt_pk_bf16_f32 v88, v16, v17
    v_cvt_pk_bf16_f32 v89, v18, v19
    ds_write_b64 v184, v[88:89]
    v_cvt_pk_bf16_f32 v90, v20, v21
    v_cvt_pk_bf16_f32 v91, v22, v23
    ds_write_b64 v185, v[90:91]
    v_cvt_pk_bf16_f32 v92, v24, v25
    v_cvt_pk_bf16_f32 v93, v26, v27
    ds_write_b64 v186, v[92:93]
    v_cvt_pk_bf16_f32 v94, v28, v29
    v_cvt_pk_bf16_f32 v95, v30, v31
    ds_write_b64 v187, v[94:95]
    v_cvt_pk_bf16_f32 v88, v32, v33
    v_cvt_pk_bf16_f32 v89, v34, v35
    ds_write_b64 v188, v[88:89]
    v_cvt_pk_bf16_f32 v90, v36, v37
    v_cvt_pk_bf16_f32 v91, v38, v39
    ds_write_b64 v189, v[90:91]
    v_cvt_pk_bf16_f32 v92, v40, v41
    v_cvt_pk_bf16_f32 v93, v42, v43
    ds_write_b64 v190, v[92:93]
    v_cvt_pk_bf16_f32 v94, v44, v45
    v_cvt_pk_bf16_f32 v95, v46, v47
    ds_write_b64 v191, v[94:95]
    s_waitcnt lgkmcnt(0)
    s_branch m1_h_p3
m1_u_c:
    s_and_b32 s4, s2, 7
    s_lshr_b32 s5, s2, 3
    s_lshl_b32 s6, s4, 1
    s_and_b32 s7, s5, 1
    s_add_u32 s44, s6, s7
    s_lshr_b32 s45, s5, 1
    s_sub_u32 s45, s45, 10
    s_add_u32 s88, s44, 48
    s_lshl_b32 s88, s88, 7
    s_lshl_b32 s89, s45, 3
    s_add_u32 s95, s88, s89
    s_mov_b32 s48, s10
    s_mov_b32 s49, s11
    s_mov_b32 s50, 1280
    s_mov_b32 s51, 0x20000
    s_mov_b32 s52, s12
    s_mov_b32 s53, s13
    s_mov_b32 s54, 1280
    s_mov_b32 s55, 0x20000
    s_mov_b32 s56, s22
    s_mov_b32 s57, s23
    s_mov_b32 s58, 1280
    s_mov_b32 s59, 0x20000
    s_add_u32 s60, s40, 16240640
    s_addc_u32 s61, s41, 0
    s_mov_b32 s62, 5242880
    s_mov_b32 s63, 0x20000
    s_add_u32 s64, s40, 13115392
    s_addc_u32 s65, s41, 0
    s_mov_b32 s66, 327680
    s_mov_b32 s67, 0x20000
    s_lshr_b32 s4, s3, 1
    s_and_b32 s5, s3, 1
    s_lshl_b32 s6, s45, 1
    s_add_u32 s6, s6, s5
    v_and_b32 v14, 31, v1
    s_lshl_b32 s7, s6, 6
    v_add_u32 v252, s7, v14
    v_lshlrev_b32 v15, 1, v252
    buffer_load_ushort v20, v15, s[48:51], 0 offen offset:0
    buffer_load_ushort v21, v15, s[52:55], 0 offen offset:0
    buffer_load_ushort v22, v15, s[56:59], 0 offen offset:0
    buffer_load_ushort v23, v15, s[48:51], 0 offen offset:64
    buffer_load_ushort v24, v15, s[52:55], 0 offen offset:64
    buffer_load_ushort v25, v15, s[56:59], 0 offen offset:64
    s_lshl_b32 s42, s4, 13
    v_and_b32 v10, 31, v1
    v_lshlrev_b32 v10, 7, v10
    v_lshrrev_b32 v11, 5, v1
    v_bfe_u32 v12, v1, 1, 3
    v_xor_b32 v11, v11, v12
    v_add_u32 v10, s42, v10
    v_xor_b32 v12, 0, v11
    v_lshl_add_u32 v216, v12, 4, v10
    v_xor_b32 v12, 2, v11
    v_lshl_add_u32 v217, v12, 4, v10
    v_xor_b32 v12, 4, v11
    v_lshl_add_u32 v218, v12, 4, v10
    v_xor_b32 v12, 6, v11
    v_lshl_add_u32 v219, v12, 4, v10
    s_lshl_b32 s42, s5, 13
    v_and_b32 v10, 31, v1
    v_lshlrev_b32 v10, 7, v10
    v_lshrrev_b32 v11, 5, v1
    v_bfe_u32 v12, v1, 1, 3
    v_xor_b32 v11, v11, v12
    v_add_u32 v10, s42, v10
    v_add_u32 v10, 16384, v10
    v_xor_b32 v12, 0, v11
    v_lshl_add_u32 v228, v12, 4, v10
    v_xor_b32 v12, 2, v11
    v_lshl_add_u32 v229, v12, 4, v10
    v_xor_b32 v12, 4, v11
    v_lshl_add_u32 v230, v12, 4, v10
    v_xor_b32 v12, 6, v11
    v_lshl_add_u32 v231, v12, 4, v10
    s_waitcnt vmcnt(0)
    v_lshlrev_b32 v20, 16, v20
    v_lshlrev_b32 v21, 16, v21
    v_lshlrev_b32 v22, 16, v22
    v_mul_f32 v22, 0x3fb8aa3b, v22
    v_exp_f32 v22, v22
    s_nop 0
    v_cvt_pk_bf16_f32 v22, v22, v22
    v_lshlrev_b32 v22, 16, v22
    v_mul_f32 v40, v22, v20
    v_mul_f32 v41, v22, v21
    v_mul_f32 v40, 0x3fb8aa3b, v40
    v_mul_f32 v41, 0x3e22f983, v41
    v_exp_f32 v42, v40
    v_fract_f32 v43, v41
    v_cos_f32 v44, v43
    v_sin_f32 v45, v43
    v_mul_f32 v30, v42, v44
    v_mul_f32 v31, v42, v45
    v_add_f32 v42, -1.0, v30
    v_mul_f32 v43, v20, v20
    v_fmac_f32 v43, v21, v21
    v_rcp_f32 v43, v43
    v_mul_f32 v44, v42, v20
    v_fmac_f32 v44, v31, v21
    v_mul_f32 v45, v31, v20
    v_fma_f32 v45, -v42, v21, v45
    v_add_f32 v43, v43, v43
    v_mul_f32 v32, v44, v43
    v_mul_f32 v33, v45, v43
    v_mov_b32 v240, v30
    v_mov_b32 v241, v31
    v_mov_b32 v242, v32
    v_mov_b32 v243, v33
    v_mul_f32 v50, 0x42000000, v40
    v_mul_f32 v51, 0x42000000, v41
    v_exp_f32 v50, v50
    v_fract_f32 v51, v51
    v_cos_f32 v52, v51
    v_sin_f32 v53, v51
    v_mul_f32 v2, v50, v52
    v_mul_f32 v3, v50, v53
    v_mul_f32 v50, 0x42800000, v40
    v_mul_f32 v51, 0x42800000, v41
    v_exp_f32 v50, v50
    v_fract_f32 v51, v51
    v_cos_f32 v52, v51
    v_sin_f32 v53, v51
    v_mul_f32 v6, v50, v52
    v_mul_f32 v7, v50, v53
    v_mul_f32 v50, 0x44800000, v40
    v_mul_f32 v51, 0x44800000, v41
    v_exp_f32 v50, v50
    v_fract_f32 v51, v51
    v_cos_f32 v52, v51
    v_sin_f32 v53, v51
    v_mul_f32 v10, v50, v52
    v_mul_f32 v11, v50, v53
    v_lshlrev_b32 v23, 16, v23
    v_lshlrev_b32 v24, 16, v24
    v_lshlrev_b32 v25, 16, v25
    v_mul_f32 v25, 0x3fb8aa3b, v25
    v_exp_f32 v25, v25
    s_nop 0
    v_cvt_pk_bf16_f32 v25, v25, v25
    v_lshlrev_b32 v25, 16, v25
    v_mul_f32 v40, v25, v23
    v_mul_f32 v41, v25, v24
    v_mul_f32 v40, 0x3fb8aa3b, v40
    v_mul_f32 v41, 0x3e22f983, v41
    v_exp_f32 v42, v40
    v_fract_f32 v43, v41
    v_cos_f32 v44, v43
    v_sin_f32 v45, v43
    v_mul_f32 v30, v42, v44
    v_mul_f32 v31, v42, v45
    v_add_f32 v42, -1.0, v30
    v_mul_f32 v43, v23, v23
    v_fmac_f32 v43, v24, v24
    v_rcp_f32 v43, v43
    v_mul_f32 v44, v42, v23
    v_fmac_f32 v44, v31, v24
    v_mul_f32 v45, v31, v23
    v_fma_f32 v45, -v42, v24, v45
    v_add_f32 v43, v43, v43
    v_mul_f32 v32, v44, v43
    v_mul_f32 v33, v45, v43
    v_mov_b32 v246, v30
    v_mov_b32 v247, v31
    v_mov_b32 v248, v32
    v_mov_b32 v249, v33
    v_mul_f32 v50, 0x42000000, v40
    v_mul_f32 v51, 0x42000000, v41
    v_exp_f32 v50, v50
    v_fract_f32 v51, v51
    v_cos_f32 v52, v51
    v_sin_f32 v53, v51
    v_mul_f32 v4, v50, v52
    v_mul_f32 v5, v50, v53
    v_mul_f32 v50, 0x42800000, v40
    v_mul_f32 v51, 0x42800000, v41
    v_exp_f32 v50, v50
    v_fract_f32 v51, v51
    v_cos_f32 v52, v51
    v_sin_f32 v53, v51
    v_mul_f32 v8, v50, v52
    v_mul_f32 v9, v50, v53
    v_mul_f32 v50, 0x44800000, v40
    v_mul_f32 v51, 0x44800000, v41
    v_exp_f32 v50, v50
    v_fract_f32 v51, v51
    v_cos_f32 v52, v51
    v_sin_f32 v53, v51
    v_mul_f32 v12, v50, v52
    v_mul_f32 v13, v50, v53
    s_cmp_lg_u32 s3, 0
    s_cbranch_scc1 dw6
    s_add_u32 s84, s40, 34656256
    s_addc_u32 s85, s41, 0
    s_mov_b32 s86, 22528
    s_mov_b32 s87, 0x20000
    s_add_u32 s90, s44, 0
    s_lshl_b32 s90, s90, 7
    v_lshlrev_b32 v20, 3, v1
    v_add_u32 v20, s90, v20
    v_cmp_gt_u32 vcc, 16, v1
    s_nop 1
    s_and_saveexec_b64 s[88:89], vcc
    s_cbranch_execz pd8
    v_mov_b32 v24, s96
    v_mov_b32 v25, s97
    s_mov_b32 s90, 0
pl7:
    buffer_load_dwordx2 v[22:23], v20, s[84:87], 0 offen sc1
    s_waitcnt vmcnt(0)
    v_sub_co_u32 v22, vcc, v22, v24
    s_nop 1
    v_subb_co_u32 v23, vcc, v23, v25, vcc
    v_cmp_eq_u32 s[92:93], 0, v23
    s_mov_b32 s91, 16777216
    v_cmp_gt_u32 vcc, s91, v22
    s_nop 1
    s_and_b64 vcc, vcc, s[92:93]
    s_cmp_eq_u64 vcc, exec
    s_cbranch_scc1 pd8
    s_add_u32 s90, s90, 1
    s_cmp_lt_u32 s90, 262144
    s_cbranch_scc1 pl7
pd8:
    s_waitcnt vmcnt(0)
    s_mov_b64 exec, s[88:89]
dw6:
    s_barrier
    v_add_u32 v220, 49152, v216
    v_add_u32 v221, 49152, v217
    v_add_u32 v222, 49152, v218
    v_add_u32 v223, 49152, v219
    v_add_u32 v232, 49152, v228
    v_add_u32 v233, 49152, v229
    v_add_u32 v234, 49152, v230
    v_add_u32 v235, 49152, v231
    v_add_u32 v224, 98304, v216
    v_add_u32 v225, 98304, v217
    v_add_u32 v226, 98304, v218
    v_add_u32 v227, 98304, v219
    v_add_u32 v236, 98304, v228
    v_add_u32 v237, 98304, v229
    v_add_u32 v238, 98304, v230
    v_add_u32 v239, 98304, v231
    s_barrier
    ds_read_b128 v[144:147], v216 offset:0
    ds_read_b128 v[148:151], v216 offset:4096
    ds_read_b128 v[152:155], v228 offset:0
    ds_read_b128 v[156:159], v228 offset:4096
    ds_read_b128 v[160:163], v228 offset:16384
    ds_read_b128 v[164:167], v228 offset:20480
    ds_read_b128 v[168:171], v217 offset:0
    ds_read_b128 v[172:175], v217 offset:4096
    ds_read_b128 v[176:179], v229 offset:0
    ds_read_b128 v[180:183], v229 offset:4096
    ds_read_b128 v[184:187], v229 offset:16384
    ds_read_b128 v[188:191], v229 offset:20480
    s_waitcnt lgkmcnt(6)
    v_mfma_f32_32x32x16_bf16 v[16:31], v[144:147], v[152:155], 0
    ds_read_b128 v[192:195], v218 offset:0
    ds_read_b128 v[196:199], v218 offset:4096
    v_mfma_f32_32x32x16_bf16 v[32:47], v[148:151], v[152:155], 0
    ds_read_b128 v[200:203], v230 offset:0
    ds_read_b128 v[204:207], v230 offset:4096
    v_mfma_f32_32x32x16_bf16 v[48:63], v[144:147], v[156:159], 0
    ds_read_b128 v[208:211], v230 offset:16384
    ds_read_b128 v[212:215], v230 offset:20480
    v_mfma_f32_32x32x16_bf16 v[64:79], v[148:151], v[156:159], 0
    v_mfma_f32_32x32x16_bf16 v[80:95], v[144:147], v[160:163], 0
    v_mfma_f32_32x32x16_bf16 v[96:111], v[148:151], v[160:163], 0
    v_mfma_f32_32x32x16_bf16 v[112:127], v[144:147], v[164:167], 0
    v_mfma_f32_32x32x16_bf16 v[128:143], v[148:151], v[164:167], 0
    s_waitcnt lgkmcnt(6)
    v_mfma_f32_32x32x16_bf16 v[16:31], v[168:171], v[176:179], v[16:31]
    ds_read_b128 v[144:147], v219 offset:0
    ds_read_b128 v[148:151], v219 offset:4096
    v_mfma_f32_32x32x16_bf16 v[32:47], v[172:175], v[176:179], v[32:47]
    ds_read_b128 v[152:155], v231 offset:0
    ds_read_b128 v[156:159], v231 offset:4096
    v_mfma_f32_32x32x16_bf16 v[48:63], v[168:171], v[180:183], v[48:63]
    ds_read_b128 v[160:163], v231 offset:16384
    ds_read_b128 v[164:167], v231 offset:20480
    v_mfma_f32_32x32x16_bf16 v[64:79], v[172:175], v[180:183], v[64:79]
    v_mfma_f32_32x32x16_bf16 v[80:95], v[168:171], v[184:187], v[80:95]
    v_mfma_f32_32x32x16_bf16 v[96:111], v[172:175], v[184:187], v[96:111]
    v_mfma_f32_32x32x16_bf16 v[112:127], v[168:171], v[188:191], v[112:127]
    v_mfma_f32_32x32x16_bf16 v[128:143], v[172:175], v[188:191], v[128:143]
    s_waitcnt lgkmcnt(0)
    s_barrier
    v_mfma_f32_32x32x16_bf16 v[16:31], v[192:195], v[200:203], v[16:31]
    ds_read_b128 v[168:171], v220 offset:0
    ds_read_b128 v[172:175], v220 offset:4096
    v_mfma_f32_32x32x16_bf16 v[32:47], v[196:199], v[200:203], v[32:47]
    ds_read_b128 v[176:179], v232 offset:0
    ds_read_b128 v[180:183], v232 offset:4096
    v_mfma_f32_32x32x16_bf16 v[48:63], v[192:195], v[204:207], v[48:63]
    ds_read_b128 v[184:187], v232 offset:16384
    ds_read_b128 v[188:191], v232 offset:20480
    v_mfma_f32_32x32x16_bf16 v[64:79], v[196:199], v[204:207], v[64:79]
    v_mfma_f32_32x32x16_bf16 v[80:95], v[192:195], v[208:211], v[80:95]
    v_mfma_f32_32x32x16_bf16 v[96:111], v[196:199], v[208:211], v[96:111]
    v_mfma_f32_32x32x16_bf16 v[112:127], v[192:195], v[212:215], v[112:127]
    v_mfma_f32_32x32x16_bf16 v[128:143], v[196:199], v[212:215], v[128:143]
    s_waitcnt lgkmcnt(6)
    v_mfma_f32_32x32x16_bf16 v[16:31], v[144:147], v[152:155], v[16:31]
    ds_read_b128 v[192:195], v221 offset:0
    ds_read_b128 v[196:199], v221 offset:4096
    v_mfma_f32_32x32x16_bf16 v[32:47], v[148:151], v[152:155], v[32:47]
    ds_read_b128 v[200:203], v233 offset:0
    ds_read_b128 v[204:207], v233 offset:4096
    v_mfma_f32_32x32x16_bf16 v[48:63], v[144:147], v[156:159], v[48:63]
    ds_read_b128 v[208:211], v233 offset:16384
    ds_read_b128 v[212:215], v233 offset:20480
    v_mfma_f32_32x32x16_bf16 v[64:79], v[148:151], v[156:159], v[64:79]
    v_mfma_f32_32x32x16_bf16 v[80:95], v[144:147], v[160:163], v[80:95]
    v_mfma_f32_32x32x16_bf16 v[96:111], v[148:151], v[160:163], v[96:111]
    v_mfma_f32_32x32x16_bf16 v[112:127], v[144:147], v[164:167], v[112:127]
    v_mfma_f32_32x32x16_bf16 v[128:143], v[148:151], v[164:167], v[128:143]
    s_waitcnt lgkmcnt(6)
    v_mfma_f32_32x32x16_bf16 v[16:31], v[168:171], v[176:179], v[16:31]
    ds_read_b128 v[144:147], v222 offset:0
    ds_read_b128 v[148:151], v222 offset:4096
    v_mfma_f32_32x32x16_bf16 v[32:47], v[172:175], v[176:179], v[32:47]
    ds_read_b128 v[152:155], v234 offset:0
    ds_read_b128 v[156:159], v234 offset:4096
    v_mfma_f32_32x32x16_bf16 v[48:63], v[168:171], v[180:183], v[48:63]
    ds_read_b128 v[160:163], v234 offset:16384
    ds_read_b128 v[164:167], v234 offset:20480
    v_mfma_f32_32x32x16_bf16 v[64:79], v[172:175], v[180:183], v[64:79]
    v_mfma_f32_32x32x16_bf16 v[80:95], v[168:171], v[184:187], v[80:95]
    v_mfma_f32_32x32x16_bf16 v[96:111], v[172:175], v[184:187], v[96:111]
    v_mfma_f32_32x32x16_bf16 v[112:127], v[168:171], v[188:191], v[112:127]
    v_mfma_f32_32x32x16_bf16 v[128:143], v[172:175], v[188:191], v[128:143]
    s_waitcnt lgkmcnt(6)
    v_mfma_f32_32x32x16_bf16 v[16:31], v[192:195], v[200:203], v[16:31]
    ds_read_b128 v[168:171], v223 offset:0
    ds_read_b128 v[172:175], v223 offset:4096
    v_mfma_f32_32x32x16_bf16 v[32:47], v[196:199], v[200:203], v[32:47]
    ds_read_b128 v[176:179], v235 offset:0
    ds_read_b128 v[180:183], v235 offset:4096
    v_mfma_f32_32x32x16_bf16 v[48:63], v[192:195], v[204:207], v[48:63]
    ds_read_b128 v[184:187], v235 offset:16384
    ds_read_b128 v[188:191], v235 offset:20480
    v_mfma_f32_32x32x16_bf16 v[64:79], v[196:199], v[204:207], v[64:79]
    v_mfma_f32_32x32x16_bf16 v[80:95], v[192:195], v[208:211], v[80:95]
    v_mfma_f32_32x32x16_bf16 v[96:111], v[196:199], v[208:211], v[96:111]
    v_mfma_f32_32x32x16_bf16 v[112:127], v[192:195], v[212:215], v[112:127]
    v_mfma_f32_32x32x16_bf16 v[128:143], v[196:199], v[212:215], v[128:143]
    s_waitcnt lgkmcnt(0)
    s_barrier
    v_mfma_f32_32x32x16_bf16 v[16:31], v[144:147], v[152:155], v[16:31]
    ds_read_b128 v[192:195], v224 offset:0
    ds_read_b128 v[196:199], v224 offset:4096
    v_mfma_f32_32x32x16_bf16 v[32:47], v[148:151], v[152:155], v[32:47]
    ds_read_b128 v[200:203], v236 offset:0
    ds_read_b128 v[204:207], v236 offset:4096
    v_mfma_f32_32x32x16_bf16 v[48:63], v[144:147], v[156:159], v[48:63]
    ds_read_b128 v[208:211], v236 offset:16384
    ds_read_b128 v[212:215], v236 offset:20480
    v_mfma_f32_32x32x16_bf16 v[64:79], v[148:151], v[156:159], v[64:79]
    v_mfma_f32_32x32x16_bf16 v[80:95], v[144:147], v[160:163], v[80:95]
    v_mfma_f32_32x32x16_bf16 v[96:111], v[148:151], v[160:163], v[96:111]
    v_mfma_f32_32x32x16_bf16 v[112:127], v[144:147], v[164:167], v[112:127]
    v_mfma_f32_32x32x16_bf16 v[128:143], v[148:151], v[164:167], v[128:143]
    s_waitcnt lgkmcnt(6)
    v_mfma_f32_32x32x16_bf16 v[16:31], v[168:171], v[176:179], v[16:31]
    ds_read_b128 v[144:147], v225 offset:0
    ds_read_b128 v[148:151], v225 offset:4096
    v_mfma_f32_32x32x16_bf16 v[32:47], v[172:175], v[176:179], v[32:47]
    ds_read_b128 v[152:155], v237 offset:0
    ds_read_b128 v[156:159], v237 offset:4096
    v_mfma_f32_32x32x16_bf16 v[48:63], v[168:171], v[180:183], v[48:63]
    ds_read_b128 v[160:163], v237 offset:16384
    ds_read_b128 v[164:167], v237 offset:20480
    v_mfma_f32_32x32x16_bf16 v[64:79], v[172:175], v[180:183], v[64:79]
    v_mfma_f32_32x32x16_bf16 v[80:95], v[168:171], v[184:187], v[80:95]
    v_mfma_f32_32x32x16_bf16 v[96:111], v[172:175], v[184:187], v[96:111]
    v_mfma_f32_32x32x16_bf16 v[112:127], v[168:171], v[188:191], v[112:127]
    v_mfma_f32_32x32x16_bf16 v[128:143], v[172:175], v[188:191], v[128:143]
    s_waitcnt lgkmcnt(6)
    v_mfma_f32_32x32x16_bf16 v[16:31], v[192:195], v[200:203], v[16:31]
    ds_read_b128 v[168:171], v226 offset:0
    ds_read_b128 v[172:175], v226 offset:4096
    v_mfma_f32_32x32x16_bf16 v[32:47], v[196:199], v[200:203], v[32:47]
    ds_read_b128 v[176:179], v238 offset:0
    ds_read_b128 v[180:183], v238 offset:4096
    v_mfma_f32_32x32x16_bf16 v[48:63], v[192:195], v[204:207], v[48:63]
    ds_read_b128 v[184:187], v238 offset:16384
    ds_read_b128 v[188:191], v238 offset:20480
    v_mfma_f32_32x32x16_bf16 v[64:79], v[196:199], v[204:207], v[64:79]
    v_mfma_f32_32x32x16_bf16 v[80:95], v[192:195], v[208:211], v[80:95]
    v_mfma_f32_32x32x16_bf16 v[96:111], v[196:199], v[208:211], v[96:111]
    v_mfma_f32_32x32x16_bf16 v[112:127], v[192:195], v[212:215], v[112:127]
    v_mfma_f32_32x32x16_bf16 v[128:143], v[196:199], v[212:215], v[128:143]
    s_waitcnt lgkmcnt(6)
    v_mfma_f32_32x32x16_bf16 v[16:31], v[144:147], v[152:155], v[16:31]
    ds_read_b128 v[192:195], v227 offset:0
    ds_read_b128 v[196:199], v227 offset:4096
    v_mfma_f32_32x32x16_bf16 v[32:47], v[148:151], v[152:155], v[32:47]
    ds_read_b128 v[200:203], v239 offset:0
    ds_read_b128 v[204:207], v239 offset:4096
    v_mfma_f32_32x32x16_bf16 v[48:63], v[144:147], v[156:159], v[48:63]
    ds_read_b128 v[208:211], v239 offset:16384
    ds_read_b128 v[212:215], v239 offset:20480
    v_mfma_f32_32x32x16_bf16 v[64:79], v[148:151], v[156:159], v[64:79]
    v_mfma_f32_32x32x16_bf16 v[80:95], v[144:147], v[160:163], v[80:95]
    v_mfma_f32_32x32x16_bf16 v[96:111], v[148:151], v[160:163], v[96:111]
    v_mfma_f32_32x32x16_bf16 v[112:127], v[144:147], v[164:167], v[112:127]
    v_mfma_f32_32x32x16_bf16 v[128:143], v[148:151], v[164:167], v[128:143]
    s_waitcnt lgkmcnt(0)
    s_barrier
    v_mfma_f32_32x32x16_bf16 v[16:31], v[168:171], v[176:179], v[16:31]
    ds_read_b128 v[144:147], v216 offset:0
    ds_read_b128 v[148:151], v216 offset:4096
    v_mfma_f32_32x32x16_bf16 v[32:47], v[172:175], v[176:179], v[32:47]
    ds_read_b128 v[152:155], v228 offset:0
    ds_read_b128 v[156:159], v228 offset:4096
    v_mfma_f32_32x32x16_bf16 v[48:63], v[168:171], v[180:183], v[48:63]
    ds_read_b128 v[160:163], v228 offset:16384
    ds_read_b128 v[164:167], v228 offset:20480
    v_mfma_f32_32x32x16_bf16 v[64:79], v[172:175], v[180:183], v[64:79]
    v_mfma_f32_32x32x16_bf16 v[80:95], v[168:171], v[184:187], v[80:95]
    v_mfma_f32_32x32x16_bf16 v[96:111], v[172:175], v[184:187], v[96:111]
    v_mfma_f32_32x32x16_bf16 v[112:127], v[168:171], v[188:191], v[112:127]
    v_mfma_f32_32x32x16_bf16 v[128:143], v[172:175], v[188:191], v[128:143]
    s_waitcnt lgkmcnt(6)
    v_mfma_f32_32x32x16_bf16 v[16:31], v[192:195], v[200:203], v[16:31]
    ds_read_b128 v[168:171], v217 offset:0
    ds_read_b128 v[172:175], v217 offset:4096
    v_mfma_f32_32x32x16_bf16 v[32:47], v[196:199], v[200:203], v[32:47]
    ds_read_b128 v[176:179], v229 offset:0
    ds_read_b128 v[180:183], v229 offset:4096
    v_mfma_f32_32x32x16_bf16 v[48:63], v[192:195], v[204:207], v[48:63]
    ds_read_b128 v[184:187], v229 offset:16384
    ds_read_b128 v[188:191], v229 offset:20480
    v_mfma_f32_32x32x16_bf16 v[64:79], v[196:199], v[204:207], v[64:79]
    v_mfma_f32_32x32x16_bf16 v[80:95], v[192:195], v[208:211], v[80:95]
    v_mfma_f32_32x32x16_bf16 v[96:111], v[196:199], v[208:211], v[96:111]
    v_mfma_f32_32x32x16_bf16 v[112:127], v[192:195], v[212:215], v[112:127]
    v_mfma_f32_32x32x16_bf16 v[128:143], v[196:199], v[212:215], v[128:143]
    s_waitcnt lgkmcnt(6)
    v_mfma_f32_32x32x16_bf16 v[16:31], v[144:147], v[152:155], v[16:31]
    ds_read_b128 v[192:195], v218 offset:0
    ds_read_b128 v[196:199], v218 offset:4096
    v_mfma_f32_32x32x16_bf16 v[32:47], v[148:151], v[152:155], v[32:47]
    ds_read_b128 v[200:203], v230 offset:0
    ds_read_b128 v[204:207], v230 offset:4096
    v_mfma_f32_32x32x16_bf16 v[48:63], v[144:147], v[156:159], v[48:63]
    ds_read_b128 v[208:211], v230 offset:16384
    ds_read_b128 v[212:215], v230 offset:20480
    v_mfma_f32_32x32x16_bf16 v[64:79], v[148:151], v[156:159], v[64:79]
    v_mfma_f32_32x32x16_bf16 v[80:95], v[144:147], v[160:163], v[80:95]
    v_mfma_f32_32x32x16_bf16 v[96:111], v[148:151], v[160:163], v[96:111]
    v_mfma_f32_32x32x16_bf16 v[112:127], v[144:147], v[164:167], v[112:127]
    v_mfma_f32_32x32x16_bf16 v[128:143], v[148:151], v[164:167], v[128:143]
    s_waitcnt lgkmcnt(6)
    v_mfma_f32_32x32x16_bf16 v[16:31], v[168:171], v[176:179], v[16:31]
    ds_read_b128 v[144:147], v219 offset:0
    ds_read_b128 v[148:151], v219 offset:4096
    v_mfma_f32_32x32x16_bf16 v[32:47], v[172:175], v[176:179], v[32:47]
    ds_read_b128 v[152:155], v231 offset:0
    ds_read_b128 v[156:159], v231 offset:4096
    v_mfma_f32_32x32x16_bf16 v[48:63], v[168:171], v[180:183], v[48:63]
    ds_read_b128 v[160:163], v231 offset:16384
    ds_read_b128 v[164:167], v231 offset:20480
    v_mfma_f32_32x32x16_bf16 v[64:79], v[172:175], v[180:183], v[64:79]
    v_mfma_f32_32x32x16_bf16 v[80:95], v[168:171], v[184:187], v[80:95]
    v_mfma_f32_32x32x16_bf16 v[96:111], v[172:175], v[184:187], v[96:111]
    v_mfma_f32_32x32x16_bf16 v[112:127], v[168:171], v[188:191], v[112:127]
    v_mfma_f32_32x32x16_bf16 v[128:143], v[172:175], v[188:191], v[128:143]
    s_waitcnt lgkmcnt(0)
    s_barrier
    v_mfma_f32_32x32x16_bf16 v[16:31], v[192:195], v[200:203], v[16:31]
    ds_read_b128 v[168:171], v220 offset:0
    ds_read_b128 v[172:175], v220 offset:4096
    v_mfma_f32_32x32x16_bf16 v[32:47], v[196:199], v[200:203], v[32:47]
    ds_read_b128 v[176:179], v232 offset:0
    ds_read_b128 v[180:183], v232 offset:4096
    v_mfma_f32_32x32x16_bf16 v[48:63], v[192:195], v[204:207], v[48:63]
    ds_read_b128 v[184:187], v232 offset:16384
    ds_read_b128 v[188:191], v232 offset:20480
    v_mfma_f32_32x32x16_bf16 v[64:79], v[196:199], v[204:207], v[64:79]
    v_mfma_f32_32x32x16_bf16 v[80:95], v[192:195], v[208:211], v[80:95]
    v_mfma_f32_32x32x16_bf16 v[96:111], v[196:199], v[208:211], v[96:111]
    v_mfma_f32_32x32x16_bf16 v[112:127], v[192:195], v[212:215], v[112:127]
    v_mfma_f32_32x32x16_bf16 v[128:143], v[196:199], v[212:215], v[128:143]
    s_waitcnt lgkmcnt(6)
    v_mfma_f32_32x32x16_bf16 v[16:31], v[144:147], v[152:155], v[16:31]
    ds_read_b128 v[192:195], v221 offset:0
    ds_read_b128 v[196:199], v221 offset:4096
    v_mfma_f32_32x32x16_bf16 v[32:47], v[148:151], v[152:155], v[32:47]
    ds_read_b128 v[200:203], v233 offset:0
    ds_read_b128 v[204:207], v233 offset:4096
    v_mfma_f32_32x32x16_bf16 v[48:63], v[144:147], v[156:159], v[48:63]
    ds_read_b128 v[208:211], v233 offset:16384
    ds_read_b128 v[212:215], v233 offset:20480
    v_mfma_f32_32x32x16_bf16 v[64:79], v[148:151], v[156:159], v[64:79]
    v_mfma_f32_32x32x16_bf16 v[80:95], v[144:147], v[160:163], v[80:95]
    v_mfma_f32_32x32x16_bf16 v[96:111], v[148:151], v[160:163], v[96:111]
    v_mfma_f32_32x32x16_bf16 v[112:127], v[144:147], v[164:167], v[112:127]
    v_mfma_f32_32x32x16_bf16 v[128:143], v[148:151], v[164:167], v[128:143]
    s_waitcnt lgkmcnt(6)
    v_mfma_f32_32x32x16_bf16 v[16:31], v[168:171], v[176:179], v[16:31]
    ds_read_b128 v[144:147], v222 offset:0
    ds_read_b128 v[148:151], v222 offset:4096
    v_mfma_f32_32x32x16_bf16 v[32:47], v[172:175], v[176:179], v[32:47]
    ds_read_b128 v[152:155], v234 offset:0
    ds_read_b128 v[156:159], v234 offset:4096
    v_mfma_f32_32x32x16_bf16 v[48:63], v[168:171], v[180:183], v[48:63]
    ds_read_b128 v[160:163], v234 offset:16384
    ds_read_b128 v[164:167], v234 offset:20480
    v_mfma_f32_32x32x16_bf16 v[64:79], v[172:175], v[180:183], v[64:79]
    v_mfma_f32_32x32x16_bf16 v[80:95], v[168:171], v[184:187], v[80:95]
    v_mfma_f32_32x32x16_bf16 v[96:111], v[172:175], v[184:187], v[96:111]
    v_mfma_f32_32x32x16_bf16 v[112:127], v[168:171], v[188:191], v[112:127]
    v_mfma_f32_32x32x16_bf16 v[128:143], v[172:175], v[188:191], v[128:143]
    s_waitcnt lgkmcnt(6)
    v_mfma_f32_32x32x16_bf16 v[16:31], v[192:195], v[200:203], v[16:31]
    ds_read_b128 v[168:171], v223 offset:0
    ds_read_b128 v[172:175], v223 offset:4096
    v_mfma_f32_32x32x16_bf16 v[32:47], v[196:199], v[200:203], v[32:47]
    ds_read_b128 v[176:179], v235 offset:0
    ds_read_b128 v[180:183], v235 offset:4096
    v_mfma_f32_32x32x16_bf16 v[48:63], v[192:195], v[204:207], v[48:63]
    ds_read_b128 v[184:187], v235 offset:16384
    ds_read_b128 v[188:191], v235 offset:20480
    v_mfma_f32_32x32x16_bf16 v[64:79], v[196:199], v[204:207], v[64:79]
    v_mfma_f32_32x32x16_bf16 v[80:95], v[192:195], v[208:211], v[80:95]
    v_mfma_f32_32x32x16_bf16 v[96:111], v[196:199], v[208:211], v[96:111]
    v_mfma_f32_32x32x16_bf16 v[112:127], v[192:195], v[212:215], v[112:127]
    v_mfma_f32_32x32x16_bf16 v[128:143], v[196:199], v[212:215], v[128:143]
    s_waitcnt lgkmcnt(0)
    s_barrier
    v_mfma_f32_32x32x16_bf16 v[16:31], v[144:147], v[152:155], v[16:31]
    ds_read_b128 v[192:195], v224 offset:0
    ds_read_b128 v[196:199], v224 offset:4096
    v_mfma_f32_32x32x16_bf16 v[32:47], v[148:151], v[152:155], v[32:47]
    ds_read_b128 v[200:203], v236 offset:0
    ds_read_b128 v[204:207], v236 offset:4096
    v_mfma_f32_32x32x16_bf16 v[48:63], v[144:147], v[156:159], v[48:63]
    ds_read_b128 v[208:211], v236 offset:16384
    ds_read_b128 v[212:215], v236 offset:20480
    v_mfma_f32_32x32x16_bf16 v[64:79], v[148:151], v[156:159], v[64:79]
    v_mfma_f32_32x32x16_bf16 v[80:95], v[144:147], v[160:163], v[80:95]
    v_mfma_f32_32x32x16_bf16 v[96:111], v[148:151], v[160:163], v[96:111]
    v_mfma_f32_32x32x16_bf16 v[112:127], v[144:147], v[164:167], v[112:127]
    v_mfma_f32_32x32x16_bf16 v[128:143], v[148:151], v[164:167], v[128:143]
    s_waitcnt lgkmcnt(6)
    v_mfma_f32_32x32x16_bf16 v[16:31], v[168:171], v[176:179], v[16:31]
    ds_read_b128 v[144:147], v225 offset:0
    ds_read_b128 v[148:151], v225 offset:4096
    v_mfma_f32_32x32x16_bf16 v[32:47], v[172:175], v[176:179], v[32:47]
    ds_read_b128 v[152:155], v237 offset:0
    ds_read_b128 v[156:159], v237 offset:4096
    v_mfma_f32_32x32x16_bf16 v[48:63], v[168:171], v[180:183], v[48:63]
    ds_read_b128 v[160:163], v237 offset:16384
    ds_read_b128 v[164:167], v237 offset:20480
    v_mfma_f32_32x32x16_bf16 v[64:79], v[172:175], v[180:183], v[64:79]
    v_mfma_f32_32x32x16_bf16 v[80:95], v[168:171], v[184:187], v[80:95]
    v_mfma_f32_32x32x16_bf16 v[96:111], v[172:175], v[184:187], v[96:111]
    v_mfma_f32_32x32x16_bf16 v[112:127], v[168:171], v[188:191], v[112:127]
    v_mfma_f32_32x32x16_bf16 v[128:143], v[172:175], v[188:191], v[128:143]
    s_waitcnt lgkmcnt(6)
    v_mfma_f32_32x32x16_bf16 v[16:31], v[192:195], v[200:203], v[16:31]
    ds_read_b128 v[168:171], v226 offset:0
    ds_read_b128 v[172:175], v226 offset:4096
    v_mfma_f32_32x32x16_bf16 v[32:47], v[196:199], v[200:203], v[32:47]
    ds_read_b128 v[176:179], v238 offset:0
    ds_read_b128 v[180:183], v238 offset:4096
    v_mfma_f32_32x32x16_bf16 v[48:63], v[192:195], v[204:207], v[48:63]
    ds_read_b128 v[184:187], v238 offset:16384
    ds_read_b128 v[188:191], v238 offset:20480
    v_mfma_f32_32x32x16_bf16 v[64:79], v[196:199], v[204:207], v[64:79]
    v_mfma_f32_32x32x16_bf16 v[80:95], v[192:195], v[208:211], v[80:95]
    v_mfma_f32_32x32x16_bf16 v[96:111], v[196:199], v[208:211], v[96:111]
    v_mfma_f32_32x32x16_bf16 v[112:127], v[192:195], v[212:215], v[112:127]
    v_mfma_f32_32x32x16_bf16 v[128:143], v[196:199], v[212:215], v[128:143]
    s_waitcnt lgkmcnt(6)
    v_mfma_f32_32x32x16_bf16 v[16:31], v[144:147], v[152:155], v[16:31]
    ds_read_b128 v[192:195], v227 offset:0
    ds_read_b128 v[196:199], v227 offset:4096
    v_mfma_f32_32x32x16_bf16 v[32:47], v[148:151], v[152:155], v[32:47]
    ds_read_b128 v[200:203], v239 offset:0
    ds_read_b128 v[204:207], v239 offset:4096
    v_mfma_f32_32x32x16_bf16 v[48:63], v[144:147], v[156:159], v[48:63]
    ds_read_b128 v[208:211], v239 offset:16384
    ds_read_b128 v[212:215], v239 offset:20480
    v_mfma_f32_32x32x16_bf16 v[64:79], v[148:151], v[156:159], v[64:79]
    v_mfma_f32_32x32x16_bf16 v[80:95], v[144:147], v[160:163], v[80:95]
    v_mfma_f32_32x32x16_bf16 v[96:111], v[148:151], v[160:163], v[96:111]
    v_mfma_f32_32x32x16_bf16 v[112:127], v[144:147], v[164:167], v[112:127]
    v_mfma_f32_32x32x16_bf16 v[128:143], v[148:151], v[164:167], v[128:143]
    s_waitcnt lgkmcnt(0)
    s_barrier
    v_mfma_f32_32x32x16_bf16 v[16:31], v[168:171], v[176:179], v[16:31]
    ds_read_b128 v[144:147], v216 offset:0
    ds_read_b128 v[148:151], v216 offset:4096
    v_mfma_f32_32x32x16_bf16 v[32:47], v[172:175], v[176:179], v[32:47]
    ds_read_b128 v[152:155], v228 offset:0
    ds_read_b128 v[156:159], v228 offset:4096
    v_mfma_f32_32x32x16_bf16 v[48:63], v[168:171], v[180:183], v[48:63]
    ds_read_b128 v[160:163], v228 offset:16384
    ds_read_b128 v[164:167], v228 offset:20480
    v_mfma_f32_32x32x16_bf16 v[64:79], v[172:175], v[180:183], v[64:79]
    v_mfma_f32_32x32x16_bf16 v[80:95], v[168:171], v[184:187], v[80:95]
    v_mfma_f32_32x32x16_bf16 v[96:111], v[172:175], v[184:187], v[96:111]
    v_mfma_f32_32x32x16_bf16 v[112:127], v[168:171], v[188:191], v[112:127]
    v_mfma_f32_32x32x16_bf16 v[128:143], v[172:175], v[188:191], v[128:143]
    s_waitcnt lgkmcnt(6)
    v_mfma_f32_32x32x16_bf16 v[16:31], v[192:195], v[200:203], v[16:31]
    ds_read_b128 v[168:171], v217 offset:0
    ds_read_b128 v[172:175], v217 offset:4096
    v_mfma_f32_32x32x16_bf16 v[32:47], v[196:199], v[200:203], v[32:47]
    ds_read_b128 v[176:179], v229 offset:0
    ds_read_b128 v[180:183], v229 offset:4096
    v_mfma_f32_32x32x16_bf16 v[48:63], v[192:195], v[204:207], v[48:63]
    ds_read_b128 v[184:187], v229 offset:16384
    ds_read_b128 v[188:191], v229 offset:20480
    v_mfma_f32_32x32x16_bf16 v[64:79], v[196:199], v[204:207], v[64:79]
    v_mfma_f32_32x32x16_bf16 v[80:95], v[192:195], v[208:211], v[80:95]
    v_mfma_f32_32x32x16_bf16 v[96:111], v[196:199], v[208:211], v[96:111]
    v_mfma_f32_32x32x16_bf16 v[112:127], v[192:195], v[212:215], v[112:127]
    v_mfma_f32_32x32x16_bf16 v[128:143], v[196:199], v[212:215], v[128:143]
    s_waitcnt lgkmcnt(6)
    v_mfma_f32_32x32x16_bf16 v[16:31], v[144:147], v[152:155], v[16:31]
    ds_read_b128 v[192:195], v218 offset:0
    ds_read_b128 v[196:199], v218 offset:4096
    v_mfma_f32_32x32x16_bf16 v[32:47], v[148:151], v[152:155], v[32:47]
    ds_read_b128 v[200:203], v230 offset:0
    ds_read_b128 v[204:207], v230 offset:4096
    v_mfma_f32_32x32x16_bf16 v[48:63], v[144:147], v[156:159], v[48:63]
    ds_read_b128 v[208:211], v230 offset:16384
    ds_read_b128 v[212:215], v230 offset:20480
    v_mfma_f32_32x32x16_bf16 v[64:79], v[148:151], v[156:159], v[64:79]
    v_mfma_f32_32x32x16_bf16 v[80:95], v[144:147], v[160:163], v[80:95]
    v_mfma_f32_32x32x16_bf16 v[96:111], v[148:151], v[160:163], v[96:111]
    v_mfma_f32_32x32x16_bf16 v[112:127], v[144:147], v[164:167], v[112:127]
    v_mfma_f32_32x32x16_bf16 v[128:143], v[148:151], v[164:167], v[128:143]
    s_waitcnt lgkmcnt(6)
    v_mfma_f32_32x32x16_bf16 v[16:31], v[168:171], v[176:179], v[16:31]
    ds_read_b128 v[144:147], v219 offset:0
    ds_read_b128 v[148:151], v219 offset:4096
    v_mfma_f32_32x32x16_bf16 v[32:47], v[172:175], v[176:179], v[32:47]
    ds_read_b128 v[152:155], v231 offset:0
    ds_read_b128 v[156:159], v231 offset:4096
    v_mfma_f32_32x32x16_bf16 v[48:63], v[168:171], v[180:183], v[48:63]
    ds_read_b128 v[160:163], v231 offset:16384
    ds_read_b128 v[164:167], v231 offset:20480
    v_mfma_f32_32x32x16_bf16 v[64:79], v[172:175], v[180:183], v[64:79]
    v_mfma_f32_32x32x16_bf16 v[80:95], v[168:171], v[184:187], v[80:95]
    v_mfma_f32_32x32x16_bf16 v[96:111], v[172:175], v[184:187], v[96:111]
    v_mfma_f32_32x32x16_bf16 v[112:127], v[168:171], v[188:191], v[112:127]
    v_mfma_f32_32x32x16_bf16 v[128:143], v[172:175], v[188:191], v[128:143]
    s_waitcnt lgkmcnt(0)
    s_barrier
    v_mfma_f32_32x32x16_bf16 v[16:31], v[192:195], v[200:203], v[16:31]
    ds_read_b128 v[168:171], v220 offset:0
    ds_read_b128 v[172:175], v220 offset:4096
    v_mfma_f32_32x32x16_bf16 v[32:47], v[196:199], v[200:203], v[32:47]
    ds_read_b128 v[176:179], v232 offset:0
    ds_read_b128 v[180:183], v232 offset:4096
    v_mfma_f32_32x32x16_bf16 v[48:63], v[192:195], v[204:207], v[48:63]
    ds_read_b128 v[184:187], v232 offset:16384
    ds_read_b128 v[188:191], v232 offset:20480
    v_mfma_f32_32x32x16_bf16 v[64:79], v[196:199], v[204:207], v[64:79]
    v_mfma_f32_32x32x16_bf16 v[80:95], v[192:195], v[208:211], v[80:95]
    v_mfma_f32_32x32x16_bf16 v[96:111], v[196:199], v[208:211], v[96:111]
    v_mfma_f32_32x32x16_bf16 v[112:127], v[192:195], v[212:215], v[112:127]
    v_mfma_f32_32x32x16_bf16 v[128:143], v[196:199], v[212:215], v[128:143]
    s_waitcnt lgkmcnt(6)
    v_mfma_f32_32x32x16_bf16 v[16:31], v[144:147], v[152:155], v[16:31]
    ds_read_b128 v[192:195], v221 offset:0
    ds_read_b128 v[196:199], v221 offset:4096
    v_mfma_f32_32x32x16_bf16 v[32:47], v[148:151], v[152:155], v[32:47]
    ds_read_b128 v[200:203], v233 offset:0
    ds_read_b128 v[204:207], v233 offset:4096
    v_mfma_f32_32x32x16_bf16 v[48:63], v[144:147], v[156:159], v[48:63]
    ds_read_b128 v[208:211], v233 offset:16384
    ds_read_b128 v[212:215], v233 offset:20480
    v_mfma_f32_32x32x16_bf16 v[64:79], v[148:151], v[156:159], v[64:79]
    v_mfma_f32_32x32x16_bf16 v[80:95], v[144:147], v[160:163], v[80:95]
    v_mfma_f32_32x32x16_bf16 v[96:111], v[148:151], v[160:163], v[96:111]
    v_mfma_f32_32x32x16_bf16 v[112:127], v[144:147], v[164:167], v[112:127]
    v_mfma_f32_32x32x16_bf16 v[128:143], v[148:151], v[164:167], v[128:143]
    s_waitcnt lgkmcnt(6)
    v_mfma_f32_32x32x16_bf16 v[16:31], v[168:171], v[176:179], v[16:31]
    ds_read_b128 v[144:147], v222 offset:0
    ds_read_b128 v[148:151], v222 offset:4096
    v_mfma_f32_32x32x16_bf16 v[32:47], v[172:175], v[176:179], v[32:47]
    ds_read_b128 v[152:155], v234 offset:0
    ds_read_b128 v[156:159], v234 offset:4096
    v_mfma_f32_32x32x16_bf16 v[48:63], v[168:171], v[180:183], v[48:63]
    ds_read_b128 v[160:163], v234 offset:16384
    ds_read_b128 v[164:167], v234 offset:20480
    v_mfma_f32_32x32x16_bf16 v[64:79], v[172:175], v[180:183], v[64:79]
    v_mfma_f32_32x32x16_bf16 v[80:95], v[168:171], v[184:187], v[80:95]
    v_mfma_f32_32x32x16_bf16 v[96:111], v[172:175], v[184:187], v[96:111]
    v_mfma_f32_32x32x16_bf16 v[112:127], v[168:171], v[188:191], v[112:127]
    v_mfma_f32_32x32x16_bf16 v[128:143], v[172:175], v[188:191], v[128:143]
    s_waitcnt lgkmcnt(6)
    v_mfma_f32_32x32x16_bf16 v[16:31], v[192:195], v[200:203], v[16:31]
    ds_read_b128 v[168:171], v223 offset:0
    ds_read_b128 v[172:175], v223 offset:4096
    v_mfma_f32_32x32x16_bf16 v[32:47], v[196:199], v[200:203], v[32:47]
    ds_read_b128 v[176:179], v235 offset:0
    ds_read_b128 v[180:183], v235 offset:4096
    v_mfma_f32_32x32x16_bf16 v[48:63], v[192:195], v[204:207], v[48:63]
    ds_read_b128 v[184:187], v235 offset:16384
    ds_read_b128 v[188:191], v235 offset:20480
    v_mfma_f32_32x32x16_bf16 v[64:79], v[196:199], v[204:207], v[64:79]
    v_mfma_f32_32x32x16_bf16 v[80:95], v[192:195], v[208:211], v[80:95]
    v_mfma_f32_32x32x16_bf16 v[96:111], v[196:199], v[208:211], v[96:111]
    v_mfma_f32_32x32x16_bf16 v[112:127], v[192:195], v[212:215], v[112:127]
    v_mfma_f32_32x32x16_bf16 v[128:143], v[196:199], v[212:215], v[128:143]
    s_waitcnt lgkmcnt(0)
    s_barrier
    v_mfma_f32_32x32x16_bf16 v[16:31], v[144:147], v[152:155], v[16:31]
    ds_read_b128 v[192:195], v224 offset:0
    ds_read_b128 v[196:199], v224 offset:4096
    v_mfma_f32_32x32x16_bf16 v[32:47], v[148:151], v[152:155], v[32:47]
    ds_read_b128 v[200:203], v236 offset:0
    ds_read_b128 v[204:207], v236 offset:4096
    v_mfma_f32_32x32x16_bf16 v[48:63], v[144:147], v[156:159], v[48:63]
    ds_read_b128 v[208:211], v236 offset:16384
    ds_read_b128 v[212:215], v236 offset:20480
    v_mfma_f32_32x32x16_bf16 v[64:79], v[148:151], v[156:159], v[64:79]
    v_mfma_f32_32x32x16_bf16 v[80:95], v[144:147], v[160:163], v[80:95]
    v_mfma_f32_32x32x16_bf16 v[96:111], v[148:151], v[160:163], v[96:111]
    v_mfma_f32_32x32x16_bf16 v[112:127], v[144:147], v[164:167], v[112:127]
    v_mfma_f32_32x32x16_bf16 v[128:143], v[148:151], v[164:167], v[128:143]
    s_waitcnt lgkmcnt(6)
    v_mfma_f32_32x32x16_bf16 v[16:31], v[168:171], v[176:179], v[16:31]
    ds_read_b128 v[144:147], v225 offset:0
    ds_read_b128 v[148:151], v225 offset:4096
    v_mfma_f32_32x32x16_bf16 v[32:47], v[172:175], v[176:179], v[32:47]
    ds_read_b128 v[152:155], v237 offset:0
    ds_read_b128 v[156:159], v237 offset:4096
    v_mfma_f32_32x32x16_bf16 v[48:63], v[168:171], v[180:183], v[48:63]
    ds_read_b128 v[160:163], v237 offset:16384
    ds_read_b128 v[164:167], v237 offset:20480
    v_mfma_f32_32x32x16_bf16 v[64:79], v[172:175], v[180:183], v[64:79]
    v_mfma_f32_32x32x16_bf16 v[80:95], v[168:171], v[184:187], v[80:95]
    v_mfma_f32_32x32x16_bf16 v[96:111], v[172:175], v[184:187], v[96:111]
    v_mfma_f32_32x32x16_bf16 v[112:127], v[168:171], v[188:191], v[112:127]
    v_mfma_f32_32x32x16_bf16 v[128:143], v[172:175], v[188:191], v[128:143]
    s_waitcnt lgkmcnt(6)
    v_mfma_f32_32x32x16_bf16 v[16:31], v[192:195], v[200:203], v[16:31]
    ds_read_b128 v[168:171], v226 offset:0
    ds_read_b128 v[172:175], v226 offset:4096
    v_mfma_f32_32x32x16_bf16 v[32:47], v[196:199], v[200:203], v[32:47]
    ds_read_b128 v[176:179], v238 offset:0
    ds_read_b128 v[180:183], v238 offset:4096
    v_mfma_f32_32x32x16_bf16 v[48:63], v[192:195], v[204:207], v[48:63]
    ds_read_b128 v[184:187], v238 offset:16384
    ds_read_b128 v[188:191], v238 offset:20480
    v_mfma_f32_32x32x16_bf16 v[64:79], v[196:199], v[204:207], v[64:79]
    v_mfma_f32_32x32x16_bf16 v[80:95], v[192:195], v[208:211], v[80:95]
    v_mfma_f32_32x32x16_bf16 v[96:111], v[196:199], v[208:211], v[96:111]
    v_mfma_f32_32x32x16_bf16 v[112:127], v[192:195], v[212:215], v[112:127]
    v_mfma_f32_32x32x16_bf16 v[128:143], v[196:199], v[212:215], v[128:143]
    s_waitcnt lgkmcnt(6)
    v_mfma_f32_32x32x16_bf16 v[16:31], v[144:147], v[152:155], v[16:31]
    ds_read_b128 v[192:195], v227 offset:0
    ds_read_b128 v[196:199], v227 offset:4096
    v_mfma_f32_32x32x16_bf16 v[32:47], v[148:151], v[152:155], v[32:47]
    ds_read_b128 v[200:203], v239 offset:0
    ds_read_b128 v[204:207], v239 offset:4096
    v_mfma_f32_32x32x16_bf16 v[48:63], v[144:147], v[156:159], v[48:63]
    ds_read_b128 v[208:211], v239 offset:16384
    ds_read_b128 v[212:215], v239 offset:20480
    v_mfma_f32_32x32x16_bf16 v[64:79], v[148:151], v[156:159], v[64:79]
    v_mfma_f32_32x32x16_bf16 v[80:95], v[144:147], v[160:163], v[80:95]
    v_mfma_f32_32x32x16_bf16 v[96:111], v[148:151], v[160:163], v[96:111]
    v_mfma_f32_32x32x16_bf16 v[112:127], v[144:147], v[164:167], v[112:127]
    v_mfma_f32_32x32x16_bf16 v[128:143], v[148:151], v[164:167], v[128:143]
    s_waitcnt lgkmcnt(0)
    s_barrier
    v_mfma_f32_32x32x16_bf16 v[16:31], v[168:171], v[176:179], v[16:31]
    ds_read_b128 v[144:147], v216 offset:0
    ds_read_b128 v[148:151], v216 offset:4096
    v_mfma_f32_32x32x16_bf16 v[32:47], v[172:175], v[176:179], v[32:47]
    ds_read_b128 v[152:155], v228 offset:0
    ds_read_b128 v[156:159], v228 offset:4096
    v_mfma_f32_32x32x16_bf16 v[48:63], v[168:171], v[180:183], v[48:63]
    ds_read_b128 v[160:163], v228 offset:16384
    ds_read_b128 v[164:167], v228 offset:20480
    v_mfma_f32_32x32x16_bf16 v[64:79], v[172:175], v[180:183], v[64:79]
    v_mfma_f32_32x32x16_bf16 v[80:95], v[168:171], v[184:187], v[80:95]
    v_mfma_f32_32x32x16_bf16 v[96:111], v[172:175], v[184:187], v[96:111]
    v_mfma_f32_32x32x16_bf16 v[112:127], v[168:171], v[188:191], v[112:127]
    v_mfma_f32_32x32x16_bf16 v[128:143], v[172:175], v[188:191], v[128:143]
    s_waitcnt lgkmcnt(6)
    v_mfma_f32_32x32x16_bf16 v[16:31], v[192:195], v[200:203], v[16:31]
    ds_read_b128 v[168:171], v217 offset:0
    ds_read_b128 v[172:175], v217 offset:4096
    v_mfma_f32_32x32x16_bf16 v[32:47], v[196:199], v[200:203], v[32:47]
    ds_read_b128 v[176:179], v229 offset:0
    ds_read_b128 v[180:183], v229 offset:4096
    v_mfma_f32_32x32x16_bf16 v[48:63], v[192:195], v[204:207], v[48:63]
    ds_read_b128 v[184:187], v229 offset:16384
    ds_read_b128 v[188:191], v229 offset:20480
    v_mfma_f32_32x32x16_bf16 v[64:79], v[196:199], v[204:207], v[64:79]
    v_mfma_f32_32x32x16_bf16 v[80:95], v[192:195], v[208:211], v[80:95]
    v_mfma_f32_32x32x16_bf16 v[96:111], v[196:199], v[208:211], v[96:111]
    v_mfma_f32_32x32x16_bf16 v[112:127], v[192:195], v[212:215], v[112:127]
    v_mfma_f32_32x32x16_bf16 v[128:143], v[196:199], v[212:215], v[128:143]
    s_waitcnt lgkmcnt(6)
    v_mfma_f32_32x32x16_bf16 v[16:31], v[144:147], v[152:155], v[16:31]
    ds_read_b128 v[192:195], v218 offset:0
    ds_read_b128 v[196:199], v218 offset:4096
    v_mfma_f32_32x32x16_bf16 v[32:47], v[148:151], v[152:155], v[32:47]
    ds_read_b128 v[200:203], v230 offset:0
    ds_read_b128 v[204:207], v230 offset:4096
    v_mfma_f32_32x32x16_bf16 v[48:63], v[144:147], v[156:159], v[48:63]
    ds_read_b128 v[208:211], v230 offset:16384
    ds_read_b128 v[212:215], v230 offset:20480
    v_mfma_f32_32x32x16_bf16 v[64:79], v[148:151], v[156:159], v[64:79]
    v_mfma_f32_32x32x16_bf16 v[80:95], v[144:147], v[160:163], v[80:95]
    v_mfma_f32_32x32x16_bf16 v[96:111], v[148:151], v[160:163], v[96:111]
    v_mfma_f32_32x32x16_bf16 v[112:127], v[144:147], v[164:167], v[112:127]
    v_mfma_f32_32x32x16_bf16 v[128:143], v[148:151], v[164:167], v[128:143]
    s_waitcnt lgkmcnt(6)
    v_mfma_f32_32x32x16_bf16 v[16:31], v[168:171], v[176:179], v[16:31]
    ds_read_b128 v[144:147], v219 offset:0
    ds_read_b128 v[148:151], v219 offset:4096
    v_mfma_f32_32x32x16_bf16 v[32:47], v[172:175], v[176:179], v[32:47]
    ds_read_b128 v[152:155], v231 offset:0
    ds_read_b128 v[156:159], v231 offset:4096
    v_mfma_f32_32x32x16_bf16 v[48:63], v[168:171], v[180:183], v[48:63]
    ds_read_b128 v[160:163], v231 offset:16384
    ds_read_b128 v[164:167], v231 offset:20480
    v_mfma_f32_32x32x16_bf16 v[64:79], v[172:175], v[180:183], v[64:79]
    v_mfma_f32_32x32x16_bf16 v[80:95], v[168:171], v[184:187], v[80:95]
    v_mfma_f32_32x32x16_bf16 v[96:111], v[172:175], v[184:187], v[96:111]
    v_mfma_f32_32x32x16_bf16 v[112:127], v[168:171], v[188:191], v[112:127]
    v_mfma_f32_32x32x16_bf16 v[128:143], v[172:175], v[188:191], v[128:143]
    s_waitcnt lgkmcnt(6)
    v_mfma_f32_32x32x16_bf16 v[16:31], v[192:195], v[200:203], v[16:31]
    v_mfma_f32_32x32x16_bf16 v[32:47], v[196:199], v[200:203], v[32:47]
    v_mfma_f32_32x32x16_bf16 v[48:63], v[192:195], v[204:207], v[48:63]
    v_mfma_f32_32x32x16_bf16 v[64:79], v[196:199], v[204:207], v[64:79]
    v_mfma_f32_32x32x16_bf16 v[80:95], v[192:195], v[208:211], v[80:95]
    v_mfma_f32_32x32x16_bf16 v[96:111], v[196:199], v[208:211], v[96:111]
    v_mfma_f32_32x32x16_bf16 v[112:127], v[192:195], v[212:215], v[112:127]
    v_mfma_f32_32x32x16_bf16 v[128:143], v[196:199], v[212:215], v[128:143]
    s_waitcnt lgkmcnt(0)
    v_mfma_f32_32x32x16_bf16 v[16:31], v[144:147], v[152:155], v[16:31]
    v_mfma_f32_32x32x16_bf16 v[32:47], v[148:151], v[152:155], v[32:47]
    v_mfma_f32_32x32x16_bf16 v[48:63], v[144:147], v[156:159], v[48:63]
    v_mfma_f32_32x32x16_bf16 v[64:79], v[148:151], v[156:159], v[64:79]
    v_mfma_f32_32x32x16_bf16 v[80:95], v[144:147], v[160:163], v[80:95]
    v_mfma_f32_32x32x16_bf16 v[96:111], v[148:151], v[160:163], v[96:111]
    v_mfma_f32_32x32x16_bf16 v[112:127], v[144:147], v[164:167], v[112:127]
    v_mfma_f32_32x32x16_bf16 v[128:143], v[148:151], v[164:167], v[128:143]
    v_mov_b32 v152, 0
    v_mov_b32 v153, 0
    v_mov_b32 v154, 0
    v_mov_b32 v155, 0
    s_nop 0
    v_pk_mul_f32 v[224:225], v[16:17], v[242:243] op_sel_hi:[1,0]
    v_pk_mul_f32 v[226:227], v[16:17], v[242:243] op_sel:[0,1] op_sel_hi:[1,1]
    s_nop 1
    v_fma_f32 v16, -v243, v80, v224
    v_fma_f32 v17, v242, v80, v226
    v_fma_f32 v80, -v243, v81, v225
    v_fma_f32 v81, v242, v81, v227
    v_pk_mul_f32 v[228:229], v[48:49], v[248:249] op_sel_hi:[1,0]
    v_pk_mul_f32 v[230:231], v[48:49], v[248:249] op_sel:[0,1] op_sel_hi:[1,1]
    v_fma_f32 v48, -v249, v112, v228
    v_fma_f32 v49, v248, v112, v230
    v_fma_f32 v112, -v249, v113, v229
    v_fma_f32 v113, v248, v113, v231
    v_pk_fma_f32 v[156:157], v[240:241], v[152:153], v[16:17] op_sel_hi:[0,1,1]
    v_pk_fma_f32 v[158:159], v[246:247], v[154:155], v[48:49] op_sel_hi:[0,1,1]
    v_pk_fma_f32 v[152:153], v[240:241], v[152:153], v[156:157] op_sel:[1,1,0] op_sel_hi:[1,0,1] neg_lo:[1,0,0]
    v_pk_fma_f32 v[154:155], v[246:247], v[154:155], v[158:159] op_sel:[1,1,0] op_sel_hi:[1,0,1] neg_lo:[1,0,0]
    v_pk_fma_f32 v[156:157], v[240:241], v[152:153], v[80:81] op_sel_hi:[0,1,1]
    v_pk_fma_f32 v[158:159], v[246:247], v[154:155], v[112:113] op_sel_hi:[0,1,1]
    v_pk_fma_f32 v[152:153], v[240:241], v[152:153], v[156:157] op_sel:[1,1,0] op_sel_hi:[1,0,1] neg_lo:[1,0,0]
    v_pk_fma_f32 v[154:155], v[246:247], v[154:155], v[158:159] op_sel:[1,1,0] op_sel_hi:[1,0,1] neg_lo:[1,0,0]
    v_pk_mul_f32 v[224:225], v[18:19], v[242:243] op_sel_hi:[1,0]
    v_pk_mul_f32 v[226:227], v[18:19], v[242:243] op_sel:[0,1] op_sel_hi:[1,1]
    v_fma_f32 v18, -v243, v82, v224
    v_fma_f32 v19, v242, v82, v226
    v_fma_f32 v82, -v243, v83, v225
    v_fma_f32 v83, v242, v83, v227
    v_pk_mul_f32 v[228:229], v[50:51], v[248:249] op_sel_hi:[1,0]
    v_pk_mul_f32 v[230:231], v[50:51], v[248:249] op_sel:[0,1] op_sel_hi:[1,1]
    v_fma_f32 v50, -v249, v114, v228
    v_fma_f32 v51, v248, v114, v230
    v_fma_f32 v114, -v249, v115, v229
    v_fma_f32 v115, v248, v115, v231
    v_pk_fma_f32 v[156:157], v[240:241], v[152:153], v[18:19] op_sel_hi:[0,1,1]
    v_pk_fma_f32 v[158:159], v[246:247], v[154:155], v[50:51] op_sel_hi:[0,1,1]
    v_pk_fma_f32 v[152:153], v[240:241], v[152:153], v[156:157] op_sel:[1,1,0] op_sel_hi:[1,0,1] neg_lo:[1,0,0]
    v_pk_fma_f32 v[154:155], v[246:247], v[154:155], v[158:159] op_sel:[1,1,0] op_sel_hi:[1,0,1] neg_lo:[1,0,0]
    v_pk_fma_f32 v[156:157], v[240:241], v[152:153], v[82:83] op_sel_hi:[0,1,1]
    v_pk_fma_f32 v[158:159], v[246:247], v[154:155], v[114:115] op_sel_hi:[0,1,1]
    v_pk_fma_f32 v[152:153], v[240:241], v[152:153], v[156:157] op_sel:[1,1,0] op_sel_hi:[1,0,1] neg_lo:[1,0,0]
    v_pk_fma_f32 v[154:155], v[246:247], v[154:155], v[158:159] op_sel:[1,1,0] op_sel_hi:[1,0,1] neg_lo:[1,0,0]
    v_pk_mul_f32 v[224:225], v[20:21], v[242:243] op_sel_hi:[1,0]
    v_pk_mul_f32 v[226:227], v[20:21], v[242:243] op_sel:[0,1] op_sel_hi:[1,1]
    v_fma_f32 v20, -v243, v84, v224
    v_fma_f32 v21, v242, v84, v226
    v_fma_f32 v84, -v243, v85, v225
    v_fma_f32 v85, v242, v85, v227
    v_pk_mul_f32 v[228:229], v[52:53], v[248:249] op_sel_hi:[1,0]
    v_pk_mul_f32 v[230:231], v[52:53], v[248:249] op_sel:[0,1] op_sel_hi:[1,1]
    v_fma_f32 v52, -v249, v116, v228
    v_fma_f32 v53, v248, v116, v230
    v_fma_f32 v116, -v249, v117, v229
    v_fma_f32 v117, v248, v117, v231
    v_pk_fma_f32 v[156:157], v[240:241], v[152:153], v[20:21] op_sel_hi:[0,1,1]
    v_pk_fma_f32 v[158:159], v[246:247], v[154:155], v[52:53] op_sel_hi:[0,1,1]
    v_pk_fma_f32 v[152:153], v[240:241], v[152:153], v[156:157] op_sel:[1,1,0] op_sel_hi:[1,0,1] neg_lo:[1,0,0]
    v_pk_fma_f32 v[154:155], v[246:247], v[154:155], v[158:159] op_sel:[1,1,0] op_sel_hi:[1,0,1] neg_lo:[1,0,0]
    v_pk_fma_f32 v[156:157], v[240:241], v[152:153], v[84:85] op_sel_hi:[0,1,1]
    v_pk_fma_f32 v[158:159], v[246:247], v[154:155], v[116:117] op_sel_hi:[0,1,1]
    v_pk_fma_f32 v[152:153], v[240:241], v[152:153], v[156:157] op_sel:[1,1,0] op_sel_hi:[1,0,1] neg_lo:[1,0,0]
    v_pk_fma_f32 v[154:155], v[246:247], v[154:155], v[158:159] op_sel:[1,1,0] op_sel_hi:[1,0,1] neg_lo:[1,0,0]
    v_pk_mul_f32 v[224:225], v[22:23], v[242:243] op_sel_hi:[1,0]
    v_pk_mul_f32 v[226:227], v[22:23], v[242:243] op_sel:[0,1] op_sel_hi:[1,1]
    v_fma_f32 v22, -v243, v86, v224
    v_fma_f32 v23, v242, v86, v226
    v_fma_f32 v86, -v243, v87, v225
    v_fma_f32 v87, v242, v87, v227
    v_pk_mul_f32 v[228:229], v[54:55], v[248:249] op_sel_hi:[1,0]
    v_pk_mul_f32 v[230:231], v[54:55], v[248:249] op_sel:[0,1] op_sel_hi:[1,1]
    v_fma_f32 v54, -v249, v118, v228
    v_fma_f32 v55, v248, v118, v230
    v_fma_f32 v118, -v249, v119, v229
    v_fma_f32 v119, v248, v119, v231
    v_pk_fma_f32 v[156:157], v[240:241], v[152:153], v[22:23] op_sel_hi:[0,1,1]
    v_pk_fma_f32 v[158:159], v[246:247], v[154:155], v[54:55] op_sel_hi:[0,1,1]
    v_pk_fma_f32 v[152:153], v[240:241], v[152:153], v[156:157] op_sel:[1,1,0] op_sel_hi:[1,0,1] neg_lo:[1,0,0]
    v_pk_fma_f32 v[154:155], v[246:247], v[154:155], v[158:159] op_sel:[1,1,0] op_sel_hi:[1,0,1] neg_lo:[1,0,0]
    v_pk_fma_f32 v[156:157], v[240:241], v[152:153], v[86:87] op_sel_hi:[0,1,1]
    v_pk_fma_f32 v[158:159], v[246:247], v[154:155], v[118:119] op_sel_hi:[0,1,1]
    v_pk_fma_f32 v[152:153], v[240:241], v[152:153], v[156:157] op_sel:[1,1,0] op_sel_hi:[1,0,1] neg_lo:[1,0,0]
    v_pk_fma_f32 v[154:155], v[246:247], v[154:155], v[158:159] op_sel:[1,1,0] op_sel_hi:[1,0,1] neg_lo:[1,0,0]
    v_pk_mul_f32 v[224:225], v[24:25], v[242:243] op_sel_hi:[1,0]
    v_pk_mul_f32 v[226:227], v[24:25], v[242:243] op_sel:[0,1] op_sel_hi:[1,1]
    v_fma_f32 v24, -v243, v88, v224
    v_fma_f32 v25, v242, v88, v226
    v_fma_f32 v88, -v243, v89, v225
    v_fma_f32 v89, v242, v89, v227
    v_pk_mul_f32 v[228:229], v[56:57], v[248:249] op_sel_hi:[1,0]
    v_pk_mul_f32 v[230:231], v[56:57], v[248:249] op_sel:[0,1] op_sel_hi:[1,1]
    v_fma_f32 v56, -v249, v120, v228
    v_fma_f32 v57, v248, v120, v230
    v_fma_f32 v120, -v249, v121, v229
    v_fma_f32 v121, v248, v121, v231
    v_pk_fma_f32 v[156:157], v[240:241], v[152:153], v[24:25] op_sel_hi:[0,1,1]
    v_pk_fma_f32 v[158:159], v[246:247], v[154:155], v[56:57] op_sel_hi:[0,1,1]
    v_pk_fma_f32 v[152:153], v[240:241], v[152:153], v[156:157] op_sel:[1,1,0] op_sel_hi:[1,0,1] neg_lo:[1,0,0]
    v_pk_fma_f32 v[154:155], v[246:247], v[154:155], v[158:159] op_sel:[1,1,0] op_sel_hi:[1,0,1] neg_lo:[1,0,0]
    v_pk_fma_f32 v[156:157], v[240:241], v[152:153], v[88:89] op_sel_hi:[0,1,1]
    v_pk_fma_f32 v[158:159], v[246:247], v[154:155], v[120:121] op_sel_hi:[0,1,1]
    v_pk_fma_f32 v[152:153], v[240:241], v[152:153], v[156:157] op_sel:[1,1,0] op_sel_hi:[1,0,1] neg_lo:[1,0,0]
    v_pk_fma_f32 v[154:155], v[246:247], v[154:155], v[158:159] op_sel:[1,1,0] op_sel_hi:[1,0,1] neg_lo:[1,0,0]
    v_pk_mul_f32 v[224:225], v[26:27], v[242:243] op_sel_hi:[1,0]
    v_pk_mul_f32 v[226:227], v[26:27], v[242:243] op_sel:[0,1] op_sel_hi:[1,1]
    v_fma_f32 v26, -v243, v90, v224
    v_fma_f32 v27, v242, v90, v226
    v_fma_f32 v90, -v243, v91, v225
    v_fma_f32 v91, v242, v91, v227
    v_pk_mul_f32 v[228:229], v[58:59], v[248:249] op_sel_hi:[1,0]
    v_pk_mul_f32 v[230:231], v[58:59], v[248:249] op_sel:[0,1] op_sel_hi:[1,1]
    v_fma_f32 v58, -v249, v122, v228
    v_fma_f32 v59, v248, v122, v230
    v_fma_f32 v122, -v249, v123, v229
    v_fma_f32 v123, v248, v123, v231
    v_pk_fma_f32 v[156:157], v[240:241], v[152:153], v[26:27] op_sel_hi:[0,1,1]
    v_pk_fma_f32 v[158:159], v[246:247], v[154:155], v[58:59] op_sel_hi:[0,1,1]
    v_pk_fma_f32 v[152:153], v[240:241], v[152:153], v[156:157] op_sel:[1,1,0] op_sel_hi:[1,0,1] neg_lo:[1,0,0]
    v_pk_fma_f32 v[154:155], v[246:247], v[154:155], v[158:159] op_sel:[1,1,0] op_sel_hi:[1,0,1] neg_lo:[1,0,0]
    v_pk_fma_f32 v[156:157], v[240:241], v[152:153], v[90:91] op_sel_hi:[0,1,1]
    v_pk_fma_f32 v[158:159], v[246:247], v[154:155], v[122:123] op_sel_hi:[0,1,1]
    v_pk_fma_f32 v[152:153], v[240:241], v[152:153], v[156:157] op_sel:[1,1,0] op_sel_hi:[1,0,1] neg_lo:[1,0,0]
    v_pk_fma_f32 v[154:155], v[246:247], v[154:155], v[158:159] op_sel:[1,1,0] op_sel_hi:[1,0,1] neg_lo:[1,0,0]
    v_pk_mul_f32 v[224:225], v[28:29], v[242:243] op_sel_hi:[1,0]
    v_pk_mul_f32 v[226:227], v[28:29], v[242:243] op_sel:[0,1] op_sel_hi:[1,1]
    v_fma_f32 v28, -v243, v92, v224
    v_fma_f32 v29, v242, v92, v226
    v_fma_f32 v92, -v243, v93, v225
    v_fma_f32 v93, v242, v93, v227
    v_pk_mul_f32 v[228:229], v[60:61], v[248:249] op_sel_hi:[1,0]
    v_pk_mul_f32 v[230:231], v[60:61], v[248:249] op_sel:[0,1] op_sel_hi:[1,1]
    v_fma_f32 v60, -v249, v124, v228
    v_fma_f32 v61, v248, v124, v230
    v_fma_f32 v124, -v249, v125, v229
    v_fma_f32 v125, v248, v125, v231
    v_pk_fma_f32 v[156:157], v[240:241], v[152:153], v[28:29] op_sel_hi:[0,1,1]
    v_pk_fma_f32 v[158:159], v[246:247], v[154:155], v[60:61] op_sel_hi:[0,1,1]
    v_pk_fma_f32 v[152:153], v[240:241], v[152:153], v[156:157] op_sel:[1,1,0] op_sel_hi:[1,0,1] neg_lo:[1,0,0]
    v_pk_fma_f32 v[154:155], v[246:247], v[154:155], v[158:159] op_sel:[1,1,0] op_sel_hi:[1,0,1] neg_lo:[1,0,0]
    v_pk_fma_f32 v[156:157], v[240:241], v[152:153], v[92:93] op_sel_hi:[0,1,1]
    v_pk_fma_f32 v[158:159], v[246:247], v[154:155], v[124:125] op_sel_hi:[0,1,1]
    v_pk_fma_f32 v[152:153], v[240:241], v[152:153], v[156:157] op_sel:[1,1,0] op_sel_hi:[1,0,1] neg_lo:[1,0,0]
    v_pk_fma_f32 v[154:155], v[246:247], v[154:155], v[158:159] op_sel:[1,1,0] op_sel_hi:[1,0,1] neg_lo:[1,0,0]
    v_pk_mul_f32 v[224:225], v[30:31], v[242:243] op_sel_hi:[1,0]
    v_pk_mul_f32 v[226:227], v[30:31], v[242:243] op_sel:[0,1] op_sel_hi:[1,1]
    v_fma_f32 v30, -v243, v94, v224
    v_fma_f32 v31, v242, v94, v226
    v_fma_f32 v94, -v243, v95, v225
    v_fma_f32 v95, v242, v95, v227
    v_pk_mul_f32 v[228:229], v[62:63], v[248:249] op_sel_hi:[1,0]
    v_pk_mul_f32 v[230:231], v[62:63], v[248:249] op_sel:[0,1] op_sel_hi:[1,1]
    v_fma_f32 v62, -v249, v126, v228
    v_fma_f32 v63, v248, v126, v230
    v_fma_f32 v126, -v249, v127, v229
    v_fma_f32 v127, v248, v127, v231
    v_pk_fma_f32 v[156:157], v[240:241], v[152:153], v[30:31] op_sel_hi:[0,1,1]
    v_pk_fma_f32 v[158:159], v[246:247], v[154:155], v[62:63] op_sel_hi:[0,1,1]
    v_pk_fma_f32 v[152:153], v[240:241], v[152:153], v[156:157] op_sel:[1,1,0] op_sel_hi:[1,0,1] neg_lo:[1,0,0]
    v_pk_fma_f32 v[154:155], v[246:247], v[154:155], v[158:159] op_sel:[1,1,0] op_sel_hi:[1,0,1] neg_lo:[1,0,0]
    v_pk_fma_f32 v[156:157], v[240:241], v[152:153], v[94:95] op_sel_hi:[0,1,1]
    v_pk_fma_f32 v[158:159], v[246:247], v[154:155], v[126:127] op_sel_hi:[0,1,1]
    v_pk_fma_f32 v[152:153], v[240:241], v[152:153], v[156:157] op_sel:[1,1,0] op_sel_hi:[1,0,1] neg_lo:[1,0,0]
    v_pk_fma_f32 v[154:155], v[246:247], v[154:155], v[158:159] op_sel:[1,1,0] op_sel_hi:[1,0,1] neg_lo:[1,0,0]
    v_pk_mul_f32 v[224:225], v[32:33], v[242:243] op_sel_hi:[1,0]
    v_pk_mul_f32 v[226:227], v[32:33], v[242:243] op_sel:[0,1] op_sel_hi:[1,1]
    v_fma_f32 v32, -v243, v96, v224
    v_fma_f32 v33, v242, v96, v226
    v_fma_f32 v96, -v243, v97, v225
    v_fma_f32 v97, v242, v97, v227
    v_pk_mul_f32 v[228:229], v[64:65], v[248:249] op_sel_hi:[1,0]
    v_pk_mul_f32 v[230:231], v[64:65], v[248:249] op_sel:[0,1] op_sel_hi:[1,1]
    v_fma_f32 v64, -v249, v128, v228
    v_fma_f32 v65, v248, v128, v230
    v_fma_f32 v128, -v249, v129, v229
    v_fma_f32 v129, v248, v129, v231
    v_pk_fma_f32 v[156:157], v[240:241], v[152:153], v[32:33] op_sel_hi:[0,1,1]
    v_pk_fma_f32 v[158:159], v[246:247], v[154:155], v[64:65] op_sel_hi:[0,1,1]
    v_pk_fma_f32 v[152:153], v[240:241], v[152:153], v[156:157] op_sel:[1,1,0] op_sel_hi:[1,0,1] neg_lo:[1,0,0]
    v_pk_fma_f32 v[154:155], v[246:247], v[154:155], v[158:159] op_sel:[1,1,0] op_sel_hi:[1,0,1] neg_lo:[1,0,0]
    v_pk_fma_f32 v[156:157], v[240:241], v[152:153], v[96:97] op_sel_hi:[0,1,1]
    v_pk_fma_f32 v[158:159], v[246:247], v[154:155], v[128:129] op_sel_hi:[0,1,1]
    v_pk_fma_f32 v[152:153], v[240:241], v[152:153], v[156:157] op_sel:[1,1,0] op_sel_hi:[1,0,1] neg_lo:[1,0,0]
    v_pk_fma_f32 v[154:155], v[246:247], v[154:155], v[158:159] op_sel:[1,1,0] op_sel_hi:[1,0,1] neg_lo:[1,0,0]
    v_pk_mul_f32 v[224:225], v[34:35], v[242:243] op_sel_hi:[1,0]
    v_pk_mul_f32 v[226:227], v[34:35], v[242:243] op_sel:[0,1] op_sel_hi:[1,1]
    v_fma_f32 v34, -v243, v98, v224
    v_fma_f32 v35, v242, v98, v226
    v_fma_f32 v98, -v243, v99, v225
    v_fma_f32 v99, v242, v99, v227
    v_pk_mul_f32 v[228:229], v[66:67], v[248:249] op_sel_hi:[1,0]
    v_pk_mul_f32 v[230:231], v[66:67], v[248:249] op_sel:[0,1] op_sel_hi:[1,1]
    v_fma_f32 v66, -v249, v130, v228
    v_fma_f32 v67, v248, v130, v230
    v_fma_f32 v130, -v249, v131, v229
    v_fma_f32 v131, v248, v131, v231
    v_pk_fma_f32 v[156:157], v[240:241], v[152:153], v[34:35] op_sel_hi:[0,1,1]
    v_pk_fma_f32 v[158:159], v[246:247], v[154:155], v[66:67] op_sel_hi:[0,1,1]
    v_pk_fma_f32 v[152:153], v[240:241], v[152:153], v[156:157] op_sel:[1,1,0] op_sel_hi:[1,0,1] neg_lo:[1,0,0]
    v_pk_fma_f32 v[154:155], v[246:247], v[154:155], v[158:159] op_sel:[1,1,0] op_sel_hi:[1,0,1] neg_lo:[1,0,0]
    v_pk_fma_f32 v[156:157], v[240:241], v[152:153], v[98:99] op_sel_hi:[0,1,1]
    v_pk_fma_f32 v[158:159], v[246:247], v[154:155], v[130:131] op_sel_hi:[0,1,1]
    v_pk_fma_f32 v[152:153], v[240:241], v[152:153], v[156:157] op_sel:[1,1,0] op_sel_hi:[1,0,1] neg_lo:[1,0,0]
    v_pk_fma_f32 v[154:155], v[246:247], v[154:155], v[158:159] op_sel:[1,1,0] op_sel_hi:[1,0,1] neg_lo:[1,0,0]
    v_pk_mul_f32 v[224:225], v[36:37], v[242:243] op_sel_hi:[1,0]
    v_pk_mul_f32 v[226:227], v[36:37], v[242:243] op_sel:[0,1] op_sel_hi:[1,1]
    v_fma_f32 v36, -v243, v100, v224
    v_fma_f32 v37, v242, v100, v226
    v_fma_f32 v100, -v243, v101, v225
    v_fma_f32 v101, v242, v101, v227
    v_pk_mul_f32 v[228:229], v[68:69], v[248:249] op_sel_hi:[1,0]
    v_pk_mul_f32 v[230:231], v[68:69], v[248:249] op_sel:[0,1] op_sel_hi:[1,1]
    v_fma_f32 v68, -v249, v132, v228
    v_fma_f32 v69, v248, v132, v230
    v_fma_f32 v132, -v249, v133, v229
    v_fma_f32 v133, v248, v133, v231
    v_pk_fma_f32 v[156:157], v[240:241], v[152:153], v[36:37] op_sel_hi:[0,1,1]
    v_pk_fma_f32 v[158:159], v[246:247], v[154:155], v[68:69] op_sel_hi:[0,1,1]
    v_pk_fma_f32 v[152:153], v[240:241], v[152:153], v[156:157] op_sel:[1,1,0] op_sel_hi:[1,0,1] neg_lo:[1,0,0]
    v_pk_fma_f32 v[154:155], v[246:247], v[154:155], v[158:159] op_sel:[1,1,0] op_sel_hi:[1,0,1] neg_lo:[1,0,0]
    v_pk_fma_f32 v[156:157], v[240:241], v[152:153], v[100:101] op_sel_hi:[0,1,1]
    v_pk_fma_f32 v[158:159], v[246:247], v[154:155], v[132:133] op_sel_hi:[0,1,1]
    v_pk_fma_f32 v[152:153], v[240:241], v[152:153], v[156:157] op_sel:[1,1,0] op_sel_hi:[1,0,1] neg_lo:[1,0,0]
    v_pk_fma_f32 v[154:155], v[246:247], v[154:155], v[158:159] op_sel:[1,1,0] op_sel_hi:[1,0,1] neg_lo:[1,0,0]
    v_pk_mul_f32 v[224:225], v[38:39], v[242:243] op_sel_hi:[1,0]
    v_pk_mul_f32 v[226:227], v[38:39], v[242:243] op_sel:[0,1] op_sel_hi:[1,1]
    v_fma_f32 v38, -v243, v102, v224
    v_fma_f32 v39, v242, v102, v226
    v_fma_f32 v102, -v243, v103, v225
    v_fma_f32 v103, v242, v103, v227
    v_pk_mul_f32 v[228:229], v[70:71], v[248:249] op_sel_hi:[1,0]
    v_pk_mul_f32 v[230:231], v[70:71], v[248:249] op_sel:[0,1] op_sel_hi:[1,1]
    v_fma_f32 v70, -v249, v134, v228
    v_fma_f32 v71, v248, v134, v230
    v_fma_f32 v134, -v249, v135, v229
    v_fma_f32 v135, v248, v135, v231
    v_pk_fma_f32 v[156:157], v[240:241], v[152:153], v[38:39] op_sel_hi:[0,1,1]
    v_pk_fma_f32 v[158:159], v[246:247], v[154:155], v[70:71] op_sel_hi:[0,1,1]
    v_pk_fma_f32 v[152:153], v[240:241], v[152:153], v[156:157] op_sel:[1,1,0] op_sel_hi:[1,0,1] neg_lo:[1,0,0]
    v_pk_fma_f32 v[154:155], v[246:247], v[154:155], v[158:159] op_sel:[1,1,0] op_sel_hi:[1,0,1] neg_lo:[1,0,0]
    v_pk_fma_f32 v[156:157], v[240:241], v[152:153], v[102:103] op_sel_hi:[0,1,1]
    v_pk_fma_f32 v[158:159], v[246:247], v[154:155], v[134:135] op_sel_hi:[0,1,1]
    v_pk_fma_f32 v[152:153], v[240:241], v[152:153], v[156:157] op_sel:[1,1,0] op_sel_hi:[1,0,1] neg_lo:[1,0,0]
    v_pk_fma_f32 v[154:155], v[246:247], v[154:155], v[158:159] op_sel:[1,1,0] op_sel_hi:[1,0,1] neg_lo:[1,0,0]
    v_pk_mul_f32 v[224:225], v[40:41], v[242:243] op_sel_hi:[1,0]
    v_pk_mul_f32 v[226:227], v[40:41], v[242:243] op_sel:[0,1] op_sel_hi:[1,1]
    v_fma_f32 v40, -v243, v104, v224
    v_fma_f32 v41, v242, v104, v226
    v_fma_f32 v104, -v243, v105, v225
    v_fma_f32 v105, v242, v105, v227
    v_pk_mul_f32 v[228:229], v[72:73], v[248:249] op_sel_hi:[1,0]
    v_pk_mul_f32 v[230:231], v[72:73], v[248:249] op_sel:[0,1] op_sel_hi:[1,1]
    v_fma_f32 v72, -v249, v136, v228
    v_fma_f32 v73, v248, v136, v230
    v_fma_f32 v136, -v249, v137, v229
    v_fma_f32 v137, v248, v137, v231
    v_pk_fma_f32 v[156:157], v[240:241], v[152:153], v[40:41] op_sel_hi:[0,1,1]
    v_pk_fma_f32 v[158:159], v[246:247], v[154:155], v[72:73] op_sel_hi:[0,1,1]
    v_pk_fma_f32 v[152:153], v[240:241], v[152:153], v[156:157] op_sel:[1,1,0] op_sel_hi:[1,0,1] neg_lo:[1,0,0]
    v_pk_fma_f32 v[154:155], v[246:247], v[154:155], v[158:159] op_sel:[1,1,0] op_sel_hi:[1,0,1] neg_lo:[1,0,0]
    v_pk_fma_f32 v[156:157], v[240:241], v[152:153], v[104:105] op_sel_hi:[0,1,1]
    v_pk_fma_f32 v[158:159], v[246:247], v[154:155], v[136:137] op_sel_hi:[0,1,1]
    v_pk_fma_f32 v[152:153], v[240:241], v[152:153], v[156:157] op_sel:[1,1,0] op_sel_hi:[1,0,1] neg_lo:[1,0,0]
    v_pk_fma_f32 v[154:155], v[246:247], v[154:155], v[158:159] op_sel:[1,1,0] op_sel_hi:[1,0,1] neg_lo:[1,0,0]
    v_pk_mul_f32 v[224:225], v[42:43], v[242:243] op_sel_hi:[1,0]
    v_pk_mul_f32 v[226:227], v[42:43], v[242:243] op_sel:[0,1] op_sel_hi:[1,1]
    v_fma_f32 v42, -v243, v106, v224
    v_fma_f32 v43, v242, v106, v226
    v_fma_f32 v106, -v243, v107, v225
    v_fma_f32 v107, v242, v107, v227
    v_pk_mul_f32 v[228:229], v[74:75], v[248:249] op_sel_hi:[1,0]
    v_pk_mul_f32 v[230:231], v[74:75], v[248:249] op_sel:[0,1] op_sel_hi:[1,1]
    v_fma_f32 v74, -v249, v138, v228
    v_fma_f32 v75, v248, v138, v230
    v_fma_f32 v138, -v249, v139, v229
    v_fma_f32 v139, v248, v139, v231
    v_pk_fma_f32 v[156:157], v[240:241], v[152:153], v[42:43] op_sel_hi:[0,1,1]
    v_pk_fma_f32 v[158:159], v[246:247], v[154:155], v[74:75] op_sel_hi:[0,1,1]
    v_pk_fma_f32 v[152:153], v[240:241], v[152:153], v[156:157] op_sel:[1,1,0] op_sel_hi:[1,0,1] neg_lo:[1,0,0]
    v_pk_fma_f32 v[154:155], v[246:247], v[154:155], v[158:159] op_sel:[1,1,0] op_sel_hi:[1,0,1] neg_lo:[1,0,0]
    v_pk_fma_f32 v[156:157], v[240:241], v[152:153], v[106:107] op_sel_hi:[0,1,1]
    v_pk_fma_f32 v[158:159], v[246:247], v[154:155], v[138:139] op_sel_hi:[0,1,1]
    v_pk_fma_f32 v[152:153], v[240:241], v[152:153], v[156:157] op_sel:[1,1,0] op_sel_hi:[1,0,1] neg_lo:[1,0,0]
    v_pk_fma_f32 v[154:155], v[246:247], v[154:155], v[158:159] op_sel:[1,1,0] op_sel_hi:[1,0,1] neg_lo:[1,0,0]
    v_pk_mul_f32 v[224:225], v[44:45], v[242:243] op_sel_hi:[1,0]
    v_pk_mul_f32 v[226:227], v[44:45], v[242:243] op_sel:[0,1] op_sel_hi:[1,1]
    v_fma_f32 v44, -v243, v108, v224
    v_fma_f32 v45, v242, v108, v226
    v_fma_f32 v108, -v243, v109, v225
    v_fma_f32 v109, v242, v109, v227
    v_pk_mul_f32 v[228:229], v[76:77], v[248:249] op_sel_hi:[1,0]
    v_pk_mul_f32 v[230:231], v[76:77], v[248:249] op_sel:[0,1] op_sel_hi:[1,1]
    v_fma_f32 v76, -v249, v140, v228
    v_fma_f32 v77, v248, v140, v230
    v_fma_f32 v140, -v249, v141, v229
    v_fma_f32 v141, v248, v141, v231
    v_pk_fma_f32 v[156:157], v[240:241], v[152:153], v[44:45] op_sel_hi:[0,1,1]
    v_pk_fma_f32 v[158:159], v[246:247], v[154:155], v[76:77] op_sel_hi:[0,1,1]
    v_pk_fma_f32 v[152:153], v[240:241], v[152:153], v[156:157] op_sel:[1,1,0] op_sel_hi:[1,0,1] neg_lo:[1,0,0]
    v_pk_fma_f32 v[154:155], v[246:247], v[154:155], v[158:159] op_sel:[1,1,0] op_sel_hi:[1,0,1] neg_lo:[1,0,0]
    v_pk_fma_f32 v[156:157], v[240:241], v[152:153], v[108:109] op_sel_hi:[0,1,1]
    v_pk_fma_f32 v[158:159], v[246:247], v[154:155], v[140:141] op_sel_hi:[0,1,1]
    v_pk_fma_f32 v[152:153], v[240:241], v[152:153], v[156:157] op_sel:[1,1,0] op_sel_hi:[1,0,1] neg_lo:[1,0,0]
    v_pk_fma_f32 v[154:155], v[246:247], v[154:155], v[158:159] op_sel:[1,1,0] op_sel_hi:[1,0,1] neg_lo:[1,0,0]
    v_pk_mul_f32 v[224:225], v[46:47], v[242:243] op_sel_hi:[1,0]
    v_pk_mul_f32 v[226:227], v[46:47], v[242:243] op_sel:[0,1] op_sel_hi:[1,1]
    v_fma_f32 v46, -v243, v110, v224
    v_fma_f32 v47, v242, v110, v226
    v_fma_f32 v110, -v243, v111, v225
    v_fma_f32 v111, v242, v111, v227
    v_pk_mul_f32 v[228:229], v[78:79], v[248:249] op_sel_hi:[1,0]
    v_pk_mul_f32 v[230:231], v[78:79], v[248:249] op_sel:[0,1] op_sel_hi:[1,1]
    v_fma_f32 v78, -v249, v142, v228
    v_fma_f32 v79, v248, v142, v230
    v_fma_f32 v142, -v249, v143, v229
    v_fma_f32 v143, v248, v143, v231
    v_pk_fma_f32 v[156:157], v[240:241], v[152:153], v[46:47] op_sel_hi:[0,1,1]
    v_pk_fma_f32 v[158:159], v[246:247], v[154:155], v[78:79] op_sel_hi:[0,1,1]
    v_pk_fma_f32 v[152:153], v[240:241], v[152:153], v[156:157] op_sel:[1,1,0] op_sel_hi:[1,0,1] neg_lo:[1,0,0]
    v_pk_fma_f32 v[154:155], v[246:247], v[154:155], v[158:159] op_sel:[1,1,0] op_sel_hi:[1,0,1] neg_lo:[1,0,0]
    v_pk_fma_f32 v[156:157], v[240:241], v[152:153], v[110:111] op_sel_hi:[0,1,1]
    v_pk_fma_f32 v[158:159], v[246:247], v[154:155], v[142:143] op_sel_hi:[0,1,1]
    v_pk_fma_f32 v[152:153], v[240:241], v[152:153], v[156:157] op_sel:[1,1,0] op_sel_hi:[1,0,1] neg_lo:[1,0,0]
    v_pk_fma_f32 v[154:155], v[246:247], v[154:155], v[158:159] op_sel:[1,1,0] op_sel_hi:[1,0,1] neg_lo:[1,0,0]
    v_mov_b32 v144, v152
    v_mov_b32 v146, v152
    v_mov_b32 v145, v153
    v_mov_b32 v147, v153
    v_permlane32_swap_b32 v144, v146
    s_nop 0
    v_permlane32_swap_b32 v145, v147
    v_pk_fma_f32 v[156:157], v[2:3], v[144:145], v[146:147] op_sel_hi:[0,1,1]
    v_pk_fma_f32 v[152:153], v[2:3], v[144:145], v[156:157] op_sel:[1,1,0] op_sel_hi:[1,0,1] neg_lo:[1,0,0]
    v_mov_b32 v148, v154
    v_mov_b32 v150, v154
    v_mov_b32 v149, v155
    v_mov_b32 v151, v155
    v_permlane32_swap_b32 v148, v150
    s_nop 0
    v_permlane32_swap_b32 v149, v151
    v_pk_fma_f32 v[158:159], v[4:5], v[148:149], v[150:151] op_sel_hi:[0,1,1]
    v_pk_fma_f32 v[154:155], v[4:5], v[148:149], v[158:159] op_sel:[1,1,0] op_sel_hi:[1,0,1] neg_lo:[1,0,0]
    s_lshl_b32 s74, s44, 1
    s_add_u32 s74, s74, s4
    s_lshl_b32 s77, s45, 1
    s_add_u32 s77, s77, s5
    v_and_b32 v160, 31, v1
    v_lshlrev_b32 v160, 4, v160
    s_lshl_b32 s6, s77, 9
    v_add_u32 v160, s6, v160
    s_mul_i32 s6, s74, 5248
    buffer_store_dwordx4 v[152:155], v160, s[64:67], s6 offen sc1
    s_add_u32 s84, s40, 34656256
    s_addc_u32 s85, s41, 0
    s_mov_b32 s86, 22528
    s_mov_b32 s87, 0x20000
    s_add_u32 s88, s96, 2000
    s_addc_u32 s89, s97, 0
    v_mov_b32 v234, s88
    v_mov_b32 v235, s89
    v_mov_b32 v232, s95
    s_waitcnt vmcnt(0) lgkmcnt(0)
    s_barrier
    s_cmp_lg_u32 s3, 0
    s_cbranch_scc1 pb9
    s_cmp_eq_u32 s95, -1
    s_cbranch_scc1 pb9
    s_mov_b64 s[90:91], exec
    s_mov_b64 exec, 1
    buffer_store_dwordx2 v[234:235], v232, s[84:87], 0 offen sc1
    s_mov_b64 exec, s[90:91]
pb9:
    s_cmp_lg_u32 s3, 0
    s_cbranch_scc1 dw10
    s_add_u32 s84, s40, 34656256
    s_addc_u32 s85, s41, 0
    s_mov_b32 s86, 22528
    s_mov_b32 s87, 0x20000
    s_lshl_b32 s91, s45, 3
    v_add_u32 v234, 48, v1
    v_lshlrev_b32 v228, 7, v234
    v_add_u32 v228, s91, v228
    v_cmp_gt_u32 vcc, s44, v1
    s_nop 1
    s_and_saveexec_b64 s[88:89], vcc
    s_cbranch_execz pd12
    v_mov_b32 v232, s96
    v_mov_b32 v233, s97
    s_mov_b32 s90, 0
pl11:
    buffer_load_dwordx2 v[230:231], v228, s[84:87], 0 offen sc1
    s_waitcnt vmcnt(0)
    v_sub_co_u32 v230, vcc, v230, v232
    s_nop 1
    v_subb_co_u32 v231, vcc, v231, v233, vcc
    v_cmp_eq_u32 s[92:93], 0, v231
    s_mov_b32 s91, 16777216
    v_cmp_gt_u32 vcc, s91, v230
    s_nop 1
    s_and_b64 vcc, vcc, s[92:93]
    s_cmp_eq_u64 vcc, exec
    s_cbranch_scc1 pd12
    s_add_u32 s90, s90, 1
    s_cmp_lt_u32 s90, 262144
    s_cbranch_scc1 pl11
pd12:
    s_waitcnt vmcnt(0)
    s_mov_b64 exec, s[88:89]
dw10:
    s_barrier
    v_lshrrev_b32 v161, 5, v1
    v_lshlrev_b32 v161, 4, v161
    s_sub_u32 s75, s74, 32
    v_add_u32 v161, s75, v161
    s_movk_i32 s76, 5248
    v_mul_lo_u32 v161, v161, s76
    v_add_u32 v161, v161, v160
    v_add_u32 v162, 0, v161
    buffer_load_dwordx4 v[164:167], v162, s[64:67], 0 offen
    v_add_u32 v163, 5248, v161
    buffer_load_dwordx4 v[168:171], v163, s[64:67], 0 offen
    v_add_u32 v162, 10496, v161
    buffer_load_dwordx4 v[172:175], v162, s[64:67], 0 offen
    v_add_u32 v163, 15744, v161
    buffer_load_dwordx4 v[176:179], v163, s[64:67], 0 offen
    v_add_u32 v162, 20992, v161
    buffer_load_dwordx4 v[180:183], v162, s[64:67], 0 offen
    v_add_u32 v163, 26240, v161
    buffer_load_dwordx4 v[184:187], v163, s[64:67], 0 offen
    v_add_u32 v162, 31488, v161
    buffer_load_dwordx4 v[188:191], v162, s[64:67], 0 offen
    v_add_u32 v163, 36736, v161
    buffer_load_dwordx4 v[192:195], v163, s[64:67], 0 offen
    v_add_u32 v162, 41984, v161
    buffer_load_dwordx4 v[196:199], v162, s[64:67], 0 offen
    v_add_u32 v163, 47232, v161
    buffer_load_dwordx4 v[200:203], v163, s[64:67], 0 offen
    v_add_u32 v162, 52480, v161
    buffer_load_dwordx4 v[204:207], v162, s[64:67], 0 offen
    v_add_u32 v163, 57728, v161
    buffer_load_dwordx4 v[208:211], v163, s[64:67], 0 offen
    v_add_u32 v162, 62976, v161
    buffer_load_dwordx4 v[212:215], v162, s[64:67], 0 offen
    v_add_u32 v163, 68224, v161
    buffer_load_dwordx4 v[216:219], v163, s[64:67], 0 offen
    v_add_u32 v162, 73472, v161
    buffer_load_dwordx4 v[220:223], v162, s[64:67], 0 offen
    v_add_u32 v163, 78720, v161
    buffer_load_dwordx4 v[224:227], v163, s[64:67], 0 offen
    v_and_b32 v162, 31, v1
    s_lshl_b32 s7, s5, 6
    v_add_u32 v162, s7, v162
    v_lshrrev_b32 v163, 2, v162
    v_and_b32 v162, 3, v162
    v_lshlrev_b32 v162, 2, v162
    v_lshrrev_b32 v161, 5, v1
    v_lshlrev_b32 v161, 5, v161
    s_lshl_b32 s7, s4, 6
    v_add_u32 v161, s7, v161
    v_lshl_add_u32 v162, v161, 9, v162
    v_xor_b32 v236, 0, v163
    v_lshl_add_u32 v236, v236, 4, v162
    v_xor_b32 v237, 1, v163
    v_lshl_add_u32 v237, v237, 4, v162
    v_xor_b32 v238, 2, v163
    v_lshl_add_u32 v238, v238, 4, v162
    v_xor_b32 v239, 3, v163
    v_lshl_add_u32 v239, v239, 4, v162
    v_xor_b32 v242, 4, v163
    v_lshl_add_u32 v242, v242, 4, v162
    v_xor_b32 v243, 5, v163
    v_lshl_add_u32 v243, v243, 4, v162
    v_xor_b32 v244, 6, v163
    v_lshl_add_u32 v244, v244, 4, v162
    v_xor_b32 v245, 7, v163
    v_lshl_add_u32 v245, v245, 4, v162
    s_waitcnt vmcnt(15)
    v_mov_b32 v152, v164
    v_mov_b32 v153, v165
    v_mov_b32 v154, v166
    v_mov_b32 v155, v167
    s_waitcnt vmcnt(14)
    v_pk_fma_f32 v[156:157], v[6:7], v[152:153], v[168:169] op_sel_hi:[0,1,1]
    v_pk_fma_f32 v[158:159], v[8:9], v[154:155], v[170:171] op_sel_hi:[0,1,1]
    v_pk_fma_f32 v[152:153], v[6:7], v[152:153], v[156:157] op_sel:[1,1,0] op_sel_hi:[1,0,1] neg_lo:[1,0,0]
    v_pk_fma_f32 v[154:155], v[8:9], v[154:155], v[158:159] op_sel:[1,1,0] op_sel_hi:[1,0,1] neg_lo:[1,0,0]
    s_waitcnt vmcnt(13)
    v_pk_fma_f32 v[156:157], v[6:7], v[152:153], v[172:173] op_sel_hi:[0,1,1]
    v_pk_fma_f32 v[158:159], v[8:9], v[154:155], v[174:175] op_sel_hi:[0,1,1]
    v_pk_fma_f32 v[152:153], v[6:7], v[152:153], v[156:157] op_sel:[1,1,0] op_sel_hi:[1,0,1] neg_lo:[1,0,0]
    v_pk_fma_f32 v[154:155], v[8:9], v[154:155], v[158:159] op_sel:[1,1,0] op_sel_hi:[1,0,1] neg_lo:[1,0,0]
    s_waitcnt vmcnt(12)
    v_pk_fma_f32 v[156:157], v[6:7], v[152:153], v[176:177] op_sel_hi:[0,1,1]
    v_pk_fma_f32 v[158:159], v[8:9], v[154:155], v[178:179] op_sel_hi:[0,1,1]
    v_pk_fma_f32 v[152:153], v[6:7], v[152:153], v[156:157] op_sel:[1,1,0] op_sel_hi:[1,0,1] neg_lo:[1,0,0]
    v_pk_fma_f32 v[154:155], v[8:9], v[154:155], v[158:159] op_sel:[1,1,0] op_sel_hi:[1,0,1] neg_lo:[1,0,0]
    s_waitcnt vmcnt(11)
    v_pk_fma_f32 v[156:157], v[6:7], v[152:153], v[180:181] op_sel_hi:[0,1,1]
    v_pk_fma_f32 v[158:159], v[8:9], v[154:155], v[182:183] op_sel_hi:[0,1,1]
    v_pk_fma_f32 v[152:153], v[6:7], v[152:153], v[156:157] op_sel:[1,1,0] op_sel_hi:[1,0,1] neg_lo:[1,0,0]
    v_pk_fma_f32 v[154:155], v[8:9], v[154:155], v[158:159] op_sel:[1,1,0] op_sel_hi:[1,0,1] neg_lo:[1,0,0]
    s_waitcnt vmcnt(10)
    v_pk_fma_f32 v[156:157], v[6:7], v[152:153], v[184:185] op_sel_hi:[0,1,1]
    v_pk_fma_f32 v[158:159], v[8:9], v[154:155], v[186:187] op_sel_hi:[0,1,1]
    v_pk_fma_f32 v[152:153], v[6:7], v[152:153], v[156:157] op_sel:[1,1,0] op_sel_hi:[1,0,1] neg_lo:[1,0,0]
    v_pk_fma_f32 v[154:155], v[8:9], v[154:155], v[158:159] op_sel:[1,1,0] op_sel_hi:[1,0,1] neg_lo:[1,0,0]
    s_waitcnt vmcnt(9)
    v_pk_fma_f32 v[156:157], v[6:7], v[152:153], v[188:189] op_sel_hi:[0,1,1]
    v_pk_fma_f32 v[158:159], v[8:9], v[154:155], v[190:191] op_sel_hi:[0,1,1]
    v_pk_fma_f32 v[152:153], v[6:7], v[152:153], v[156:157] op_sel:[1,1,0] op_sel_hi:[1,0,1] neg_lo:[1,0,0]
    v_pk_fma_f32 v[154:155], v[8:9], v[154:155], v[158:159] op_sel:[1,1,0] op_sel_hi:[1,0,1] neg_lo:[1,0,0]
    s_waitcnt vmcnt(8)
    v_pk_fma_f32 v[156:157], v[6:7], v[152:153], v[192:193] op_sel_hi:[0,1,1]
    v_pk_fma_f32 v[158:159], v[8:9], v[154:155], v[194:195] op_sel_hi:[0,1,1]
    v_pk_fma_f32 v[152:153], v[6:7], v[152:153], v[156:157] op_sel:[1,1,0] op_sel_hi:[1,0,1] neg_lo:[1,0,0]
    v_pk_fma_f32 v[154:155], v[8:9], v[154:155], v[158:159] op_sel:[1,1,0] op_sel_hi:[1,0,1] neg_lo:[1,0,0]
    s_waitcnt vmcnt(7)
    v_pk_fma_f32 v[156:157], v[6:7], v[152:153], v[196:197] op_sel_hi:[0,1,1]
    v_pk_fma_f32 v[158:159], v[8:9], v[154:155], v[198:199] op_sel_hi:[0,1,1]
    v_pk_fma_f32 v[152:153], v[6:7], v[152:153], v[156:157] op_sel:[1,1,0] op_sel_hi:[1,0,1] neg_lo:[1,0,0]
    v_pk_fma_f32 v[154:155], v[8:9], v[154:155], v[158:159] op_sel:[1,1,0] op_sel_hi:[1,0,1] neg_lo:[1,0,0]
    s_waitcnt vmcnt(6)
    v_pk_fma_f32 v[156:157], v[6:7], v[152:153], v[200:201] op_sel_hi:[0,1,1]
    v_pk_fma_f32 v[158:159], v[8:9], v[154:155], v[202:203] op_sel_hi:[0,1,1]
    v_pk_fma_f32 v[152:153], v[6:7], v[152:153], v[156:157] op_sel:[1,1,0] op_sel_hi:[1,0,1] neg_lo:[1,0,0]
    v_pk_fma_f32 v[154:155], v[8:9], v[154:155], v[158:159] op_sel:[1,1,0] op_sel_hi:[1,0,1] neg_lo:[1,0,0]
    s_waitcnt vmcnt(5)
    v_pk_fma_f32 v[156:157], v[6:7], v[152:153], v[204:205] op_sel_hi:[0,1,1]
    v_pk_fma_f32 v[158:159], v[8:9], v[154:155], v[206:207] op_sel_hi:[0,1,1]
    v_pk_fma_f32 v[152:153], v[6:7], v[152:153], v[156:157] op_sel:[1,1,0] op_sel_hi:[1,0,1] neg_lo:[1,0,0]
    v_pk_fma_f32 v[154:155], v[8:9], v[154:155], v[158:159] op_sel:[1,1,0] op_sel_hi:[1,0,1] neg_lo:[1,0,0]
    s_waitcnt vmcnt(4)
    v_pk_fma_f32 v[156:157], v[6:7], v[152:153], v[208:209] op_sel_hi:[0,1,1]
    v_pk_fma_f32 v[158:159], v[8:9], v[154:155], v[210:211] op_sel_hi:[0,1,1]
    v_pk_fma_f32 v[152:153], v[6:7], v[152:153], v[156:157] op_sel:[1,1,0] op_sel_hi:[1,0,1] neg_lo:[1,0,0]
    v_pk_fma_f32 v[154:155], v[8:9], v[154:155], v[158:159] op_sel:[1,1,0] op_sel_hi:[1,0,1] neg_lo:[1,0,0]
    s_waitcnt vmcnt(3)
    v_pk_fma_f32 v[156:157], v[6:7], v[152:153], v[212:213] op_sel_hi:[0,1,1]
    v_pk_fma_f32 v[158:159], v[8:9], v[154:155], v[214:215] op_sel_hi:[0,1,1]
    v_pk_fma_f32 v[152:153], v[6:7], v[152:153], v[156:157] op_sel:[1,1,0] op_sel_hi:[1,0,1] neg_lo:[1,0,0]
    v_pk_fma_f32 v[154:155], v[8:9], v[154:155], v[158:159] op_sel:[1,1,0] op_sel_hi:[1,0,1] neg_lo:[1,0,0]
    s_waitcnt vmcnt(2)
    v_pk_fma_f32 v[156:157], v[6:7], v[152:153], v[216:217] op_sel_hi:[0,1,1]
    v_pk_fma_f32 v[158:159], v[8:9], v[154:155], v[218:219] op_sel_hi:[0,1,1]
    v_pk_fma_f32 v[152:153], v[6:7], v[152:153], v[156:157] op_sel:[1,1,0] op_sel_hi:[1,0,1] neg_lo:[1,0,0]
    v_pk_fma_f32 v[154:155], v[8:9], v[154:155], v[158:159] op_sel:[1,1,0] op_sel_hi:[1,0,1] neg_lo:[1,0,0]
    s_waitcnt vmcnt(1)
    v_pk_fma_f32 v[156:157], v[6:7], v[152:153], v[220:221] op_sel_hi:[0,1,1]
    v_pk_fma_f32 v[158:159], v[8:9], v[154:155], v[222:223] op_sel_hi:[0,1,1]
    v_pk_fma_f32 v[152:153], v[6:7], v[152:153], v[156:157] op_sel:[1,1,0] op_sel_hi:[1,0,1] neg_lo:[1,0,0]
    v_pk_fma_f32 v[154:155], v[8:9], v[154:155], v[158:159] op_sel:[1,1,0] op_sel_hi:[1,0,1] neg_lo:[1,0,0]
    s_waitcnt vmcnt(0)
    v_pk_fma_f32 v[156:157], v[6:7], v[152:153], v[224:225] op_sel_hi:[0,1,1]
    v_pk_fma_f32 v[158:159], v[8:9], v[154:155], v[226:227] op_sel_hi:[0,1,1]
    v_pk_fma_f32 v[152:153], v[6:7], v[152:153], v[156:157] op_sel:[1,1,0] op_sel_hi:[1,0,1] neg_lo:[1,0,0]
    v_pk_fma_f32 v[154:155], v[8:9], v[154:155], v[158:159] op_sel:[1,1,0] op_sel_hi:[1,0,1] neg_lo:[1,0,0]
    v_mov_b32 v228, v152
    v_mov_b32 v230, v152
    v_mov_b32 v229, v153
    v_mov_b32 v231, v153
    v_permlane32_swap_b32 v228, v230
    s_nop 0
    v_permlane32_swap_b32 v229, v231
    v_pk_fma_f32 v[156:157], v[10:11], v[228:229], v[230:231] op_sel_hi:[0,1,1]
    v_pk_fma_f32 v[152:153], v[10:11], v[228:229], v[156:157] op_sel:[1,1,0] op_sel_hi:[1,0,1] neg_lo:[1,0,0]
    v_pk_fma_f32 v[156:157], v[2:3], v[152:153], v[144:145] op_sel_hi:[0,1,1]
    v_pk_fma_f32 v[228:229], v[2:3], v[152:153], v[156:157] op_sel:[1,1,0] op_sel_hi:[1,0,1] neg_lo:[1,0,0]
    v_cmp_gt_u32 vcc, 32, v1
    s_nop 1
    v_cndmask_b32 v152, v228, v152, vcc
    v_cndmask_b32 v153, v229, v153, vcc
    v_mov_b32 v228, v154
    v_mov_b32 v230, v154
    v_mov_b32 v229, v155
    v_mov_b32 v231, v155
    v_permlane32_swap_b32 v228, v230
    s_nop 0
    v_permlane32_swap_b32 v229, v231
    v_pk_fma_f32 v[158:159], v[12:13], v[228:229], v[230:231] op_sel_hi:[0,1,1]
    v_pk_fma_f32 v[154:155], v[12:13], v[228:229], v[158:159] op_sel:[1,1,0] op_sel_hi:[1,0,1] neg_lo:[1,0,0]
    v_pk_fma_f32 v[158:159], v[4:5], v[154:155], v[148:149] op_sel_hi:[0,1,1]
    v_pk_fma_f32 v[228:229], v[4:5], v[154:155], v[158:159] op_sel:[1,1,0] op_sel_hi:[1,0,1] neg_lo:[1,0,0]
    v_cmp_gt_u32 vcc, 32, v1
    s_nop 1
    v_cndmask_b32 v154, v228, v154, vcc
    v_cndmask_b32 v155, v229, v155, vcc
    v_pk_fma_f32 v[156:157], v[240:241], v[152:153], v[16:17] op_sel_hi:[0,1,1]
    v_pk_fma_f32 v[158:159], v[246:247], v[154:155], v[48:49] op_sel_hi:[0,1,1]
    v_pk_fma_f32 v[152:153], v[240:241], v[152:153], v[156:157] op_sel:[1,1,0] op_sel_hi:[1,0,1] neg_lo:[1,0,0]
    v_pk_fma_f32 v[154:155], v[246:247], v[154:155], v[158:159] op_sel:[1,1,0] op_sel_hi:[1,0,1] neg_lo:[1,0,0]
    v_cvt_pk_bf16_f32 v232, v152, v153
    ds_write_b32 v236, v232 offset:0
    v_cvt_pk_bf16_f32 v233, v154, v155
    ds_write_b32 v236, v233 offset:128
    v_pk_fma_f32 v[156:157], v[240:241], v[152:153], v[80:81] op_sel_hi:[0,1,1]
    v_pk_fma_f32 v[158:159], v[246:247], v[154:155], v[112:113] op_sel_hi:[0,1,1]
    v_pk_fma_f32 v[152:153], v[240:241], v[152:153], v[156:157] op_sel:[1,1,0] op_sel_hi:[1,0,1] neg_lo:[1,0,0]
    v_pk_fma_f32 v[154:155], v[246:247], v[154:155], v[158:159] op_sel:[1,1,0] op_sel_hi:[1,0,1] neg_lo:[1,0,0]
    v_cvt_pk_bf16_f32 v234, v152, v153
    ds_write_b32 v237, v234 offset:512
    v_cvt_pk_bf16_f32 v235, v154, v155
    ds_write_b32 v237, v235 offset:640
    v_pk_fma_f32 v[156:157], v[240:241], v[152:153], v[18:19] op_sel_hi:[0,1,1]
    v_pk_fma_f32 v[158:159], v[246:247], v[154:155], v[50:51] op_sel_hi:[0,1,1]
    v_pk_fma_f32 v[152:153], v[240:241], v[152:153], v[156:157] op_sel:[1,1,0] op_sel_hi:[1,0,1] neg_lo:[1,0,0]
    v_pk_fma_f32 v[154:155], v[246:247], v[154:155], v[158:159] op_sel:[1,1,0] op_sel_hi:[1,0,1] neg_lo:[1,0,0]
    v_cvt_pk_bf16_f32 v232, v152, v153
    ds_write_b32 v238, v232 offset:1024
    v_cvt_pk_bf16_f32 v233, v154, v155
    ds_write_b32 v238, v233 offset:1152
    v_pk_fma_f32 v[156:157], v[240:241], v[152:153], v[82:83] op_sel_hi:[0,1,1]
    v_pk_fma_f32 v[158:159], v[246:247], v[154:155], v[114:115] op_sel_hi:[0,1,1]
    v_pk_fma_f32 v[152:153], v[240:241], v[152:153], v[156:157] op_sel:[1,1,0] op_sel_hi:[1,0,1] neg_lo:[1,0,0]
    v_pk_fma_f32 v[154:155], v[246:247], v[154:155], v[158:159] op_sel:[1,1,0] op_sel_hi:[1,0,1] neg_lo:[1,0,0]
    v_cvt_pk_bf16_f32 v234, v152, v153
    ds_write_b32 v239, v234 offset:1536
    v_cvt_pk_bf16_f32 v235, v154, v155
    ds_write_b32 v239, v235 offset:1664
    v_pk_fma_f32 v[156:157], v[240:241], v[152:153], v[20:21] op_sel_hi:[0,1,1]
    v_pk_fma_f32 v[158:159], v[246:247], v[154:155], v[52:53] op_sel_hi:[0,1,1]
    v_pk_fma_f32 v[152:153], v[240:241], v[152:153], v[156:157] op_sel:[1,1,0] op_sel_hi:[1,0,1] neg_lo:[1,0,0]
    v_pk_fma_f32 v[154:155], v[246:247], v[154:155], v[158:159] op_sel:[1,1,0] op_sel_hi:[1,0,1] neg_lo:[1,0,0]
    v_cvt_pk_bf16_f32 v232, v152, v153
    ds_write_b32 v242, v232 offset:2048
    v_cvt_pk_bf16_f32 v233, v154, v155
    ds_write_b32 v242, v233 offset:2176
    v_pk_fma_f32 v[156:157], v[240:241], v[152:153], v[84:85] op_sel_hi:[0,1,1]
    v_pk_fma_f32 v[158:159], v[246:247], v[154:155], v[116:117] op_sel_hi:[0,1,1]
    v_pk_fma_f32 v[152:153], v[240:241], v[152:153], v[156:157] op_sel:[1,1,0] op_sel_hi:[1,0,1] neg_lo:[1,0,0]
    v_pk_fma_f32 v[154:155], v[246:247], v[154:155], v[158:159] op_sel:[1,1,0] op_sel_hi:[1,0,1] neg_lo:[1,0,0]
    v_cvt_pk_bf16_f32 v234, v152, v153
    ds_write_b32 v243, v234 offset:2560
    v_cvt_pk_bf16_f32 v235, v154, v155
    ds_write_b32 v243, v235 offset:2688
    v_pk_fma_f32 v[156:157], v[240:241], v[152:153], v[22:23] op_sel_hi:[0,1,1]
    v_pk_fma_f32 v[158:159], v[246:247], v[154:155], v[54:55] op_sel_hi:[0,1,1]
    v_pk_fma_f32 v[152:153], v[240:241], v[152:153], v[156:157] op_sel:[1,1,0] op_sel_hi:[1,0,1] neg_lo:[1,0,0]
    v_pk_fma_f32 v[154:155], v[246:247], v[154:155], v[158:159] op_sel:[1,1,0] op_sel_hi:[1,0,1] neg_lo:[1,0,0]
    v_cvt_pk_bf16_f32 v232, v152, v153
    ds_write_b32 v244, v232 offset:3072
    v_cvt_pk_bf16_f32 v233, v154, v155
    ds_write_b32 v244, v233 offset:3200
    v_pk_fma_f32 v[156:157], v[240:241], v[152:153], v[86:87] op_sel_hi:[0,1,1]
    v_pk_fma_f32 v[158:159], v[246:247], v[154:155], v[118:119] op_sel_hi:[0,1,1]
    v_pk_fma_f32 v[152:153], v[240:241], v[152:153], v[156:157] op_sel:[1,1,0] op_sel_hi:[1,0,1] neg_lo:[1,0,0]
    v_pk_fma_f32 v[154:155], v[246:247], v[154:155], v[158:159] op_sel:[1,1,0] op_sel_hi:[1,0,1] neg_lo:[1,0,0]
    v_cvt_pk_bf16_f32 v234, v152, v153
    ds_write_b32 v245, v234 offset:3584
    v_cvt_pk_bf16_f32 v235, v154, v155
    ds_write_b32 v245, v235 offset:3712
    v_pk_fma_f32 v[156:157], v[240:241], v[152:153], v[24:25] op_sel_hi:[0,1,1]
    v_pk_fma_f32 v[158:159], v[246:247], v[154:155], v[56:57] op_sel_hi:[0,1,1]
    v_pk_fma_f32 v[152:153], v[240:241], v[152:153], v[156:157] op_sel:[1,1,0] op_sel_hi:[1,0,1] neg_lo:[1,0,0]
    v_pk_fma_f32 v[154:155], v[246:247], v[154:155], v[158:159] op_sel:[1,1,0] op_sel_hi:[1,0,1] neg_lo:[1,0,0]
    v_cvt_pk_bf16_f32 v232, v152, v153
    ds_write_b32 v236, v232 offset:4096
    v_cvt_pk_bf16_f32 v233, v154, v155
    ds_write_b32 v236, v233 offset:4224
    v_pk_fma_f32 v[156:157], v[240:241], v[152:153], v[88:89] op_sel_hi:[0,1,1]
    v_pk_fma_f32 v[158:159], v[246:247], v[154:155], v[120:121] op_sel_hi:[0,1,1]
    v_pk_fma_f32 v[152:153], v[240:241], v[152:153], v[156:157] op_sel:[1,1,0] op_sel_hi:[1,0,1] neg_lo:[1,0,0]
    v_pk_fma_f32 v[154:155], v[246:247], v[154:155], v[158:159] op_sel:[1,1,0] op_sel_hi:[1,0,1] neg_lo:[1,0,0]
    v_cvt_pk_bf16_f32 v234, v152, v153
    ds_write_b32 v237, v234 offset:4608
    v_cvt_pk_bf16_f32 v235, v154, v155
    ds_write_b32 v237, v235 offset:4736
    v_pk_fma_f32 v[156:157], v[240:241], v[152:153], v[26:27] op_sel_hi:[0,1,1]
    v_pk_fma_f32 v[158:159], v[246:247], v[154:155], v[58:59] op_sel_hi:[0,1,1]
    v_pk_fma_f32 v[152:153], v[240:241], v[152:153], v[156:157] op_sel:[1,1,0] op_sel_hi:[1,0,1] neg_lo:[1,0,0]
    v_pk_fma_f32 v[154:155], v[246:247], v[154:155], v[158:159] op_sel:[1,1,0] op_sel_hi:[1,0,1] neg_lo:[1,0,0]
    v_cvt_pk_bf16_f32 v232, v152, v153
    ds_write_b32 v238, v232 offset:5120
    v_cvt_pk_bf16_f32 v233, v154, v155
    ds_write_b32 v238, v233 offset:5248
    v_pk_fma_f32 v[156:157], v[240:241], v[152:153], v[90:91] op_sel_hi:[0,1,1]
    v_pk_fma_f32 v[158:159], v[246:247], v[154:155], v[122:123] op_sel_hi:[0,1,1]
    v_pk_fma_f32 v[152:153], v[240:241], v[152:153], v[156:157] op_sel:[1,1,0] op_sel_hi:[1,0,1] neg_lo:[1,0,0]
    v_pk_fma_f32 v[154:155], v[246:247], v[154:155], v[158:159] op_sel:[1,1,0] op_sel_hi:[1,0,1] neg_lo:[1,0,0]
    v_cvt_pk_bf16_f32 v234, v152, v153
    ds_write_b32 v239, v234 offset:5632
    v_cvt_pk_bf16_f32 v235, v154, v155
    ds_write_b32 v239, v235 offset:5760
    v_pk_fma_f32 v[156:157], v[240:241], v[152:153], v[28:29] op_sel_hi:[0,1,1]
    v_pk_fma_f32 v[158:159], v[246:247], v[154:155], v[60:61] op_sel_hi:[0,1,1]
    v_pk_fma_f32 v[152:153], v[240:241], v[152:153], v[156:157] op_sel:[1,1,0] op_sel_hi:[1,0,1] neg_lo:[1,0,0]
    v_pk_fma_f32 v[154:155], v[246:247], v[154:155], v[158:159] op_sel:[1,1,0] op_sel_hi:[1,0,1] neg_lo:[1,0,0]
    v_cvt_pk_bf16_f32 v232, v152, v153
    ds_write_b32 v242, v232 offset:6144
    v_cvt_pk_bf16_f32 v233, v154, v155
    ds_write_b32 v242, v233 offset:6272
    v_pk_fma_f32 v[156:157], v[240:241], v[152:153], v[92:93] op_sel_hi:[0,1,1]
    v_pk_fma_f32 v[158:159], v[246:247], v[154:155], v[124:125] op_sel_hi:[0,1,1]
    v_pk_fma_f32 v[152:153], v[240:241], v[152:153], v[156:157] op_sel:[1,1,0] op_sel_hi:[1,0,1] neg_lo:[1,0,0]
    v_pk_fma_f32 v[154:155], v[246:247], v[154:155], v[158:159] op_sel:[1,1,0] op_sel_hi:[1,0,1] neg_lo:[1,0,0]
    v_cvt_pk_bf16_f32 v234, v152, v153
    ds_write_b32 v243, v234 offset:6656
    v_cvt_pk_bf16_f32 v235, v154, v155
    ds_write_b32 v243, v235 offset:6784
    v_pk_fma_f32 v[156:157], v[240:241], v[152:153], v[30:31] op_sel_hi:[0,1,1]
    v_pk_fma_f32 v[158:159], v[246:247], v[154:155], v[62:63] op_sel_hi:[0,1,1]
    v_pk_fma_f32 v[152:153], v[240:241], v[152:153], v[156:157] op_sel:[1,1,0] op_sel_hi:[1,0,1] neg_lo:[1,0,0]
    v_pk_fma_f32 v[154:155], v[246:247], v[154:155], v[158:159] op_sel:[1,1,0] op_sel_hi:[1,0,1] neg_lo:[1,0,0]
    v_cvt_pk_bf16_f32 v232, v152, v153
    ds_write_b32 v244, v232 offset:7168
    v_cvt_pk_bf16_f32 v233, v154, v155
    ds_write_b32 v244, v233 offset:7296
    v_pk_fma_f32 v[156:157], v[240:241], v[152:153], v[94:95] op_sel_hi:[0,1,1]
    v_pk_fma_f32 v[158:159], v[246:247], v[154:155], v[126:127] op_sel_hi:[0,1,1]
    v_pk_fma_f32 v[152:153], v[240:241], v[152:153], v[156:157] op_sel:[1,1,0] op_sel_hi:[1,0,1] neg_lo:[1,0,0]
    v_pk_fma_f32 v[154:155], v[246:247], v[154:155], v[158:159] op_sel:[1,1,0] op_sel_hi:[1,0,1] neg_lo:[1,0,0]
    v_cvt_pk_bf16_f32 v234, v152, v153
    ds_write_b32 v245, v234 offset:7680
    v_cvt_pk_bf16_f32 v235, v154, v155
    ds_write_b32 v245, v235 offset:7808
    v_pk_fma_f32 v[156:157], v[240:241], v[152:153], v[32:33] op_sel_hi:[0,1,1]
    v_pk_fma_f32 v[158:159], v[246:247], v[154:155], v[64:65] op_sel_hi:[0,1,1]
    v_pk_fma_f32 v[152:153], v[240:241], v[152:153], v[156:157] op_sel:[1,1,0] op_sel_hi:[1,0,1] neg_lo:[1,0,0]
    v_pk_fma_f32 v[154:155], v[246:247], v[154:155], v[158:159] op_sel:[1,1,0] op_sel_hi:[1,0,1] neg_lo:[1,0,0]
    v_cvt_pk_bf16_f32 v232, v152, v153
    ds_write_b32 v236, v232 offset:8192
    v_cvt_pk_bf16_f32 v233, v154, v155
    ds_write_b32 v236, v233 offset:8320
    v_pk_fma_f32 v[156:157], v[240:241], v[152:153], v[96:97] op_sel_hi:[0,1,1]
    v_pk_fma_f32 v[158:159], v[246:247], v[154:155], v[128:129] op_sel_hi:[0,1,1]
    v_pk_fma_f32 v[152:153], v[240:241], v[152:153], v[156:157] op_sel:[1,1,0] op_sel_hi:[1,0,1] neg_lo:[1,0,0]
    v_pk_fma_f32 v[154:155], v[246:247], v[154:155], v[158:159] op_sel:[1,1,0] op_sel_hi:[1,0,1] neg_lo:[1,0,0]
    v_cvt_pk_bf16_f32 v234, v152, v153
    ds_write_b32 v237, v234 offset:8704
    v_cvt_pk_bf16_f32 v235, v154, v155
    ds_write_b32 v237, v235 offset:8832
    v_pk_fma_f32 v[156:157], v[240:241], v[152:153], v[34:35] op_sel_hi:[0,1,1]
    v_pk_fma_f32 v[158:159], v[246:247], v[154:155], v[66:67] op_sel_hi:[0,1,1]
    v_pk_fma_f32 v[152:153], v[240:241], v[152:153], v[156:157] op_sel:[1,1,0] op_sel_hi:[1,0,1] neg_lo:[1,0,0]
    v_pk_fma_f32 v[154:155], v[246:247], v[154:155], v[158:159] op_sel:[1,1,0] op_sel_hi:[1,0,1] neg_lo:[1,0,0]
    v_cvt_pk_bf16_f32 v232, v152, v153
    ds_write_b32 v238, v232 offset:9216
    v_cvt_pk_bf16_f32 v233, v154, v155
    ds_write_b32 v238, v233 offset:9344
    v_pk_fma_f32 v[156:157], v[240:241], v[152:153], v[98:99] op_sel_hi:[0,1,1]
    v_pk_fma_f32 v[158:159], v[246:247], v[154:155], v[130:131] op_sel_hi:[0,1,1]
    v_pk_fma_f32 v[152:153], v[240:241], v[152:153], v[156:157] op_sel:[1,1,0] op_sel_hi:[1,0,1] neg_lo:[1,0,0]
    v_pk_fma_f32 v[154:155], v[246:247], v[154:155], v[158:159] op_sel:[1,1,0] op_sel_hi:[1,0,1] neg_lo:[1,0,0]
    v_cvt_pk_bf16_f32 v234, v152, v153
    ds_write_b32 v239, v234 offset:9728
    v_cvt_pk_bf16_f32 v235, v154, v155
    ds_write_b32 v239, v235 offset:9856
    v_pk_fma_f32 v[156:157], v[240:241], v[152:153], v[36:37] op_sel_hi:[0,1,1]
    v_pk_fma_f32 v[158:159], v[246:247], v[154:155], v[68:69] op_sel_hi:[0,1,1]
    v_pk_fma_f32 v[152:153], v[240:241], v[152:153], v[156:157] op_sel:[1,1,0] op_sel_hi:[1,0,1] neg_lo:[1,0,0]
    v_pk_fma_f32 v[154:155], v[246:247], v[154:155], v[158:159] op_sel:[1,1,0] op_sel_hi:[1,0,1] neg_lo:[1,0,0]
    v_cvt_pk_bf16_f32 v232, v152, v153
    ds_write_b32 v242, v232 offset:10240
    v_cvt_pk_bf16_f32 v233, v154, v155
    ds_write_b32 v242, v233 offset:10368
    v_pk_fma_f32 v[156:157], v[240:241], v[152:153], v[100:101] op_sel_hi:[0,1,1]
    v_pk_fma_f32 v[158:159], v[246:247], v[154:155], v[132:133] op_sel_hi:[0,1,1]
    v_pk_fma_f32 v[152:153], v[240:241], v[152:153], v[156:157] op_sel:[1,1,0] op_sel_hi:[1,0,1] neg_lo:[1,0,0]
    v_pk_fma_f32 v[154:155], v[246:247], v[154:155], v[158:159] op_sel:[1,1,0] op_sel_hi:[1,0,1] neg_lo:[1,0,0]
    v_cvt_pk_bf16_f32 v234, v152, v153
    ds_write_b32 v243, v234 offset:10752
    v_cvt_pk_bf16_f32 v235, v154, v155
    ds_write_b32 v243, v235 offset:10880
    v_pk_fma_f32 v[156:157], v[240:241], v[152:153], v[38:39] op_sel_hi:[0,1,1]
    v_pk_fma_f32 v[158:159], v[246:247], v[154:155], v[70:71] op_sel_hi:[0,1,1]
    v_pk_fma_f32 v[152:153], v[240:241], v[152:153], v[156:157] op_sel:[1,1,0] op_sel_hi:[1,0,1] neg_lo:[1,0,0]
    v_pk_fma_f32 v[154:155], v[246:247], v[154:155], v[158:159] op_sel:[1,1,0] op_sel_hi:[1,0,1] neg_lo:[1,0,0]
    v_cvt_pk_bf16_f32 v232, v152, v153
    ds_write_b32 v244, v232 offset:11264
    v_cvt_pk_bf16_f32 v233, v154, v155
    ds_write_b32 v244, v233 offset:11392
    v_pk_fma_f32 v[156:157], v[240:241], v[152:153], v[102:103] op_sel_hi:[0,1,1]
    v_pk_fma_f32 v[158:159], v[246:247], v[154:155], v[134:135] op_sel_hi:[0,1,1]
    v_pk_fma_f32 v[152:153], v[240:241], v[152:153], v[156:157] op_sel:[1,1,0] op_sel_hi:[1,0,1] neg_lo:[1,0,0]
    v_pk_fma_f32 v[154:155], v[246:247], v[154:155], v[158:159] op_sel:[1,1,0] op_sel_hi:[1,0,1] neg_lo:[1,0,0]
    v_cvt_pk_bf16_f32 v234, v152, v153
    ds_write_b32 v245, v234 offset:11776
    v_cvt_pk_bf16_f32 v235, v154, v155
    ds_write_b32 v245, v235 offset:11904
    v_pk_fma_f32 v[156:157], v[240:241], v[152:153], v[40:41] op_sel_hi:[0,1,1]
    v_pk_fma_f32 v[158:159], v[246:247], v[154:155], v[72:73] op_sel_hi:[0,1,1]
    v_pk_fma_f32 v[152:153], v[240:241], v[152:153], v[156:157] op_sel:[1,1,0] op_sel_hi:[1,0,1] neg_lo:[1,0,0]
    v_pk_fma_f32 v[154:155], v[246:247], v[154:155], v[158:159] op_sel:[1,1,0] op_sel_hi:[1,0,1] neg_lo:[1,0,0]
    v_cvt_pk_bf16_f32 v232, v152, v153
    ds_write_b32 v236, v232 offset:12288
    v_cvt_pk_bf16_f32 v233, v154, v155
    ds_write_b32 v236, v233 offset:12416
    v_pk_fma_f32 v[156:157], v[240:241], v[152:153], v[104:105] op_sel_hi:[0,1,1]
    v_pk_fma_f32 v[158:159], v[246:247], v[154:155], v[136:137] op_sel_hi:[0,1,1]
    v_pk_fma_f32 v[152:153], v[240:241], v[152:153], v[156:157] op_sel:[1,1,0] op_sel_hi:[1,0,1] neg_lo:[1,0,0]
    v_pk_fma_f32 v[154:155], v[246:247], v[154:155], v[158:159] op_sel:[1,1,0] op_sel_hi:[1,0,1] neg_lo:[1,0,0]
    v_cvt_pk_bf16_f32 v234, v152, v153
    ds_write_b32 v237, v234 offset:12800
    v_cvt_pk_bf16_f32 v235, v154, v155
    ds_write_b32 v237, v235 offset:12928
    v_pk_fma_f32 v[156:157], v[240:241], v[152:153], v[42:43] op_sel_hi:[0,1,1]
    v_pk_fma_f32 v[158:159], v[246:247], v[154:155], v[74:75] op_sel_hi:[0,1,1]
    v_pk_fma_f32 v[152:153], v[240:241], v[152:153], v[156:157] op_sel:[1,1,0] op_sel_hi:[1,0,1] neg_lo:[1,0,0]
    v_pk_fma_f32 v[154:155], v[246:247], v[154:155], v[158:159] op_sel:[1,1,0] op_sel_hi:[1,0,1] neg_lo:[1,0,0]
    v_cvt_pk_bf16_f32 v232, v152, v153
    ds_write_b32 v238, v232 offset:13312
    v_cvt_pk_bf16_f32 v233, v154, v155
    ds_write_b32 v238, v233 offset:13440
    v_pk_fma_f32 v[156:157], v[240:241], v[152:153], v[106:107] op_sel_hi:[0,1,1]
    v_pk_fma_f32 v[158:159], v[246:247], v[154:155], v[138:139] op_sel_hi:[0,1,1]
    v_pk_fma_f32 v[152:153], v[240:241], v[152:153], v[156:157] op_sel:[1,1,0] op_sel_hi:[1,0,1] neg_lo:[1,0,0]
    v_pk_fma_f32 v[154:155], v[246:247], v[154:155], v[158:159] op_sel:[1,1,0] op_sel_hi:[1,0,1] neg_lo:[1,0,0]
    v_cvt_pk_bf16_f32 v234, v152, v153
    ds_write_b32 v239, v234 offset:13824
    v_cvt_pk_bf16_f32 v235, v154, v155
    ds_write_b32 v239, v235 offset:13952
    v_pk_fma_f32 v[156:157], v[240:241], v[152:153], v[44:45] op_sel_hi:[0,1,1]
    v_pk_fma_f32 v[158:159], v[246:247], v[154:155], v[76:77] op_sel_hi:[0,1,1]
    v_pk_fma_f32 v[152:153], v[240:241], v[152:153], v[156:157] op_sel:[1,1,0] op_sel_hi:[1,0,1] neg_lo:[1,0,0]
    v_pk_fma_f32 v[154:155], v[246:247], v[154:155], v[158:159] op_sel:[1,1,0] op_sel_hi:[1,0,1] neg_lo:[1,0,0]
    v_cvt_pk_bf16_f32 v232, v152, v153
    ds_write_b32 v242, v232 offset:14336
    v_cvt_pk_bf16_f32 v233, v154, v155
    ds_write_b32 v242, v233 offset:14464
    v_pk_fma_f32 v[156:157], v[240:241], v[152:153], v[108:109] op_sel_hi:[0,1,1]
    v_pk_fma_f32 v[158:159], v[246:247], v[154:155], v[140:141] op_sel_hi:[0,1,1]
    v_pk_fma_f32 v[152:153], v[240:241], v[152:153], v[156:157] op_sel:[1,1,0] op_sel_hi:[1,0,1] neg_lo:[1,0,0]
    v_pk_fma_f32 v[154:155], v[246:247], v[154:155], v[158:159] op_sel:[1,1,0] op_sel_hi:[1,0,1] neg_lo:[1,0,0]
    v_cvt_pk_bf16_f32 v234, v152, v153
    ds_write_b32 v243, v234 offset:14848
    v_cvt_pk_bf16_f32 v235, v154, v155
    ds_write_b32 v243, v235 offset:14976
    v_pk_fma_f32 v[156:157], v[240:241], v[152:153], v[46:47] op_sel_hi:[0,1,1]
    v_pk_fma_f32 v[158:159], v[246:247], v[154:155], v[78:79] op_sel_hi:[0,1,1]
    v_pk_fma_f32 v[152:153], v[240:241], v[152:153], v[156:157] op_sel:[1,1,0] op_sel_hi:[1,0,1] neg_lo:[1,0,0]
    v_pk_fma_f32 v[154:155], v[246:247], v[154:155], v[158:159] op_sel:[1,1,0] op_sel_hi:[1,0,1] neg_lo:[1,0,0]
    v_cvt_pk_bf16_f32 v232, v152, v153
    ds_write_b32 v244, v232 offset:15360
    v_cvt_pk_bf16_f32 v233, v154, v155
    ds_write_b32 v244, v233 offset:15488
    v_pk_fma_f32 v[156:157], v[240:241], v[152:153], v[110:111] op_sel_hi:[0,1,1]
    v_pk_fma_f32 v[158:159], v[246:247], v[154:155], v[142:143] op_sel_hi:[0,1,1]
    v_pk_fma_f32 v[152:153], v[240:241], v[152:153], v[156:157] op_sel:[1,1,0] op_sel_hi:[1,0,1] neg_lo:[1,0,0]
    v_pk_fma_f32 v[154:155], v[246:247], v[154:155], v[158:159] op_sel:[1,1,0] op_sel_hi:[1,0,1] neg_lo:[1,0,0]
    v_cvt_pk_bf16_f32 v234, v152, v153
    ds_write_b32 v245, v234 offset:15872
    v_cvt_pk_bf16_f32 v235, v154, v155
    ds_write_b32 v245, v235 offset:16000
    s_waitcnt lgkmcnt(0)
    s_add_u32 s88, s44, 112
    s_lshl_b32 s88, s88, 7
    s_lshl_b32 s89, s45, 3
    s_add_u32 s95, s88, s89
    s_branch m1_u_p3
m1_idle_c:
    s_branch m1_idle
m1_loaders:
    s_lshl_b32 s60, s2, 2
    s_add_u32 s60, s60, s3
    s_sub_u32 s60, s60, 4
    v_lshlrev_b32 v60, 7, v1
    s_mov_b32 s64, s14
    s_mov_b32 s65, s15
    s_mov_b32 s66, 819200
    s_mov_b32 s67, 0x20000
    s_mul_i32 s68, s60, 896
    v_cmp_gt_u32 vcc, 7, v1
    s_nop 1
    s_and_saveexec_b64 s[70:71], vcc
    s_add_u32 s69, s68, 0
    buffer_load_dword v61, v60, s[64:67], s69 offen
    s_mov_b64 exec, s[70:71]
    s_mov_b32 s64, s16
    s_mov_b32 s65, s17
    s_mov_b32 s66, 819200
    s_mov_b32 s67, 0x20000
    s_mul_i32 s68, s60, 896
    v_cmp_gt_u32 vcc, 7, v1
    s_nop 1
    s_and_saveexec_b64 s[70:71], vcc
    s_add_u32 s69, s68, 0
    buffer_load_dword v62, v60, s[64:67], s69 offen
    s_mov_b64 exec, s[70:71]
    s_mov_b32 s64, s28
    s_mov_b32 s65, s29
    s_mov_b32 s66, 819200
    s_mov_b32 s67, 0x20000
    s_mul_i32 s68, s60, 896
    v_cmp_gt_u32 vcc, 7, v1
    s_nop 1
    s_and_saveexec_b64 s[70:71], vcc
    s_add_u32 s69, s68, 0
    buffer_load_dword v63, v60, s[64:67], s69 offen
    s_mov_b64 exec, s[70:71]
    s_cmp_ge_u32 s46, 30
    s_cbranch_scc1 m1_idle_l
    s_cmp_ge_u32 s46, 20
    s_cbranch_scc1 m1_u_l
    s_and_b32 s4, s2, 7
    s_lshr_b32 s5, s2, 3
    s_lshl_b32 s6, s4, 2
    s_and_b32 s7, s5, 3
    s_add_u32 s44, s6, s7
    s_lshr_b32 s45, s5, 2
    s_add_u32 s48, s40, 2621440
    s_addc_u32 s49, s41, 0
    s_mov_b32 s50, 2621440
    s_mov_b32 s51, 0x20000
    s_mov_b32 s52, s28
    s_mov_b32 s53, s29
    s_mov_b32 s54, 819200
    s_mov_b32 s55, 0x20000
    s_sub_u32 s4, s3, 4
    s_lshl_b32 s5, s4, 10
    s_mul_i32 s6, s44, 81920
    s_lshl_b32 s7, s45, 8
    v_lshrrev_b32 v10, 3, v1
    v_and_b32 v11, 7, v1
    v_bfe_u32 v12, v10, 1, 1
    v_lshlrev_b32 v12, 2, v12
    v_xor_b32 v11, v11, v12
    s_lshl_b32 s42, s4, 3
    v_add_u32 v13, s42, v10
    v_mul_u32_u24 v13, 1280, v13
    v_lshl_add_u32 v9, v11, 4, v13
    v_lshrrev_b32 v10, 3, v1
    v_and_b32 v11, 7, v1
    v_lshrrev_b32 v12, 1, v10
    s_and_b32 s42, s4, 1
    s_lshl_b32 s42, s42, 2
    v_or_b32 v12, s42, v12
    v_xor_b32 v11, v11, v12
    s_lshl_b32 s42, s4, 3
    v_add_u32 v13, s42, v10
    v_mul_u32_u24 v13, 1280, v13
    v_lshl_add_u32 v2, v11, 4, v13
    s_add_u32 s64, s40, 5242880
    s_addc_u32 s65, s41, 0
    s_mov_b32 s66, 2626560
    s_mov_b32 s67, 0x20000
    s_mov_b32 s70, 0xc0135761
    s_mov_b32 s71, 0xc0135761
    s_mov_b32 s72, 0xbdd2d3e8
    s_mov_b32 s73, 0xbdd2d3e8
    s_mov_b32 s74, 0xffff0000
    v_mov_b32 v196, s70
    v_mov_b32 v197, s70
    v_lshrrev_b32 v7, 4, v1
    s_lshl_b32 s60, s3, 3
    v_add_u32 v7, s60, v7
    v_and_b32 v11, 15, v1
    v_lshlrev_b32 v4, 8, v7
    v_lshl_add_u32 v4, v11, 4, v4
    v_add_u32 v12, 0, v7
    v_and_b32 v13, 15, v12
    v_xor_b32 v13, v13, v11
    v_mul_u32_u24 v12, 1280, v12
    v_lshl_add_u32 v5, v13, 4, v12
    v_add_u32 v12, 4, v7
    v_and_b32 v13, 15, v12
    v_xor_b32 v13, v13, v11
    v_mul_u32_u24 v12, 1280, v12
    v_lshl_add_u32 v6, v13, 4, v12
    s_lshl_b32 s61, s44, 6
    s_add_u32 s61, s61, 2
    s_mul_i32 s61, s61, 1280
    s_lshl_b32 s62, s45, 8
    s_add_u32 s75, s61, s62
    s_barrier
    s_add_u32 m0, s5, 8192
    s_nop 0
    buffer_load_dwordx4 v9, s[52:55], s7 offen lds
    s_add_u32 m0, s5, 12288
    s_add_u32 s43, s7, 40960
    buffer_load_dwordx4 v9, s[52:55], s43 offen lds
    s_add_u32 m0, s5, 16384
    s_add_u32 s43, s7, 128
    buffer_load_dwordx4 v9, s[52:55], s43 offen lds
    s_add_u32 m0, s5, 20480
    s_add_u32 s43, s7, 41088
    buffer_load_dwordx4 v9, s[52:55], s43 offen lds
    s_add_u32 m0, s5, 32768
    s_add_u32 s43, s7, 81920
    buffer_load_dwordx4 v9, s[52:55], s43 offen lds
    s_add_u32 m0, s5, 36864
    s_add_u32 s43, s7, 122880
    buffer_load_dwordx4 v9, s[52:55], s43 offen lds
    s_add_u32 m0, s5, 40960
    s_add_u32 s43, s7, 82048
    buffer_load_dwordx4 v9, s[52:55], s43 offen lds
    s_add_u32 m0, s5, 45056
    s_add_u32 s43, s7, 123008
    buffer_load_dwordx4 v9, s[52:55], s43 offen lds
    s_add_u32 m0, s5, 57344
    s_add_u32 s43, s7, 163840
    buffer_load_dwordx4 v9, s[52:55], s43 offen lds
    s_add_u32 m0, s5, 61440
    s_add_u32 s43, s7, 204800
    buffer_load_dwordx4 v9, s[52:55], s43 offen lds
    s_add_u32 m0, s5, 65536
    s_add_u32 s43, s7, 163968
    buffer_load_dwordx4 v9, s[52:55], s43 offen lds
    s_add_u32 m0, s5, 69632
    s_add_u32 s43, s7, 204928
    buffer_load_dwordx4 v9, s[52:55], s43 offen lds
    s_add_u32 m0, s5, 81920
    s_add_u32 s43, s7, 245760
    buffer_load_dwordx4 v9, s[52:55], s43 offen lds
    s_add_u32 m0, s5, 86016
    s_add_u32 s43, s7, 286720
    buffer_load_dwordx4 v9, s[52:55], s43 offen lds
    s_add_u32 m0, s5, 90112
    s_add_u32 s43, s7, 245888
    buffer_load_dwordx4 v9, s[52:55], s43 offen lds
    s_add_u32 m0, s5, 94208
    s_add_u32 s43, s7, 286848
    buffer_load_dwordx4 v9, s[52:55], s43 offen lds
    s_add_u32 m0, s5, 106496
    s_add_u32 s43, s7, 327680
    buffer_load_dwordx4 v9, s[52:55], s43 offen lds
    s_add_u32 m0, s5, 110592
    s_add_u32 s43, s7, 368640
    buffer_load_dwordx4 v9, s[52:55], s43 offen lds
    s_add_u32 m0, s5, 114688
    s_add_u32 s43, s7, 327808
    buffer_load_dwordx4 v9, s[52:55], s43 offen lds
    s_add_u32 m0, s5, 118784
    s_add_u32 s43, s7, 368768
    buffer_load_dwordx4 v9, s[52:55], s43 offen lds
    s_add_u32 m0, s5, 131072
    s_add_u32 s43, s7, 409600
    buffer_load_dwordx4 v9, s[52:55], s43 offen lds
    s_add_u32 m0, s5, 135168
    s_add_u32 s43, s7, 450560
    buffer_load_dwordx4 v9, s[52:55], s43 offen lds
    s_add_u32 m0, s5, 139264
    s_add_u32 s43, s7, 409728
    buffer_load_dwordx4 v9, s[52:55], s43 offen lds
    s_add_u32 m0, s5, 143360
    s_add_u32 s43, s7, 450688
    buffer_load_dwordx4 v9, s[52:55], s43 offen lds
    s_barrier
    s_add_u32 m0, s5, 0
    s_nop 0
    buffer_load_dwordx4 v2, s[48:51], s6 offen lds
    s_add_u32 m0, s5, 4096
    s_add_u32 s43, s6, 40960
    buffer_load_dwordx4 v2, s[48:51], s43 offen lds
    s_add_u32 m0, s5, 24576
    s_add_u32 s43, s6, 128
    buffer_load_dwordx4 v2, s[48:51], s43 offen lds
    s_add_u32 m0, s5, 28672
    s_add_u32 s43, s6, 41088
    buffer_load_dwordx4 v2, s[48:51], s43 offen lds
    s_waitcnt vmcnt(2)
    s_barrier
    s_add_u32 m0, s5, 49152
    s_add_u32 s43, s6, 256
    buffer_load_dwordx4 v2, s[48:51], s43 offen lds
    s_add_u32 m0, s5, 53248
    s_add_u32 s43, s6, 41216
    buffer_load_dwordx4 v2, s[48:51], s43 offen lds
    s_add_u32 m0, s5, 73728
    s_add_u32 s43, s6, 384
    buffer_load_dwordx4 v2, s[48:51], s43 offen lds
    s_add_u32 m0, s5, 77824
    s_add_u32 s43, s6, 41344
    buffer_load_dwordx4 v2, s[48:51], s43 offen lds
    s_waitcnt vmcnt(4)
    s_barrier
    s_add_u32 m0, s5, 98304
    s_add_u32 s43, s6, 512
    buffer_load_dwordx4 v2, s[48:51], s43 offen lds
    s_add_u32 m0, s5, 102400
    s_add_u32 s43, s6, 41472
    buffer_load_dwordx4 v2, s[48:51], s43 offen lds
    s_add_u32 m0, s5, 122880
    s_add_u32 s43, s6, 640
    buffer_load_dwordx4 v2, s[48:51], s43 offen lds
    s_add_u32 m0, s5, 126976
    s_add_u32 s43, s6, 41600
    buffer_load_dwordx4 v2, s[48:51], s43 offen lds
    s_waitcnt vmcnt(6)
    s_barrier
    s_add_u32 m0, s5, 0
    s_add_u32 s43, s6, 768
    buffer_load_dwordx4 v2, s[48:51], s43 offen lds
    s_add_u32 m0, s5, 4096
    s_add_u32 s43, s6, 41728
    buffer_load_dwordx4 v2, s[48:51], s43 offen lds
    s_add_u32 m0, s5, 8192
    s_add_u32 s43, s7, 491520
    buffer_load_dwordx4 v9, s[52:55], s43 offen lds
    s_add_u32 m0, s5, 12288
    s_add_u32 s43, s7, 532480
    buffer_load_dwordx4 v9, s[52:55], s43 offen lds
    s_add_u32 m0, s5, 16384
    s_add_u32 s43, s7, 491648
    buffer_load_dwordx4 v9, s[52:55], s43 offen lds
    s_add_u32 m0, s5, 20480
    s_add_u32 s43, s7, 532608
    buffer_load_dwordx4 v9, s[52:55], s43 offen lds
    s_waitcnt vmcnt(10)
    s_barrier
    s_add_u32 m0, s5, 24576
    s_add_u32 s43, s6, 896
    buffer_load_dwordx4 v2, s[48:51], s43 offen lds
    s_add_u32 m0, s5, 28672
    s_add_u32 s43, s6, 41856
    buffer_load_dwordx4 v2, s[48:51], s43 offen lds
    s_add_u32 m0, s5, 32768
    s_add_u32 s43, s7, 573440
    buffer_load_dwordx4 v9, s[52:55], s43 offen lds
    s_add_u32 m0, s5, 36864
    s_add_u32 s43, s7, 614400
    buffer_load_dwordx4 v9, s[52:55], s43 offen lds
    s_add_u32 m0, s5, 40960
    s_add_u32 s43, s7, 573568
    buffer_load_dwordx4 v9, s[52:55], s43 offen lds
    s_add_u32 m0, s5, 45056
    s_add_u32 s43, s7, 614528
    buffer_load_dwordx4 v9, s[52:55], s43 offen lds
    s_waitcnt vmcnt(14)
    s_barrier
    s_add_u32 m0, s5, 49152
    s_add_u32 s43, s6, 1024
    buffer_load_dwordx4 v2, s[48:51], s43 offen lds
    s_add_u32 m0, s5, 53248
    s_add_u32 s43, s6, 41984
    buffer_load_dwordx4 v2, s[48:51], s43 offen lds
    s_add_u32 m0, s5, 57344
    s_add_u32 s43, s7, 655360
    buffer_load_dwordx4 v9, s[52:55], s43 offen lds
    s_add_u32 m0, s5, 61440
    s_add_u32 s43, s7, 696320
    buffer_load_dwordx4 v9, s[52:55], s43 offen lds
    s_add_u32 m0, s5, 65536
    s_add_u32 s43, s7, 655488
    buffer_load_dwordx4 v9, s[52:55], s43 offen lds
    s_add_u32 m0, s5, 69632
    s_add_u32 s43, s7, 696448
    buffer_load_dwordx4 v9, s[52:55], s43 offen lds
    s_waitcnt vmcnt(18)
    s_barrier
    s_add_u32 m0, s5, 73728
    s_add_u32 s43, s6, 1152
    buffer_load_dwordx4 v2, s[48:51], s43 offen lds
    s_add_u32 m0, s5, 77824
    s_add_u32 s43, s6, 42112
    buffer_load_dwordx4 v2, s[48:51], s43 offen lds
    s_add_u32 m0, s5, 81920
    s_add_u32 s43, s7, 737280
    buffer_load_dwordx4 v9, s[52:55], s43 offen lds
    s_add_u32 m0, s5, 86016
    s_add_u32 s43, s7, 778240
    buffer_load_dwordx4 v9, s[52:55], s43 offen lds
    s_add_u32 m0, s5, 90112
    s_add_u32 s43, s7, 737408
    buffer_load_dwordx4 v9, s[52:55], s43 offen lds
    s_add_u32 m0, s5, 94208
    s_add_u32 s43, s7, 778368
    buffer_load_dwordx4 v9, s[52:55], s43 offen lds
    s_waitcnt vmcnt(18)
    s_barrier
    s_waitcnt vmcnt(12)
    s_barrier
    s_waitcnt vmcnt(6)
    s_barrier
    s_waitcnt vmcnt(0)
    s_barrier
m1_h_p3:
    s_barrier
    ds_read_b128 v[16:19], v4 offset:0
    ds_read_b128 v[20:23], v4 offset:1024
    s_waitcnt lgkmcnt(0)
    v_lshlrev_b32 v40, 16, v16
    v_and_b32 v41, s74, v16
    v_lshlrev_b32 v44, 16, v17
    v_and_b32 v45, s74, v17
    v_lshlrev_b32 v48, 16, v18
    v_and_b32 v49, s74, v18
    v_lshlrev_b32 v52, 16, v19
    v_and_b32 v53, s74, v19
    v_lshlrev_b32 v56, 16, v20
    v_and_b32 v57, s74, v20
    v_lshlrev_b32 v60, 16, v21
    v_and_b32 v61, s74, v21
    v_lshlrev_b32 v64, 16, v22
    v_and_b32 v65, s74, v22
    v_lshlrev_b32 v68, 16, v23
    v_and_b32 v69, s74, v23
    v_pk_mul_f32 v[42:43], v[40:41], v[40:41]
    v_pk_mul_f32 v[46:47], v[44:45], v[44:45]
    v_pk_mul_f32 v[50:51], v[48:49], v[48:49]
    v_pk_mul_f32 v[54:55], v[52:53], v[52:53]
    v_pk_mul_f32 v[58:59], v[56:57], v[56:57]
    v_pk_mul_f32 v[62:63], v[60:61], v[60:61]
    v_pk_mul_f32 v[66:67], v[64:65], v[64:65]
    v_pk_mul_f32 v[70:71], v[68:69], v[68:69]
    v_pk_fma_f32 v[42:43], v[42:43], s[72:73], v[196:197]
    v_pk_fma_f32 v[46:47], v[46:47], s[72:73], v[196:197]
    v_pk_fma_f32 v[50:51], v[50:51], s[72:73], v[196:197]
    v_pk_fma_f32 v[54:55], v[54:55], s[72:73], v[196:197]
    v_pk_fma_f32 v[58:59], v[58:59], s[72:73], v[196:197]
    v_pk_fma_f32 v[62:63], v[62:63], s[72:73], v[196:197]
    v_pk_fma_f32 v[66:67], v[66:67], s[72:73], v[196:197]
    v_pk_fma_f32 v[70:71], v[70:71], s[72:73], v[196:197]
    v_pk_mul_f32 v[42:43], v[42:43], v[40:41]
    v_pk_mul_f32 v[46:47], v[46:47], v[44:45]
    v_pk_mul_f32 v[50:51], v[50:51], v[48:49]
    v_pk_mul_f32 v[54:55], v[54:55], v[52:53]
    v_pk_mul_f32 v[58:59], v[58:59], v[56:57]
    v_pk_mul_f32 v[62:63], v[62:63], v[60:61]
    v_pk_mul_f32 v[66:67], v[66:67], v[64:65]
    v_pk_mul_f32 v[70:71], v[70:71], v[68:69]
    v_exp_f32 v42, v42
    v_exp_f32 v43, v43
    v_exp_f32 v46, v46
    v_exp_f32 v47, v47
    v_exp_f32 v50, v50
    v_exp_f32 v51, v51
    v_exp_f32 v54, v54
    v_exp_f32 v55, v55
    v_exp_f32 v58, v58
    v_exp_f32 v59, v59
    v_exp_f32 v62, v62
    v_exp_f32 v63, v63
    v_exp_f32 v66, v66
    v_exp_f32 v67, v67
    v_exp_f32 v70, v70
    v_exp_f32 v71, v71
    v_pk_add_f32 v[42:43], v[42:43], 1.0 op_sel_hi:[1,0]
    v_pk_add_f32 v[46:47], v[46:47], 1.0 op_sel_hi:[1,0]
    v_pk_add_f32 v[50:51], v[50:51], 1.0 op_sel_hi:[1,0]
    v_pk_add_f32 v[54:55], v[54:55], 1.0 op_sel_hi:[1,0]
    v_pk_add_f32 v[58:59], v[58:59], 1.0 op_sel_hi:[1,0]
    v_pk_add_f32 v[62:63], v[62:63], 1.0 op_sel_hi:[1,0]
    v_pk_add_f32 v[66:67], v[66:67], 1.0 op_sel_hi:[1,0]
    v_pk_add_f32 v[70:71], v[70:71], 1.0 op_sel_hi:[1,0]
    v_rcp_f32 v42, v42
    v_rcp_f32 v43, v43
    v_rcp_f32 v46, v46
    v_rcp_f32 v47, v47
    v_rcp_f32 v50, v50
    v_rcp_f32 v51, v51
    v_rcp_f32 v54, v54
    v_rcp_f32 v55, v55
    v_rcp_f32 v58, v58
    v_rcp_f32 v59, v59
    v_rcp_f32 v62, v62
    v_rcp_f32 v63, v63
    v_rcp_f32 v66, v66
    v_rcp_f32 v67, v67
    v_rcp_f32 v70, v70
    v_rcp_f32 v71, v71
    v_pk_mul_f32 v[42:43], v[42:43], v[40:41]
    v_pk_mul_f32 v[46:47], v[46:47], v[44:45]
    v_pk_mul_f32 v[50:51], v[50:51], v[48:49]
    v_pk_mul_f32 v[54:55], v[54:55], v[52:53]
    v_pk_mul_f32 v[58:59], v[58:59], v[56:57]
    v_pk_mul_f32 v[62:63], v[62:63], v[60:61]
    v_pk_mul_f32 v[66:67], v[66:67], v[64:65]
    v_pk_mul_f32 v[70:71], v[70:71], v[68:69]
    v_cvt_pk_bf16_f32 v16, v42, v43
    v_cvt_pk_bf16_f32 v17, v46, v47
    v_cvt_pk_bf16_f32 v18, v50, v51
    v_cvt_pk_bf16_f32 v19, v54, v55
    v_cvt_pk_bf16_f32 v20, v58, v59
    v_cvt_pk_bf16_f32 v21, v62, v63
    v_cvt_pk_bf16_f32 v22, v66, v67
    v_cvt_pk_bf16_f32 v23, v70, v71
    buffer_store_dwordx4 v[16:19], v5, s[64:67], s75 offen sc1
    buffer_store_dwordx4 v[20:23], v6, s[64:67], s75 offen sc1
    s_branch m1_end
m1_u_l:
    s_and_b32 s4, s2, 7
    s_lshr_b32 s5, s2, 3
    s_lshl_b32 s6, s4, 1
    s_and_b32 s7, s5, 1
    s_add_u32 s44, s6, s7
    s_lshr_b32 s45, s5, 1
    s_sub_u32 s45, s45, 10
    s_mov_b32 s48, s40
    s_mov_b32 s49, s41
    s_mov_b32 s50, 2621440
    s_mov_b32 s51, 0x20000
    s_mov_b32 s52, s14
    s_mov_b32 s53, s15
    s_mov_b32 s54, 819200
    s_mov_b32 s55, 0x20000
    s_mov_b32 s56, s16
    s_mov_b32 s57, s17
    s_mov_b32 s58, 819200
    s_mov_b32 s59, 0x20000
    s_sub_u32 s4, s3, 4
    s_lshl_b32 s5, s4, 10
    s_mul_i32 s6, s44, 163840
    s_mul_i32 s7, s45, 163840
    v_lshrrev_b32 v10, 3, v1
    v_and_b32 v11, 7, v1
    v_lshrrev_b32 v12, 1, v10
    s_and_b32 s42, s4, 1
    s_lshl_b32 s42, s42, 2
    v_or_b32 v12, s42, v12
    v_xor_b32 v11, v11, v12
    s_lshl_b32 s42, s4, 3
    v_add_u32 v13, s42, v10
    v_mul_u32_u24 v13, 1280, v13
    v_lshl_add_u32 v3, v11, 4, v13
    v_lshrrev_b32 v10, 3, v1
    v_and_b32 v11, 7, v1
    v_lshrrev_b32 v12, 1, v10
    s_and_b32 s42, s4, 1
    s_lshl_b32 s42, s42, 2
    v_or_b32 v12, s42, v12
    v_xor_b32 v11, v11, v12
    v_lshrrev_b32 v13, 2, v10
    v_lshlrev_b32 v13, 5, v13
    v_and_b32 v12, 3, v10
    v_add_u32 v13, v13, v12
    s_lshl_b32 s42, s4, 2
    v_add_u32 v13, s42, v13
    v_mul_u32_u24 v13, 1280, v13
    v_lshl_add_u32 v2, v11, 4, v13
    s_barrier
    s_add_u32 m0, s5, 16384
    s_nop 0
    buffer_load_dwordx4 v3, s[52:55], s7 offen lds
    s_add_u32 m0, s5, 20480
    s_add_u32 s43, s7, 40960
    buffer_load_dwordx4 v3, s[52:55], s43 offen lds
    s_add_u32 m0, s5, 24576
    s_add_u32 s43, s7, 81920
    buffer_load_dwordx4 v3, s[52:55], s43 offen lds
    s_add_u32 m0, s5, 28672
    s_add_u32 s43, s7, 122880
    buffer_load_dwordx4 v3, s[52:55], s43 offen lds
    s_add_u32 m0, s5, 32768
    s_nop 0
    buffer_load_dwordx4 v3, s[56:59], s7 offen lds
    s_add_u32 m0, s5, 36864
    s_add_u32 s43, s7, 40960
    buffer_load_dwordx4 v3, s[56:59], s43 offen lds
    s_add_u32 m0, s5, 40960
    s_add_u32 s43, s7, 81920
    buffer_load_dwordx4 v3, s[56:59], s43 offen lds
    s_add_u32 m0, s5, 45056
    s_add_u32 s43, s7, 122880
    buffer_load_dwordx4 v3, s[56:59], s43 offen lds
    s_add_u32 m0, s5, 65536
    s_add_u32 s43, s7, 128
    buffer_load_dwordx4 v3, s[52:55], s43 offen lds
    s_add_u32 m0, s5, 69632
    s_add_u32 s43, s7, 41088
    buffer_load_dwordx4 v3, s[52:55], s43 offen lds
    s_add_u32 m0, s5, 73728
    s_add_u32 s43, s7, 82048
    buffer_load_dwordx4 v3, s[52:55], s43 offen lds
    s_add_u32 m0, s5, 77824
    s_add_u32 s43, s7, 123008
    buffer_load_dwordx4 v3, s[52:55], s43 offen lds
    s_add_u32 m0, s5, 81920
    s_add_u32 s43, s7, 128
    buffer_load_dwordx4 v3, s[56:59], s43 offen lds
    s_add_u32 m0, s5, 86016
    s_add_u32 s43, s7, 41088
    buffer_load_dwordx4 v3, s[56:59], s43 offen lds
    s_add_u32 m0, s5, 90112
    s_add_u32 s43, s7, 82048
    buffer_load_dwordx4 v3, s[56:59], s43 offen lds
    s_add_u32 m0, s5, 94208
    s_add_u32 s43, s7, 123008
    buffer_load_dwordx4 v3, s[56:59], s43 offen lds
    s_barrier
    s_add_u32 m0, s5, 0
    s_nop 0
    buffer_load_dwordx4 v2, s[48:51], s6 offen lds
    s_add_u32 m0, s5, 4096
    s_add_u32 s43, s6, 20480
    buffer_load_dwordx4 v2, s[48:51], s43 offen lds
    s_add_u32 m0, s5, 8192
    s_add_u32 s43, s6, 81920
    buffer_load_dwordx4 v2, s[48:51], s43 offen lds
    s_add_u32 m0, s5, 12288
    s_add_u32 s43, s6, 102400
    buffer_load_dwordx4 v2, s[48:51], s43 offen lds
    s_add_u32 m0, s5, 49152
    s_add_u32 s43, s6, 128
    buffer_load_dwordx4 v2, s[48:51], s43 offen lds
    s_add_u32 m0, s5, 53248
    s_add_u32 s43, s6, 20608
    buffer_load_dwordx4 v2, s[48:51], s43 offen lds
    s_add_u32 m0, s5, 57344
    s_add_u32 s43, s6, 82048
    buffer_load_dwordx4 v2, s[48:51], s43 offen lds
    s_add_u32 m0, s5, 61440
    s_add_u32 s43, s6, 102528
    buffer_load_dwordx4 v2, s[48:51], s43 offen lds
    s_waitcnt vmcnt(4)
    s_barrier
    s_add_u32 m0, s5, 98304
    s_add_u32 s43, s6, 256
    buffer_load_dwordx4 v2, s[48:51], s43 offen lds
    s_add_u32 m0, s5, 102400
    s_add_u32 s43, s6, 20736
    buffer_load_dwordx4 v2, s[48:51], s43 offen lds
    s_add_u32 m0, s5, 106496
    s_add_u32 s43, s6, 82176
    buffer_load_dwordx4 v2, s[48:51], s43 offen lds
    s_add_u32 m0, s5, 110592
    s_add_u32 s43, s6, 102656
    buffer_load_dwordx4 v2, s[48:51], s43 offen lds
    s_add_u32 m0, s5, 114688
    s_add_u32 s43, s7, 256
    buffer_load_dwordx4 v3, s[52:55], s43 offen lds
    s_add_u32 m0, s5, 118784
    s_add_u32 s43, s7, 41216
    buffer_load_dwordx4 v3, s[52:55], s43 offen lds
    s_add_u32 m0, s5, 122880
    s_add_u32 s43, s7, 82176
    buffer_load_dwordx4 v3, s[52:55], s43 offen lds
    s_add_u32 m0, s5, 126976
    s_add_u32 s43, s7, 123136
    buffer_load_dwordx4 v3, s[52:55], s43 offen lds
    s_add_u32 m0, s5, 131072
    s_add_u32 s43, s7, 256
    buffer_load_dwordx4 v3, s[56:59], s43 offen lds
    s_add_u32 m0, s5, 135168
    s_add_u32 s43, s7, 41216
    buffer_load_dwordx4 v3, s[56:59], s43 offen lds
    s_add_u32 m0, s5, 139264
    s_add_u32 s43, s7, 82176
    buffer_load_dwordx4 v3, s[56:59], s43 offen lds
    s_add_u32 m0, s5, 143360
    s_add_u32 s43, s7, 123136
    buffer_load_dwordx4 v3, s[56:59], s43 offen lds
    s_waitcnt vmcnt(12)
    s_barrier
    s_add_u32 m0, s5, 0
    s_add_u32 s43, s6, 384
    buffer_load_dwordx4 v2, s[48:51], s43 offen lds
    s_add_u32 m0, s5, 4096
    s_add_u32 s43, s6, 20864
    buffer_load_dwordx4 v2, s[48:51], s43 offen lds
    s_add_u32 m0, s5, 8192
    s_add_u32 s43, s6, 82304
    buffer_load_dwordx4 v2, s[48:51], s43 offen lds
    s_add_u32 m0, s5, 12288
    s_add_u32 s43, s6, 102784
    buffer_load_dwordx4 v2, s[48:51], s43 offen lds
    s_add_u32 m0, s5, 16384
    s_add_u32 s43, s7, 384
    buffer_load_dwordx4 v3, s[52:55], s43 offen lds
    s_add_u32 m0, s5, 20480
    s_add_u32 s43, s7, 41344
    buffer_load_dwordx4 v3, s[52:55], s43 offen lds
    s_add_u32 m0, s5, 24576
    s_add_u32 s43, s7, 82304
    buffer_load_dwordx4 v3, s[52:55], s43 offen lds
    s_add_u32 m0, s5, 28672
    s_add_u32 s43, s7, 123264
    buffer_load_dwordx4 v3, s[52:55], s43 offen lds
    s_add_u32 m0, s5, 32768
    s_add_u32 s43, s7, 384
    buffer_load_dwordx4 v3, s[56:59], s43 offen lds
    s_add_u32 m0, s5, 36864
    s_add_u32 s43, s7, 41344
    buffer_load_dwordx4 v3, s[56:59], s43 offen lds
    s_add_u32 m0, s5, 40960
    s_add_u32 s43, s7, 82304
    buffer_load_dwordx4 v3, s[56:59], s43 offen lds
    s_add_u32 m0, s5, 45056
    s_add_u32 s43, s7, 123264
    buffer_load_dwordx4 v3, s[56:59], s43 offen lds
    s_waitcnt vmcnt(12)
    s_barrier
    s_add_u32 m0, s5, 49152
    s_add_u32 s43, s6, 512
    buffer_load_dwordx4 v2, s[48:51], s43 offen lds
    s_add_u32 m0, s5, 53248
    s_add_u32 s43, s6, 20992
    buffer_load_dwordx4 v2, s[48:51], s43 offen lds
    s_add_u32 m0, s5, 57344
    s_add_u32 s43, s6, 82432
    buffer_load_dwordx4 v2, s[48:51], s43 offen lds
    s_add_u32 m0, s5, 61440
    s_add_u32 s43, s6, 102912
    buffer_load_dwordx4 v2, s[48:51], s43 offen lds
    s_add_u32 m0, s5, 65536
    s_add_u32 s43, s7, 512
    buffer_load_dwordx4 v3, s[52:55], s43 offen lds
    s_add_u32 m0, s5, 69632
    s_add_u32 s43, s7, 41472
    buffer_load_dwordx4 v3, s[52:55], s43 offen lds
    s_add_u32 m0, s5, 73728
    s_add_u32 s43, s7, 82432
    buffer_load_dwordx4 v3, s[52:55], s43 offen lds
    s_add_u32 m0, s5, 77824
    s_add_u32 s43, s7, 123392
    buffer_load_dwordx4 v3, s[52:55], s43 offen lds
    s_add_u32 m0, s5, 81920
    s_add_u32 s43, s7, 512
    buffer_load_dwordx4 v3, s[56:59], s43 offen lds
    s_add_u32 m0, s5, 86016
    s_add_u32 s43, s7, 41472
    buffer_load_dwordx4 v3, s[56:59], s43 offen lds
    s_add_u32 m0, s5, 90112
    s_add_u32 s43, s7, 82432
    buffer_load_dwordx4 v3, s[56:59], s43 offen lds
    s_add_u32 m0, s5, 94208
    s_add_u32 s43, s7, 123392
    buffer_load_dwordx4 v3, s[56:59], s43 offen lds
    s_waitcnt vmcnt(12)
    s_barrier
    s_add_u32 m0, s5, 98304
    s_add_u32 s43, s6, 640
    buffer_load_dwordx4 v2, s[48:51], s43 offen lds
    s_add_u32 m0, s5, 102400
    s_add_u32 s43, s6, 21120
    buffer_load_dwordx4 v2, s[48:51], s43 offen lds
    s_add_u32 m0, s5, 106496
    s_add_u32 s43, s6, 82560
    buffer_load_dwordx4 v2, s[48:51], s43 offen lds
    s_add_u32 m0, s5, 110592
    s_add_u32 s43, s6, 103040
    buffer_load_dwordx4 v2, s[48:51], s43 offen lds
    s_add_u32 m0, s5, 114688
    s_add_u32 s43, s7, 640
    buffer_load_dwordx4 v3, s[52:55], s43 offen lds
    s_add_u32 m0, s5, 118784
    s_add_u32 s43, s7, 41600
    buffer_load_dwordx4 v3, s[52:55], s43 offen lds
    s_add_u32 m0, s5, 122880
    s_add_u32 s43, s7, 82560
    buffer_load_dwordx4 v3, s[52:55], s43 offen lds
    s_add_u32 m0, s5, 126976
    s_add_u32 s43, s7, 123520
    buffer_load_dwordx4 v3, s[52:55], s43 offen lds
    s_add_u32 m0, s5, 131072
    s_add_u32 s43, s7, 640
    buffer_load_dwordx4 v3, s[56:59], s43 offen lds
    s_add_u32 m0, s5, 135168
    s_add_u32 s43, s7, 41600
    buffer_load_dwordx4 v3, s[56:59], s43 offen lds
    s_add_u32 m0, s5, 139264
    s_add_u32 s43, s7, 82560
    buffer_load_dwordx4 v3, s[56:59], s43 offen lds
    s_add_u32 m0, s5, 143360
    s_add_u32 s43, s7, 123520
    buffer_load_dwordx4 v3, s[56:59], s43 offen lds
    s_waitcnt vmcnt(12)
    s_barrier
    s_add_u32 m0, s5, 0
    s_add_u32 s43, s6, 768
    buffer_load_dwordx4 v2, s[48:51], s43 offen lds
    s_add_u32 m0, s5, 4096
    s_add_u32 s43, s6, 21248
    buffer_load_dwordx4 v2, s[48:51], s43 offen lds
    s_add_u32 m0, s5, 8192
    s_add_u32 s43, s6, 82688
    buffer_load_dwordx4 v2, s[48:51], s43 offen lds
    s_add_u32 m0, s5, 12288
    s_add_u32 s43, s6, 103168
    buffer_load_dwordx4 v2, s[48:51], s43 offen lds
    s_add_u32 m0, s5, 16384
    s_add_u32 s43, s7, 768
    buffer_load_dwordx4 v3, s[52:55], s43 offen lds
    s_add_u32 m0, s5, 20480
    s_add_u32 s43, s7, 41728
    buffer_load_dwordx4 v3, s[52:55], s43 offen lds
    s_add_u32 m0, s5, 24576
    s_add_u32 s43, s7, 82688
    buffer_load_dwordx4 v3, s[52:55], s43 offen lds
    s_add_u32 m0, s5, 28672
    s_add_u32 s43, s7, 123648
    buffer_load_dwordx4 v3, s[52:55], s43 offen lds
    s_add_u32 m0, s5, 32768
    s_add_u32 s43, s7, 768
    buffer_load_dwordx4 v3, s[56:59], s43 offen lds
    s_add_u32 m0, s5, 36864
    s_add_u32 s43, s7, 41728
    buffer_load_dwordx4 v3, s[56:59], s43 offen lds
    s_add_u32 m0, s5, 40960
    s_add_u32 s43, s7, 82688
    buffer_load_dwordx4 v3, s[56:59], s43 offen lds
    s_add_u32 m0, s5, 45056
    s_add_u32 s43, s7, 123648
    buffer_load_dwordx4 v3, s[56:59], s43 offen lds
    s_waitcnt vmcnt(12)
    s_barrier
    s_add_u32 m0, s5, 49152
    s_add_u32 s43, s6, 896
    buffer_load_dwordx4 v2, s[48:51], s43 offen lds
    s_add_u32 m0, s5, 53248
    s_add_u32 s43, s6, 21376
    buffer_load_dwordx4 v2, s[48:51], s43 offen lds
    s_add_u32 m0, s5, 57344
    s_add_u32 s43, s6, 82816
    buffer_load_dwordx4 v2, s[48:51], s43 offen lds
    s_add_u32 m0, s5, 61440
    s_add_u32 s43, s6, 103296
    buffer_load_dwordx4 v2, s[48:51], s43 offen lds
    s_add_u32 m0, s5, 65536
    s_add_u32 s43, s7, 896
    buffer_load_dwordx4 v3, s[52:55], s43 offen lds
    s_add_u32 m0, s5, 69632
    s_add_u32 s43, s7, 41856
    buffer_load_dwordx4 v3, s[52:55], s43 offen lds
    s_add_u32 m0, s5, 73728
    s_add_u32 s43, s7, 82816
    buffer_load_dwordx4 v3, s[52:55], s43 offen lds
    s_add_u32 m0, s5, 77824
    s_add_u32 s43, s7, 123776
    buffer_load_dwordx4 v3, s[52:55], s43 offen lds
    s_add_u32 m0, s5, 81920
    s_add_u32 s43, s7, 896
    buffer_load_dwordx4 v3, s[56:59], s43 offen lds
    s_add_u32 m0, s5, 86016
    s_add_u32 s43, s7, 41856
    buffer_load_dwordx4 v3, s[56:59], s43 offen lds
    s_add_u32 m0, s5, 90112
    s_add_u32 s43, s7, 82816
    buffer_load_dwordx4 v3, s[56:59], s43 offen lds
    s_add_u32 m0, s5, 94208
    s_add_u32 s43, s7, 123776
    buffer_load_dwordx4 v3, s[56:59], s43 offen lds
    s_waitcnt vmcnt(12)
    s_barrier
    s_add_u32 m0, s5, 98304
    s_add_u32 s43, s6, 1024
    buffer_load_dwordx4 v2, s[48:51], s43 offen lds
    s_add_u32 m0, s5, 102400
    s_add_u32 s43, s6, 21504
    buffer_load_dwordx4 v2, s[48:51], s43 offen lds
    s_add_u32 m0, s5, 106496
    s_add_u32 s43, s6, 82944
    buffer_load_dwordx4 v2, s[48:51], s43 offen lds
    s_add_u32 m0, s5, 110592
    s_add_u32 s43, s6, 103424
    buffer_load_dwordx4 v2, s[48:51], s43 offen lds
    s_add_u32 m0, s5, 114688
    s_add_u32 s43, s7, 1024
    buffer_load_dwordx4 v3, s[52:55], s43 offen lds
    s_add_u32 m0, s5, 118784
    s_add_u32 s43, s7, 41984
    buffer_load_dwordx4 v3, s[52:55], s43 offen lds
    s_add_u32 m0, s5, 122880
    s_add_u32 s43, s7, 82944
    buffer_load_dwordx4 v3, s[52:55], s43 offen lds
    s_add_u32 m0, s5, 126976
    s_add_u32 s43, s7, 123904
    buffer_load_dwordx4 v3, s[52:55], s43 offen lds
    s_add_u32 m0, s5, 131072
    s_add_u32 s43, s7, 1024
    buffer_load_dwordx4 v3, s[56:59], s43 offen lds
    s_add_u32 m0, s5, 135168
    s_add_u32 s43, s7, 41984
    buffer_load_dwordx4 v3, s[56:59], s43 offen lds
    s_add_u32 m0, s5, 139264
    s_add_u32 s43, s7, 82944
    buffer_load_dwordx4 v3, s[56:59], s43 offen lds
    s_add_u32 m0, s5, 143360
    s_add_u32 s43, s7, 123904
    buffer_load_dwordx4 v3, s[56:59], s43 offen lds
    s_waitcnt vmcnt(12)
    s_barrier
    s_add_u32 m0, s5, 0
    s_add_u32 s43, s6, 1152
    buffer_load_dwordx4 v2, s[48:51], s43 offen lds
    s_add_u32 m0, s5, 4096
    s_add_u32 s43, s6, 21632
    buffer_load_dwordx4 v2, s[48:51], s43 offen lds
    s_add_u32 m0, s5, 8192
    s_add_u32 s43, s6, 83072
    buffer_load_dwordx4 v2, s[48:51], s43 offen lds
    s_add_u32 m0, s5, 12288
    s_add_u32 s43, s6, 103552
    buffer_load_dwordx4 v2, s[48:51], s43 offen lds
    s_add_u32 m0, s5, 16384
    s_add_u32 s43, s7, 1152
    buffer_load_dwordx4 v3, s[52:55], s43 offen lds
    s_add_u32 m0, s5, 20480
    s_add_u32 s43, s7, 42112
    buffer_load_dwordx4 v3, s[52:55], s43 offen lds
    s_add_u32 m0, s5, 24576
    s_add_u32 s43, s7, 83072
    buffer_load_dwordx4 v3, s[52:55], s43 offen lds
    s_add_u32 m0, s5, 28672
    s_add_u32 s43, s7, 124032
    buffer_load_dwordx4 v3, s[52:55], s43 offen lds
    s_add_u32 m0, s5, 32768
    s_add_u32 s43, s7, 1152
    buffer_load_dwordx4 v3, s[56:59], s43 offen lds
    s_add_u32 m0, s5, 36864
    s_add_u32 s43, s7, 42112
    buffer_load_dwordx4 v3, s[56:59], s43 offen lds
    s_add_u32 m0, s5, 40960
    s_add_u32 s43, s7, 83072
    buffer_load_dwordx4 v3, s[56:59], s43 offen lds
    s_add_u32 m0, s5, 45056
    s_add_u32 s43, s7, 124032
    buffer_load_dwordx4 v3, s[56:59], s43 offen lds
    s_waitcnt vmcnt(12)
    s_barrier
    s_waitcnt vmcnt(0)
    s_barrier
    s_sub_u32 s78, s46, 20
    s_lshl_b32 s78, s78, 2
    s_add_u32 s78, s78, s4
    s_mov_b32 s64, s32
    s_mov_b32 s65, s33
    s_mov_b32 s66, 1966080
    s_mov_b32 s67, 0x20000
    s_and_b32 s68, s2, 7
    s_lshr_b32 s68, s68, 2
    s_mul_i32 s68, s68, 1536
    s_mul_i32 s69, s78, 192
    s_movk_i32 s70, 5462
    v_add_u32 v100, 0, v1
    v_add_u32 v100, s69, v100
    v_mul_u32_u24 v101, s70, v100
    v_lshrrev_b32 v101, 16, v101
    v_mul_u32_u24 v102, 12, v101
    v_sub_u32 v102, v100, v102
    v_mul_u32_u24 v101, 3072, v101
    v_lshl_add_u32 v104, v102, 7, v101
    buffer_load_dword v110, v104, s[64:67], s68 offen
    v_add_u32 v100, 64, v1
    v_add_u32 v100, s69, v100
    v_mul_u32_u24 v101, s70, v100
    v_lshrrev_b32 v101, 16, v101
    v_mul_u32_u24 v102, 12, v101
    v_sub_u32 v102, v100, v102
    v_mul_u32_u24 v101, 3072, v101
    v_lshl_add_u32 v105, v102, 7, v101
    buffer_load_dword v111, v105, s[64:67], s68 offen
    v_add_u32 v100, 128, v1
    v_add_u32 v100, s69, v100
    v_mul_u32_u24 v101, s70, v100
    v_lshrrev_b32 v101, 16, v101
    v_mul_u32_u24 v102, 12, v101
    v_sub_u32 v102, v100, v102
    v_mul_u32_u24 v101, 3072, v101
    v_lshl_add_u32 v106, v102, 7, v101
    buffer_load_dword v112, v106, s[64:67], s68 offen
    s_barrier
    s_barrier
m1_u_p3:
    s_add_u32 s60, s40, 16240640
    s_addc_u32 s61, s41, 0
    s_mov_b32 s62, 5242880
    s_mov_b32 s63, 0x20000
    v_lshrrev_b32 v10, 5, v0
    v_and_b32 v11, 31, v0
    v_and_b32 v12, 7, v10
    v_xor_b32 v12, v12, v11
    v_mul_u32_u24 v13, 2560, v10
    v_lshl_add_u32 v13, v12, 4, v13
    v_lshlrev_b32 v14, 4, v0
    s_mul_i32 s72, s44, 327680
    s_lshl_b32 s73, s45, 9
    s_add_u32 s72, s72, s73
    s_barrier
    ds_read_b128 v[16:19], v14 offset:0
    ds_read_b128 v[20:23], v14 offset:8192
    ds_read_b128 v[24:27], v14 offset:16384
    ds_read_b128 v[28:31], v14 offset:24576
    ds_read_b128 v[32:35], v14 offset:32768
    ds_read_b128 v[36:39], v14 offset:40960
    ds_read_b128 v[40:43], v14 offset:49152
    ds_read_b128 v[44:47], v14 offset:57344
    s_waitcnt lgkmcnt(7)
    buffer_store_dwordx4 v[16:19], v13, s[60:63], s72 offen sc1
    s_add_u32 s72, s72, 40960
    s_waitcnt lgkmcnt(6)
    buffer_store_dwordx4 v[20:23], v13, s[60:63], s72 offen sc1
    s_add_u32 s72, s72, 40960
    s_waitcnt lgkmcnt(5)
    buffer_store_dwordx4 v[24:27], v13, s[60:63], s72 offen sc1
    s_add_u32 s72, s72, 40960
    s_waitcnt lgkmcnt(4)
    buffer_store_dwordx4 v[28:31], v13, s[60:63], s72 offen sc1
    s_add_u32 s72, s72, 40960
    s_waitcnt lgkmcnt(3)
    buffer_store_dwordx4 v[32:35], v13, s[60:63], s72 offen sc1
    s_add_u32 s72, s72, 40960
    s_waitcnt lgkmcnt(2)
    buffer_store_dwordx4 v[36:39], v13, s[60:63], s72 offen sc1
    s_add_u32 s72, s72, 40960
    s_waitcnt lgkmcnt(1)
    buffer_store_dwordx4 v[40:43], v13, s[60:63], s72 offen sc1
    s_add_u32 s72, s72, 40960
    s_waitcnt lgkmcnt(0)
    buffer_store_dwordx4 v[44:47], v13, s[60:63], s72 offen sc1
    s_branch m1_end
m1_idle_l:
    s_barrier
m1_idle:
    s_and_b32 s44, s2, 7
    s_lshl_b32 s44, s44, 1
    s_add_u32 s44, s44, s46
    s_sub_u32 s44, s44, 30
    s_lshl_b32 s78, s44, 3
    s_add_u32 s78, s78, s3
    v_lshlrev_b32 v60, 7, v1
    s_mov_b32 s64, s30
    s_mov_b32 s65, s31
    s_mov_b32 s66, 819200
    s_mov_b32 s67, 0x20000
    s_mul_i32 s68, s78, 6400
    v_cmp_gt_u32 vcc, 50, v1
    s_nop 1
    s_and_saveexec_b64 s[70:71], vcc
    s_add_u32 s69, s68, 0
    buffer_load_dword v61, v60, s[64:67], s69 offen
    s_mov_b64 exec, s[70:71]
    s_lshl_b32 s78, s44, 3
    s_add_u32 s95, s78, 18560
    s_add_u32 s78, s78, s3
    s_mov_b32 s48, s18
    s_mov_b32 s49, s19
    s_mov_b32 s50, 819200
    s_mov_b32 s51, 0x20000
    s_mov_b32 s52, s20
    s_mov_b32 s53, s21
    s_mov_b32 s54, 819200
    s_mov_b32 s55, 0x20000
    s_add_u32 s56, s40, 21483520
    s_addc_u32 s57, s41, 0
    s_mov_b32 s58, 1638400
    s_mov_b32 s59, 0x20000
    s_mul_i32 s61, s78, 6400
    v_mov_b32 v99, 0x7ffffff0
    v_add_u32 v88, 0, v1
    v_lshlrev_b32 v88, 4, v88
    buffer_load_dwordx4 v[100:103], v88, s[48:51], s61 offen
    buffer_load_dwordx4 v[104:107], v88, s[52:55], s61 offen
    v_add_u32 v89, 64, v1
    v_lshlrev_b32 v89, 4, v89
    buffer_load_dwordx4 v[108:111], v89, s[48:51], s61 offen
    buffer_load_dwordx4 v[112:115], v89, s[52:55], s61 offen
    v_add_u32 v90, 128, v1
    v_lshlrev_b32 v90, 4, v90
    buffer_load_dwordx4 v[116:119], v90, s[48:51], s61 offen
    buffer_load_dwordx4 v[120:123], v90, s[52:55], s61 offen
    v_add_u32 v91, 192, v1
    v_lshlrev_b32 v91, 4, v91
    buffer_load_dwordx4 v[124:127], v91, s[48:51], s61 offen
    buffer_load_dwordx4 v[128:131], v91, s[52:55], s61 offen
    v_add_u32 v92, 256, v1
    v_lshlrev_b32 v92, 4, v92
    buffer_load_dwordx4 v[132:135], v92, s[48:51], s61 offen
    buffer_load_dwordx4 v[136:139], v92, s[52:55], s61 offen
    v_add_u32 v93, 320, v1
    v_lshlrev_b32 v93, 4, v93
    buffer_load_dwordx4 v[140:143], v93, s[48:51], s61 offen
    buffer_load_dwordx4 v[144:147], v93, s[52:55], s61 offen
    v_add_u32 v94, 384, v1
    v_cmp_gt_u32 vcc, 400, v94
    v_lshlrev_b32 v94, 4, v94
    s_nop 0
    v_cndmask_b32 v94, v99, v94, vcc
    buffer_load_dwordx4 v[148:151], v94, s[48:51], s61 offen
    buffer_load_dwordx4 v[152:155], v94, s[52:55], s61 offen
    s_mul_i32 s61, s78, 12800
    s_mov_b32 s62, 0x05040100
    s_mov_b32 s63, 0x07060302
    s_mov_b32 s64, 0x80008000
    s_mov_b32 s65, 0xffff0000
    s_movk_i32 s66, 3277
    s_waitcnt vmcnt(12)
    v_xor_b32 v104, s64, v104
    v_perm_b32 v160, v104, v100, s62
    v_perm_b32 v161, v104, v100, s63
    v_xor_b32 v105, s64, v105
    v_perm_b32 v162, v105, v101, s62
    v_perm_b32 v163, v105, v101, s63
    v_xor_b32 v106, s64, v106
    v_perm_b32 v164, v106, v102, s62
    v_perm_b32 v165, v106, v102, s63
    v_xor_b32 v107, s64, v107
    v_perm_b32 v166, v107, v103, s62
    v_perm_b32 v167, v107, v103, s63
    v_lshlrev_b32 v96, 1, v88
    buffer_store_dwordx4 v[160:163], v96, s[56:59], s61 offen sc1
    buffer_store_dwordx4 v[164:167], v96, s[56:59], s61 offen offset:16 sc1
    s_waitcnt vmcnt(12)
    v_xor_b32 v112, s64, v112
    v_perm_b32 v168, v112, v108, s62
    v_perm_b32 v169, v112, v108, s63
    v_xor_b32 v113, s64, v113
    v_perm_b32 v170, v113, v109, s62
    v_perm_b32 v171, v113, v109, s63
    v_xor_b32 v114, s64, v114
    v_perm_b32 v172, v114, v110, s62
    v_perm_b32 v173, v114, v110, s63
    v_xor_b32 v115, s64, v115
    v_perm_b32 v174, v115, v111, s62
    v_perm_b32 v175, v115, v111, s63
    v_lshlrev_b32 v97, 1, v89
    buffer_store_dwordx4 v[168:171], v97, s[56:59], s61 offen sc1
    buffer_store_dwordx4 v[172:175], v97, s[56:59], s61 offen offset:16 sc1
    s_waitcnt vmcnt(12)
    v_xor_b32 v120, s64, v120
    v_perm_b32 v160, v120, v116, s62
    v_perm_b32 v161, v120, v116, s63
    v_xor_b32 v121, s64, v121
    v_perm_b32 v162, v121, v117, s62
    v_perm_b32 v163, v121, v117, s63
    v_xor_b32 v122, s64, v122
    v_perm_b32 v164, v122, v118, s62
    v_perm_b32 v165, v122, v118, s63
    v_xor_b32 v123, s64, v123
    v_perm_b32 v166, v123, v119, s62
    v_perm_b32 v167, v123, v119, s63
    v_lshlrev_b32 v96, 1, v90
    buffer_store_dwordx4 v[160:163], v96, s[56:59], s61 offen sc1
    buffer_store_dwordx4 v[164:167], v96, s[56:59], s61 offen offset:16 sc1
    s_waitcnt vmcnt(12)
    v_xor_b32 v128, s64, v128
    v_perm_b32 v168, v128, v124, s62
    v_perm_b32 v169, v128, v124, s63
    v_xor_b32 v129, s64, v129
    v_perm_b32 v170, v129, v125, s62
    v_perm_b32 v171, v129, v125, s63
    v_xor_b32 v130, s64, v130
    v_perm_b32 v172, v130, v126, s62
    v_perm_b32 v173, v130, v126, s63
    v_xor_b32 v131, s64, v131
    v_perm_b32 v174, v131, v127, s62
    v_perm_b32 v175, v131, v127, s63
    v_lshlrev_b32 v97, 1, v91
    buffer_store_dwordx4 v[168:171], v97, s[56:59], s61 offen sc1
    buffer_store_dwordx4 v[172:175], v97, s[56:59], s61 offen offset:16 sc1
    s_waitcnt vmcnt(12)
    v_xor_b32 v136, s64, v136
    v_perm_b32 v160, v136, v132, s62
    v_perm_b32 v161, v136, v132, s63
    v_xor_b32 v137, s64, v137
    v_perm_b32 v162, v137, v133, s62
    v_perm_b32 v163, v137, v133, s63
    v_xor_b32 v138, s64, v138
    v_perm_b32 v164, v138, v134, s62
    v_perm_b32 v165, v138, v134, s63
    v_xor_b32 v139, s64, v139
    v_perm_b32 v166, v139, v135, s62
    v_perm_b32 v167, v139, v135, s63
    v_lshlrev_b32 v96, 1, v92
    buffer_store_dwordx4 v[160:163], v96, s[56:59], s61 offen sc1
    buffer_store_dwordx4 v[164:167], v96, s[56:59], s61 offen offset:16 sc1
    s_waitcnt vmcnt(12)
    v_xor_b32 v144, s64, v144
    v_perm_b32 v168, v144, v140, s62
    v_perm_b32 v169, v144, v140, s63
    v_xor_b32 v145, s64, v145
    v_perm_b32 v170, v145, v141, s62
    v_perm_b32 v171, v145, v141, s63
    v_xor_b32 v146, s64, v146
    v_perm_b32 v172, v146, v142, s62
    v_perm_b32 v173, v146, v142, s63
    v_xor_b32 v147, s64, v147
    v_perm_b32 v174, v147, v143, s62
    v_perm_b32 v175, v147, v143, s63
    v_lshlrev_b32 v97, 1, v93
    buffer_store_dwordx4 v[168:171], v97, s[56:59], s61 offen sc1
    buffer_store_dwordx4 v[172:175], v97, s[56:59], s61 offen offset:16 sc1
    s_waitcnt vmcnt(12)
    v_xor_b32 v152, s64, v152
    v_perm_b32 v160, v152, v148, s62
    v_perm_b32 v161, v152, v148, s63
    v_xor_b32 v153, s64, v153
    v_perm_b32 v162, v153, v149, s62
    v_perm_b32 v163, v153, v149, s63
    v_xor_b32 v154, s64, v154
    v_perm_b32 v164, v154, v150, s62
    v_perm_b32 v165, v154, v150, s63
    v_xor_b32 v155, s64, v155
    v_perm_b32 v166, v155, v151, s62
    v_perm_b32 v167, v155, v151, s63
    v_lshlrev_b32 v96, 1, v94
    v_cmp_gt_u32 vcc, 16, v1
    s_nop 1
    v_cndmask_b32 v96, v99, v96, vcc
    buffer_store_dwordx4 v[160:163], v96, s[56:59], s61 offen sc1
    buffer_store_dwordx4 v[164:167], v96, s[56:59], s61 offen offset:16 sc1
    s_add_u32 s84, s40, 34656256
    s_addc_u32 s85, s41, 0
    s_mov_b32 s86, 22528
    s_mov_b32 s87, 0x20000
    s_add_u32 s88, s96, 2000
    s_addc_u32 s89, s97, 0
    v_mov_b32 v22, s88
    v_mov_b32 v23, s89
    v_mov_b32 v20, s95
    s_waitcnt vmcnt(0) lgkmcnt(0)
    s_barrier
    s_cmp_lg_u32 s3, 0
    s_cbranch_scc1 pb13
    s_cmp_eq_u32 s95, -1
    s_cbranch_scc1 pb13
    s_mov_b64 s[90:91], exec
    s_mov_b64 exec, 1
    buffer_store_dwordx2 v[22:23], v20, s[84:87], 0 offen sc1
    s_mov_b64 exec, s[90:91]
pb13:
    s_lshl_b32 s6, s44, 3
    s_add_u32 s95, s6, 18432
    s_mov_b32 s48, s32
    s_mov_b32 s49, s33
    s_mov_b32 s50, 1966080
    s_mov_b32 s51, 0x20000
    s_add_u32 s52, s40, 16228352
    s_addc_u32 s53, s41, 0
    s_mov_b32 s54, 12288
    s_mov_b32 s55, 0x20000
    v_and_b32 v2, 7, v0
    v_lshrrev_b32 v4, 3, v0
    v_mul_u32_u24 v4, 3072, v4
    v_lshl_add_u32 v4, v2, 4, v4
    s_mul_i32 s46, s44, 3
    s_add_u32 s46, s46, 0
    s_lshr_b32 s7, s46, 1
    s_lshl_b32 s4, s7, 7
    s_and_b32 s6, s46, 1
    s_mul_i32 s5, s6, 983040
    s_add_u32 s4, s4, s5
    s_lshl_b32 s7, s7, 8
    s_mul_i32 s6, s6, 6144
    s_add_u32 s56, s7, s6
    s_add_u32 s5, s4, 0
    buffer_load_dwordx4 v[16:19], v4, s[48:51], s5 offen
    s_add_u32 s5, s4, 196608
    buffer_load_dwordx4 v[20:23], v4, s[48:51], s5 offen
    s_add_u32 s5, s4, 393216
    buffer_load_dwordx4 v[24:27], v4, s[48:51], s5 offen
    s_add_u32 s5, s4, 589824
    buffer_load_dwordx4 v[28:31], v4, s[48:51], s5 offen
    s_add_u32 s5, s4, 786432
    buffer_load_dwordx4 v[32:35], v4, s[48:51], s5 offen
    s_mul_i32 s46, s44, 3
    s_add_u32 s46, s46, 1
    s_lshr_b32 s7, s46, 1
    s_lshl_b32 s4, s7, 7
    s_and_b32 s6, s46, 1
    s_mul_i32 s5, s6, 983040
    s_add_u32 s4, s4, s5
    s_lshl_b32 s7, s7, 8
    s_mul_i32 s6, s6, 6144
    s_add_u32 s57, s7, s6
    s_add_u32 s5, s4, 0
    buffer_load_dwordx4 v[36:39], v4, s[48:51], s5 offen
    s_add_u32 s5, s4, 196608
    buffer_load_dwordx4 v[40:43], v4, s[48:51], s5 offen
    s_add_u32 s5, s4, 393216
    buffer_load_dwordx4 v[44:47], v4, s[48:51], s5 offen
    s_add_u32 s5, s4, 589824
    buffer_load_dwordx4 v[48:51], v4, s[48:51], s5 offen
    s_add_u32 s5, s4, 786432
    buffer_load_dwordx4 v[52:55], v4, s[48:51], s5 offen
    s_mul_i32 s46, s44, 3
    s_add_u32 s46, s46, 2
    s_lshr_b32 s7, s46, 1
    s_lshl_b32 s4, s7, 7
    s_and_b32 s6, s46, 1
    s_mul_i32 s5, s6, 983040
    s_add_u32 s4, s4, s5
    s_lshl_b32 s7, s7, 8
    s_mul_i32 s6, s6, 6144
    s_add_u32 s58, s7, s6
    s_add_u32 s5, s4, 0
    buffer_load_dwordx4 v[56:59], v4, s[48:51], s5 offen
    s_add_u32 s5, s4, 196608
    buffer_load_dwordx4 v[60:63], v4, s[48:51], s5 offen
    s_add_u32 s5, s4, 393216
    buffer_load_dwordx4 v[64:67], v4, s[48:51], s5 offen
    s_add_u32 s5, s4, 589824
    buffer_load_dwordx4 v[68:71], v4, s[48:51], s5 offen
    s_add_u32 s5, s4, 786432
    buffer_load_dwordx4 v[72:75], v4, s[48:51], s5 offen
    v_lshlrev_b32 v6, 2, v1
    s_mov_b32 s60, 0x00003f80
    s_mov_b32 s61, 0x3f800000
    v_lshlrev_b32 v7, 5, v2
    v_mov_b32 v80, 0
    v_mov_b32 v81, 0
    v_mov_b32 v82, 0
    v_mov_b32 v83, 0
    v_mov_b32 v84, 0
    v_mov_b32 v85, 0
    v_mov_b32 v86, 0
    v_mov_b32 v87, 0
    s_waitcnt vmcnt(10)
    v_dot2c_f32_bf16 v80, s60, v16
    v_dot2c_f32_bf16 v81, s61, v16
    v_dot2c_f32_bf16 v82, s60, v17
    v_dot2c_f32_bf16 v83, s61, v17
    v_dot2c_f32_bf16 v84, s60, v18
    v_dot2c_f32_bf16 v85, s61, v18
    v_dot2c_f32_bf16 v86, s60, v19
    v_dot2c_f32_bf16 v87, s61, v19
    v_dot2c_f32_bf16 v80, s60, v20
    v_dot2c_f32_bf16 v81, s61, v20
    v_dot2c_f32_bf16 v82, s60, v21
    v_dot2c_f32_bf16 v83, s61, v21
    v_dot2c_f32_bf16 v84, s60, v22
    v_dot2c_f32_bf16 v85, s61, v22
    v_dot2c_f32_bf16 v86, s60, v23
    v_dot2c_f32_bf16 v87, s61, v23
    v_dot2c_f32_bf16 v80, s60, v24
    v_dot2c_f32_bf16 v81, s61, v24
    v_dot2c_f32_bf16 v82, s60, v25
    v_dot2c_f32_bf16 v83, s61, v25
    v_dot2c_f32_bf16 v84, s60, v26
    v_dot2c_f32_bf16 v85, s61, v26
    v_dot2c_f32_bf16 v86, s60, v27
    v_dot2c_f32_bf16 v87, s61, v27
    v_dot2c_f32_bf16 v80, s60, v28
    v_dot2c_f32_bf16 v81, s61, v28
    v_dot2c_f32_bf16 v82, s60, v29
    v_dot2c_f32_bf16 v83, s61, v29
    v_dot2c_f32_bf16 v84, s60, v30
    v_dot2c_f32_bf16 v85, s61, v30
    v_dot2c_f32_bf16 v86, s60, v31
    v_dot2c_f32_bf16 v87, s61, v31
    v_dot2c_f32_bf16 v80, s60, v32
    v_dot2c_f32_bf16 v81, s61, v32
    v_dot2c_f32_bf16 v82, s60, v33
    v_dot2c_f32_bf16 v83, s61, v33
    v_dot2c_f32_bf16 v84, s60, v34
    v_dot2c_f32_bf16 v85, s61, v34
    v_dot2c_f32_bf16 v86, s60, v35
    v_dot2c_f32_bf16 v87, s61, v35
    v_add_f32_dpp v80, v80, v80 row_ror:8 row_mask:0xf bank_mask:0xf
    v_add_f32_dpp v81, v81, v81 row_ror:8 row_mask:0xf bank_mask:0xf
    v_add_f32_dpp v82, v82, v82 row_ror:8 row_mask:0xf bank_mask:0xf
    v_add_f32_dpp v83, v83, v83 row_ror:8 row_mask:0xf bank_mask:0xf
    v_add_f32_dpp v84, v84, v84 row_ror:8 row_mask:0xf bank_mask:0xf
    v_add_f32_dpp v85, v85, v85 row_ror:8 row_mask:0xf bank_mask:0xf
    v_add_f32_dpp v86, v86, v86 row_ror:8 row_mask:0xf bank_mask:0xf
    v_add_f32_dpp v87, v87, v87 row_ror:8 row_mask:0xf bank_mask:0xf
    v_mov_b32 v88, 0
    v_mov_b32 v89, 0
    v_mov_b32 v90, 0
    v_mov_b32 v91, 0
    v_mov_b32 v92, 0
    v_mov_b32 v93, 0
    v_mov_b32 v94, 0
    v_mov_b32 v95, 0
    s_waitcnt vmcnt(5)
    v_dot2c_f32_bf16 v88, s60, v36
    v_dot2c_f32_bf16 v89, s61, v36
    v_dot2c_f32_bf16 v90, s60, v37
    v_dot2c_f32_bf16 v91, s61, v37
    v_dot2c_f32_bf16 v92, s60, v38
    v_dot2c_f32_bf16 v93, s61, v38
    v_dot2c_f32_bf16 v94, s60, v39
    v_dot2c_f32_bf16 v95, s61, v39
    v_dot2c_f32_bf16 v88, s60, v40
    v_dot2c_f32_bf16 v89, s61, v40
    v_dot2c_f32_bf16 v90, s60, v41
    v_dot2c_f32_bf16 v91, s61, v41
    v_dot2c_f32_bf16 v92, s60, v42
    v_dot2c_f32_bf16 v93, s61, v42
    v_dot2c_f32_bf16 v94, s60, v43
    v_dot2c_f32_bf16 v95, s61, v43
    v_dot2c_f32_bf16 v88, s60, v44
    v_dot2c_f32_bf16 v89, s61, v44
    v_dot2c_f32_bf16 v90, s60, v45
    v_dot2c_f32_bf16 v91, s61, v45
    v_dot2c_f32_bf16 v92, s60, v46
    v_dot2c_f32_bf16 v93, s61, v46
    v_dot2c_f32_bf16 v94, s60, v47
    v_dot2c_f32_bf16 v95, s61, v47
    v_dot2c_f32_bf16 v88, s60, v48
    v_dot2c_f32_bf16 v89, s61, v48
    v_dot2c_f32_bf16 v90, s60, v49
    v_dot2c_f32_bf16 v91, s61, v49
    v_dot2c_f32_bf16 v92, s60, v50
    v_dot2c_f32_bf16 v93, s61, v50
    v_dot2c_f32_bf16 v94, s60, v51
    v_dot2c_f32_bf16 v95, s61, v51
    v_dot2c_f32_bf16 v88, s60, v52
    v_dot2c_f32_bf16 v89, s61, v52
    v_dot2c_f32_bf16 v90, s60, v53
    v_dot2c_f32_bf16 v91, s61, v53
    v_dot2c_f32_bf16 v92, s60, v54
    v_dot2c_f32_bf16 v93, s61, v54
    v_dot2c_f32_bf16 v94, s60, v55
    v_dot2c_f32_bf16 v95, s61, v55
    v_add_f32_dpp v88, v88, v88 row_ror:8 row_mask:0xf bank_mask:0xf
    v_add_f32_dpp v89, v89, v89 row_ror:8 row_mask:0xf bank_mask:0xf
    v_add_f32_dpp v90, v90, v90 row_ror:8 row_mask:0xf bank_mask:0xf
    v_add_f32_dpp v91, v91, v91 row_ror:8 row_mask:0xf bank_mask:0xf
    v_add_f32_dpp v92, v92, v92 row_ror:8 row_mask:0xf bank_mask:0xf
    v_add_f32_dpp v93, v93, v93 row_ror:8 row_mask:0xf bank_mask:0xf
    v_add_f32_dpp v94, v94, v94 row_ror:8 row_mask:0xf bank_mask:0xf
    v_add_f32_dpp v95, v95, v95 row_ror:8 row_mask:0xf bank_mask:0xf
    v_mov_b32 v96, 0
    v_mov_b32 v97, 0
    v_mov_b32 v98, 0
    v_mov_b32 v99, 0
    v_mov_b32 v100, 0
    v_mov_b32 v101, 0
    v_mov_b32 v102, 0
    v_mov_b32 v103, 0
    s_waitcnt vmcnt(0)
    v_dot2c_f32_bf16 v96, s60, v56
    v_dot2c_f32_bf16 v97, s61, v56
    v_dot2c_f32_bf16 v98, s60, v57
    v_dot2c_f32_bf16 v99, s61, v57
    v_dot2c_f32_bf16 v100, s60, v58
    v_dot2c_f32_bf16 v101, s61, v58
    v_dot2c_f32_bf16 v102, s60, v59
    v_dot2c_f32_bf16 v103, s61, v59
    v_dot2c_f32_bf16 v96, s60, v60
    v_dot2c_f32_bf16 v97, s61, v60
    v_dot2c_f32_bf16 v98, s60, v61
    v_dot2c_f32_bf16 v99, s61, v61
    v_dot2c_f32_bf16 v100, s60, v62
    v_dot2c_f32_bf16 v101, s61, v62
    v_dot2c_f32_bf16 v102, s60, v63
    v_dot2c_f32_bf16 v103, s61, v63
    v_dot2c_f32_bf16 v96, s60, v64
    v_dot2c_f32_bf16 v97, s61, v64
    v_dot2c_f32_bf16 v98, s60, v65
    v_dot2c_f32_bf16 v99, s61, v65
    v_dot2c_f32_bf16 v100, s60, v66
    v_dot2c_f32_bf16 v101, s61, v66
    v_dot2c_f32_bf16 v102, s60, v67
    v_dot2c_f32_bf16 v103, s61, v67
    v_dot2c_f32_bf16 v96, s60, v68
    v_dot2c_f32_bf16 v97, s61, v68
    v_dot2c_f32_bf16 v98, s60, v69
    v_dot2c_f32_bf16 v99, s61, v69
    v_dot2c_f32_bf16 v100, s60, v70
    v_dot2c_f32_bf16 v101, s61, v70
    v_dot2c_f32_bf16 v102, s60, v71
    v_dot2c_f32_bf16 v103, s61, v71
    v_dot2c_f32_bf16 v96, s60, v72
    v_dot2c_f32_bf16 v97, s61, v72
    v_dot2c_f32_bf16 v98, s60, v73
    v_dot2c_f32_bf16 v99, s61, v73
    v_dot2c_f32_bf16 v100, s60, v74
    v_dot2c_f32_bf16 v101, s61, v74
    v_dot2c_f32_bf16 v102, s60, v75
    v_dot2c_f32_bf16 v103, s61, v75
    v_add_f32_dpp v96, v96, v96 row_ror:8 row_mask:0xf bank_mask:0xf
    v_add_f32_dpp v97, v97, v97 row_ror:8 row_mask:0xf bank_mask:0xf
    v_add_f32_dpp v98, v98, v98 row_ror:8 row_mask:0xf bank_mask:0xf
    v_add_f32_dpp v99, v99, v99 row_ror:8 row_mask:0xf bank_mask:0xf
    v_add_f32_dpp v100, v100, v100 row_ror:8 row_mask:0xf bank_mask:0xf
    v_add_f32_dpp v101, v101, v101 row_ror:8 row_mask:0xf bank_mask:0xf
    v_add_f32_dpp v102, v102, v102 row_ror:8 row_mask:0xf bank_mask:0xf
    v_add_f32_dpp v103, v103, v103 row_ror:8 row_mask:0xf bank_mask:0xf
    v_mov_b32 v10, v80
    s_nop 1
    v_permlane16_swap_b32 v80, v10
    v_add_f32 v80, v80, v10
    v_mov_b32 v11, v80
    s_nop 1
    v_permlane32_swap_b32 v80, v11
    v_add_f32 v80, v80, v11
    v_mov_b32 v10, v81
    s_nop 1
    v_permlane16_swap_b32 v81, v10
    v_add_f32 v81, v81, v10
    v_mov_b32 v11, v81
    s_nop 1
    v_permlane32_swap_b32 v81, v11
    v_add_f32 v81, v81, v11
    v_mov_b32 v10, v82
    s_nop 1
    v_permlane16_swap_b32 v82, v10
    v_add_f32 v82, v82, v10
    v_mov_b32 v11, v82
    s_nop 1
    v_permlane32_swap_b32 v82, v11
    v_add_f32 v82, v82, v11
    v_mov_b32 v10, v83
    s_nop 1
    v_permlane16_swap_b32 v83, v10
    v_add_f32 v83, v83, v10
    v_mov_b32 v11, v83
    s_nop 1
    v_permlane32_swap_b32 v83, v11
    v_add_f32 v83, v83, v11
    v_mov_b32 v10, v84
    s_nop 1
    v_permlane16_swap_b32 v84, v10
    v_add_f32 v84, v84, v10
    v_mov_b32 v11, v84
    s_nop 1
    v_permlane32_swap_b32 v84, v11
    v_add_f32 v84, v84, v11
    v_mov_b32 v10, v85
    s_nop 1
    v_permlane16_swap_b32 v85, v10
    v_add_f32 v85, v85, v10
    v_mov_b32 v11, v85
    s_nop 1
    v_permlane32_swap_b32 v85, v11
    v_add_f32 v85, v85, v11
    v_mov_b32 v10, v86
    s_nop 1
    v_permlane16_swap_b32 v86, v10
    v_add_f32 v86, v86, v10
    v_mov_b32 v11, v86
    s_nop 1
    v_permlane32_swap_b32 v86, v11
    v_add_f32 v86, v86, v11
    v_mov_b32 v10, v87
    s_nop 1
    v_permlane16_swap_b32 v87, v10
    v_add_f32 v87, v87, v10
    v_mov_b32 v11, v87
    s_nop 1
    v_permlane32_swap_b32 v87, v11
    v_add_f32 v87, v87, v11
    v_mov_b32 v10, v88
    s_nop 1
    v_permlane16_swap_b32 v88, v10
    v_add_f32 v88, v88, v10
    v_mov_b32 v11, v88
    s_nop 1
    v_permlane32_swap_b32 v88, v11
    v_add_f32 v88, v88, v11
    v_mov_b32 v10, v89
    s_nop 1
    v_permlane16_swap_b32 v89, v10
    v_add_f32 v89, v89, v10
    v_mov_b32 v11, v89
    s_nop 1
    v_permlane32_swap_b32 v89, v11
    v_add_f32 v89, v89, v11
    v_mov_b32 v10, v90
    s_nop 1
    v_permlane16_swap_b32 v90, v10
    v_add_f32 v90, v90, v10
    v_mov_b32 v11, v90
    s_nop 1
    v_permlane32_swap_b32 v90, v11
    v_add_f32 v90, v90, v11
    v_mov_b32 v10, v91
    s_nop 1
    v_permlane16_swap_b32 v91, v10
    v_add_f32 v91, v91, v10
    v_mov_b32 v11, v91
    s_nop 1
    v_permlane32_swap_b32 v91, v11
    v_add_f32 v91, v91, v11
    v_mov_b32 v10, v92
    s_nop 1
    v_permlane16_swap_b32 v92, v10
    v_add_f32 v92, v92, v10
    v_mov_b32 v11, v92
    s_nop 1
    v_permlane32_swap_b32 v92, v11
    v_add_f32 v92, v92, v11
    v_mov_b32 v10, v93
    s_nop 1
    v_permlane16_swap_b32 v93, v10
    v_add_f32 v93, v93, v10
    v_mov_b32 v11, v93
    s_nop 1
    v_permlane32_swap_b32 v93, v11
    v_add_f32 v93, v93, v11
    v_mov_b32 v10, v94
    s_nop 1
    v_permlane16_swap_b32 v94, v10
    v_add_f32 v94, v94, v10
    v_mov_b32 v11, v94
    s_nop 1
    v_permlane32_swap_b32 v94, v11
    v_add_f32 v94, v94, v11
    v_mov_b32 v10, v95
    s_nop 1
    v_permlane16_swap_b32 v95, v10
    v_add_f32 v95, v95, v10
    v_mov_b32 v11, v95
    s_nop 1
    v_permlane32_swap_b32 v95, v11
    v_add_f32 v95, v95, v11
    v_mov_b32 v10, v96
    s_nop 1
    v_permlane16_swap_b32 v96, v10
    v_add_f32 v96, v96, v10
    v_mov_b32 v11, v96
    s_nop 1
    v_permlane32_swap_b32 v96, v11
    v_add_f32 v96, v96, v11
    v_mov_b32 v10, v97
    s_nop 1
    v_permlane16_swap_b32 v97, v10
    v_add_f32 v97, v97, v10
    v_mov_b32 v11, v97
    s_nop 1
    v_permlane32_swap_b32 v97, v11
    v_add_f32 v97, v97, v11
    v_mov_b32 v10, v98
    s_nop 1
    v_permlane16_swap_b32 v98, v10
    v_add_f32 v98, v98, v10
    v_mov_b32 v11, v98
    s_nop 1
    v_permlane32_swap_b32 v98, v11
    v_add_f32 v98, v98, v11
    v_mov_b32 v10, v99
    s_nop 1
    v_permlane16_swap_b32 v99, v10
    v_add_f32 v99, v99, v10
    v_mov_b32 v11, v99
    s_nop 1
    v_permlane32_swap_b32 v99, v11
    v_add_f32 v99, v99, v11
    v_mov_b32 v10, v100
    s_nop 1
    v_permlane16_swap_b32 v100, v10
    v_add_f32 v100, v100, v10
    v_mov_b32 v11, v100
    s_nop 1
    v_permlane32_swap_b32 v100, v11
    v_add_f32 v100, v100, v11
    v_mov_b32 v10, v101
    s_nop 1
    v_permlane16_swap_b32 v101, v10
    v_add_f32 v101, v101, v10
    v_mov_b32 v11, v101
    s_nop 1
    v_permlane32_swap_b32 v101, v11
    v_add_f32 v101, v101, v11
    v_mov_b32 v10, v102
    s_nop 1
    v_permlane16_swap_b32 v102, v10
    v_add_f32 v102, v102, v10
    v_mov_b32 v11, v102
    s_nop 1
    v_permlane32_swap_b32 v102, v11
    v_add_f32 v102, v102, v11
    v_mov_b32 v10, v103
    s_nop 1
    v_permlane16_swap_b32 v103, v10
    v_add_f32 v103, v103, v10
    v_mov_b32 v11, v103
    s_nop 1
    v_permlane32_swap_b32 v103, v11
    v_add_f32 v103, v103, v11
    s_lshl_b32 s4, s3, 8
    v_add_u32 v9, s4, v7
    v_cmp_gt_u32 vcc, 8, v1
    s_nop 1
    s_and_saveexec_b64 s[62:63], vcc
    ds_write_b128 v9, v[80:83] offset:0
    ds_write_b128 v9, v[84:87] offset:16
    ds_write_b128 v9, v[88:91] offset:2048
    ds_write_b128 v9, v[92:95] offset:2064
    ds_write_b128 v9, v[96:99] offset:4096
    ds_write_b128 v9, v[100:103] offset:4112
    s_mov_b64 exec, s[62:63]
    s_waitcnt lgkmcnt(0)
    s_barrier
    s_cmp_ge_u32 s3, 3
    s_cbranch_scc1 m1_cs_done
    s_lshl_b32 s4, s3, 11
    v_add_u32 v9, s4, v6
    ds_read_b32 v16, v9 offset:0
    ds_read_b32 v17, v9 offset:256
    ds_read_b32 v18, v9 offset:512
    ds_read_b32 v19, v9 offset:768
    ds_read_b32 v20, v9 offset:1024
    ds_read_b32 v21, v9 offset:1280
    ds_read_b32 v22, v9 offset:1536
    ds_read_b32 v23, v9 offset:1792
    s_cmp_eq_u32 s3, 1
    s_cselect_b32 s4, s57, s56
    s_cmp_eq_u32 s3, 2
    s_cselect_b32 s4, s58, s4
    s_waitcnt lgkmcnt(0)
    v_add_f32 v16, v16, v17
    v_add_f32 v16, v16, v18
    v_add_f32 v16, v16, v19
    v_add_f32 v16, v16, v20
    v_add_f32 v16, v16, v21
    v_add_f32 v16, v16, v22
    v_add_f32 v16, v16, v23
    buffer_store_dword v16, v6, s[52:55], s4 offen sc1
    s_branch m1_cs_done
m1_cs_done:
    s_add_u32 s84, s40, 34656256
    s_addc_u32 s85, s41, 0
    s_mov_b32 s86, 22528
    s_mov_b32 s87, 0x20000
    s_add_u32 s88, s96, 2000
    s_addc_u32 s89, s97, 0
    v_mov_b32 v22, s88
    v_mov_b32 v23, s89
    v_mov_b32 v20, s95
    s_waitcnt vmcnt(0) lgkmcnt(0)
    s_barrier
    s_cmp_lg_u32 s3, 0
    s_cbranch_scc1 pb14
    s_cmp_eq_u32 s95, -1
    s_cbranch_scc1 pb14
    s_mov_b64 s[90:91], exec
    s_mov_b64 exec, 1
    buffer_store_dwordx2 v[22:23], v20, s[84:87], 0 offen sc1
    s_mov_b64 exec, s[90:91]
pb14:
    s_lshl_b32 s78, s44, 3
    s_add_u32 s78, s78, s3
    v_lshlrev_b32 v60, 7, v1
    s_mov_b32 s64, s34
    s_mov_b32 s65, s35
    s_mov_b32 s66, 1966080
    s_mov_b32 s67, 0x20000
    s_mul_i32 s68, s78, 15360
    s_add_u32 s69, s68, 0
    buffer_load_dword v61, v60, s[64:67], s69 offen
    v_cmp_gt_u32 vcc, 56, v1
    s_nop 1
    s_and_saveexec_b64 s[70:71], vcc
    s_add_u32 s69, s68, 8192
    buffer_load_dword v62, v60, s[64:67], s69 offen
    s_mov_b64 exec, s[70:71]
    s_mov_b32 s95, -1
    s_branch m2_skip
m1_end:
    s_add_u32 s84, s40, 34656256
    s_addc_u32 s85, s41, 0
    s_mov_b32 s86, 22528
    s_mov_b32 s87, 0x20000
    s_add_u32 s88, s96, 2000
    s_addc_u32 s89, s97, 0
    v_mov_b32 v22, s88
    v_mov_b32 v23, s89
    v_mov_b32 v20, s95
    s_waitcnt vmcnt(0) lgkmcnt(0)
    s_barrier
    s_cmp_lg_u32 s3, 0
    s_cbranch_scc1 pb15
    s_cmp_eq_u32 s95, -1
    s_cbranch_scc1 pb15
    s_mov_b64 s[90:91], exec
    s_mov_b64 exec, 1
    buffer_store_dwordx2 v[22:23], v20, s[84:87], 0 offen sc1
    s_mov_b64 exec, s[90:91]
pb15:
    s_and_b32 s4, s2, 7
    s_lshr_b32 s5, s2, 3
    s_lshl_b32 s6, s4, 2
    s_and_b32 s7, s5, 3
    s_add_u32 s44, s6, s7
    s_lshr_b32 s45, s5, 2
    s_cmp_ge_u32 s5, 20
    s_cbranch_scc1 m2_skip
    s_add_u32 s88, s44, 80
    s_lshl_b32 s88, s88, 7
    s_lshl_b32 s89, s45, 3
    s_add_u32 s95, s88, s89
    s_cmp_ge_u32 s3, 4
    s_cbranch_scc1 m2_load
    s_and_b32 s4, s3, 1
    s_lshr_b32 s5, s3, 1
    s_lshl_b32 s42, s5, 12
    v_and_b32 v10, 31, v1
    v_lshlrev_b32 v10, 7, v10
    v_lshrrev_b32 v11, 5, v1
    v_bfe_u32 v12, v1, 1, 3
    v_xor_b32 v11, v11, v12
    v_add_u32 v10, s42, v10
    v_xor_b32 v12, 0, v11
    v_lshl_add_u32 v208, v12, 4, v10
    v_xor_b32 v12, 2, v11
    v_lshl_add_u32 v209, v12, 4, v10
    v_xor_b32 v12, 4, v11
    v_lshl_add_u32 v210, v12, 4, v10
    v_xor_b32 v12, 6, v11
    v_lshl_add_u32 v211, v12, 4, v10
    v_lshrrev_b32 v10, 5, v1
    v_lshlrev_b32 v10, 3, v10
    v_bfe_u32 v11, v1, 2, 2
    v_add_u32 v10, v10, v11
    v_lshlrev_b32 v10, 7, v10
    v_bfe_u32 v11, v1, 3, 1
    v_lshlrev_b32 v11, 6, v11
    v_or_b32 v10, v10, v11
    v_bfe_u32 v11, v1, 4, 1
    v_lshlrev_b32 v11, 5, v11
    v_or_b32 v10, v10, v11
    v_bfe_u32 v11, v1, 1, 1
    v_lshlrev_b32 v11, 4, v11
    v_or_b32 v10, v10, v11
    v_and_b32 v11, 1, v1
    v_lshlrev_b32 v11, 3, v11
    v_or_b32 v224, v10, v11
    s_lshl_b32 s42, s4, 13
    s_add_u32 s42, s42, 8192
    v_add_u32 v224, s42, v224
    v_xor_b32 v225, 64, v224
    s_lshl_b32 s60, s5, 5
    s_lshl_b32 s62, s4, 3
    v_and_b32 v10, 31, v1
    v_add_u32 v10, s60, v10
    v_and_b32 v13, 15, v10
    v_mul_u32_u24 v12, 256, v10
    v_lshrrev_b32 v10, 5, v1
    v_lshl_add_u32 v12, v10, 3, v12
    s_add_u32 s42, s62, 0
    v_xor_b32 v14, s42, v13
    v_lshl_add_u32 v184, v14, 4, v12
    s_add_u32 s42, s62, 1
    v_xor_b32 v14, s42, v13
    v_lshl_add_u32 v185, v14, 4, v12
    s_add_u32 s42, s62, 2
    v_xor_b32 v14, s42, v13
    v_lshl_add_u32 v186, v14, 4, v12
    s_add_u32 s42, s62, 3
    v_xor_b32 v14, s42, v13
    v_lshl_add_u32 v187, v14, 4, v12
    s_add_u32 s42, s62, 4
    v_xor_b32 v14, s42, v13
    v_lshl_add_u32 v188, v14, 4, v12
    s_add_u32 s42, s62, 5
    v_xor_b32 v14, s42, v13
    v_lshl_add_u32 v189, v14, 4, v12
    s_add_u32 s42, s62, 6
    v_xor_b32 v14, s42, v13
    v_lshl_add_u32 v190, v14, 4, v12
    s_add_u32 s42, s62, 7
    v_xor_b32 v14, s42, v13
    v_lshl_add_u32 v191, v14, 4, v12
    s_cmp_lg_u32 s3, 0
    s_cbranch_scc1 dw16
    s_add_u32 s84, s40, 34656256
    s_addc_u32 s85, s41, 0
    s_mov_b32 s86, 22528
    s_mov_b32 s87, 0x20000
    v_mul_u32_u24 v237, 52, v1
    v_lshrrev_b32 v237, 8, v237
    v_mul_u32_u24 v236, 5, v237
    v_sub_u32 v236, v1, v236
    s_sub_u32 s90, s44, 1
    v_add_u32 v237, s90, v237
    v_lshlrev_b32 v236, 3, v236
    v_add_u32 v242, 16, v237
    v_lshl_add_u32 v236, v242, 7, v236
    v_cmp_gt_u32 s[92:93], 32, v237
    v_cmp_gt_u32 vcc, 15, v1
    s_nop 1
    s_and_b64 vcc, vcc, s[92:93]
    s_and_saveexec_b64 s[88:89], vcc
    s_cbranch_execz pd18
    v_mov_b32 v240, s96
    v_mov_b32 v241, s97
    s_mov_b32 s90, 0
pl17:
    buffer_load_dwordx2 v[238:239], v236, s[84:87], 0 offen sc1
    s_waitcnt vmcnt(0)
    v_sub_co_u32 v238, vcc, v238, v240
    s_nop 1
    v_subb_co_u32 v239, vcc, v239, v241, vcc
    v_cmp_eq_u32 s[92:93], 0, v239
    s_mov_b32 s91, 16777216
    v_cmp_gt_u32 vcc, s91, v238
    s_nop 1
    s_and_b64 vcc, vcc, s[92:93]
    s_cmp_eq_u64 vcc, exec
    s_cbranch_scc1 pd18
    s_add_u32 s90, s90, 1
    s_cmp_lt_u32 s90, 262144
    s_cbranch_scc1 pl17
pd18:
    s_mov_b64 exec, s[88:89]
dw16:
    s_barrier
    v_add_u32 v212, 73728, v208
    v_add_u32 v213, 73728, v209
    v_add_u32 v214, 73728, v210
    v_add_u32 v215, 73728, v211
    v_add_u32 v226, 73728, v224
    v_add_u32 v227, 73728, v225
    s_barrier
    ds_read_b128 v[48:51], v208 offset:0
    ds_read_b64_tr_b16 v[52:53], v224 offset:0
    ds_read_b64_tr_b16 v[54:55], v224 offset:512
    ds_read_b64_tr_b16 v[56:57], v225 offset:0
    ds_read_b64_tr_b16 v[58:59], v225 offset:512
    ds_read_b128 v[60:63], v209 offset:0
    ds_read_b64_tr_b16 v[64:65], v224 offset:2048
    ds_read_b64_tr_b16 v[66:67], v224 offset:2560
    ds_read_b64_tr_b16 v[68:69], v225 offset:2048
    ds_read_b64_tr_b16 v[70:71], v225 offset:2560
    ds_read_b128 v[72:75], v210 offset:0
    ds_read_b64_tr_b16 v[76:77], v224 offset:4096
    ds_read_b64_tr_b16 v[78:79], v224 offset:4608
    ds_read_b64_tr_b16 v[80:81], v225 offset:4096
    ds_read_b64_tr_b16 v[82:83], v225 offset:4608
    s_waitcnt lgkmcnt(10)
    v_mfma_f32_32x32x16_bf16 v[16:31], v[52:55], v[48:51], 0
    ds_read_b128 v[84:87], v211 offset:0
    ds_read_b64_tr_b16 v[88:89], v224 offset:6144
    ds_read_b64_tr_b16 v[90:91], v224 offset:6656
    v_mfma_f32_32x32x16_bf16 v[32:47], v[56:59], v[48:51], 0
    ds_read_b64_tr_b16 v[92:93], v225 offset:6144
    ds_read_b64_tr_b16 v[94:95], v225 offset:6656
    s_waitcnt lgkmcnt(10)
    s_barrier
    v_mfma_f32_32x32x16_bf16 v[16:31], v[64:67], v[60:63], v[16:31]
    ds_read_b128 v[48:51], v208 offset:24576
    ds_read_b64_tr_b16 v[52:53], v224 offset:24576
    ds_read_b64_tr_b16 v[54:55], v224 offset:25088
    v_mfma_f32_32x32x16_bf16 v[32:47], v[68:71], v[60:63], v[32:47]
    ds_read_b64_tr_b16 v[56:57], v225 offset:24576
    ds_read_b64_tr_b16 v[58:59], v225 offset:25088
    s_waitcnt lgkmcnt(10)
    v_mfma_f32_32x32x16_bf16 v[16:31], v[76:79], v[72:75], v[16:31]
    ds_read_b128 v[60:63], v209 offset:24576
    ds_read_b64_tr_b16 v[64:65], v224 offset:26624
    ds_read_b64_tr_b16 v[66:67], v224 offset:27136
    v_mfma_f32_32x32x16_bf16 v[32:47], v[80:83], v[72:75], v[32:47]
    ds_read_b64_tr_b16 v[68:69], v225 offset:26624
    ds_read_b64_tr_b16 v[70:71], v225 offset:27136
    s_waitcnt lgkmcnt(10)
    v_mfma_f32_32x32x16_bf16 v[16:31], v[88:91], v[84:87], v[16:31]
    ds_read_b128 v[72:75], v210 offset:24576
    ds_read_b64_tr_b16 v[76:77], v224 offset:28672
    ds_read_b64_tr_b16 v[78:79], v224 offset:29184
    v_mfma_f32_32x32x16_bf16 v[32:47], v[92:95], v[84:87], v[32:47]
    ds_read_b64_tr_b16 v[80:81], v225 offset:28672
    ds_read_b64_tr_b16 v[82:83], v225 offset:29184
    s_waitcnt lgkmcnt(10)
    v_mfma_f32_32x32x16_bf16 v[16:31], v[52:55], v[48:51], v[16:31]
    ds_read_b128 v[84:87], v211 offset:24576
    ds_read_b64_tr_b16 v[88:89], v224 offset:30720
    ds_read_b64_tr_b16 v[90:91], v224 offset:31232
    v_mfma_f32_32x32x16_bf16 v[32:47], v[56:59], v[48:51], v[32:47]
    ds_read_b64_tr_b16 v[92:93], v225 offset:30720
    ds_read_b64_tr_b16 v[94:95], v225 offset:31232
    s_waitcnt lgkmcnt(10)
    s_barrier
    v_mfma_f32_32x32x16_bf16 v[16:31], v[64:67], v[60:63], v[16:31]
    ds_read_b128 v[48:51], v208 offset:49152
    ds_read_b64_tr_b16 v[52:53], v224 offset:49152
    ds_read_b64_tr_b16 v[54:55], v224 offset:49664
    v_mfma_f32_32x32x16_bf16 v[32:47], v[68:71], v[60:63], v[32:47]
    ds_read_b64_tr_b16 v[56:57], v225 offset:49152
    ds_read_b64_tr_b16 v[58:59], v225 offset:49664
    s_waitcnt lgkmcnt(10)
    v_mfma_f32_32x32x16_bf16 v[16:31], v[76:79], v[72:75], v[16:31]
    ds_read_b128 v[60:63], v209 offset:49152
    ds_read_b64_tr_b16 v[64:65], v224 offset:51200
    ds_read_b64_tr_b16 v[66:67], v224 offset:51712
    v_mfma_f32_32x32x16_bf16 v[32:47], v[80:83], v[72:75], v[32:47]
    ds_read_b64_tr_b16 v[68:69], v225 offset:51200
    ds_read_b64_tr_b16 v[70:71], v225 offset:51712
    s_waitcnt lgkmcnt(10)
    v_mfma_f32_32x32x16_bf16 v[16:31], v[88:91], v[84:87], v[16:31]
    ds_read_b128 v[72:75], v210 offset:49152
    ds_read_b64_tr_b16 v[76:77], v224 offset:53248
    ds_read_b64_tr_b16 v[78:79], v224 offset:53760
    v_mfma_f32_32x32x16_bf16 v[32:47], v[92:95], v[84:87], v[32:47]
    ds_read_b64_tr_b16 v[80:81], v225 offset:53248
    ds_read_b64_tr_b16 v[82:83], v225 offset:53760
    s_waitcnt lgkmcnt(10)
    v_mfma_f32_32x32x16_bf16 v[16:31], v[52:55], v[48:51], v[16:31]
    ds_read_b128 v[84:87], v211 offset:49152
    ds_read_b64_tr_b16 v[88:89], v224 offset:55296
    ds_read_b64_tr_b16 v[90:91], v224 offset:55808
    v_mfma_f32_32x32x16_bf16 v[32:47], v[56:59], v[48:51], v[32:47]
    ds_read_b64_tr_b16 v[92:93], v225 offset:55296
    ds_read_b64_tr_b16 v[94:95], v225 offset:55808
    s_waitcnt lgkmcnt(10)
    s_barrier
    v_mfma_f32_32x32x16_bf16 v[16:31], v[64:67], v[60:63], v[16:31]
    ds_read_b128 v[48:51], v212 offset:0
    ds_read_b64_tr_b16 v[52:53], v226 offset:0
    ds_read_b64_tr_b16 v[54:55], v226 offset:512
    v_mfma_f32_32x32x16_bf16 v[32:47], v[68:71], v[60:63], v[32:47]
    ds_read_b64_tr_b16 v[56:57], v227 offset:0
    ds_read_b64_tr_b16 v[58:59], v227 offset:512
    s_waitcnt lgkmcnt(10)
    v_mfma_f32_32x32x16_bf16 v[16:31], v[76:79], v[72:75], v[16:31]
    ds_read_b128 v[60:63], v213 offset:0
    ds_read_b64_tr_b16 v[64:65], v226 offset:2048
    ds_read_b64_tr_b16 v[66:67], v226 offset:2560
    v_mfma_f32_32x32x16_bf16 v[32:47], v[80:83], v[72:75], v[32:47]
    ds_read_b64_tr_b16 v[68:69], v227 offset:2048
    ds_read_b64_tr_b16 v[70:71], v227 offset:2560
    s_waitcnt lgkmcnt(10)
    v_mfma_f32_32x32x16_bf16 v[16:31], v[88:91], v[84:87], v[16:31]
    ds_read_b128 v[72:75], v214 offset:0
    ds_read_b64_tr_b16 v[76:77], v226 offset:4096
    ds_read_b64_tr_b16 v[78:79], v226 offset:4608
    v_mfma_f32_32x32x16_bf16 v[32:47], v[92:95], v[84:87], v[32:47]
    ds_read_b64_tr_b16 v[80:81], v227 offset:4096
    ds_read_b64_tr_b16 v[82:83], v227 offset:4608
    s_waitcnt lgkmcnt(10)
    v_mfma_f32_32x32x16_bf16 v[16:31], v[52:55], v[48:51], v[16:31]
    ds_read_b128 v[84:87], v215 offset:0
    ds_read_b64_tr_b16 v[88:89], v226 offset:6144
    ds_read_b64_tr_b16 v[90:91], v226 offset:6656
    v_mfma_f32_32x32x16_bf16 v[32:47], v[56:59], v[48:51], v[32:47]
    ds_read_b64_tr_b16 v[92:93], v227 offset:6144
    ds_read_b64_tr_b16 v[94:95], v227 offset:6656
    s_waitcnt lgkmcnt(10)
    s_barrier
    v_mfma_f32_32x32x16_bf16 v[16:31], v[64:67], v[60:63], v[16:31]
    ds_read_b128 v[48:51], v212 offset:24576
    ds_read_b64_tr_b16 v[52:53], v226 offset:24576
    ds_read_b64_tr_b16 v[54:55], v226 offset:25088
    v_mfma_f32_32x32x16_bf16 v[32:47], v[68:71], v[60:63], v[32:47]
    ds_read_b64_tr_b16 v[56:57], v227 offset:24576
    ds_read_b64_tr_b16 v[58:59], v227 offset:25088
    s_waitcnt lgkmcnt(10)
    v_mfma_f32_32x32x16_bf16 v[16:31], v[76:79], v[72:75], v[16:31]
    ds_read_b128 v[60:63], v213 offset:24576
    ds_read_b64_tr_b16 v[64:65], v226 offset:26624
    ds_read_b64_tr_b16 v[66:67], v226 offset:27136
    v_mfma_f32_32x32x16_bf16 v[32:47], v[80:83], v[72:75], v[32:47]
    ds_read_b64_tr_b16 v[68:69], v227 offset:26624
    ds_read_b64_tr_b16 v[70:71], v227 offset:27136
    s_waitcnt lgkmcnt(10)
    v_mfma_f32_32x32x16_bf16 v[16:31], v[88:91], v[84:87], v[16:31]
    ds_read_b128 v[72:75], v214 offset:24576
    ds_read_b64_tr_b16 v[76:77], v226 offset:28672
    ds_read_b64_tr_b16 v[78:79], v226 offset:29184
    v_mfma_f32_32x32x16_bf16 v[32:47], v[92:95], v[84:87], v[32:47]
    ds_read_b64_tr_b16 v[80:81], v227 offset:28672
    ds_read_b64_tr_b16 v[82:83], v227 offset:29184
    s_waitcnt lgkmcnt(10)
    v_mfma_f32_32x32x16_bf16 v[16:31], v[52:55], v[48:51], v[16:31]
    ds_read_b128 v[84:87], v215 offset:24576
    ds_read_b64_tr_b16 v[88:89], v226 offset:30720
    ds_read_b64_tr_b16 v[90:91], v226 offset:31232
    v_mfma_f32_32x32x16_bf16 v[32:47], v[56:59], v[48:51], v[32:47]
    ds_read_b64_tr_b16 v[92:93], v227 offset:30720
    ds_read_b64_tr_b16 v[94:95], v227 offset:31232
    s_waitcnt lgkmcnt(10)
    s_barrier
    v_mfma_f32_32x32x16_bf16 v[16:31], v[64:67], v[60:63], v[16:31]
    ds_read_b128 v[48:51], v212 offset:49152
    ds_read_b64_tr_b16 v[52:53], v226 offset:49152
    ds_read_b64_tr_b16 v[54:55], v226 offset:49664
    v_mfma_f32_32x32x16_bf16 v[32:47], v[68:71], v[60:63], v[32:47]
    ds_read_b64_tr_b16 v[56:57], v227 offset:49152
    ds_read_b64_tr_b16 v[58:59], v227 offset:49664
    s_waitcnt lgkmcnt(10)
    v_mfma_f32_32x32x16_bf16 v[16:31], v[76:79], v[72:75], v[16:31]
    ds_read_b128 v[60:63], v213 offset:49152
    ds_read_b64_tr_b16 v[64:65], v226 offset:51200
    ds_read_b64_tr_b16 v[66:67], v226 offset:51712
    v_mfma_f32_32x32x16_bf16 v[32:47], v[80:83], v[72:75], v[32:47]
    ds_read_b64_tr_b16 v[68:69], v227 offset:51200
    ds_read_b64_tr_b16 v[70:71], v227 offset:51712
    s_waitcnt lgkmcnt(10)
    v_mfma_f32_32x32x16_bf16 v[16:31], v[88:91], v[84:87], v[16:31]
    ds_read_b128 v[72:75], v214 offset:49152
    ds_read_b64_tr_b16 v[76:77], v226 offset:53248
    ds_read_b64_tr_b16 v[78:79], v226 offset:53760
    v_mfma_f32_32x32x16_bf16 v[32:47], v[92:95], v[84:87], v[32:47]
    ds_read_b64_tr_b16 v[80:81], v227 offset:53248
    ds_read_b64_tr_b16 v[82:83], v227 offset:53760
    s_waitcnt lgkmcnt(10)
    v_mfma_f32_32x32x16_bf16 v[16:31], v[52:55], v[48:51], v[16:31]
    ds_read_b128 v[84:87], v215 offset:49152
    ds_read_b64_tr_b16 v[88:89], v226 offset:55296
    ds_read_b64_tr_b16 v[90:91], v226 offset:55808
    v_mfma_f32_32x32x16_bf16 v[32:47], v[56:59], v[48:51], v[32:47]
    ds_read_b64_tr_b16 v[92:93], v227 offset:55296
    ds_read_b64_tr_b16 v[94:95], v227 offset:55808
    s_waitcnt lgkmcnt(10)
    s_barrier
    v_mfma_f32_32x32x16_bf16 v[16:31], v[64:67], v[60:63], v[16:31]
    ds_read_b128 v[48:51], v208 offset:0
    ds_read_b64_tr_b16 v[52:53], v224 offset:0
    ds_read_b64_tr_b16 v[54:55], v224 offset:512
    v_mfma_f32_32x32x16_bf16 v[32:47], v[68:71], v[60:63], v[32:47]
    ds_read_b64_tr_b16 v[56:57], v225 offset:0
    ds_read_b64_tr_b16 v[58:59], v225 offset:512
    s_waitcnt lgkmcnt(10)
    v_mfma_f32_32x32x16_bf16 v[16:31], v[76:79], v[72:75], v[16:31]
    ds_read_b128 v[60:63], v209 offset:0
    ds_read_b64_tr_b16 v[64:65], v224 offset:2048
    ds_read_b64_tr_b16 v[66:67], v224 offset:2560
    v_mfma_f32_32x32x16_bf16 v[32:47], v[80:83], v[72:75], v[32:47]
    ds_read_b64_tr_b16 v[68:69], v225 offset:2048
    ds_read_b64_tr_b16 v[70:71], v225 offset:2560
    s_waitcnt lgkmcnt(10)
    v_mfma_f32_32x32x16_bf16 v[16:31], v[88:91], v[84:87], v[16:31]
    ds_read_b128 v[72:75], v210 offset:0
    ds_read_b64_tr_b16 v[76:77], v224 offset:4096
    ds_read_b64_tr_b16 v[78:79], v224 offset:4608
    v_mfma_f32_32x32x16_bf16 v[32:47], v[92:95], v[84:87], v[32:47]
    ds_read_b64_tr_b16 v[80:81], v225 offset:4096
    ds_read_b64_tr_b16 v[82:83], v225 offset:4608
    s_waitcnt lgkmcnt(10)
    v_mfma_f32_32x32x16_bf16 v[16:31], v[52:55], v[48:51], v[16:31]
    ds_read_b128 v[84:87], v211 offset:0
    ds_read_b64_tr_b16 v[88:89], v224 offset:6144
    ds_read_b64_tr_b16 v[90:91], v224 offset:6656
    v_mfma_f32_32x32x16_bf16 v[32:47], v[56:59], v[48:51], v[32:47]
    ds_read_b64_tr_b16 v[92:93], v225 offset:6144
    ds_read_b64_tr_b16 v[94:95], v225 offset:6656
    s_waitcnt lgkmcnt(10)
    s_barrier
    v_mfma_f32_32x32x16_bf16 v[16:31], v[64:67], v[60:63], v[16:31]
    ds_read_b128 v[48:51], v208 offset:24576
    ds_read_b64_tr_b16 v[52:53], v224 offset:24576
    ds_read_b64_tr_b16 v[54:55], v224 offset:25088
    v_mfma_f32_32x32x16_bf16 v[32:47], v[68:71], v[60:63], v[32:47]
    ds_read_b64_tr_b16 v[56:57], v225 offset:24576
    ds_read_b64_tr_b16 v[58:59], v225 offset:25088
    s_waitcnt lgkmcnt(10)
    v_mfma_f32_32x32x16_bf16 v[16:31], v[76:79], v[72:75], v[16:31]
    ds_read_b128 v[60:63], v209 offset:24576
    ds_read_b64_tr_b16 v[64:65], v224 offset:26624
    ds_read_b64_tr_b16 v[66:67], v224 offset:27136
    v_mfma_f32_32x32x16_bf16 v[32:47], v[80:83], v[72:75], v[32:47]
    ds_read_b64_tr_b16 v[68:69], v225 offset:26624
    ds_read_b64_tr_b16 v[70:71], v225 offset:27136
    s_waitcnt lgkmcnt(10)
    v_mfma_f32_32x32x16_bf16 v[16:31], v[88:91], v[84:87], v[16:31]
    ds_read_b128 v[72:75], v210 offset:24576
    ds_read_b64_tr_b16 v[76:77], v224 offset:28672
    ds_read_b64_tr_b16 v[78:79], v224 offset:29184
    v_mfma_f32_32x32x16_bf16 v[32:47], v[92:95], v[84:87], v[32:47]
    ds_read_b64_tr_b16 v[80:81], v225 offset:28672
    ds_read_b64_tr_b16 v[82:83], v225 offset:29184
    s_waitcnt lgkmcnt(10)
    s_mov_b32 s76, s40
    s_mov_b32 s77, s41
    s_mov_b32 s78, 2621440
    s_mov_b32 s79, 0x20000
    v_lshrrev_b32 v103, 4, v1
    s_lshl_b32 s60, s3, 3
    v_add_u32 v103, s60, v103
    v_and_b32 v11, 15, v1
    v_lshlrev_b32 v100, 8, v103
    v_lshl_add_u32 v100, v11, 4, v100
    v_add_u32 v12, 0, v103
    v_and_b32 v13, 15, v12
    v_xor_b32 v13, v13, v11
    v_mul_u32_u24 v12, 1280, v12
    v_lshl_add_u32 v101, v13, 4, v12
    v_add_u32 v12, 4, v103
    v_and_b32 v13, 15, v12
    v_xor_b32 v13, v13, v11
    v_mul_u32_u24 v12, 1280, v12
    v_lshl_add_u32 v102, v13, 4, v12
    s_mul_i32 s80, s44, 81920
    s_lshl_b32 s61, s45, 8
    s_add_u32 s80, s80, s61
    buffer_load_dwordx4 v[104:107], v101, s[76:79], s80 offen
    buffer_load_dwordx4 v[108:111], v102, s[76:79], s80 offen
    s_add_u32 s64, s40, 13443072
    s_addc_u32 s65, s41, 0
    s_mov_b32 s66, 2621440
    s_mov_b32 s67, 0x20000
    s_add_u32 s68, s40, 16064512
    s_addc_u32 s69, s41, 0
    s_mov_b32 s70, 163840
    s_mov_b32 s71, 0x20000
    s_mov_b32 s72, 0xffff0000
    s_mov_b32 s73, 0x3f803f80
    s_lshl_b32 s74, s45, 14
    s_lshl_b32 s75, s44, 9
    s_add_u32 s74, s74, s75
    v_lshlrev_b32 v112, 3, v103
    v_mfma_f32_32x32x16_bf16 v[16:31], v[52:55], v[48:51], v[16:31]
    ds_read_b128 v[84:87], v211 offset:24576
    ds_read_b64_tr_b16 v[88:89], v224 offset:30720
    ds_read_b64_tr_b16 v[90:91], v224 offset:31232
    v_mfma_f32_32x32x16_bf16 v[32:47], v[56:59], v[48:51], v[32:47]
    ds_read_b64_tr_b16 v[92:93], v225 offset:30720
    ds_read_b64_tr_b16 v[94:95], v225 offset:31232
    s_waitcnt lgkmcnt(10)
    s_barrier
    v_mfma_f32_32x32x16_bf16 v[16:31], v[64:67], v[60:63], v[16:31]
    ds_read_b128 v[48:51], v208 offset:49152
    ds_read_b64_tr_b16 v[52:53], v224 offset:49152
    ds_read_b64_tr_b16 v[54:55], v224 offset:49664
    v_mfma_f32_32x32x16_bf16 v[32:47], v[68:71], v[60:63], v[32:47]
    ds_read_b64_tr_b16 v[56:57], v225 offset:49152
    ds_read_b64_tr_b16 v[58:59], v225 offset:49664
    s_waitcnt lgkmcnt(10)
    v_mfma_f32_32x32x16_bf16 v[16:31], v[76:79], v[72:75], v[16:31]
    ds_read_b128 v[60:63], v209 offset:49152
    ds_read_b64_tr_b16 v[64:65], v224 offset:51200
    ds_read_b64_tr_b16 v[66:67], v224 offset:51712
    v_mfma_f32_32x32x16_bf16 v[32:47], v[80:83], v[72:75], v[32:47]
    ds_read_b64_tr_b16 v[68:69], v225 offset:51200
    ds_read_b64_tr_b16 v[70:71], v225 offset:51712
    s_waitcnt lgkmcnt(10)
    v_mfma_f32_32x32x16_bf16 v[16:31], v[88:91], v[84:87], v[16:31]
    ds_read_b128 v[72:75], v210 offset:49152
    ds_read_b64_tr_b16 v[76:77], v224 offset:53248
    ds_read_b64_tr_b16 v[78:79], v224 offset:53760
    v_mfma_f32_32x32x16_bf16 v[32:47], v[92:95], v[84:87], v[32:47]
    ds_read_b64_tr_b16 v[80:81], v225 offset:53248
    ds_read_b64_tr_b16 v[82:83], v225 offset:53760
    s_waitcnt lgkmcnt(10)
    v_mfma_f32_32x32x16_bf16 v[16:31], v[52:55], v[48:51], v[16:31]
    ds_read_b128 v[84:87], v211 offset:49152
    ds_read_b64_tr_b16 v[88:89], v224 offset:55296
    ds_read_b64_tr_b16 v[90:91], v224 offset:55808
    v_mfma_f32_32x32x16_bf16 v[32:47], v[56:59], v[48:51], v[32:47]
    ds_read_b64_tr_b16 v[92:93], v225 offset:55296
    ds_read_b64_tr_b16 v[94:95], v225 offset:55808
    s_waitcnt lgkmcnt(10)
    s_barrier
    v_mfma_f32_32x32x16_bf16 v[16:31], v[64:67], v[60:63], v[16:31]
    ds_read_b128 v[48:51], v212 offset:0
    ds_read_b64_tr_b16 v[52:53], v226 offset:0
    ds_read_b64_tr_b16 v[54:55], v226 offset:512
    v_mfma_f32_32x32x16_bf16 v[32:47], v[68:71], v[60:63], v[32:47]
    ds_read_b64_tr_b16 v[56:57], v227 offset:0
    ds_read_b64_tr_b16 v[58:59], v227 offset:512
    s_waitcnt lgkmcnt(10)
    v_mfma_f32_32x32x16_bf16 v[16:31], v[76:79], v[72:75], v[16:31]
    ds_read_b128 v[60:63], v213 offset:0
    ds_read_b64_tr_b16 v[64:65], v226 offset:2048
    ds_read_b64_tr_b16 v[66:67], v226 offset:2560
    v_mfma_f32_32x32x16_bf16 v[32:47], v[80:83], v[72:75], v[32:47]
    ds_read_b64_tr_b16 v[68:69], v227 offset:2048
    ds_read_b64_tr_b16 v[70:71], v227 offset:2560
    s_waitcnt lgkmcnt(10)
    v_mfma_f32_32x32x16_bf16 v[16:31], v[88:91], v[84:87], v[16:31]
    ds_read_b128 v[72:75], v214 offset:0
    ds_read_b64_tr_b16 v[76:77], v226 offset:4096
    ds_read_b64_tr_b16 v[78:79], v226 offset:4608
    v_mfma_f32_32x32x16_bf16 v[32:47], v[92:95], v[84:87], v[32:47]
    ds_read_b64_tr_b16 v[80:81], v227 offset:4096
    ds_read_b64_tr_b16 v[82:83], v227 offset:4608
    s_waitcnt lgkmcnt(10)
    v_mfma_f32_32x32x16_bf16 v[16:31], v[52:55], v[48:51], v[16:31]
    ds_read_b128 v[84:87], v215 offset:0
    ds_read_b64_tr_b16 v[88:89], v226 offset:6144
    ds_read_b64_tr_b16 v[90:91], v226 offset:6656
    v_mfma_f32_32x32x16_bf16 v[32:47], v[56:59], v[48:51], v[32:47]
    ds_read_b64_tr_b16 v[92:93], v227 offset:6144
    ds_read_b64_tr_b16 v[94:95], v227 offset:6656
    s_waitcnt lgkmcnt(10)
    v_mfma_f32_32x32x16_bf16 v[16:31], v[64:67], v[60:63], v[16:31]
    v_mfma_f32_32x32x16_bf16 v[32:47], v[68:71], v[60:63], v[32:47]
    s_waitcnt lgkmcnt(5)
    v_mfma_f32_32x32x16_bf16 v[16:31], v[76:79], v[72:75], v[16:31]
    v_mfma_f32_32x32x16_bf16 v[32:47], v[80:83], v[72:75], v[32:47]
    s_waitcnt lgkmcnt(0)
    v_mfma_f32_32x32x16_bf16 v[16:31], v[88:91], v[84:87], v[16:31]
    v_mfma_f32_32x32x16_bf16 v[32:47], v[92:95], v[84:87], v[32:47]
    s_nop 10
    v_cvt_pk_bf16_f32 v88, v16, v17
    v_cvt_pk_bf16_f32 v89, v18, v19
    ds_write_b64 v184, v[88:89]
    v_cvt_pk_bf16_f32 v90, v20, v21
    v_cvt_pk_bf16_f32 v91, v22, v23
    ds_write_b64 v185, v[90:91]
    v_cvt_pk_bf16_f32 v92, v24, v25
    v_cvt_pk_bf16_f32 v93, v26, v27
    ds_write_b64 v186, v[92:93]
    v_cvt_pk_bf16_f32 v94, v28, v29
    v_cvt_pk_bf16_f32 v95, v30, v31
    ds_write_b64 v187, v[94:95]
    v_cvt_pk_bf16_f32 v88, v32, v33
    v_cvt_pk_bf16_f32 v89, v34, v35
    ds_write_b64 v188, v[88:89]
    v_cvt_pk_bf16_f32 v90, v36, v37
    v_cvt_pk_bf16_f32 v91, v38, v39
    ds_write_b64 v189, v[90:91]
    v_cvt_pk_bf16_f32 v92, v40, v41
    v_cvt_pk_bf16_f32 v93, v42, v43
    ds_write_b64 v190, v[92:93]
    v_cvt_pk_bf16_f32 v94, v44, v45
    v_cvt_pk_bf16_f32 v95, v46, v47
    ds_write_b64 v191, v[94:95]
    s_waitcnt lgkmcnt(0)
    s_branch m2_p3
m2_load:
    s_add_u32 s48, s40, 5242880
    s_addc_u32 s49, s41, 0
    s_mov_b32 s50, 2626560
    s_mov_b32 s51, 0x20000
    s_mov_b32 s52, s30
    s_mov_b32 s53, s31
    s_mov_b32 s54, 819200
    s_mov_b32 s55, 0x20000
    s_sub_u32 s4, s3, 4
    s_lshl_b32 s5, s4, 10
    s_mul_i32 s6, s44, 81920
    s_lshl_b32 s7, s45, 8
    v_lshrrev_b32 v10, 3, v1
    v_and_b32 v11, 7, v1
    v_bfe_u32 v12, v10, 1, 1
    v_lshlrev_b32 v12, 2, v12
    v_xor_b32 v11, v11, v12
    s_lshl_b32 s42, s4, 3
    v_add_u32 v13, s42, v10
    v_mul_u32_u24 v13, 1280, v13
    v_lshl_add_u32 v9, v11, 4, v13
    v_lshrrev_b32 v10, 3, v1
    v_and_b32 v11, 7, v1
    v_lshrrev_b32 v12, 1, v10
    s_and_b32 s42, s4, 1
    s_lshl_b32 s42, s42, 2
    v_or_b32 v12, s42, v12
    v_xor_b32 v11, v11, v12
    s_lshl_b32 s42, s4, 3
    v_add_u32 v13, s42, v10
    v_mul_u32_u24 v13, 1280, v13
    v_lshl_add_u32 v2, v11, 4, v13
    v_add_u32 v3, 1280, v2
    v_add_u32 v4, 3840, v2
    v_add_u32 v5, 0, v2
    v_add_u32 v6, 5120, v2
    v_cmp_gt_u32 vcc, 4, v11
    s_nop 1
    v_cndmask_b32 v7, v4, v3, vcc
    v_cndmask_b32 v8, v6, v5, vcc
    s_add_u32 m0, s5, 8192
    s_nop 0
    buffer_load_dwordx4 v9, s[52:55], s7 offen lds
    s_add_u32 m0, s5, 12288
    s_add_u32 s43, s7, 40960
    buffer_load_dwordx4 v9, s[52:55], s43 offen lds
    s_add_u32 m0, s5, 16384
    s_add_u32 s43, s7, 128
    buffer_load_dwordx4 v9, s[52:55], s43 offen lds
    s_add_u32 m0, s5, 20480
    s_add_u32 s43, s7, 41088
    buffer_load_dwordx4 v9, s[52:55], s43 offen lds
    s_add_u32 m0, s5, 32768
    s_add_u32 s43, s7, 81920
    buffer_load_dwordx4 v9, s[52:55], s43 offen lds
    s_add_u32 m0, s5, 36864
    s_add_u32 s43, s7, 122880
    buffer_load_dwordx4 v9, s[52:55], s43 offen lds
    s_add_u32 m0, s5, 40960
    s_add_u32 s43, s7, 82048
    buffer_load_dwordx4 v9, s[52:55], s43 offen lds
    s_add_u32 m0, s5, 45056
    s_add_u32 s43, s7, 123008
    buffer_load_dwordx4 v9, s[52:55], s43 offen lds
    s_add_u32 m0, s5, 57344
    s_add_u32 s43, s7, 163840
    buffer_load_dwordx4 v9, s[52:55], s43 offen lds
    s_add_u32 m0, s5, 61440
    s_add_u32 s43, s7, 204800
    buffer_load_dwordx4 v9, s[52:55], s43 offen lds
    s_add_u32 m0, s5, 65536
    s_add_u32 s43, s7, 163968
    buffer_load_dwordx4 v9, s[52:55], s43 offen lds
    s_add_u32 m0, s5, 69632
    s_add_u32 s43, s7, 204928
    buffer_load_dwordx4 v9, s[52:55], s43 offen lds
    s_add_u32 m0, s5, 81920
    s_add_u32 s43, s7, 245760
    buffer_load_dwordx4 v9, s[52:55], s43 offen lds
    s_add_u32 m0, s5, 86016
    s_add_u32 s43, s7, 286720
    buffer_load_dwordx4 v9, s[52:55], s43 offen lds
    s_add_u32 m0, s5, 90112
    s_add_u32 s43, s7, 245888
    buffer_load_dwordx4 v9, s[52:55], s43 offen lds
    s_add_u32 m0, s5, 94208
    s_add_u32 s43, s7, 286848
    buffer_load_dwordx4 v9, s[52:55], s43 offen lds
    s_add_u32 m0, s5, 106496
    s_add_u32 s43, s7, 327680
    buffer_load_dwordx4 v9, s[52:55], s43 offen lds
    s_add_u32 m0, s5, 110592
    s_add_u32 s43, s7, 368640
    buffer_load_dwordx4 v9, s[52:55], s43 offen lds
    s_add_u32 m0, s5, 114688
    s_add_u32 s43, s7, 327808
    buffer_load_dwordx4 v9, s[52:55], s43 offen lds
    s_add_u32 m0, s5, 118784
    s_add_u32 s43, s7, 368768
    buffer_load_dwordx4 v9, s[52:55], s43 offen lds
    s_add_u32 m0, s5, 131072
    s_add_u32 s43, s7, 409600
    buffer_load_dwordx4 v9, s[52:55], s43 offen lds
    s_add_u32 m0, s5, 135168
    s_add_u32 s43, s7, 450560
    buffer_load_dwordx4 v9, s[52:55], s43 offen lds
    s_add_u32 m0, s5, 139264
    s_add_u32 s43, s7, 409728
    buffer_load_dwordx4 v9, s[52:55], s43 offen lds
    s_add_u32 m0, s5, 143360
    s_add_u32 s43, s7, 450688
    buffer_load_dwordx4 v9, s[52:55], s43 offen lds
    s_barrier
    s_add_u32 m0, s5, 0
    s_nop 0
    buffer_load_dwordx4 v3, s[48:51], s6 offen lds
    s_add_u32 m0, s5, 4096
    s_add_u32 s43, s6, 40960
    buffer_load_dwordx4 v3, s[48:51], s43 offen lds
    s_add_u32 m0, s5, 24576
    s_add_u32 s43, s6, 128
    buffer_load_dwordx4 v3, s[48:51], s43 offen lds
    s_add_u32 m0, s5, 28672
    s_add_u32 s43, s6, 41088
    buffer_load_dwordx4 v3, s[48:51], s43 offen lds
    s_waitcnt vmcnt(2)
    s_barrier
    s_add_u32 m0, s5, 49152
    s_add_u32 s43, s6, 256
    buffer_load_dwordx4 v7, s[48:51], s43 offen lds
    s_add_u32 m0, s5, 53248
    s_add_u32 s43, s6, 41216
    buffer_load_dwordx4 v7, s[48:51], s43 offen lds
    s_add_u32 m0, s5, 73728
    s_add_u32 s43, s6, 384
    buffer_load_dwordx4 v4, s[48:51], s43 offen lds
    s_add_u32 m0, s5, 77824
    s_add_u32 s43, s6, 41344
    buffer_load_dwordx4 v4, s[48:51], s43 offen lds
    s_waitcnt vmcnt(4)
    s_barrier
    s_add_u32 m0, s5, 98304
    s_add_u32 s43, s6, 512
    buffer_load_dwordx4 v4, s[48:51], s43 offen lds
    s_add_u32 m0, s5, 102400
    s_add_u32 s43, s6, 41472
    buffer_load_dwordx4 v4, s[48:51], s43 offen lds
    s_add_u32 m0, s5, 122880
    s_add_u32 s43, s6, 640
    buffer_load_dwordx4 v5, s[48:51], s43 offen lds
    s_add_u32 m0, s5, 126976
    s_add_u32 s43, s6, 41600
    buffer_load_dwordx4 v5, s[48:51], s43 offen lds
    s_waitcnt vmcnt(6)
    s_barrier
    s_add_u32 m0, s5, 0
    s_add_u32 s43, s6, 768
    buffer_load_dwordx4 v5, s[48:51], s43 offen lds
    s_add_u32 m0, s5, 4096
    s_add_u32 s43, s6, 41728
    buffer_load_dwordx4 v5, s[48:51], s43 offen lds
    s_add_u32 m0, s5, 8192
    s_add_u32 s43, s7, 491520
    buffer_load_dwordx4 v9, s[52:55], s43 offen lds
    s_add_u32 m0, s5, 12288
    s_add_u32 s43, s7, 532480
    buffer_load_dwordx4 v9, s[52:55], s43 offen lds
    s_add_u32 m0, s5, 16384
    s_add_u32 s43, s7, 491648
    buffer_load_dwordx4 v9, s[52:55], s43 offen lds
    s_add_u32 m0, s5, 20480
    s_add_u32 s43, s7, 532608
    buffer_load_dwordx4 v9, s[52:55], s43 offen lds
    s_waitcnt vmcnt(10)
    s_barrier
    s_add_u32 m0, s5, 24576
    s_add_u32 s43, s6, 896
    buffer_load_dwordx4 v8, s[48:51], s43 offen lds
    s_add_u32 m0, s5, 28672
    s_add_u32 s43, s6, 41856
    buffer_load_dwordx4 v8, s[48:51], s43 offen lds
    s_add_u32 m0, s5, 32768
    s_add_u32 s43, s7, 573440
    buffer_load_dwordx4 v9, s[52:55], s43 offen lds
    s_add_u32 m0, s5, 36864
    s_add_u32 s43, s7, 614400
    buffer_load_dwordx4 v9, s[52:55], s43 offen lds
    s_add_u32 m0, s5, 40960
    s_add_u32 s43, s7, 573568
    buffer_load_dwordx4 v9, s[52:55], s43 offen lds
    s_add_u32 m0, s5, 45056
    s_add_u32 s43, s7, 614528
    buffer_load_dwordx4 v9, s[52:55], s43 offen lds
    s_waitcnt vmcnt(14)
    s_barrier
    s_add_u32 m0, s5, 49152
    s_add_u32 s43, s6, 1024
    buffer_load_dwordx4 v6, s[48:51], s43 offen lds
    s_add_u32 m0, s5, 53248
    s_add_u32 s43, s6, 41984
    buffer_load_dwordx4 v6, s[48:51], s43 offen lds
    s_add_u32 m0, s5, 57344
    s_add_u32 s43, s7, 655360
    buffer_load_dwordx4 v9, s[52:55], s43 offen lds
    s_add_u32 m0, s5, 61440
    s_add_u32 s43, s7, 696320
    buffer_load_dwordx4 v9, s[52:55], s43 offen lds
    s_add_u32 m0, s5, 65536
    s_add_u32 s43, s7, 655488
    buffer_load_dwordx4 v9, s[52:55], s43 offen lds
    s_add_u32 m0, s5, 69632
    s_add_u32 s43, s7, 696448
    buffer_load_dwordx4 v9, s[52:55], s43 offen lds
    s_waitcnt vmcnt(18)
    s_barrier
    s_add_u32 m0, s5, 73728
    s_add_u32 s43, s6, 1152
    buffer_load_dwordx4 v6, s[48:51], s43 offen lds
    s_add_u32 m0, s5, 77824
    s_add_u32 s43, s6, 42112
    buffer_load_dwordx4 v6, s[48:51], s43 offen lds
    s_add_u32 m0, s5, 81920
    s_add_u32 s43, s7, 737280
    buffer_load_dwordx4 v9, s[52:55], s43 offen lds
    s_add_u32 m0, s5, 86016
    s_add_u32 s43, s7, 778240
    buffer_load_dwordx4 v9, s[52:55], s43 offen lds
    s_add_u32 m0, s5, 90112
    s_add_u32 s43, s7, 737408
    buffer_load_dwordx4 v9, s[52:55], s43 offen lds
    s_add_u32 m0, s5, 94208
    s_add_u32 s43, s7, 778368
    buffer_load_dwordx4 v9, s[52:55], s43 offen lds
    s_mov_b32 s76, s40
    s_mov_b32 s77, s41
    s_mov_b32 s78, 2621440
    s_mov_b32 s79, 0x20000
    v_lshrrev_b32 v103, 4, v1
    s_lshl_b32 s60, s3, 3
    v_add_u32 v103, s60, v103
    v_and_b32 v11, 15, v1
    v_lshlrev_b32 v100, 8, v103
    v_lshl_add_u32 v100, v11, 4, v100
    v_add_u32 v12, 0, v103
    v_and_b32 v13, 15, v12
    v_xor_b32 v13, v13, v11
    v_mul_u32_u24 v12, 1280, v12
    v_lshl_add_u32 v101, v13, 4, v12
    v_add_u32 v12, 4, v103
    v_and_b32 v13, 15, v12
    v_xor_b32 v13, v13, v11
    v_mul_u32_u24 v12, 1280, v12
    v_lshl_add_u32 v102, v13, 4, v12
    s_mul_i32 s80, s44, 81920
    s_lshl_b32 s61, s45, 8
    s_add_u32 s80, s80, s61
    buffer_load_dwordx4 v[104:107], v101, s[76:79], s80 offen
    buffer_load_dwordx4 v[108:111], v102, s[76:79], s80 offen
    s_add_u32 s64, s40, 13443072
    s_addc_u32 s65, s41, 0
    s_mov_b32 s66, 2621440
    s_mov_b32 s67, 0x20000
    s_add_u32 s68, s40, 16064512
    s_addc_u32 s69, s41, 0
    s_mov_b32 s70, 163840
    s_mov_b32 s71, 0x20000
    s_mov_b32 s72, 0xffff0000
    s_mov_b32 s73, 0x3f803f80
    s_lshl_b32 s74, s45, 14
    s_lshl_b32 s75, s44, 9
    s_add_u32 s74, s74, s75
    v_lshlrev_b32 v112, 3, v103
    s_waitcnt vmcnt(20)
    s_barrier
    s_waitcnt vmcnt(14)
    s_barrier
    s_waitcnt vmcnt(8)
    s_barrier
    s_waitcnt vmcnt(2)
    s_barrier
m2_p3:
    s_barrier
    ds_read_b128 v[16:19], v100 offset:0
    ds_read_b128 v[20:23], v100 offset:1024
    s_waitcnt vmcnt(0) lgkmcnt(0)
    v_mov_b32 v40, 0
    v_mov_b32 v41, 0
    v_lshlrev_b32 v24, 16, v16
    v_and_b32 v25, s72, v16
    v_lshlrev_b32 v26, 16, v104
    v_and_b32 v27, s72, v104
    v_pk_add_f32 v[24:25], v[24:25], v[26:27]
    v_cvt_pk_bf16_f32 v16, v24, v25
    v_lshlrev_b32 v28, 16, v17
    v_and_b32 v29, s72, v17
    v_lshlrev_b32 v30, 16, v105
    v_and_b32 v31, s72, v105
    v_pk_add_f32 v[28:29], v[28:29], v[30:31]
    v_cvt_pk_bf16_f32 v17, v28, v29
    v_lshlrev_b32 v24, 16, v18
    v_and_b32 v25, s72, v18
    v_lshlrev_b32 v26, 16, v106
    v_and_b32 v27, s72, v106
    v_pk_add_f32 v[24:25], v[24:25], v[26:27]
    v_cvt_pk_bf16_f32 v18, v24, v25
    v_lshlrev_b32 v28, 16, v19
    v_and_b32 v29, s72, v19
    v_lshlrev_b32 v30, 16, v107
    v_and_b32 v31, s72, v107
    v_pk_add_f32 v[28:29], v[28:29], v[30:31]
    v_cvt_pk_bf16_f32 v19, v28, v29
    buffer_store_dwordx4 v[16:19], v101, s[64:67], s80 offen sc1
    v_dot2c_f32_bf16 v40, s73, v16
    v_dot2c_f32_bf16 v41, v16, v16
    v_dot2c_f32_bf16 v40, s73, v17
    v_dot2c_f32_bf16 v41, v17, v17
    v_dot2c_f32_bf16 v40, s73, v18
    v_dot2c_f32_bf16 v41, v18, v18
    v_dot2c_f32_bf16 v40, s73, v19
    v_dot2c_f32_bf16 v41, v19, v19
    s_nop 1
    v_add_f32_dpp v40, v40, v40 row_ror:8 row_mask:0xf bank_mask:0xf
    v_add_f32_dpp v41, v41, v41 row_ror:8 row_mask:0xf bank_mask:0xf
    s_nop 0
    v_add_f32_dpp v40, v40, v40 row_ror:4 row_mask:0xf bank_mask:0xf
    v_add_f32_dpp v41, v41, v41 row_ror:4 row_mask:0xf bank_mask:0xf
    s_nop 0
    v_add_f32_dpp v40, v40, v40 row_ror:2 row_mask:0xf bank_mask:0xf
    v_add_f32_dpp v41, v41, v41 row_ror:2 row_mask:0xf bank_mask:0xf
    s_nop 0
    v_add_f32_dpp v40, v40, v40 row_ror:1 row_mask:0xf bank_mask:0xf
    v_add_f32_dpp v41, v41, v41 row_ror:1 row_mask:0xf bank_mask:0xf
    buffer_store_dwordx2 v[40:41], v112, s[68:71], s74 offen offset:0 sc1
    v_mov_b32 v42, 0
    v_mov_b32 v43, 0
    v_lshlrev_b32 v24, 16, v20
    v_and_b32 v25, s72, v20
    v_lshlrev_b32 v26, 16, v108
    v_and_b32 v27, s72, v108
    v_pk_add_f32 v[24:25], v[24:25], v[26:27]
    v_cvt_pk_bf16_f32 v20, v24, v25
    v_lshlrev_b32 v28, 16, v21
    v_and_b32 v29, s72, v21
    v_lshlrev_b32 v30, 16, v109
    v_and_b32 v31, s72, v109
    v_pk_add_f32 v[28:29], v[28:29], v[30:31]
    v_cvt_pk_bf16_f32 v21, v28, v29
    v_lshlrev_b32 v24, 16, v22
    v_and_b32 v25, s72, v22
    v_lshlrev_b32 v26, 16, v110
    v_and_b32 v27, s72, v110
    v_pk_add_f32 v[24:25], v[24:25], v[26:27]
    v_cvt_pk_bf16_f32 v22, v24, v25
    v_lshlrev_b32 v28, 16, v23
    v_and_b32 v29, s72, v23
    v_lshlrev_b32 v30, 16, v111
    v_and_b32 v31, s72, v111
    v_pk_add_f32 v[28:29], v[28:29], v[30:31]
    v_cvt_pk_bf16_f32 v23, v28, v29
    buffer_store_dwordx4 v[20:23], v102, s[64:67], s80 offen sc1
    v_dot2c_f32_bf16 v42, s73, v20
    v_dot2c_f32_bf16 v43, v20, v20
    v_dot2c_f32_bf16 v42, s73, v21
    v_dot2c_f32_bf16 v43, v21, v21
    v_dot2c_f32_bf16 v42, s73, v22
    v_dot2c_f32_bf16 v43, v22, v22
    v_dot2c_f32_bf16 v42, s73, v23
    v_dot2c_f32_bf16 v43, v23, v23
    s_nop 1
    v_add_f32_dpp v42, v42, v42 row_ror:8 row_mask:0xf bank_mask:0xf
    v_add_f32_dpp v43, v43, v43 row_ror:8 row_mask:0xf bank_mask:0xf
    s_nop 0
    v_add_f32_dpp v42, v42, v42 row_ror:4 row_mask:0xf bank_mask:0xf
    v_add_f32_dpp v43, v43, v43 row_ror:4 row_mask:0xf bank_mask:0xf
    s_nop 0
    v_add_f32_dpp v42, v42, v42 row_ror:2 row_mask:0xf bank_mask:0xf
    v_add_f32_dpp v43, v43, v43 row_ror:2 row_mask:0xf bank_mask:0xf
    s_nop 0
    v_add_f32_dpp v42, v42, v42 row_ror:1 row_mask:0xf bank_mask:0xf
    v_add_f32_dpp v43, v43, v43 row_ror:1 row_mask:0xf bank_mask:0xf
    buffer_store_dwordx2 v[42:43], v112, s[68:71], s74 offen offset:32 sc1
m2_end:
    s_add_u32 s84, s40, 34656256
    s_addc_u32 s85, s41, 0
    s_mov_b32 s86, 22528
    s_mov_b32 s87, 0x20000
    s_add_u32 s88, s96, 2000
    s_addc_u32 s89, s97, 0
    v_mov_b32 v22, s88
    v_mov_b32 v23, s89
    v_mov_b32 v20, s95
    s_waitcnt vmcnt(0) lgkmcnt(0)
    s_barrier
    s_cmp_lg_u32 s3, 0
    s_cbranch_scc1 pb19
    s_cmp_eq_u32 s95, -1
    s_cbranch_scc1 pb19
    s_mov_b64 s[90:91], exec
    s_mov_b64 exec, 1
    buffer_store_dwordx2 v[22:23], v20, s[84:87], 0 offen sc1
    s_mov_b64 exec, s[90:91]
pb19:
m2_skip:
    s_and_b32 s4, s2, 7
    s_lshr_b32 s5, s2, 3
    s_and_b32 s6, s4, 3
    s_lshl_b32 s6, s6, 2
    s_and_b32 s7, s5, 3
    s_add_u32 s44, s6, s7
    s_lshr_b32 s6, s4, 2
    s_lshr_b32 s7, s5, 2
    s_cmp_ge_u32 s5, 28
    s_cselect_b32 s47, 5, s7
    s_mul_i32 s45, s6, 6
    s_add_u32 s45, s45, s47
    s_cmp_ge_u32 s5, 28
    s_cbranch_scc1 m3_g4
    s_cmp_ge_u32 s5, 20
    s_cbranch_scc1 m3_g2
m3_g4:
    s_add_u32 s88, s44, 128
    s_lshl_b32 s88, s88, 7
    s_lshl_b32 s89, s45, 3
    s_add_u32 s95, s88, s89
    s_cmp_ge_u32 s3, 4
    s_cbranch_scc1 m3_g4_load
    s_and_b32 s4, s3, 1
    s_lshr_b32 s5, s3, 1
    s_lshl_b32 s42, s5, 13
    v_and_b32 v10, 31, v1
    v_lshlrev_b32 v10, 7, v10
    v_lshrrev_b32 v11, 5, v1
    v_bfe_u32 v12, v1, 1, 3
    v_xor_b32 v11, v11, v12
    v_add_u32 v10, s42, v10
    v_xor_b32 v12, 0, v11
    v_lshl_add_u32 v208, v12, 4, v10
    v_xor_b32 v12, 2, v11
    v_lshl_add_u32 v209, v12, 4, v10
    v_xor_b32 v12, 4, v11
    v_lshl_add_u32 v210, v12, 4, v10
    v_xor_b32 v12, 6, v11
    v_lshl_add_u32 v211, v12, 4, v10
    v_lshrrev_b32 v10, 5, v1
    v_lshlrev_b32 v10, 3, v10
    v_bfe_u32 v11, v1, 2, 2
    v_add_u32 v10, v10, v11
    v_lshlrev_b32 v10, 7, v10
    v_bfe_u32 v11, v1, 3, 1
    v_lshlrev_b32 v11, 6, v11
    v_or_b32 v10, v10, v11
    v_bfe_u32 v11, v1, 4, 1
    v_lshlrev_b32 v11, 5, v11
    v_or_b32 v10, v10, v11
    v_bfe_u32 v11, v1, 1, 1
    v_lshlrev_b32 v11, 4, v11
    v_or_b32 v10, v10, v11
    v_and_b32 v11, 1, v1
    v_lshlrev_b32 v11, 3, v11
    v_or_b32 v216, v10, v11
    s_lshl_b32 s42, s4, 13
    s_add_u32 s42, s42, 16384
    v_add_u32 v216, s42, v216
    v_xor_b32 v217, 64, v216
    s_cmp_lg_u32 s3, 0
    s_cbranch_scc1 dw20
    s_add_u32 s84, s40, 34656256
    s_addc_u32 s85, s41, 0
    s_mov_b32 s86, 22528
    s_mov_b32 s87, 0x20000
    v_mul_u32_u24 v237, 52, v1
    v_lshrrev_b32 v237, 8, v237
    v_mul_u32_u24 v236, 5, v237
    v_sub_u32 v236, v1, v236
    s_lshl_b32 s90, s44, 1
    s_add_u32 s90, s90, 80
    v_add_u32 v237, s90, v237
    v_lshlrev_b32 v236, 3, v236
    v_lshl_add_u32 v236, v237, 7, v236
    v_cmp_gt_u32 vcc, 10, v1
    s_nop 1
    s_and_saveexec_b64 s[88:89], vcc
    s_cbranch_execz pd22
    v_mov_b32 v240, s96
    v_mov_b32 v241, s97
    s_mov_b32 s90, 0
pl21:
    buffer_load_dwordx2 v[238:239], v236, s[84:87], 0 offen sc1
    s_waitcnt vmcnt(0)
    v_sub_co_u32 v238, vcc, v238, v240
    s_nop 1
    v_subb_co_u32 v239, vcc, v239, v241, vcc
    v_cmp_eq_u32 s[92:93], 0, v239
    s_mov_b32 s91, 16777216
    v_cmp_gt_u32 vcc, s91, v238
    s_nop 1
    s_and_b64 vcc, vcc, s[92:93]
    s_cmp_eq_u64 vcc, exec
    s_cbranch_scc1 pd22
    s_add_u32 s90, s90, 1
    s_cmp_lt_u32 s90, 262144
    s_cbranch_scc1 pl21
pd22:
    s_mov_b64 exec, s[88:89]
dw20:
    s_barrier
    s_lshl_b32 s60, s5, 6
    s_lshl_b32 s61, s4, 6
    s_lshl_b32 s62, s4, 3
    v_and_b32 v10, 31, v1
    v_add_u32 v10, s60, v10
    v_and_b32 v13, 15, v10
    v_mul_u32_u24 v12, 256, v10
    v_lshrrev_b32 v10, 5, v1
    v_lshl_add_u32 v12, v10, 3, v12
    v_add_u32 v12, 65536, v12
    s_add_u32 s42, s62, 0
    v_xor_b32 v14, s42, v13
    v_lshl_add_u32 v184, v14, 4, v12
    s_add_u32 s42, s62, 1
    v_xor_b32 v14, s42, v13
    v_lshl_add_u32 v185, v14, 4, v12
    s_add_u32 s42, s62, 2
    v_xor_b32 v14, s42, v13
    v_lshl_add_u32 v186, v14, 4, v12
    s_add_u32 s42, s62, 3
    v_xor_b32 v14, s42, v13
    v_lshl_add_u32 v187, v14, 4, v12
    s_add_u32 s42, s62, 4
    v_xor_b32 v14, s42, v13
    v_lshl_add_u32 v188, v14, 4, v12
    s_add_u32 s42, s62, 5
    v_xor_b32 v14, s42, v13
    v_lshl_add_u32 v189, v14, 4, v12
    s_add_u32 s42, s62, 6
    v_xor_b32 v14, s42, v13
    v_lshl_add_u32 v190, v14, 4, v12
    s_add_u32 s42, s62, 7
    v_xor_b32 v14, s42, v13
    v_lshl_add_u32 v191, v14, 4, v12
    v_and_b32 v10, 31, v1
    v_add_u32 v10, s60, v10
    v_lshlrev_b32 v10, 2, v10
    v_add_u32 v192, 131072, v10
    v_lshrrev_b32 v11, 5, v1
    v_lshlrev_b32 v11, 4, v11
    s_lshl_b32 s42, s61, 2
    s_add_u32 s42, s42, 132096
    v_add_u32 v193, s42, v11
    s_add_u32 s76, s40, 23121920
    s_addc_u32 s77, s41, 0
    s_mov_b32 s78, 6291456
    s_mov_b32 s79, 0x20000
    s_mov_b32 s70, 0xc0135761
    s_mov_b32 s71, 0xc0135761
    s_mov_b32 s72, 0xbdd2d3e8
    s_mov_b32 s73, 0xbdd2d3e8
    s_mov_b32 s74, 0xffff0000
    v_mov_b32 v202, s70
    v_mov_b32 v203, s70
    s_mul_i32 s75, s44, 393216
    s_lshl_b32 s63, s45, 8
    s_add_u32 s75, s75, s63
    v_lshrrev_b32 v10, 4, v1
    s_lshl_b32 s63, s3, 4
    v_add_u32 v10, s63, v10
    v_lshlrev_b32 v11, 8, v10
    v_and_b32 v12, 15, v1
    v_lshl_add_u32 v11, v12, 4, v11
    v_add_u32 v196, 65536, v11
    v_add_u32 v13, 0, v10
    v_and_b32 v14, 15, v13
    v_xor_b32 v14, v14, v12
    v_mul_u32_u24 v13, 3072, v13
    v_lshl_add_u32 v197, v14, 4, v13
    v_add_u32 v13, 4, v10
    v_and_b32 v14, 15, v13
    v_xor_b32 v14, v14, v12
    v_mul_u32_u24 v13, 3072, v13
    v_lshl_add_u32 v198, v14, 4, v13
    v_add_u32 v13, 8, v10
    v_and_b32 v14, 15, v13
    v_xor_b32 v14, v14, v12
    v_mul_u32_u24 v13, 3072, v13
    v_lshl_add_u32 v199, v14, 4, v13
    v_add_u32 v13, 12, v10
    v_and_b32 v14, 15, v13
    v_xor_b32 v14, v14, v12
    v_mul_u32_u24 v13, 3072, v13
    v_lshl_add_u32 v200, v14, 4, v13
    v_add_u32 v212, 65536, v208
    v_add_u32 v213, 65536, v209
    v_add_u32 v214, 65536, v210
    v_add_u32 v215, 65536, v211
    v_add_u32 v218, 65536, v216
    v_add_u32 v219, 65536, v217
    s_barrier
    ds_read_b128 v[80:83], v208 offset:0
    ds_read_b128 v[84:87], v208 offset:4096
    ds_read_b64_tr_b16 v[88:89], v216 offset:0
    ds_read_b64_tr_b16 v[90:91], v216 offset:512
    ds_read_b64_tr_b16 v[92:93], v217 offset:0
    ds_read_b64_tr_b16 v[94:95], v217 offset:512
    ds_read_b128 v[96:99], v209 offset:0
    ds_read_b128 v[100:103], v209 offset:4096
    ds_read_b64_tr_b16 v[104:105], v216 offset:2048
    ds_read_b64_tr_b16 v[106:107], v216 offset:2560
    ds_read_b64_tr_b16 v[108:109], v217 offset:2048
    ds_read_b64_tr_b16 v[110:111], v217 offset:2560
    s_waitcnt lgkmcnt(6)
    v_mfma_f32_32x32x16_bf16 v[16:31], v[88:91], v[80:83], 0
    ds_read_b128 v[112:115], v210 offset:0
    ds_read_b128 v[116:119], v210 offset:4096
    v_mfma_f32_32x32x16_bf16 v[32:47], v[88:91], v[84:87], 0
    ds_read_b64_tr_b16 v[120:121], v216 offset:4096
    ds_read_b64_tr_b16 v[122:123], v216 offset:4608
    v_mfma_f32_32x32x16_bf16 v[48:63], v[92:95], v[80:83], 0
    ds_read_b64_tr_b16 v[124:125], v217 offset:4096
    ds_read_b64_tr_b16 v[126:127], v217 offset:4608
    v_mfma_f32_32x32x16_bf16 v[64:79], v[92:95], v[84:87], 0
    s_waitcnt lgkmcnt(6)
    v_mfma_f32_32x32x16_bf16 v[16:31], v[104:107], v[96:99], v[16:31]
    ds_read_b128 v[80:83], v211 offset:0
    ds_read_b128 v[84:87], v211 offset:4096
    v_mfma_f32_32x32x16_bf16 v[32:47], v[104:107], v[100:103], v[32:47]
    ds_read_b64_tr_b16 v[88:89], v216 offset:6144
    ds_read_b64_tr_b16 v[90:91], v216 offset:6656
    v_mfma_f32_32x32x16_bf16 v[48:63], v[108:111], v[96:99], v[48:63]
    ds_read_b64_tr_b16 v[92:93], v217 offset:6144
    ds_read_b64_tr_b16 v[94:95], v217 offset:6656
    v_mfma_f32_32x32x16_bf16 v[64:79], v[108:111], v[100:103], v[64:79]
    s_waitcnt lgkmcnt(0)
    s_barrier
    v_mfma_f32_32x32x16_bf16 v[16:31], v[120:123], v[112:115], v[16:31]
    ds_read_b128 v[96:99], v208 offset:32768
    ds_read_b128 v[100:103], v208 offset:36864
    v_mfma_f32_32x32x16_bf16 v[32:47], v[120:123], v[116:119], v[32:47]
    ds_read_b64_tr_b16 v[104:105], v216 offset:32768
    ds_read_b64_tr_b16 v[106:107], v216 offset:33280
    v_mfma_f32_32x32x16_bf16 v[48:63], v[124:127], v[112:115], v[48:63]
    ds_read_b64_tr_b16 v[108:109], v217 offset:32768
    ds_read_b64_tr_b16 v[110:111], v217 offset:33280
    v_mfma_f32_32x32x16_bf16 v[64:79], v[124:127], v[116:119], v[64:79]
    s_waitcnt lgkmcnt(6)
    v_mfma_f32_32x32x16_bf16 v[16:31], v[88:91], v[80:83], v[16:31]
    ds_read_b128 v[112:115], v209 offset:32768
    ds_read_b128 v[116:119], v209 offset:36864
    v_mfma_f32_32x32x16_bf16 v[32:47], v[88:91], v[84:87], v[32:47]
    ds_read_b64_tr_b16 v[120:121], v216 offset:34816
    ds_read_b64_tr_b16 v[122:123], v216 offset:35328
    v_mfma_f32_32x32x16_bf16 v[48:63], v[92:95], v[80:83], v[48:63]
    ds_read_b64_tr_b16 v[124:125], v217 offset:34816
    ds_read_b64_tr_b16 v[126:127], v217 offset:35328
    v_mfma_f32_32x32x16_bf16 v[64:79], v[92:95], v[84:87], v[64:79]
    s_waitcnt lgkmcnt(6)
    v_mfma_f32_32x32x16_bf16 v[16:31], v[104:107], v[96:99], v[16:31]
    ds_read_b128 v[80:83], v210 offset:32768
    ds_read_b128 v[84:87], v210 offset:36864
    v_mfma_f32_32x32x16_bf16 v[32:47], v[104:107], v[100:103], v[32:47]
    ds_read_b64_tr_b16 v[88:89], v216 offset:36864
    ds_read_b64_tr_b16 v[90:91], v216 offset:37376
    v_mfma_f32_32x32x16_bf16 v[48:63], v[108:111], v[96:99], v[48:63]
    ds_read_b64_tr_b16 v[92:93], v217 offset:36864
    ds_read_b64_tr_b16 v[94:95], v217 offset:37376
    v_mfma_f32_32x32x16_bf16 v[64:79], v[108:111], v[100:103], v[64:79]
    s_waitcnt lgkmcnt(6)
    v_mfma_f32_32x32x16_bf16 v[16:31], v[120:123], v[112:115], v[16:31]
    ds_read_b128 v[96:99], v211 offset:32768
    ds_read_b128 v[100:103], v211 offset:36864
    v_mfma_f32_32x32x16_bf16 v[32:47], v[120:123], v[116:119], v[32:47]
    ds_read_b64_tr_b16 v[104:105], v216 offset:38912
    ds_read_b64_tr_b16 v[106:107], v216 offset:39424
    v_mfma_f32_32x32x16_bf16 v[48:63], v[124:127], v[112:115], v[48:63]
    ds_read_b64_tr_b16 v[108:109], v217 offset:38912
    ds_read_b64_tr_b16 v[110:111], v217 offset:39424
    v_mfma_f32_32x32x16_bf16 v[64:79], v[124:127], v[116:119], v[64:79]
    s_waitcnt lgkmcnt(0)
    s_barrier
    v_mfma_f32_32x32x16_bf16 v[16:31], v[88:91], v[80:83], v[16:31]
    ds_read_b128 v[112:115], v212 offset:0
    ds_read_b128 v[116:119], v212 offset:4096
    v_mfma_f32_32x32x16_bf16 v[32:47], v[88:91], v[84:87], v[32:47]
    ds_read_b64_tr_b16 v[120:121], v218 offset:0
    ds_read_b64_tr_b16 v[122:123], v218 offset:512
    v_mfma_f32_32x32x16_bf16 v[48:63], v[92:95], v[80:83], v[48:63]
    ds_read_b64_tr_b16 v[124:125], v219 offset:0
    ds_read_b64_tr_b16 v[126:127], v219 offset:512
    v_mfma_f32_32x32x16_bf16 v[64:79], v[92:95], v[84:87], v[64:79]
    s_waitcnt lgkmcnt(6)
    v_mfma_f32_32x32x16_bf16 v[16:31], v[104:107], v[96:99], v[16:31]
    ds_read_b128 v[80:83], v213 offset:0
    ds_read_b128 v[84:87], v213 offset:4096
    v_mfma_f32_32x32x16_bf16 v[32:47], v[104:107], v[100:103], v[32:47]
    ds_read_b64_tr_b16 v[88:89], v218 offset:2048
    ds_read_b64_tr_b16 v[90:91], v218 offset:2560
    v_mfma_f32_32x32x16_bf16 v[48:63], v[108:111], v[96:99], v[48:63]
    ds_read_b64_tr_b16 v[92:93], v219 offset:2048
    ds_read_b64_tr_b16 v[94:95], v219 offset:2560
    v_mfma_f32_32x32x16_bf16 v[64:79], v[108:111], v[100:103], v[64:79]
    s_waitcnt lgkmcnt(6)
    v_mfma_f32_32x32x16_bf16 v[16:31], v[120:123], v[112:115], v[16:31]
    ds_read_b128 v[96:99], v214 offset:0
    ds_read_b128 v[100:103], v214 offset:4096
    v_mfma_f32_32x32x16_bf16 v[32:47], v[120:123], v[116:119], v[32:47]
    ds_read_b64_tr_b16 v[104:105], v218 offset:4096
    ds_read_b64_tr_b16 v[106:107], v218 offset:4608
    v_mfma_f32_32x32x16_bf16 v[48:63], v[124:127], v[112:115], v[48:63]
    ds_read_b64_tr_b16 v[108:109], v219 offset:4096
    ds_read_b64_tr_b16 v[110:111], v219 offset:4608
    v_mfma_f32_32x32x16_bf16 v[64:79], v[124:127], v[116:119], v[64:79]
    s_waitcnt lgkmcnt(6)
    v_mfma_f32_32x32x16_bf16 v[16:31], v[88:91], v[80:83], v[16:31]
    ds_read_b128 v[112:115], v215 offset:0
    ds_read_b128 v[116:119], v215 offset:4096
    v_mfma_f32_32x32x16_bf16 v[32:47], v[88:91], v[84:87], v[32:47]
    ds_read_b64_tr_b16 v[120:121], v218 offset:6144
    ds_read_b64_tr_b16 v[122:123], v218 offset:6656
    v_mfma_f32_32x32x16_bf16 v[48:63], v[92:95], v[80:83], v[48:63]
    ds_read_b64_tr_b16 v[124:125], v219 offset:6144
    ds_read_b64_tr_b16 v[126:127], v219 offset:6656
    v_mfma_f32_32x32x16_bf16 v[64:79], v[92:95], v[84:87], v[64:79]
    s_waitcnt lgkmcnt(0)
    s_barrier
    v_mfma_f32_32x32x16_bf16 v[16:31], v[104:107], v[96:99], v[16:31]
    ds_read_b128 v[80:83], v212 offset:32768
    ds_read_b128 v[84:87], v212 offset:36864
    v_mfma_f32_32x32x16_bf16 v[32:47], v[104:107], v[100:103], v[32:47]
    ds_read_b64_tr_b16 v[88:89], v218 offset:32768
    ds_read_b64_tr_b16 v[90:91], v218 offset:33280
    v_mfma_f32_32x32x16_bf16 v[48:63], v[108:111], v[96:99], v[48:63]
    ds_read_b64_tr_b16 v[92:93], v219 offset:32768
    ds_read_b64_tr_b16 v[94:95], v219 offset:33280
    v_mfma_f32_32x32x16_bf16 v[64:79], v[108:111], v[100:103], v[64:79]
    s_waitcnt lgkmcnt(6)
    v_mfma_f32_32x32x16_bf16 v[16:31], v[120:123], v[112:115], v[16:31]
    ds_read_b128 v[96:99], v213 offset:32768
    ds_read_b128 v[100:103], v213 offset:36864
    v_mfma_f32_32x32x16_bf16 v[32:47], v[120:123], v[116:119], v[32:47]
    ds_read_b64_tr_b16 v[104:105], v218 offset:34816
    ds_read_b64_tr_b16 v[106:107], v218 offset:35328
    v_mfma_f32_32x32x16_bf16 v[48:63], v[124:127], v[112:115], v[48:63]
    ds_read_b64_tr_b16 v[108:109], v219 offset:34816
    ds_read_b64_tr_b16 v[110:111], v219 offset:35328
    v_mfma_f32_32x32x16_bf16 v[64:79], v[124:127], v[116:119], v[64:79]
    s_waitcnt lgkmcnt(6)
    v_mfma_f32_32x32x16_bf16 v[16:31], v[88:91], v[80:83], v[16:31]
    ds_read_b128 v[112:115], v214 offset:32768
    ds_read_b128 v[116:119], v214 offset:36864
    v_mfma_f32_32x32x16_bf16 v[32:47], v[88:91], v[84:87], v[32:47]
    ds_read_b64_tr_b16 v[120:121], v218 offset:36864
    ds_read_b64_tr_b16 v[122:123], v218 offset:37376
    v_mfma_f32_32x32x16_bf16 v[48:63], v[92:95], v[80:83], v[48:63]
    ds_read_b64_tr_b16 v[124:125], v219 offset:36864
    ds_read_b64_tr_b16 v[126:127], v219 offset:37376
    v_mfma_f32_32x32x16_bf16 v[64:79], v[92:95], v[84:87], v[64:79]
    s_waitcnt lgkmcnt(6)
    v_mfma_f32_32x32x16_bf16 v[16:31], v[104:107], v[96:99], v[16:31]
    ds_read_b128 v[80:83], v215 offset:32768
    ds_read_b128 v[84:87], v215 offset:36864
    v_mfma_f32_32x32x16_bf16 v[32:47], v[104:107], v[100:103], v[32:47]
    ds_read_b64_tr_b16 v[88:89], v218 offset:38912
    ds_read_b64_tr_b16 v[90:91], v218 offset:39424
    v_mfma_f32_32x32x16_bf16 v[48:63], v[108:111], v[96:99], v[48:63]
    ds_read_b64_tr_b16 v[92:93], v219 offset:38912
    ds_read_b64_tr_b16 v[94:95], v219 offset:39424
    v_mfma_f32_32x32x16_bf16 v[64:79], v[108:111], v[100:103], v[64:79]
    s_waitcnt lgkmcnt(0)
    s_barrier
    v_mfma_f32_32x32x16_bf16 v[16:31], v[120:123], v[112:115], v[16:31]
    ds_read_b128 v[96:99], v208 offset:0
    ds_read_b128 v[100:103], v208 offset:4096
    v_mfma_f32_32x32x16_bf16 v[32:47], v[120:123], v[116:119], v[32:47]
    ds_read_b64_tr_b16 v[104:105], v216 offset:0
    ds_read_b64_tr_b16 v[106:107], v216 offset:512
    v_mfma_f32_32x32x16_bf16 v[48:63], v[124:127], v[112:115], v[48:63]
    ds_read_b64_tr_b16 v[108:109], v217 offset:0
    ds_read_b64_tr_b16 v[110:111], v217 offset:512
    v_mfma_f32_32x32x16_bf16 v[64:79], v[124:127], v[116:119], v[64:79]
    s_waitcnt lgkmcnt(6)
    v_mfma_f32_32x32x16_bf16 v[16:31], v[88:91], v[80:83], v[16:31]
    ds_read_b128 v[112:115], v209 offset:0
    ds_read_b128 v[116:119], v209 offset:4096
    v_mfma_f32_32x32x16_bf16 v[32:47], v[88:91], v[84:87], v[32:47]
    ds_read_b64_tr_b16 v[120:121], v216 offset:2048
    ds_read_b64_tr_b16 v[122:123], v216 offset:2560
    v_mfma_f32_32x32x16_bf16 v[48:63], v[92:95], v[80:83], v[48:63]
    ds_read_b64_tr_b16 v[124:125], v217 offset:2048
    ds_read_b64_tr_b16 v[126:127], v217 offset:2560
    v_mfma_f32_32x32x16_bf16 v[64:79], v[92:95], v[84:87], v[64:79]
    s_waitcnt lgkmcnt(6)
    v_mfma_f32_32x32x16_bf16 v[16:31], v[104:107], v[96:99], v[16:31]
    ds_read_b128 v[80:83], v210 offset:0
    ds_read_b128 v[84:87], v210 offset:4096
    v_mfma_f32_32x32x16_bf16 v[32:47], v[104:107], v[100:103], v[32:47]
    ds_read_b64_tr_b16 v[88:89], v216 offset:4096
    ds_read_b64_tr_b16 v[90:91], v216 offset:4608
    v_mfma_f32_32x32x16_bf16 v[48:63], v[108:111], v[96:99], v[48:63]
    ds_read_b64_tr_b16 v[92:93], v217 offset:4096
    ds_read_b64_tr_b16 v[94:95], v217 offset:4608
    v_mfma_f32_32x32x16_bf16 v[64:79], v[108:111], v[100:103], v[64:79]
    s_waitcnt lgkmcnt(6)
    v_mfma_f32_32x32x16_bf16 v[16:31], v[120:123], v[112:115], v[16:31]
    ds_read_b128 v[96:99], v211 offset:0
    ds_read_b128 v[100:103], v211 offset:4096
    v_mfma_f32_32x32x16_bf16 v[32:47], v[120:123], v[116:119], v[32:47]
    ds_read_b64_tr_b16 v[104:105], v216 offset:6144
    ds_read_b64_tr_b16 v[106:107], v216 offset:6656
    v_mfma_f32_32x32x16_bf16 v[48:63], v[124:127], v[112:115], v[48:63]
    ds_read_b64_tr_b16 v[108:109], v217 offset:6144
    ds_read_b64_tr_b16 v[110:111], v217 offset:6656
    v_mfma_f32_32x32x16_bf16 v[64:79], v[124:127], v[116:119], v[64:79]
    s_waitcnt lgkmcnt(0)
    s_barrier
    v_mfma_f32_32x32x16_bf16 v[16:31], v[88:91], v[80:83], v[16:31]
    ds_read_b128 v[112:115], v208 offset:32768
    ds_read_b128 v[116:119], v208 offset:36864
    v_mfma_f32_32x32x16_bf16 v[32:47], v[88:91], v[84:87], v[32:47]
    ds_read_b64_tr_b16 v[120:121], v216 offset:32768
    ds_read_b64_tr_b16 v[122:123], v216 offset:33280
    v_mfma_f32_32x32x16_bf16 v[48:63], v[92:95], v[80:83], v[48:63]
    ds_read_b64_tr_b16 v[124:125], v217 offset:32768
    ds_read_b64_tr_b16 v[126:127], v217 offset:33280
    v_mfma_f32_32x32x16_bf16 v[64:79], v[92:95], v[84:87], v[64:79]
    s_waitcnt lgkmcnt(6)
    v_mfma_f32_32x32x16_bf16 v[16:31], v[104:107], v[96:99], v[16:31]
    ds_read_b128 v[80:83], v209 offset:32768
    ds_read_b128 v[84:87], v209 offset:36864
    v_mfma_f32_32x32x16_bf16 v[32:47], v[104:107], v[100:103], v[32:47]
    ds_read_b64_tr_b16 v[88:89], v216 offset:34816
    ds_read_b64_tr_b16 v[90:91], v216 offset:35328
    v_mfma_f32_32x32x16_bf16 v[48:63], v[108:111], v[96:99], v[48:63]
    ds_read_b64_tr_b16 v[92:93], v217 offset:34816
    ds_read_b64_tr_b16 v[94:95], v217 offset:35328
    v_mfma_f32_32x32x16_bf16 v[64:79], v[108:111], v[100:103], v[64:79]
    s_waitcnt lgkmcnt(6)
    v_mfma_f32_32x32x16_bf16 v[16:31], v[120:123], v[112:115], v[16:31]
    ds_read_b128 v[96:99], v210 offset:32768
    ds_read_b128 v[100:103], v210 offset:36864
    v_mfma_f32_32x32x16_bf16 v[32:47], v[120:123], v[116:119], v[32:47]
    ds_read_b64_tr_b16 v[104:105], v216 offset:36864
    ds_read_b64_tr_b16 v[106:107], v216 offset:37376
    v_mfma_f32_32x32x16_bf16 v[48:63], v[124:127], v[112:115], v[48:63]
    ds_read_b64_tr_b16 v[108:109], v217 offset:36864
    ds_read_b64_tr_b16 v[110:111], v217 offset:37376
    v_mfma_f32_32x32x16_bf16 v[64:79], v[124:127], v[116:119], v[64:79]
    s_waitcnt lgkmcnt(6)
    v_mfma_f32_32x32x16_bf16 v[16:31], v[88:91], v[80:83], v[16:31]
    ds_read_b128 v[112:115], v211 offset:32768
    ds_read_b128 v[116:119], v211 offset:36864
    v_mfma_f32_32x32x16_bf16 v[32:47], v[88:91], v[84:87], v[32:47]
    ds_read_b64_tr_b16 v[120:121], v216 offset:38912
    ds_read_b64_tr_b16 v[122:123], v216 offset:39424
    v_mfma_f32_32x32x16_bf16 v[48:63], v[92:95], v[80:83], v[48:63]
    ds_read_b64_tr_b16 v[124:125], v217 offset:38912
    ds_read_b64_tr_b16 v[126:127], v217 offset:39424
    v_mfma_f32_32x32x16_bf16 v[64:79], v[92:95], v[84:87], v[64:79]
    s_waitcnt lgkmcnt(0)
    s_barrier
    v_mfma_f32_32x32x16_bf16 v[16:31], v[104:107], v[96:99], v[16:31]
    ds_read_b128 v[80:83], v212 offset:0
    ds_read_b128 v[84:87], v212 offset:4096
    v_mfma_f32_32x32x16_bf16 v[32:47], v[104:107], v[100:103], v[32:47]
    ds_read_b64_tr_b16 v[88:89], v218 offset:0
    ds_read_b64_tr_b16 v[90:91], v218 offset:512
    v_mfma_f32_32x32x16_bf16 v[48:63], v[108:111], v[96:99], v[48:63]
    ds_read_b64_tr_b16 v[92:93], v219 offset:0
    ds_read_b64_tr_b16 v[94:95], v219 offset:512
    v_mfma_f32_32x32x16_bf16 v[64:79], v[108:111], v[100:103], v[64:79]
    s_waitcnt lgkmcnt(6)
    v_mfma_f32_32x32x16_bf16 v[16:31], v[120:123], v[112:115], v[16:31]
    ds_read_b128 v[96:99], v213 offset:0
    ds_read_b128 v[100:103], v213 offset:4096
    v_mfma_f32_32x32x16_bf16 v[32:47], v[120:123], v[116:119], v[32:47]
    ds_read_b64_tr_b16 v[104:105], v218 offset:2048
    ds_read_b64_tr_b16 v[106:107], v218 offset:2560
    v_mfma_f32_32x32x16_bf16 v[48:63], v[124:127], v[112:115], v[48:63]
    ds_read_b64_tr_b16 v[108:109], v219 offset:2048
    ds_read_b64_tr_b16 v[110:111], v219 offset:2560
    v_mfma_f32_32x32x16_bf16 v[64:79], v[124:127], v[116:119], v[64:79]
    s_waitcnt lgkmcnt(6)
    s_cmp_lg_u32 s3, 0
    s_cbranch_scc1 dw23
    s_add_u32 s84, s40, 34656256
    s_addc_u32 s85, s41, 0
    s_mov_b32 s86, 22528
    s_mov_b32 s87, 0x20000
    v_lshlrev_b32 v236, 3, v1
    v_add_u32 v236, 18432, v236
    v_cmp_gt_u32 vcc, 16, v1
    s_nop 1
    s_and_saveexec_b64 s[88:89], vcc
    s_cbranch_execz pd25
    v_mov_b32 v240, s96
    v_mov_b32 v241, s97
    s_mov_b32 s90, 0
pl24:
    buffer_load_dwordx2 v[238:239], v236, s[84:87], 0 offen sc1
    s_waitcnt vmcnt(0)
    v_sub_co_u32 v238, vcc, v238, v240
    s_nop 1
    v_subb_co_u32 v239, vcc, v239, v241, vcc
    v_cmp_eq_u32 s[92:93], 0, v239
    s_mov_b32 s91, 16777216
    v_cmp_gt_u32 vcc, s91, v238
    s_nop 1
    s_and_b64 vcc, vcc, s[92:93]
    s_cmp_eq_u64 vcc, exec
    s_cbranch_scc1 pd25
    s_add_u32 s90, s90, 1
    s_cmp_lt_u32 s90, 262144
    s_cbranch_scc1 pl24
pd25:
    s_mov_b64 exec, s[88:89]
dw23:
    v_mfma_f32_32x32x16_bf16 v[16:31], v[88:91], v[80:83], v[16:31]
    ds_read_b128 v[112:115], v214 offset:0
    ds_read_b128 v[116:119], v214 offset:4096
    v_mfma_f32_32x32x16_bf16 v[32:47], v[88:91], v[84:87], v[32:47]
    ds_read_b64_tr_b16 v[120:121], v218 offset:4096
    ds_read_b64_tr_b16 v[122:123], v218 offset:4608
    v_mfma_f32_32x32x16_bf16 v[48:63], v[92:95], v[80:83], v[48:63]
    ds_read_b64_tr_b16 v[124:125], v219 offset:4096
    ds_read_b64_tr_b16 v[126:127], v219 offset:4608
    v_mfma_f32_32x32x16_bf16 v[64:79], v[92:95], v[84:87], v[64:79]
    s_waitcnt lgkmcnt(6)
    v_mfma_f32_32x32x16_bf16 v[16:31], v[104:107], v[96:99], v[16:31]
    ds_read_b128 v[80:83], v215 offset:0
    ds_read_b128 v[84:87], v215 offset:4096
    v_mfma_f32_32x32x16_bf16 v[32:47], v[104:107], v[100:103], v[32:47]
    ds_read_b64_tr_b16 v[88:89], v218 offset:6144
    ds_read_b64_tr_b16 v[90:91], v218 offset:6656
    v_mfma_f32_32x32x16_bf16 v[48:63], v[108:111], v[96:99], v[48:63]
    ds_read_b64_tr_b16 v[92:93], v219 offset:6144
    ds_read_b64_tr_b16 v[94:95], v219 offset:6656
    v_mfma_f32_32x32x16_bf16 v[64:79], v[108:111], v[100:103], v[64:79]
    s_waitcnt lgkmcnt(0)
    s_barrier
    v_mfma_f32_32x32x16_bf16 v[16:31], v[120:123], v[112:115], v[16:31]
    ds_read_b128 v[96:99], v212 offset:32768
    ds_read_b128 v[100:103], v212 offset:36864
    v_mfma_f32_32x32x16_bf16 v[32:47], v[120:123], v[116:119], v[32:47]
    ds_read_b64_tr_b16 v[104:105], v218 offset:32768
    ds_read_b64_tr_b16 v[106:107], v218 offset:33280
    v_mfma_f32_32x32x16_bf16 v[48:63], v[124:127], v[112:115], v[48:63]
    ds_read_b64_tr_b16 v[108:109], v219 offset:32768
    ds_read_b64_tr_b16 v[110:111], v219 offset:33280
    v_mfma_f32_32x32x16_bf16 v[64:79], v[124:127], v[116:119], v[64:79]
    s_waitcnt lgkmcnt(6)
    v_mfma_f32_32x32x16_bf16 v[16:31], v[88:91], v[80:83], v[16:31]
    ds_read_b128 v[112:115], v213 offset:32768
    ds_read_b128 v[116:119], v213 offset:36864
    v_mfma_f32_32x32x16_bf16 v[32:47], v[88:91], v[84:87], v[32:47]
    ds_read_b64_tr_b16 v[120:121], v218 offset:34816
    ds_read_b64_tr_b16 v[122:123], v218 offset:35328
    v_mfma_f32_32x32x16_bf16 v[48:63], v[92:95], v[80:83], v[48:63]
    ds_read_b64_tr_b16 v[124:125], v219 offset:34816
    ds_read_b64_tr_b16 v[126:127], v219 offset:35328
    v_mfma_f32_32x32x16_bf16 v[64:79], v[92:95], v[84:87], v[64:79]
    s_waitcnt lgkmcnt(6)
    v_mfma_f32_32x32x16_bf16 v[16:31], v[104:107], v[96:99], v[16:31]
    ds_read_b128 v[80:83], v214 offset:32768
    ds_read_b128 v[84:87], v214 offset:36864
    v_mfma_f32_32x32x16_bf16 v[32:47], v[104:107], v[100:103], v[32:47]
    ds_read_b64_tr_b16 v[88:89], v218 offset:36864
    ds_read_b64_tr_b16 v[90:91], v218 offset:37376
    v_mfma_f32_32x32x16_bf16 v[48:63], v[108:111], v[96:99], v[48:63]
    ds_read_b64_tr_b16 v[92:93], v219 offset:36864
    ds_read_b64_tr_b16 v[94:95], v219 offset:37376
    v_mfma_f32_32x32x16_bf16 v[64:79], v[108:111], v[100:103], v[64:79]
    s_waitcnt lgkmcnt(6)
    v_mfma_f32_32x32x16_bf16 v[16:31], v[120:123], v[112:115], v[16:31]
    ds_read_b128 v[96:99], v215 offset:32768
    ds_read_b128 v[100:103], v215 offset:36864
    v_mfma_f32_32x32x16_bf16 v[32:47], v[120:123], v[116:119], v[32:47]
    ds_read_b64_tr_b16 v[104:105], v218 offset:38912
    ds_read_b64_tr_b16 v[106:107], v218 offset:39424
    v_mfma_f32_32x32x16_bf16 v[48:63], v[124:127], v[112:115], v[48:63]
    ds_read_b64_tr_b16 v[108:109], v219 offset:38912
    ds_read_b64_tr_b16 v[110:111], v219 offset:39424
    v_mfma_f32_32x32x16_bf16 v[64:79], v[124:127], v[116:119], v[64:79]
    s_waitcnt lgkmcnt(0)
    s_barrier
    v_mfma_f32_32x32x16_bf16 v[16:31], v[88:91], v[80:83], v[16:31]
    ds_read_b128 v[112:115], v208 offset:0
    ds_read_b128 v[116:119], v208 offset:4096
    v_mfma_f32_32x32x16_bf16 v[32:47], v[88:91], v[84:87], v[32:47]
    ds_read_b64_tr_b16 v[120:121], v216 offset:0
    ds_read_b64_tr_b16 v[122:123], v216 offset:512
    v_mfma_f32_32x32x16_bf16 v[48:63], v[92:95], v[80:83], v[48:63]
    ds_read_b64_tr_b16 v[124:125], v217 offset:0
    ds_read_b64_tr_b16 v[126:127], v217 offset:512
    v_mfma_f32_32x32x16_bf16 v[64:79], v[92:95], v[84:87], v[64:79]
    s_waitcnt lgkmcnt(6)
    v_mfma_f32_32x32x16_bf16 v[16:31], v[104:107], v[96:99], v[16:31]
    ds_read_b128 v[80:83], v209 offset:0
    ds_read_b128 v[84:87], v209 offset:4096
    v_mfma_f32_32x32x16_bf16 v[32:47], v[104:107], v[100:103], v[32:47]
    ds_read_b64_tr_b16 v[88:89], v216 offset:2048
    ds_read_b64_tr_b16 v[90:91], v216 offset:2560
    v_mfma_f32_32x32x16_bf16 v[48:63], v[108:111], v[96:99], v[48:63]
    ds_read_b64_tr_b16 v[92:93], v217 offset:2048
    ds_read_b64_tr_b16 v[94:95], v217 offset:2560
    v_mfma_f32_32x32x16_bf16 v[64:79], v[108:111], v[100:103], v[64:79]
    s_waitcnt lgkmcnt(6)
    v_mfma_f32_32x32x16_bf16 v[16:31], v[120:123], v[112:115], v[16:31]
    ds_read_b128 v[96:99], v210 offset:0
    ds_read_b128 v[100:103], v210 offset:4096
    v_mfma_f32_32x32x16_bf16 v[32:47], v[120:123], v[116:119], v[32:47]
    ds_read_b64_tr_b16 v[104:105], v216 offset:4096
    ds_read_b64_tr_b16 v[106:107], v216 offset:4608
    v_mfma_f32_32x32x16_bf16 v[48:63], v[124:127], v[112:115], v[48:63]
    ds_read_b64_tr_b16 v[108:109], v217 offset:4096
    ds_read_b64_tr_b16 v[110:111], v217 offset:4608
    v_mfma_f32_32x32x16_bf16 v[64:79], v[124:127], v[116:119], v[64:79]
    s_waitcnt lgkmcnt(6)
    v_mfma_f32_32x32x16_bf16 v[16:31], v[88:91], v[80:83], v[16:31]
    ds_read_b128 v[112:115], v211 offset:0
    ds_read_b128 v[116:119], v211 offset:4096
    v_mfma_f32_32x32x16_bf16 v[32:47], v[88:91], v[84:87], v[32:47]
    ds_read_b64_tr_b16 v[120:121], v216 offset:6144
    ds_read_b64_tr_b16 v[122:123], v216 offset:6656
    v_mfma_f32_32x32x16_bf16 v[48:63], v[92:95], v[80:83], v[48:63]
    ds_read_b64_tr_b16 v[124:125], v217 offset:6144
    ds_read_b64_tr_b16 v[126:127], v217 offset:6656
    v_mfma_f32_32x32x16_bf16 v[64:79], v[92:95], v[84:87], v[64:79]
    s_waitcnt lgkmcnt(0)
    s_barrier
    v_mfma_f32_32x32x16_bf16 v[16:31], v[104:107], v[96:99], v[16:31]
    ds_read_b128 v[80:83], v208 offset:32768
    ds_read_b128 v[84:87], v208 offset:36864
    v_mfma_f32_32x32x16_bf16 v[32:47], v[104:107], v[100:103], v[32:47]
    ds_read_b64_tr_b16 v[88:89], v216 offset:32768
    ds_read_b64_tr_b16 v[90:91], v216 offset:33280
    v_mfma_f32_32x32x16_bf16 v[48:63], v[108:111], v[96:99], v[48:63]
    ds_read_b64_tr_b16 v[92:93], v217 offset:32768
    ds_read_b64_tr_b16 v[94:95], v217 offset:33280
    v_mfma_f32_32x32x16_bf16 v[64:79], v[108:111], v[100:103], v[64:79]
    s_waitcnt lgkmcnt(6)
    v_mfma_f32_32x32x16_bf16 v[16:31], v[120:123], v[112:115], v[16:31]
    ds_read_b128 v[96:99], v209 offset:32768
    ds_read_b128 v[100:103], v209 offset:36864
    v_mfma_f32_32x32x16_bf16 v[32:47], v[120:123], v[116:119], v[32:47]
    ds_read_b64_tr_b16 v[104:105], v216 offset:34816
    ds_read_b64_tr_b16 v[106:107], v216 offset:35328
    v_mfma_f32_32x32x16_bf16 v[48:63], v[124:127], v[112:115], v[48:63]
    ds_read_b64_tr_b16 v[108:109], v217 offset:34816
    ds_read_b64_tr_b16 v[110:111], v217 offset:35328
    v_mfma_f32_32x32x16_bf16 v[64:79], v[124:127], v[116:119], v[64:79]
    s_waitcnt lgkmcnt(6)
    v_mfma_f32_32x32x16_bf16 v[16:31], v[88:91], v[80:83], v[16:31]
    ds_read_b128 v[112:115], v210 offset:32768
    ds_read_b128 v[116:119], v210 offset:36864
    v_mfma_f32_32x32x16_bf16 v[32:47], v[88:91], v[84:87], v[32:47]
    ds_read_b64_tr_b16 v[120:121], v216 offset:36864
    ds_read_b64_tr_b16 v[122:123], v216 offset:37376
    v_mfma_f32_32x32x16_bf16 v[48:63], v[92:95], v[80:83], v[48:63]
    ds_read_b64_tr_b16 v[124:125], v217 offset:36864
    ds_read_b64_tr_b16 v[126:127], v217 offset:37376
    v_mfma_f32_32x32x16_bf16 v[64:79], v[92:95], v[84:87], v[64:79]
    s_waitcnt lgkmcnt(6)
    v_mfma_f32_32x32x16_bf16 v[16:31], v[104:107], v[96:99], v[16:31]
    ds_read_b128 v[80:83], v211 offset:32768
    ds_read_b128 v[84:87], v211 offset:36864
    v_mfma_f32_32x32x16_bf16 v[32:47], v[104:107], v[100:103], v[32:47]
    ds_read_b64_tr_b16 v[88:89], v216 offset:38912
    ds_read_b64_tr_b16 v[90:91], v216 offset:39424
    v_mfma_f32_32x32x16_bf16 v[48:63], v[108:111], v[96:99], v[48:63]
    ds_read_b64_tr_b16 v[92:93], v217 offset:38912
    ds_read_b64_tr_b16 v[94:95], v217 offset:39424
    v_mfma_f32_32x32x16_bf16 v[64:79], v[108:111], v[100:103], v[64:79]
    s_waitcnt lgkmcnt(6)
    v_mfma_f32_32x32x16_bf16 v[16:31], v[120:123], v[112:115], v[16:31]
    v_mfma_f32_32x32x16_bf16 v[32:47], v[120:123], v[116:119], v[32:47]
    v_mfma_f32_32x32x16_bf16 v[48:63], v[124:127], v[112:115], v[48:63]
    v_mfma_f32_32x32x16_bf16 v[64:79], v[124:127], v[116:119], v[64:79]
    s_waitcnt lgkmcnt(0)
    v_mfma_f32_32x32x16_bf16 v[16:31], v[88:91], v[80:83], v[16:31]
    v_mfma_f32_32x32x16_bf16 v[32:47], v[88:91], v[84:87], v[32:47]
    v_mfma_f32_32x32x16_bf16 v[48:63], v[92:95], v[80:83], v[48:63]
    v_mfma_f32_32x32x16_bf16 v[64:79], v[92:95], v[84:87], v[64:79]
    s_barrier
    ds_read_b32 v128, v192 offset:0
    ds_read_b32 v129, v192 offset:512
    ds_read_b32 v130, v192 offset:128
    ds_read_b32 v131, v192 offset:640
    ds_read_b128 v[136:139], v193 offset:0
    ds_read_b128 v[140:143], v193 offset:32
    ds_read_b128 v[144:147], v193 offset:64
    ds_read_b128 v[148:151], v193 offset:96
    ds_read_b128 v[152:155], v193 offset:128
    ds_read_b128 v[156:159], v193 offset:160
    ds_read_b128 v[160:163], v193 offset:192
    ds_read_b128 v[164:167], v193 offset:224
    s_waitcnt lgkmcnt(7)
    v_pk_fma_f32 v[16:17], v[128:129], v[136:137], v[16:17] op_sel:[1,0,0] op_sel_hi:[1,1,1] neg_lo:[1,0,0] neg_hi:[1,0,0]
    v_pk_fma_f32 v[18:19], v[128:129], v[138:139], v[18:19] op_sel:[1,0,0] op_sel_hi:[1,1,1] neg_lo:[1,0,0] neg_hi:[1,0,0]
    v_pk_mul_f32 v[16:17], v[16:17], v[128:129] op_sel_hi:[1,0]
    v_pk_mul_f32 v[18:19], v[18:19], v[128:129] op_sel_hi:[1,0]
    v_cvt_pk_bf16_f32 v168, v16, v17
    v_cvt_pk_bf16_f32 v169, v18, v19
    ds_write_b64 v184, v[168:169] offset:0
    v_pk_fma_f32 v[32:33], v[130:131], v[136:137], v[32:33] op_sel:[1,0,0] op_sel_hi:[1,1,1] neg_lo:[1,0,0] neg_hi:[1,0,0]
    v_pk_fma_f32 v[34:35], v[130:131], v[138:139], v[34:35] op_sel:[1,0,0] op_sel_hi:[1,1,1] neg_lo:[1,0,0] neg_hi:[1,0,0]
    v_pk_mul_f32 v[32:33], v[32:33], v[130:131] op_sel_hi:[1,0]
    v_pk_mul_f32 v[34:35], v[34:35], v[130:131] op_sel_hi:[1,0]
    v_cvt_pk_bf16_f32 v170, v32, v33
    v_cvt_pk_bf16_f32 v171, v34, v35
    ds_write_b64 v184, v[170:171] offset:8192
    s_waitcnt lgkmcnt(8)
    v_pk_fma_f32 v[20:21], v[128:129], v[140:141], v[20:21] op_sel:[1,0,0] op_sel_hi:[1,1,1] neg_lo:[1,0,0] neg_hi:[1,0,0]
    v_pk_fma_f32 v[22:23], v[128:129], v[142:143], v[22:23] op_sel:[1,0,0] op_sel_hi:[1,1,1] neg_lo:[1,0,0] neg_hi:[1,0,0]
    v_pk_mul_f32 v[20:21], v[20:21], v[128:129] op_sel_hi:[1,0]
    v_pk_mul_f32 v[22:23], v[22:23], v[128:129] op_sel_hi:[1,0]
    v_cvt_pk_bf16_f32 v172, v20, v21
    v_cvt_pk_bf16_f32 v173, v22, v23
    ds_write_b64 v185, v[172:173] offset:0
    v_pk_fma_f32 v[36:37], v[130:131], v[140:141], v[36:37] op_sel:[1,0,0] op_sel_hi:[1,1,1] neg_lo:[1,0,0] neg_hi:[1,0,0]
    v_pk_fma_f32 v[38:39], v[130:131], v[142:143], v[38:39] op_sel:[1,0,0] op_sel_hi:[1,1,1] neg_lo:[1,0,0] neg_hi:[1,0,0]
    v_pk_mul_f32 v[36:37], v[36:37], v[130:131] op_sel_hi:[1,0]
    v_pk_mul_f32 v[38:39], v[38:39], v[130:131] op_sel_hi:[1,0]
    v_cvt_pk_bf16_f32 v174, v36, v37
    v_cvt_pk_bf16_f32 v175, v38, v39
    ds_write_b64 v185, v[174:175] offset:8192
    s_waitcnt lgkmcnt(9)
    v_pk_fma_f32 v[24:25], v[128:129], v[144:145], v[24:25] op_sel:[1,0,0] op_sel_hi:[1,1,1] neg_lo:[1,0,0] neg_hi:[1,0,0]
    v_pk_fma_f32 v[26:27], v[128:129], v[146:147], v[26:27] op_sel:[1,0,0] op_sel_hi:[1,1,1] neg_lo:[1,0,0] neg_hi:[1,0,0]
    v_pk_mul_f32 v[24:25], v[24:25], v[128:129] op_sel_hi:[1,0]
    v_pk_mul_f32 v[26:27], v[26:27], v[128:129] op_sel_hi:[1,0]
    v_cvt_pk_bf16_f32 v168, v24, v25
    v_cvt_pk_bf16_f32 v169, v26, v27
    ds_write_b64 v186, v[168:169] offset:0
    v_pk_fma_f32 v[40:41], v[130:131], v[144:145], v[40:41] op_sel:[1,0,0] op_sel_hi:[1,1,1] neg_lo:[1,0,0] neg_hi:[1,0,0]
    v_pk_fma_f32 v[42:43], v[130:131], v[146:147], v[42:43] op_sel:[1,0,0] op_sel_hi:[1,1,1] neg_lo:[1,0,0] neg_hi:[1,0,0]
    v_pk_mul_f32 v[40:41], v[40:41], v[130:131] op_sel_hi:[1,0]
    v_pk_mul_f32 v[42:43], v[42:43], v[130:131] op_sel_hi:[1,0]
    v_cvt_pk_bf16_f32 v170, v40, v41
    v_cvt_pk_bf16_f32 v171, v42, v43
    ds_write_b64 v186, v[170:171] offset:8192
    s_waitcnt lgkmcnt(10)
    v_pk_fma_f32 v[28:29], v[128:129], v[148:149], v[28:29] op_sel:[1,0,0] op_sel_hi:[1,1,1] neg_lo:[1,0,0] neg_hi:[1,0,0]
    v_pk_fma_f32 v[30:31], v[128:129], v[150:151], v[30:31] op_sel:[1,0,0] op_sel_hi:[1,1,1] neg_lo:[1,0,0] neg_hi:[1,0,0]
    v_pk_mul_f32 v[28:29], v[28:29], v[128:129] op_sel_hi:[1,0]
    v_pk_mul_f32 v[30:31], v[30:31], v[128:129] op_sel_hi:[1,0]
    v_cvt_pk_bf16_f32 v172, v28, v29
    v_cvt_pk_bf16_f32 v173, v30, v31
    ds_write_b64 v187, v[172:173] offset:0
    v_pk_fma_f32 v[44:45], v[130:131], v[148:149], v[44:45] op_sel:[1,0,0] op_sel_hi:[1,1,1] neg_lo:[1,0,0] neg_hi:[1,0,0]
    v_pk_fma_f32 v[46:47], v[130:131], v[150:151], v[46:47] op_sel:[1,0,0] op_sel_hi:[1,1,1] neg_lo:[1,0,0] neg_hi:[1,0,0]
    v_pk_mul_f32 v[44:45], v[44:45], v[130:131] op_sel_hi:[1,0]
    v_pk_mul_f32 v[46:47], v[46:47], v[130:131] op_sel_hi:[1,0]
    v_cvt_pk_bf16_f32 v174, v44, v45
    v_cvt_pk_bf16_f32 v175, v46, v47
    ds_write_b64 v187, v[174:175] offset:8192
    s_waitcnt lgkmcnt(11)
    v_pk_fma_f32 v[48:49], v[128:129], v[152:153], v[48:49] op_sel:[1,0,0] op_sel_hi:[1,1,1] neg_lo:[1,0,0] neg_hi:[1,0,0]
    v_pk_fma_f32 v[50:51], v[128:129], v[154:155], v[50:51] op_sel:[1,0,0] op_sel_hi:[1,1,1] neg_lo:[1,0,0] neg_hi:[1,0,0]
    v_pk_mul_f32 v[48:49], v[48:49], v[128:129] op_sel_hi:[1,0]
    v_pk_mul_f32 v[50:51], v[50:51], v[128:129] op_sel_hi:[1,0]
    v_cvt_pk_bf16_f32 v168, v48, v49
    v_cvt_pk_bf16_f32 v169, v50, v51
    ds_write_b64 v188, v[168:169] offset:0
    v_pk_fma_f32 v[64:65], v[130:131], v[152:153], v[64:65] op_sel:[1,0,0] op_sel_hi:[1,1,1] neg_lo:[1,0,0] neg_hi:[1,0,0]
    v_pk_fma_f32 v[66:67], v[130:131], v[154:155], v[66:67] op_sel:[1,0,0] op_sel_hi:[1,1,1] neg_lo:[1,0,0] neg_hi:[1,0,0]
    v_pk_mul_f32 v[64:65], v[64:65], v[130:131] op_sel_hi:[1,0]
    v_pk_mul_f32 v[66:67], v[66:67], v[130:131] op_sel_hi:[1,0]
    v_cvt_pk_bf16_f32 v170, v64, v65
    v_cvt_pk_bf16_f32 v171, v66, v67
    ds_write_b64 v188, v[170:171] offset:8192
    s_waitcnt lgkmcnt(12)
    v_pk_fma_f32 v[52:53], v[128:129], v[156:157], v[52:53] op_sel:[1,0,0] op_sel_hi:[1,1,1] neg_lo:[1,0,0] neg_hi:[1,0,0]
    v_pk_fma_f32 v[54:55], v[128:129], v[158:159], v[54:55] op_sel:[1,0,0] op_sel_hi:[1,1,1] neg_lo:[1,0,0] neg_hi:[1,0,0]
    v_pk_mul_f32 v[52:53], v[52:53], v[128:129] op_sel_hi:[1,0]
    v_pk_mul_f32 v[54:55], v[54:55], v[128:129] op_sel_hi:[1,0]
    v_cvt_pk_bf16_f32 v172, v52, v53
    v_cvt_pk_bf16_f32 v173, v54, v55
    ds_write_b64 v189, v[172:173] offset:0
    v_pk_fma_f32 v[68:69], v[130:131], v[156:157], v[68:69] op_sel:[1,0,0] op_sel_hi:[1,1,1] neg_lo:[1,0,0] neg_hi:[1,0,0]
    v_pk_fma_f32 v[70:71], v[130:131], v[158:159], v[70:71] op_sel:[1,0,0] op_sel_hi:[1,1,1] neg_lo:[1,0,0] neg_hi:[1,0,0]
    v_pk_mul_f32 v[68:69], v[68:69], v[130:131] op_sel_hi:[1,0]
    v_pk_mul_f32 v[70:71], v[70:71], v[130:131] op_sel_hi:[1,0]
    v_cvt_pk_bf16_f32 v174, v68, v69
    v_cvt_pk_bf16_f32 v175, v70, v71
    ds_write_b64 v189, v[174:175] offset:8192
    s_waitcnt lgkmcnt(13)
    v_pk_fma_f32 v[56:57], v[128:129], v[160:161], v[56:57] op_sel:[1,0,0] op_sel_hi:[1,1,1] neg_lo:[1,0,0] neg_hi:[1,0,0]
    v_pk_fma_f32 v[58:59], v[128:129], v[162:163], v[58:59] op_sel:[1,0,0] op_sel_hi:[1,1,1] neg_lo:[1,0,0] neg_hi:[1,0,0]
    v_pk_mul_f32 v[56:57], v[56:57], v[128:129] op_sel_hi:[1,0]
    v_pk_mul_f32 v[58:59], v[58:59], v[128:129] op_sel_hi:[1,0]
    v_cvt_pk_bf16_f32 v168, v56, v57
    v_cvt_pk_bf16_f32 v169, v58, v59
    ds_write_b64 v190, v[168:169] offset:0
    v_pk_fma_f32 v[72:73], v[130:131], v[160:161], v[72:73] op_sel:[1,0,0] op_sel_hi:[1,1,1] neg_lo:[1,0,0] neg_hi:[1,0,0]
    v_pk_fma_f32 v[74:75], v[130:131], v[162:163], v[74:75] op_sel:[1,0,0] op_sel_hi:[1,1,1] neg_lo:[1,0,0] neg_hi:[1,0,0]
    v_pk_mul_f32 v[72:73], v[72:73], v[130:131] op_sel_hi:[1,0]
    v_pk_mul_f32 v[74:75], v[74:75], v[130:131] op_sel_hi:[1,0]
    v_cvt_pk_bf16_f32 v170, v72, v73
    v_cvt_pk_bf16_f32 v171, v74, v75
    ds_write_b64 v190, v[170:171] offset:8192
    s_waitcnt lgkmcnt(14)
    v_pk_fma_f32 v[60:61], v[128:129], v[164:165], v[60:61] op_sel:[1,0,0] op_sel_hi:[1,1,1] neg_lo:[1,0,0] neg_hi:[1,0,0]
    v_pk_fma_f32 v[62:63], v[128:129], v[166:167], v[62:63] op_sel:[1,0,0] op_sel_hi:[1,1,1] neg_lo:[1,0,0] neg_hi:[1,0,0]
    v_pk_mul_f32 v[60:61], v[60:61], v[128:129] op_sel_hi:[1,0]
    v_pk_mul_f32 v[62:63], v[62:63], v[128:129] op_sel_hi:[1,0]
    v_cvt_pk_bf16_f32 v172, v60, v61
    v_cvt_pk_bf16_f32 v173, v62, v63
    ds_write_b64 v191, v[172:173] offset:0
    v_pk_fma_f32 v[76:77], v[130:131], v[164:165], v[76:77] op_sel:[1,0,0] op_sel_hi:[1,1,1] neg_lo:[1,0,0] neg_hi:[1,0,0]
    v_pk_fma_f32 v[78:79], v[130:131], v[166:167], v[78:79] op_sel:[1,0,0] op_sel_hi:[1,1,1] neg_lo:[1,0,0] neg_hi:[1,0,0]
    v_pk_mul_f32 v[76:77], v[76:77], v[130:131] op_sel_hi:[1,0]
    v_pk_mul_f32 v[78:79], v[78:79], v[130:131] op_sel_hi:[1,0]
    v_cvt_pk_bf16_f32 v174, v76, v77
    v_cvt_pk_bf16_f32 v175, v78, v79
    ds_write_b64 v191, v[174:175] offset:8192
    s_waitcnt lgkmcnt(0)
    s_branch m3_g4_p3
m3_g4_load:
    s_add_u32 s48, s40, 13443072
    s_addc_u32 s49, s41, 0
    s_mov_b32 s50, 2621440
    s_mov_b32 s51, 0x20000
    s_mov_b32 s52, s32
    s_mov_b32 s53, s33
    s_mov_b32 s54, 1966080
    s_mov_b32 s55, 0x20000
    s_sub_u32 s4, s3, 4
    s_lshl_b32 s5, s4, 10
    s_mul_i32 s6, s44, 163840
    s_lshl_b32 s7, s45, 8
    v_lshrrev_b32 v10, 3, v1
    v_and_b32 v11, 7, v1
    v_bfe_u32 v12, v10, 1, 1
    v_lshlrev_b32 v12, 2, v12
    v_xor_b32 v11, v11, v12
    s_lshl_b32 s42, s4, 3
    v_add_u32 v13, s42, v10
    v_mul_u32_u24 v13, 3072, v13
    v_lshl_add_u32 v3, v11, 4, v13
    v_lshrrev_b32 v10, 3, v1
    v_and_b32 v11, 7, v1
    v_lshrrev_b32 v12, 1, v10
    s_and_b32 s42, s4, 1
    s_lshl_b32 s42, s42, 2
    v_or_b32 v12, s42, v12
    v_xor_b32 v11, v11, v12
    s_lshl_b32 s42, s4, 3
    v_add_u32 v13, s42, v10
    v_mul_u32_u24 v13, 1280, v13
    v_lshl_add_u32 v2, v11, 4, v13
    s_add_u32 m0, s5, 16384
    s_nop 0
    buffer_load_dwordx4 v3, s[52:55], s7 offen lds
    s_add_u32 m0, s5, 20480
    s_add_u32 s43, s7, 98304
    buffer_load_dwordx4 v3, s[52:55], s43 offen lds
    s_add_u32 m0, s5, 24576
    s_add_u32 s43, s7, 128
    buffer_load_dwordx4 v3, s[52:55], s43 offen lds
    s_add_u32 m0, s5, 28672
    s_add_u32 s43, s7, 98432
    buffer_load_dwordx4 v3, s[52:55], s43 offen lds
    s_add_u32 m0, s5, 49152
    s_add_u32 s43, s7, 196608
    buffer_load_dwordx4 v3, s[52:55], s43 offen lds
    s_add_u32 m0, s5, 53248
    s_add_u32 s43, s7, 294912
    buffer_load_dwordx4 v3, s[52:55], s43 offen lds
    s_add_u32 m0, s5, 57344
    s_add_u32 s43, s7, 196736
    buffer_load_dwordx4 v3, s[52:55], s43 offen lds
    s_add_u32 m0, s5, 61440
    s_add_u32 s43, s7, 295040
    buffer_load_dwordx4 v3, s[52:55], s43 offen lds
    s_add_u32 m0, s5, 81920
    s_add_u32 s43, s7, 393216
    buffer_load_dwordx4 v3, s[52:55], s43 offen lds
    s_add_u32 m0, s5, 86016
    s_add_u32 s43, s7, 491520
    buffer_load_dwordx4 v3, s[52:55], s43 offen lds
    s_add_u32 m0, s5, 90112
    s_add_u32 s43, s7, 393344
    buffer_load_dwordx4 v3, s[52:55], s43 offen lds
    s_add_u32 m0, s5, 94208
    s_add_u32 s43, s7, 491648
    buffer_load_dwordx4 v3, s[52:55], s43 offen lds
    s_add_u32 m0, s5, 114688
    s_add_u32 s43, s7, 589824
    buffer_load_dwordx4 v3, s[52:55], s43 offen lds
    s_add_u32 m0, s5, 118784
    s_add_u32 s43, s7, 688128
    buffer_load_dwordx4 v3, s[52:55], s43 offen lds
    s_add_u32 m0, s5, 122880
    s_add_u32 s43, s7, 589952
    buffer_load_dwordx4 v3, s[52:55], s43 offen lds
    s_add_u32 m0, s5, 126976
    s_add_u32 s43, s7, 688256
    buffer_load_dwordx4 v3, s[52:55], s43 offen lds
    s_barrier
    s_add_u32 m0, s5, 0
    s_nop 0
    buffer_load_dwordx4 v2, s[48:51], s6 offen lds
    s_add_u32 m0, s5, 4096
    s_add_u32 s43, s6, 40960
    buffer_load_dwordx4 v2, s[48:51], s43 offen lds
    s_add_u32 m0, s5, 8192
    s_add_u32 s43, s6, 81920
    buffer_load_dwordx4 v2, s[48:51], s43 offen lds
    s_add_u32 m0, s5, 12288
    s_add_u32 s43, s6, 122880
    buffer_load_dwordx4 v2, s[48:51], s43 offen lds
    s_add_u32 m0, s5, 32768
    s_add_u32 s43, s6, 128
    buffer_load_dwordx4 v2, s[48:51], s43 offen lds
    s_add_u32 m0, s5, 36864
    s_add_u32 s43, s6, 41088
    buffer_load_dwordx4 v2, s[48:51], s43 offen lds
    s_add_u32 m0, s5, 40960
    s_add_u32 s43, s6, 82048
    buffer_load_dwordx4 v2, s[48:51], s43 offen lds
    s_add_u32 m0, s5, 45056
    s_add_u32 s43, s6, 123008
    buffer_load_dwordx4 v2, s[48:51], s43 offen lds
    s_waitcnt vmcnt(4)
    s_barrier
    s_add_u32 m0, s5, 65536
    s_add_u32 s43, s6, 256
    buffer_load_dwordx4 v2, s[48:51], s43 offen lds
    s_add_u32 m0, s5, 69632
    s_add_u32 s43, s6, 41216
    buffer_load_dwordx4 v2, s[48:51], s43 offen lds
    s_add_u32 m0, s5, 73728
    s_add_u32 s43, s6, 82176
    buffer_load_dwordx4 v2, s[48:51], s43 offen lds
    s_add_u32 m0, s5, 77824
    s_add_u32 s43, s6, 123136
    buffer_load_dwordx4 v2, s[48:51], s43 offen lds
    s_add_u32 m0, s5, 98304
    s_add_u32 s43, s6, 384
    buffer_load_dwordx4 v2, s[48:51], s43 offen lds
    s_add_u32 m0, s5, 102400
    s_add_u32 s43, s6, 41344
    buffer_load_dwordx4 v2, s[48:51], s43 offen lds
    s_add_u32 m0, s5, 106496
    s_add_u32 s43, s6, 82304
    buffer_load_dwordx4 v2, s[48:51], s43 offen lds
    s_add_u32 m0, s5, 110592
    s_add_u32 s43, s6, 123264
    buffer_load_dwordx4 v2, s[48:51], s43 offen lds
    s_waitcnt vmcnt(8)
    s_barrier
    s_add_u32 m0, s5, 0
    s_add_u32 s43, s6, 512
    buffer_load_dwordx4 v2, s[48:51], s43 offen lds
    s_add_u32 m0, s5, 4096
    s_add_u32 s43, s6, 41472
    buffer_load_dwordx4 v2, s[48:51], s43 offen lds
    s_add_u32 m0, s5, 8192
    s_add_u32 s43, s6, 82432
    buffer_load_dwordx4 v2, s[48:51], s43 offen lds
    s_add_u32 m0, s5, 12288
    s_add_u32 s43, s6, 123392
    buffer_load_dwordx4 v2, s[48:51], s43 offen lds
    s_add_u32 m0, s5, 16384
    s_add_u32 s43, s7, 786432
    buffer_load_dwordx4 v3, s[52:55], s43 offen lds
    s_add_u32 m0, s5, 20480
    s_add_u32 s43, s7, 884736
    buffer_load_dwordx4 v3, s[52:55], s43 offen lds
    s_add_u32 m0, s5, 24576
    s_add_u32 s43, s7, 786560
    buffer_load_dwordx4 v3, s[52:55], s43 offen lds
    s_add_u32 m0, s5, 28672
    s_add_u32 s43, s7, 884864
    buffer_load_dwordx4 v3, s[52:55], s43 offen lds
    s_waitcnt vmcnt(12)
    s_barrier
    s_add_u32 m0, s5, 32768
    s_add_u32 s43, s6, 640
    buffer_load_dwordx4 v2, s[48:51], s43 offen lds
    s_add_u32 m0, s5, 36864
    s_add_u32 s43, s6, 41600
    buffer_load_dwordx4 v2, s[48:51], s43 offen lds
    s_add_u32 m0, s5, 40960
    s_add_u32 s43, s6, 82560
    buffer_load_dwordx4 v2, s[48:51], s43 offen lds
    s_add_u32 m0, s5, 45056
    s_add_u32 s43, s6, 123520
    buffer_load_dwordx4 v2, s[48:51], s43 offen lds
    s_add_u32 m0, s5, 49152
    s_add_u32 s43, s7, 983040
    buffer_load_dwordx4 v3, s[52:55], s43 offen lds
    s_add_u32 m0, s5, 53248
    s_add_u32 s43, s7, 1081344
    buffer_load_dwordx4 v3, s[52:55], s43 offen lds
    s_add_u32 m0, s5, 57344
    s_add_u32 s43, s7, 983168
    buffer_load_dwordx4 v3, s[52:55], s43 offen lds
    s_add_u32 m0, s5, 61440
    s_add_u32 s43, s7, 1081472
    buffer_load_dwordx4 v3, s[52:55], s43 offen lds
    s_waitcnt vmcnt(16)
    s_barrier
    s_add_u32 m0, s5, 65536
    s_add_u32 s43, s6, 768
    buffer_load_dwordx4 v2, s[48:51], s43 offen lds
    s_add_u32 m0, s5, 69632
    s_add_u32 s43, s6, 41728
    buffer_load_dwordx4 v2, s[48:51], s43 offen lds
    s_add_u32 m0, s5, 73728
    s_add_u32 s43, s6, 82688
    buffer_load_dwordx4 v2, s[48:51], s43 offen lds
    s_add_u32 m0, s5, 77824
    s_add_u32 s43, s6, 123648
    buffer_load_dwordx4 v2, s[48:51], s43 offen lds
    s_add_u32 m0, s5, 81920
    s_add_u32 s43, s7, 1179648
    buffer_load_dwordx4 v3, s[52:55], s43 offen lds
    s_add_u32 m0, s5, 86016
    s_add_u32 s43, s7, 1277952
    buffer_load_dwordx4 v3, s[52:55], s43 offen lds
    s_add_u32 m0, s5, 90112
    s_add_u32 s43, s7, 1179776
    buffer_load_dwordx4 v3, s[52:55], s43 offen lds
    s_add_u32 m0, s5, 94208
    s_add_u32 s43, s7, 1278080
    buffer_load_dwordx4 v3, s[52:55], s43 offen lds
    s_waitcnt vmcnt(16)
    s_barrier
    s_add_u32 m0, s5, 98304
    s_add_u32 s43, s6, 896
    buffer_load_dwordx4 v2, s[48:51], s43 offen lds
    s_add_u32 m0, s5, 102400
    s_add_u32 s43, s6, 41856
    buffer_load_dwordx4 v2, s[48:51], s43 offen lds
    s_add_u32 m0, s5, 106496
    s_add_u32 s43, s6, 82816
    buffer_load_dwordx4 v2, s[48:51], s43 offen lds
    s_add_u32 m0, s5, 110592
    s_add_u32 s43, s6, 123776
    buffer_load_dwordx4 v2, s[48:51], s43 offen lds
    s_add_u32 m0, s5, 114688
    s_add_u32 s43, s7, 1376256
    buffer_load_dwordx4 v3, s[52:55], s43 offen lds
    s_add_u32 m0, s5, 118784
    s_add_u32 s43, s7, 1474560
    buffer_load_dwordx4 v3, s[52:55], s43 offen lds
    s_add_u32 m0, s5, 122880
    s_add_u32 s43, s7, 1376384
    buffer_load_dwordx4 v3, s[52:55], s43 offen lds
    s_add_u32 m0, s5, 126976
    s_add_u32 s43, s7, 1474688
    buffer_load_dwordx4 v3, s[52:55], s43 offen lds
    s_waitcnt vmcnt(16)
    s_barrier
    s_add_u32 m0, s5, 0
    s_add_u32 s43, s6, 1024
    buffer_load_dwordx4 v2, s[48:51], s43 offen lds
    s_add_u32 m0, s5, 4096
    s_add_u32 s43, s6, 41984
    buffer_load_dwordx4 v2, s[48:51], s43 offen lds
    s_add_u32 m0, s5, 8192
    s_add_u32 s43, s6, 82944
    buffer_load_dwordx4 v2, s[48:51], s43 offen lds
    s_add_u32 m0, s5, 12288
    s_add_u32 s43, s6, 123904
    buffer_load_dwordx4 v2, s[48:51], s43 offen lds
    s_add_u32 m0, s5, 16384
    s_add_u32 s43, s7, 1572864
    buffer_load_dwordx4 v3, s[52:55], s43 offen lds
    s_add_u32 m0, s5, 20480
    s_add_u32 s43, s7, 1671168
    buffer_load_dwordx4 v3, s[52:55], s43 offen lds
    s_add_u32 m0, s5, 24576
    s_add_u32 s43, s7, 1572992
    buffer_load_dwordx4 v3, s[52:55], s43 offen lds
    s_add_u32 m0, s5, 28672
    s_add_u32 s43, s7, 1671296
    buffer_load_dwordx4 v3, s[52:55], s43 offen lds
    s_waitcnt vmcnt(16)
    s_barrier
    s_add_u32 m0, s5, 32768
    s_add_u32 s43, s6, 1152
    buffer_load_dwordx4 v2, s[48:51], s43 offen lds
    s_add_u32 m0, s5, 36864
    s_add_u32 s43, s6, 42112
    buffer_load_dwordx4 v2, s[48:51], s43 offen lds
    s_add_u32 m0, s5, 40960
    s_add_u32 s43, s6, 83072
    buffer_load_dwordx4 v2, s[48:51], s43 offen lds
    s_add_u32 m0, s5, 45056
    s_add_u32 s43, s6, 124032
    buffer_load_dwordx4 v2, s[48:51], s43 offen lds
    s_add_u32 m0, s5, 49152
    s_add_u32 s43, s7, 1769472
    buffer_load_dwordx4 v3, s[52:55], s43 offen lds
    s_add_u32 m0, s5, 53248
    s_add_u32 s43, s7, 1867776
    buffer_load_dwordx4 v3, s[52:55], s43 offen lds
    s_add_u32 m0, s5, 57344
    s_add_u32 s43, s7, 1769600
    buffer_load_dwordx4 v3, s[52:55], s43 offen lds
    s_add_u32 m0, s5, 61440
    s_add_u32 s43, s7, 1867904
    buffer_load_dwordx4 v3, s[52:55], s43 offen lds
    s_waitcnt vmcnt(16)
    s_barrier
    s_add_u32 s76, s40, 23121920
    s_addc_u32 s77, s41, 0
    s_mov_b32 s78, 6291456
    s_mov_b32 s79, 0x20000
    s_mov_b32 s70, 0xc0135761
    s_mov_b32 s71, 0xc0135761
    s_mov_b32 s72, 0xbdd2d3e8
    s_mov_b32 s73, 0xbdd2d3e8
    s_mov_b32 s74, 0xffff0000
    v_mov_b32 v202, s70
    v_mov_b32 v203, s70
    s_mul_i32 s75, s44, 393216
    s_lshl_b32 s63, s45, 8
    s_add_u32 s75, s75, s63
    v_lshrrev_b32 v10, 4, v1
    s_lshl_b32 s63, s3, 4
    v_add_u32 v10, s63, v10
    v_lshlrev_b32 v11, 8, v10
    v_and_b32 v12, 15, v1
    v_lshl_add_u32 v11, v12, 4, v11
    v_add_u32 v196, 65536, v11
    v_add_u32 v13, 0, v10
    v_and_b32 v14, 15, v13
    v_xor_b32 v14, v14, v12
    v_mul_u32_u24 v13, 3072, v13
    v_lshl_add_u32 v197, v14, 4, v13
    v_add_u32 v13, 4, v10
    v_and_b32 v14, 15, v13
    v_xor_b32 v14, v14, v12
    v_mul_u32_u24 v13, 3072, v13
    v_lshl_add_u32 v198, v14, 4, v13
    v_add_u32 v13, 8, v10
    v_and_b32 v14, 15, v13
    v_xor_b32 v14, v14, v12
    v_mul_u32_u24 v13, 3072, v13
    v_lshl_add_u32 v199, v14, 4, v13
    v_add_u32 v13, 12, v10
    v_and_b32 v14, 15, v13
    v_xor_b32 v14, v14, v12
    v_mul_u32_u24 v13, 3072, v13
    v_lshl_add_u32 v200, v14, 4, v13
    s_add_u32 s56, s40, 16064512
    s_addc_u32 s57, s41, 0
    s_mov_b32 s58, 163840
    s_mov_b32 s59, 0x20000
    s_add_u32 s60, s40, 16228352
    s_addc_u32 s61, s41, 0
    s_mov_b32 s62, 12288
    s_mov_b32 s63, 0x20000
    v_and_b32 v14, 31, v1
    s_lshl_b32 s64, s4, 5
    v_add_u32 v14, s64, v14
    v_lshlrev_b32 v15, 3, v14
    s_lshl_b32 s65, s44, 10
    s_add_u32 s66, s65, 0
    buffer_load_dwordx2 v[32:33], v15, s[56:59], s66 offen
    s_add_u32 s66, s65, 16384
    buffer_load_dwordx2 v[34:35], v15, s[56:59], s66 offen
    s_add_u32 s66, s65, 32768
    buffer_load_dwordx2 v[36:37], v15, s[56:59], s66 offen
    s_add_u32 s66, s65, 49152
    buffer_load_dwordx2 v[38:39], v15, s[56:59], s66 offen
    s_add_u32 s66, s65, 65536
    buffer_load_dwordx2 v[40:41], v15, s[56:59], s66 offen
    v_lshlrev_b32 v16, 3, v1
    s_lshl_b32 s66, s45, 9
    buffer_load_dwordx2 v[56:57], v16, s[60:63], s66 offen
    s_add_u32 s67, s66, 6144
    buffer_load_dwordx2 v[60:61], v16, s[60:63], s67 offen
    s_waitcnt vmcnt(15)
    s_barrier
    s_waitcnt vmcnt(7)
    s_barrier
    s_waitcnt vmcnt(0)
    v_pk_add_f32 v[32:33], v[32:33], v[34:35]
    v_pk_add_f32 v[32:33], v[32:33], v[36:37]
    v_pk_add_f32 v[32:33], v[32:33], v[38:39]
    v_pk_add_f32 v[32:33], v[32:33], v[40:41]
    v_mul_f32 v26, 0x3acccccd, v32
    v_mul_f32 v27, 0x3acccccd, v33
    v_fma_f32 v27, -v26, v26, v27
    v_max_f32 v27, 0, v27
    v_cvt_pk_bf16_f32 v28, v26, v26
    v_lshlrev_b32 v28, 16, v28
    v_cvt_pk_bf16_f32 v31, v27, v27
    v_lshlrev_b32 v31, 16, v31
    v_add_f32 v31, 0x3727c5ac, v31
    v_cvt_pk_bf16_f32 v31, v31, v31
    v_lshlrev_b32 v31, 16, v31
    v_sqrt_f32 v31, v31
    s_nop 0
    v_cvt_pk_bf16_f32 v29, v31, v31
    v_lshlrev_b32 v29, 16, v29
    v_rcp_f32 v30, v29
    s_nop 0
    v_mov_b32 v24, v30
    v_mov_b32 v25, v28
    v_lshlrev_b32 v14, 2, v14
    v_add_u32 v14, 131072, v14
    ds_write_b32 v14, v24
    ds_write_b32 v14, v25 offset:512
    v_pk_add_f32 v[56:57], v[56:57], v[60:61]
    v_add_u32 v16, 132096, v16
    ds_write_b64 v16, v[56:57]
    s_waitcnt lgkmcnt(0)
    s_barrier
m3_g4_p3:
    s_barrier
    ds_read_b128 v[16:19], v196 offset:0
    ds_read_b128 v[20:23], v196 offset:1024
    ds_read_b128 v[24:27], v196 offset:2048
    ds_read_b128 v[28:31], v196 offset:3072
    s_waitcnt lgkmcnt(3)
    v_lshlrev_b32 v40, 16, v16
    v_and_b32 v41, s74, v16
    v_lshlrev_b32 v44, 16, v17
    v_and_b32 v45, s74, v17
    v_lshlrev_b32 v48, 16, v18
    v_and_b32 v49, s74, v18
    v_lshlrev_b32 v52, 16, v19
    v_and_b32 v53, s74, v19
    v_pk_mul_f32 v[42:43], v[40:41], v[40:41]
    v_pk_mul_f32 v[46:47], v[44:45], v[44:45]
    v_pk_mul_f32 v[50:51], v[48:49], v[48:49]
    v_pk_mul_f32 v[54:55], v[52:53], v[52:53]
    v_pk_fma_f32 v[42:43], v[42:43], s[72:73], v[202:203]
    v_pk_fma_f32 v[46:47], v[46:47], s[72:73], v[202:203]
    v_pk_fma_f32 v[50:51], v[50:51], s[72:73], v[202:203]
    v_pk_fma_f32 v[54:55], v[54:55], s[72:73], v[202:203]
    v_pk_mul_f32 v[42:43], v[42:43], v[40:41]
    v_pk_mul_f32 v[46:47], v[46:47], v[44:45]
    v_pk_mul_f32 v[50:51], v[50:51], v[48:49]
    v_pk_mul_f32 v[54:55], v[54:55], v[52:53]
    v_exp_f32 v42, v42
    v_exp_f32 v43, v43
    v_exp_f32 v46, v46
    v_exp_f32 v47, v47
    v_exp_f32 v50, v50
    v_exp_f32 v51, v51
    v_exp_f32 v54, v54
    v_exp_f32 v55, v55
    v_pk_add_f32 v[42:43], v[42:43], 1.0 op_sel_hi:[1,0]
    v_pk_add_f32 v[46:47], v[46:47], 1.0 op_sel_hi:[1,0]
    v_pk_add_f32 v[50:51], v[50:51], 1.0 op_sel_hi:[1,0]
    v_pk_add_f32 v[54:55], v[54:55], 1.0 op_sel_hi:[1,0]
    v_rcp_f32 v42, v42
    v_rcp_f32 v43, v43
    v_rcp_f32 v46, v46
    v_rcp_f32 v47, v47
    v_rcp_f32 v50, v50
    v_rcp_f32 v51, v51
    v_rcp_f32 v54, v54
    v_rcp_f32 v55, v55
    v_pk_mul_f32 v[42:43], v[42:43], v[40:41]
    v_pk_mul_f32 v[46:47], v[46:47], v[44:45]
    v_pk_mul_f32 v[50:51], v[50:51], v[48:49]
    v_pk_mul_f32 v[54:55], v[54:55], v[52:53]
    v_cvt_pk_bf16_f32 v16, v42, v43
    v_cvt_pk_bf16_f32 v17, v46, v47
    v_cvt_pk_bf16_f32 v18, v50, v51
    v_cvt_pk_bf16_f32 v19, v54, v55
    buffer_store_dwordx4 v[16:19], v197, s[76:79], s75 offen sc1
    s_waitcnt lgkmcnt(2)
    v_lshlrev_b32 v40, 16, v20
    v_and_b32 v41, s74, v20
    v_lshlrev_b32 v44, 16, v21
    v_and_b32 v45, s74, v21
    v_lshlrev_b32 v48, 16, v22
    v_and_b32 v49, s74, v22
    v_lshlrev_b32 v52, 16, v23
    v_and_b32 v53, s74, v23
    v_pk_mul_f32 v[42:43], v[40:41], v[40:41]
    v_pk_mul_f32 v[46:47], v[44:45], v[44:45]
    v_pk_mul_f32 v[50:51], v[48:49], v[48:49]
    v_pk_mul_f32 v[54:55], v[52:53], v[52:53]
    v_pk_fma_f32 v[42:43], v[42:43], s[72:73], v[202:203]
    v_pk_fma_f32 v[46:47], v[46:47], s[72:73], v[202:203]
    v_pk_fma_f32 v[50:51], v[50:51], s[72:73], v[202:203]
    v_pk_fma_f32 v[54:55], v[54:55], s[72:73], v[202:203]
    v_pk_mul_f32 v[42:43], v[42:43], v[40:41]
    v_pk_mul_f32 v[46:47], v[46:47], v[44:45]
    v_pk_mul_f32 v[50:51], v[50:51], v[48:49]
    v_pk_mul_f32 v[54:55], v[54:55], v[52:53]
    v_exp_f32 v42, v42
    v_exp_f32 v43, v43
    v_exp_f32 v46, v46
    v_exp_f32 v47, v47
    v_exp_f32 v50, v50
    v_exp_f32 v51, v51
    v_exp_f32 v54, v54
    v_exp_f32 v55, v55
    v_pk_add_f32 v[42:43], v[42:43], 1.0 op_sel_hi:[1,0]
    v_pk_add_f32 v[46:47], v[46:47], 1.0 op_sel_hi:[1,0]
    v_pk_add_f32 v[50:51], v[50:51], 1.0 op_sel_hi:[1,0]
    v_pk_add_f32 v[54:55], v[54:55], 1.0 op_sel_hi:[1,0]
    v_rcp_f32 v42, v42
    v_rcp_f32 v43, v43
    v_rcp_f32 v46, v46
    v_rcp_f32 v47, v47
    v_rcp_f32 v50, v50
    v_rcp_f32 v51, v51
    v_rcp_f32 v54, v54
    v_rcp_f32 v55, v55
    v_pk_mul_f32 v[42:43], v[42:43], v[40:41]
    v_pk_mul_f32 v[46:47], v[46:47], v[44:45]
    v_pk_mul_f32 v[50:51], v[50:51], v[48:49]
    v_pk_mul_f32 v[54:55], v[54:55], v[52:53]
    v_cvt_pk_bf16_f32 v20, v42, v43
    v_cvt_pk_bf16_f32 v21, v46, v47
    v_cvt_pk_bf16_f32 v22, v50, v51
    v_cvt_pk_bf16_f32 v23, v54, v55
    buffer_store_dwordx4 v[20:23], v198, s[76:79], s75 offen sc1
    s_waitcnt lgkmcnt(1)
    v_lshlrev_b32 v40, 16, v24
    v_and_b32 v41, s74, v24
    v_lshlrev_b32 v44, 16, v25
    v_and_b32 v45, s74, v25
    v_lshlrev_b32 v48, 16, v26
    v_and_b32 v49, s74, v26
    v_lshlrev_b32 v52, 16, v27
    v_and_b32 v53, s74, v27
    v_pk_mul_f32 v[42:43], v[40:41], v[40:41]
    v_pk_mul_f32 v[46:47], v[44:45], v[44:45]
    v_pk_mul_f32 v[50:51], v[48:49], v[48:49]
    v_pk_mul_f32 v[54:55], v[52:53], v[52:53]
    v_pk_fma_f32 v[42:43], v[42:43], s[72:73], v[202:203]
    v_pk_fma_f32 v[46:47], v[46:47], s[72:73], v[202:203]
    v_pk_fma_f32 v[50:51], v[50:51], s[72:73], v[202:203]
    v_pk_fma_f32 v[54:55], v[54:55], s[72:73], v[202:203]
    v_pk_mul_f32 v[42:43], v[42:43], v[40:41]
    v_pk_mul_f32 v[46:47], v[46:47], v[44:45]
    v_pk_mul_f32 v[50:51], v[50:51], v[48:49]
    v_pk_mul_f32 v[54:55], v[54:55], v[52:53]
    v_exp_f32 v42, v42
    v_exp_f32 v43, v43
    v_exp_f32 v46, v46
    v_exp_f32 v47, v47
    v_exp_f32 v50, v50
    v_exp_f32 v51, v51
    v_exp_f32 v54, v54
    v_exp_f32 v55, v55
    v_pk_add_f32 v[42:43], v[42:43], 1.0 op_sel_hi:[1,0]
    v_pk_add_f32 v[46:47], v[46:47], 1.0 op_sel_hi:[1,0]
    v_pk_add_f32 v[50:51], v[50:51], 1.0 op_sel_hi:[1,0]
    v_pk_add_f32 v[54:55], v[54:55], 1.0 op_sel_hi:[1,0]
    v_rcp_f32 v42, v42
    v_rcp_f32 v43, v43
    v_rcp_f32 v46, v46
    v_rcp_f32 v47, v47
    v_rcp_f32 v50, v50
    v_rcp_f32 v51, v51
    v_rcp_f32 v54, v54
    v_rcp_f32 v55, v55
    v_pk_mul_f32 v[42:43], v[42:43], v[40:41]
    v_pk_mul_f32 v[46:47], v[46:47], v[44:45]
    v_pk_mul_f32 v[50:51], v[50:51], v[48:49]
    v_pk_mul_f32 v[54:55], v[54:55], v[52:53]
    v_cvt_pk_bf16_f32 v24, v42, v43
    v_cvt_pk_bf16_f32 v25, v46, v47
    v_cvt_pk_bf16_f32 v26, v50, v51
    v_cvt_pk_bf16_f32 v27, v54, v55
    buffer_store_dwordx4 v[24:27], v199, s[76:79], s75 offen sc1
    s_waitcnt lgkmcnt(0)
    v_lshlrev_b32 v40, 16, v28
    v_and_b32 v41, s74, v28
    v_lshlrev_b32 v44, 16, v29
    v_and_b32 v45, s74, v29
    v_lshlrev_b32 v48, 16, v30
    v_and_b32 v49, s74, v30
    v_lshlrev_b32 v52, 16, v31
    v_and_b32 v53, s74, v31
    v_pk_mul_f32 v[42:43], v[40:41], v[40:41]
    v_pk_mul_f32 v[46:47], v[44:45], v[44:45]
    v_pk_mul_f32 v[50:51], v[48:49], v[48:49]
    v_pk_mul_f32 v[54:55], v[52:53], v[52:53]
    v_pk_fma_f32 v[42:43], v[42:43], s[72:73], v[202:203]
    v_pk_fma_f32 v[46:47], v[46:47], s[72:73], v[202:203]
    v_pk_fma_f32 v[50:51], v[50:51], s[72:73], v[202:203]
    v_pk_fma_f32 v[54:55], v[54:55], s[72:73], v[202:203]
    v_pk_mul_f32 v[42:43], v[42:43], v[40:41]
    v_pk_mul_f32 v[46:47], v[46:47], v[44:45]
    v_pk_mul_f32 v[50:51], v[50:51], v[48:49]
    v_pk_mul_f32 v[54:55], v[54:55], v[52:53]
    v_exp_f32 v42, v42
    v_exp_f32 v43, v43
    v_exp_f32 v46, v46
    v_exp_f32 v47, v47
    v_exp_f32 v50, v50
    v_exp_f32 v51, v51
    v_exp_f32 v54, v54
    v_exp_f32 v55, v55
    v_pk_add_f32 v[42:43], v[42:43], 1.0 op_sel_hi:[1,0]
    v_pk_add_f32 v[46:47], v[46:47], 1.0 op_sel_hi:[1,0]
    v_pk_add_f32 v[50:51], v[50:51], 1.0 op_sel_hi:[1,0]
    v_pk_add_f32 v[54:55], v[54:55], 1.0 op_sel_hi:[1,0]
    v_rcp_f32 v42, v42
    v_rcp_f32 v43, v43
    v_rcp_f32 v46, v46
    v_rcp_f32 v47, v47
    v_rcp_f32 v50, v50
    v_rcp_f32 v51, v51
    v_rcp_f32 v54, v54
    v_rcp_f32 v55, v55
    v_pk_mul_f32 v[42:43], v[42:43], v[40:41]
    v_pk_mul_f32 v[46:47], v[46:47], v[44:45]
    v_pk_mul_f32 v[50:51], v[50:51], v[48:49]
    v_pk_mul_f32 v[54:55], v[54:55], v[52:53]
    v_cvt_pk_bf16_f32 v28, v42, v43
    v_cvt_pk_bf16_f32 v29, v46, v47
    v_cvt_pk_bf16_f32 v30, v50, v51
    v_cvt_pk_bf16_f32 v31, v54, v55
    buffer_store_dwordx4 v[28:31], v200, s[76:79], s75 offen sc1
    s_branch m3_end
m3_g2:
    s_and_b32 s4, s2, 7
    s_lshr_b32 s5, s2, 3
    s_lshl_b32 s6, s4, 1
    s_and_b32 s7, s5, 1
    s_add_u32 s44, s6, s7
    s_lshr_b32 s45, s5, 1
    s_sub_u32 s45, s45, 10
    s_add_u32 s88, s44, 146
    s_lshl_b32 s88, s88, 7
    s_lshl_b32 s89, s45, 3
    s_add_u32 s95, s88, s89
    s_cmp_ge_u32 s3, 4
    s_cbranch_scc1 m3_g2_load
    s_lshl_b32 s42, s3, 12
    v_and_b32 v10, 31, v1
    v_lshlrev_b32 v10, 7, v10
    v_lshrrev_b32 v11, 5, v1
    v_bfe_u32 v12, v1, 1, 3
    v_xor_b32 v11, v11, v12
    v_add_u32 v10, s42, v10
    v_xor_b32 v12, 0, v11
    v_lshl_add_u32 v192, v12, 4, v10
    v_xor_b32 v12, 2, v11
    v_lshl_add_u32 v193, v12, 4, v10
    v_xor_b32 v12, 4, v11
    v_lshl_add_u32 v194, v12, 4, v10
    v_xor_b32 v12, 6, v11
    v_lshl_add_u32 v195, v12, 4, v10
    v_and_b32 v10, 31, v1
    v_lshlrev_b32 v10, 7, v10
    v_lshrrev_b32 v11, 5, v1
    v_bfe_u32 v12, v1, 1, 3
    v_xor_b32 v11, v11, v12
    v_add_u32 v10, 16384, v10
    v_xor_b32 v12, 0, v11
    v_lshl_add_u32 v200, v12, 4, v10
    v_xor_b32 v12, 2, v11
    v_lshl_add_u32 v201, v12, 4, v10
    v_xor_b32 v12, 4, v11
    v_lshl_add_u32 v202, v12, 4, v10
    v_xor_b32 v12, 6, v11
    v_lshl_add_u32 v203, v12, 4, v10
    s_cmp_lg_u32 s3, 0
    s_cbranch_scc1 dw26
    s_add_u32 s84, s40, 34656256
    s_addc_u32 s85, s41, 0
    s_mov_b32 s86, 22528
    s_mov_b32 s87, 0x20000
    v_lshlrev_b32 v236, 3, v1
    v_add_u32 v236, 18560, v236
    v_cmp_gt_u32 vcc, 16, v1
    s_nop 1
    s_and_saveexec_b64 s[88:89], vcc
    s_cbranch_execz pd28
    v_mov_b32 v240, s96
    v_mov_b32 v241, s97
    s_mov_b32 s90, 0
pl27:
    buffer_load_dwordx2 v[238:239], v236, s[84:87], 0 offen sc1
    s_waitcnt vmcnt(0)
    v_sub_co_u32 v238, vcc, v238, v240
    s_nop 1
    v_subb_co_u32 v239, vcc, v239, v241, vcc
    v_cmp_eq_u32 s[92:93], 0, v239
    s_mov_b32 s91, 16777216
    v_cmp_gt_u32 vcc, s91, v238
    s_nop 1
    s_and_b64 vcc, vcc, s[92:93]
    s_cmp_eq_u64 vcc, exec
    s_cbranch_scc1 pd28
    s_add_u32 s90, s90, 1
    s_cmp_lt_u32 s90, 262144
    s_cbranch_scc1 pl27
pd28:
    s_mov_b64 exec, s[88:89]
dw26:
    s_barrier
    s_cmp_lg_u32 s3, 0
    s_cbranch_scc1 dw29
    s_add_u32 s84, s40, 34656256
    s_addc_u32 s85, s41, 0
    s_mov_b32 s86, 22528
    s_mov_b32 s87, 0x20000
    s_add_u32 s90, s44, 112
    s_lshl_b32 s90, s90, 7
    v_lshlrev_b32 v236, 3, v1
    v_add_u32 v236, s90, v236
    v_cmp_gt_u32 vcc, 5, v1
    s_nop 1
    s_and_saveexec_b64 s[88:89], vcc
    s_cbranch_execz pd31
    v_mov_b32 v240, s96
    v_mov_b32 v241, s97
    s_mov_b32 s90, 0
pl30:
    buffer_load_dwordx2 v[238:239], v236, s[84:87], 0 offen sc1
    s_waitcnt vmcnt(0)
    v_sub_co_u32 v238, vcc, v238, v240
    s_nop 1
    v_subb_co_u32 v239, vcc, v239, v241, vcc
    v_cmp_eq_u32 s[92:93], 0, v239
    s_mov_b32 s91, 16777216
    v_cmp_gt_u32 vcc, s91, v238
    s_nop 1
    s_and_b64 vcc, vcc, s[92:93]
    s_cmp_eq_u64 vcc, exec
    s_cbranch_scc1 pd31
    s_add_u32 s90, s90, 1
    s_cmp_lt_u32 s90, 262144
    s_cbranch_scc1 pl30
pd31:
    s_mov_b64 exec, s[88:89]
dw29:
    s_barrier
    s_add_u32 s48, s40, 29413376
    s_addc_u32 s49, s41, 0
    s_mov_b32 s50, 5242880
    s_mov_b32 s51, 0x20000
    v_lshrrev_b32 v10, 5, v1
    v_lshlrev_b32 v10, 2, v10
    s_lshl_b32 s60, s3, 5
    v_add_u32 v10, s60, v10
    v_mul_u32_u24 v10, 2560, v10
    v_and_b32 v11, 31, v1
    v_lshl_add_u32 v210, v11, 2, v10
    v_add_u32 v211, 2560, v210
    v_add_u32 v212, 5120, v210
    v_add_u32 v213, 7680, v210
    s_mul_i32 s61, s44, 327680
    s_mul_i32 s62, s45, 640
    s_add_u32 s64, s61, s62
    s_add_u32 s65, s64, 20480
    s_add_u32 s66, s64, 40960
    s_add_u32 s67, s64, 61440
    v_add_u32 v196, 73728, v192
    v_add_u32 v197, 73728, v193
    v_add_u32 v198, 73728, v194
    v_add_u32 v199, 73728, v195
    v_add_u32 v204, 73728, v200
    v_add_u32 v205, 73728, v201
    v_add_u32 v206, 73728, v202
    v_add_u32 v207, 73728, v203
    s_barrier
    ds_read_b128 v[96:99], v192 offset:0
    ds_read_b128 v[100:103], v200 offset:0
    ds_read_b128 v[104:107], v200 offset:4096
    ds_read_b128 v[108:111], v200 offset:8192
    ds_read_b128 v[112:115], v200 offset:12288
    ds_read_b128 v[116:119], v200 offset:16384
    ds_read_b128 v[120:123], v193 offset:0
    ds_read_b128 v[124:127], v201 offset:0
    ds_read_b128 v[128:131], v201 offset:4096
    ds_read_b128 v[132:135], v201 offset:8192
    ds_read_b128 v[136:139], v201 offset:12288
    ds_read_b128 v[140:143], v201 offset:16384
    s_waitcnt lgkmcnt(6)
    v_mfma_f32_32x32x16_bf16 v[16:31], v[96:99], v[100:103], 0
    ds_read_b128 v[144:147], v194 offset:0
    ds_read_b128 v[148:151], v202 offset:0
    v_mfma_f32_32x32x16_bf16 v[32:47], v[96:99], v[104:107], 0
    ds_read_b128 v[152:155], v202 offset:4096
    ds_read_b128 v[156:159], v202 offset:8192
    v_mfma_f32_32x32x16_bf16 v[48:63], v[96:99], v[108:111], 0
    ds_read_b128 v[160:163], v202 offset:12288
    ds_read_b128 v[164:167], v202 offset:16384
    v_mfma_f32_32x32x16_bf16 v[64:79], v[96:99], v[112:115], 0
    v_mfma_f32_32x32x16_bf16 v[80:95], v[96:99], v[116:119], 0
    s_waitcnt lgkmcnt(6)
    v_mfma_f32_32x32x16_bf16 v[16:31], v[120:123], v[124:127], v[16:31]
    ds_read_b128 v[96:99], v195 offset:0
    ds_read_b128 v[100:103], v203 offset:0
    v_mfma_f32_32x32x16_bf16 v[32:47], v[120:123], v[128:131], v[32:47]
    ds_read_b128 v[104:107], v203 offset:4096
    ds_read_b128 v[108:111], v203 offset:8192
    v_mfma_f32_32x32x16_bf16 v[48:63], v[120:123], v[132:135], v[48:63]
    ds_read_b128 v[112:115], v203 offset:12288
    ds_read_b128 v[116:119], v203 offset:16384
    v_mfma_f32_32x32x16_bf16 v[64:79], v[120:123], v[136:139], v[64:79]
    v_mfma_f32_32x32x16_bf16 v[80:95], v[120:123], v[140:143], v[80:95]
    s_waitcnt lgkmcnt(0)
    s_barrier
    v_mfma_f32_32x32x16_bf16 v[16:31], v[144:147], v[148:151], v[16:31]
    ds_read_b128 v[120:123], v192 offset:36864
    ds_read_b128 v[124:127], v200 offset:36864
    v_mfma_f32_32x32x16_bf16 v[32:47], v[144:147], v[152:155], v[32:47]
    ds_read_b128 v[128:131], v200 offset:40960
    ds_read_b128 v[132:135], v200 offset:45056
    v_mfma_f32_32x32x16_bf16 v[48:63], v[144:147], v[156:159], v[48:63]
    ds_read_b128 v[136:139], v200 offset:49152
    ds_read_b128 v[140:143], v200 offset:53248
    v_mfma_f32_32x32x16_bf16 v[64:79], v[144:147], v[160:163], v[64:79]
    v_mfma_f32_32x32x16_bf16 v[80:95], v[144:147], v[164:167], v[80:95]
    s_waitcnt lgkmcnt(6)
    v_mfma_f32_32x32x16_bf16 v[16:31], v[96:99], v[100:103], v[16:31]
    ds_read_b128 v[144:147], v193 offset:36864
    ds_read_b128 v[148:151], v201 offset:36864
    v_mfma_f32_32x32x16_bf16 v[32:47], v[96:99], v[104:107], v[32:47]
    ds_read_b128 v[152:155], v201 offset:40960
    ds_read_b128 v[156:159], v201 offset:45056
    v_mfma_f32_32x32x16_bf16 v[48:63], v[96:99], v[108:111], v[48:63]
    ds_read_b128 v[160:163], v201 offset:49152
    ds_read_b128 v[164:167], v201 offset:53248
    v_mfma_f32_32x32x16_bf16 v[64:79], v[96:99], v[112:115], v[64:79]
    v_mfma_f32_32x32x16_bf16 v[80:95], v[96:99], v[116:119], v[80:95]
    s_waitcnt lgkmcnt(6)
    v_mfma_f32_32x32x16_bf16 v[16:31], v[120:123], v[124:127], v[16:31]
    ds_read_b128 v[96:99], v194 offset:36864
    ds_read_b128 v[100:103], v202 offset:36864
    v_mfma_f32_32x32x16_bf16 v[32:47], v[120:123], v[128:131], v[32:47]
    ds_read_b128 v[104:107], v202 offset:40960
    ds_read_b128 v[108:111], v202 offset:45056
    v_mfma_f32_32x32x16_bf16 v[48:63], v[120:123], v[132:135], v[48:63]
    ds_read_b128 v[112:115], v202 offset:49152
    ds_read_b128 v[116:119], v202 offset:53248
    v_mfma_f32_32x32x16_bf16 v[64:79], v[120:123], v[136:139], v[64:79]
    v_mfma_f32_32x32x16_bf16 v[80:95], v[120:123], v[140:143], v[80:95]
    s_waitcnt lgkmcnt(6)
    v_mfma_f32_32x32x16_bf16 v[16:31], v[144:147], v[148:151], v[16:31]
    ds_read_b128 v[120:123], v195 offset:36864
    ds_read_b128 v[124:127], v203 offset:36864
    v_mfma_f32_32x32x16_bf16 v[32:47], v[144:147], v[152:155], v[32:47]
    ds_read_b128 v[128:131], v203 offset:40960
    ds_read_b128 v[132:135], v203 offset:45056
    v_mfma_f32_32x32x16_bf16 v[48:63], v[144:147], v[156:159], v[48:63]
    ds_read_b128 v[136:139], v203 offset:49152
    ds_read_b128 v[140:143], v203 offset:53248
    v_mfma_f32_32x32x16_bf16 v[64:79], v[144:147], v[160:163], v[64:79]
    v_mfma_f32_32x32x16_bf16 v[80:95], v[144:147], v[164:167], v[80:95]
    s_waitcnt lgkmcnt(0)
    s_barrier
    v_mfma_f32_32x32x16_bf16 v[16:31], v[96:99], v[100:103], v[16:31]
    ds_read_b128 v[144:147], v196 offset:0
    ds_read_b128 v[148:151], v204 offset:0
    v_mfma_f32_32x32x16_bf16 v[32:47], v[96:99], v[104:107], v[32:47]
    ds_read_b128 v[152:155], v204 offset:4096
    ds_read_b128 v[156:159], v204 offset:8192
    v_mfma_f32_32x32x16_bf16 v[48:63], v[96:99], v[108:111], v[48:63]
    ds_read_b128 v[160:163], v204 offset:12288
    ds_read_b128 v[164:167], v204 offset:16384
    v_mfma_f32_32x32x16_bf16 v[64:79], v[96:99], v[112:115], v[64:79]
    v_mfma_f32_32x32x16_bf16 v[80:95], v[96:99], v[116:119], v[80:95]
    s_waitcnt lgkmcnt(6)
    v_mfma_f32_32x32x16_bf16 v[16:31], v[120:123], v[124:127], v[16:31]
    ds_read_b128 v[96:99], v197 offset:0
    ds_read_b128 v[100:103], v205 offset:0
    v_mfma_f32_32x32x16_bf16 v[32:47], v[120:123], v[128:131], v[32:47]
    ds_read_b128 v[104:107], v205 offset:4096
    ds_read_b128 v[108:111], v205 offset:8192
    v_mfma_f32_32x32x16_bf16 v[48:63], v[120:123], v[132:135], v[48:63]
    ds_read_b128 v[112:115], v205 offset:12288
    ds_read_b128 v[116:119], v205 offset:16384
    v_mfma_f32_32x32x16_bf16 v[64:79], v[120:123], v[136:139], v[64:79]
    v_mfma_f32_32x32x16_bf16 v[80:95], v[120:123], v[140:143], v[80:95]
    s_waitcnt lgkmcnt(6)
    v_mfma_f32_32x32x16_bf16 v[16:31], v[144:147], v[148:151], v[16:31]
    ds_read_b128 v[120:123], v198 offset:0
    ds_read_b128 v[124:127], v206 offset:0
    v_mfma_f32_32x32x16_bf16 v[32:47], v[144:147], v[152:155], v[32:47]
    ds_read_b128 v[128:131], v206 offset:4096
    ds_read_b128 v[132:135], v206 offset:8192
    v_mfma_f32_32x32x16_bf16 v[48:63], v[144:147], v[156:159], v[48:63]
    ds_read_b128 v[136:139], v206 offset:12288
    ds_read_b128 v[140:143], v206 offset:16384
    v_mfma_f32_32x32x16_bf16 v[64:79], v[144:147], v[160:163], v[64:79]
    v_mfma_f32_32x32x16_bf16 v[80:95], v[144:147], v[164:167], v[80:95]
    s_waitcnt lgkmcnt(6)
    v_mfma_f32_32x32x16_bf16 v[16:31], v[96:99], v[100:103], v[16:31]
    ds_read_b128 v[144:147], v199 offset:0
    ds_read_b128 v[148:151], v207 offset:0
    v_mfma_f32_32x32x16_bf16 v[32:47], v[96:99], v[104:107], v[32:47]
    ds_read_b128 v[152:155], v207 offset:4096
    ds_read_b128 v[156:159], v207 offset:8192
    v_mfma_f32_32x32x16_bf16 v[48:63], v[96:99], v[108:111], v[48:63]
    ds_read_b128 v[160:163], v207 offset:12288
    ds_read_b128 v[164:167], v207 offset:16384
    v_mfma_f32_32x32x16_bf16 v[64:79], v[96:99], v[112:115], v[64:79]
    v_mfma_f32_32x32x16_bf16 v[80:95], v[96:99], v[116:119], v[80:95]
    s_waitcnt lgkmcnt(0)
    s_barrier
    v_mfma_f32_32x32x16_bf16 v[16:31], v[120:123], v[124:127], v[16:31]
    ds_read_b128 v[96:99], v196 offset:36864
    ds_read_b128 v[100:103], v204 offset:36864
    v_mfma_f32_32x32x16_bf16 v[32:47], v[120:123], v[128:131], v[32:47]
    ds_read_b128 v[104:107], v204 offset:40960
    ds_read_b128 v[108:111], v204 offset:45056
    v_mfma_f32_32x32x16_bf16 v[48:63], v[120:123], v[132:135], v[48:63]
    ds_read_b128 v[112:115], v204 offset:49152
    ds_read_b128 v[116:119], v204 offset:53248
    v_mfma_f32_32x32x16_bf16 v[64:79], v[120:123], v[136:139], v[64:79]
    v_mfma_f32_32x32x16_bf16 v[80:95], v[120:123], v[140:143], v[80:95]
    s_waitcnt lgkmcnt(6)
    v_mfma_f32_32x32x16_bf16 v[16:31], v[144:147], v[148:151], v[16:31]
    ds_read_b128 v[120:123], v197 offset:36864
    ds_read_b128 v[124:127], v205 offset:36864
    v_mfma_f32_32x32x16_bf16 v[32:47], v[144:147], v[152:155], v[32:47]
    ds_read_b128 v[128:131], v205 offset:40960
    ds_read_b128 v[132:135], v205 offset:45056
    v_mfma_f32_32x32x16_bf16 v[48:63], v[144:147], v[156:159], v[48:63]
    ds_read_b128 v[136:139], v205 offset:49152
    ds_read_b128 v[140:143], v205 offset:53248
    v_mfma_f32_32x32x16_bf16 v[64:79], v[144:147], v[160:163], v[64:79]
    v_mfma_f32_32x32x16_bf16 v[80:95], v[144:147], v[164:167], v[80:95]
    s_waitcnt lgkmcnt(6)
    v_mfma_f32_32x32x16_bf16 v[16:31], v[96:99], v[100:103], v[16:31]
    ds_read_b128 v[144:147], v198 offset:36864
    ds_read_b128 v[148:151], v206 offset:36864
    v_mfma_f32_32x32x16_bf16 v[32:47], v[96:99], v[104:107], v[32:47]
    ds_read_b128 v[152:155], v206 offset:40960
    ds_read_b128 v[156:159], v206 offset:45056
    v_mfma_f32_32x32x16_bf16 v[48:63], v[96:99], v[108:111], v[48:63]
    ds_read_b128 v[160:163], v206 offset:49152
    ds_read_b128 v[164:167], v206 offset:53248
    v_mfma_f32_32x32x16_bf16 v[64:79], v[96:99], v[112:115], v[64:79]
    v_mfma_f32_32x32x16_bf16 v[80:95], v[96:99], v[116:119], v[80:95]
    s_waitcnt lgkmcnt(6)
    v_mfma_f32_32x32x16_bf16 v[16:31], v[120:123], v[124:127], v[16:31]
    ds_read_b128 v[96:99], v199 offset:36864
    ds_read_b128 v[100:103], v207 offset:36864
    v_mfma_f32_32x32x16_bf16 v[32:47], v[120:123], v[128:131], v[32:47]
    ds_read_b128 v[104:107], v207 offset:40960
    ds_read_b128 v[108:111], v207 offset:45056
    v_mfma_f32_32x32x16_bf16 v[48:63], v[120:123], v[132:135], v[48:63]
    ds_read_b128 v[112:115], v207 offset:49152
    ds_read_b128 v[116:119], v207 offset:53248
    v_mfma_f32_32x32x16_bf16 v[64:79], v[120:123], v[136:139], v[64:79]
    v_mfma_f32_32x32x16_bf16 v[80:95], v[120:123], v[140:143], v[80:95]
    s_waitcnt lgkmcnt(0)
    s_barrier
    v_mfma_f32_32x32x16_bf16 v[16:31], v[144:147], v[148:151], v[16:31]
    ds_read_b128 v[120:123], v192 offset:0
    ds_read_b128 v[124:127], v200 offset:0
    v_mfma_f32_32x32x16_bf16 v[32:47], v[144:147], v[152:155], v[32:47]
    ds_read_b128 v[128:131], v200 offset:4096
    ds_read_b128 v[132:135], v200 offset:8192
    v_mfma_f32_32x32x16_bf16 v[48:63], v[144:147], v[156:159], v[48:63]
    ds_read_b128 v[136:139], v200 offset:12288
    ds_read_b128 v[140:143], v200 offset:16384
    v_mfma_f32_32x32x16_bf16 v[64:79], v[144:147], v[160:163], v[64:79]
    v_mfma_f32_32x32x16_bf16 v[80:95], v[144:147], v[164:167], v[80:95]
    s_waitcnt lgkmcnt(6)
    v_mfma_f32_32x32x16_bf16 v[16:31], v[96:99], v[100:103], v[16:31]
    ds_read_b128 v[144:147], v193 offset:0
    ds_read_b128 v[148:151], v201 offset:0
    v_mfma_f32_32x32x16_bf16 v[32:47], v[96:99], v[104:107], v[32:47]
    ds_read_b128 v[152:155], v201 offset:4096
    ds_read_b128 v[156:159], v201 offset:8192
    v_mfma_f32_32x32x16_bf16 v[48:63], v[96:99], v[108:111], v[48:63]
    ds_read_b128 v[160:163], v201 offset:12288
    ds_read_b128 v[164:167], v201 offset:16384
    v_mfma_f32_32x32x16_bf16 v[64:79], v[96:99], v[112:115], v[64:79]
    v_mfma_f32_32x32x16_bf16 v[80:95], v[96:99], v[116:119], v[80:95]
    s_waitcnt lgkmcnt(6)
    v_mfma_f32_32x32x16_bf16 v[16:31], v[120:123], v[124:127], v[16:31]
    ds_read_b128 v[96:99], v194 offset:0
    ds_read_b128 v[100:103], v202 offset:0
    v_mfma_f32_32x32x16_bf16 v[32:47], v[120:123], v[128:131], v[32:47]
    ds_read_b128 v[104:107], v202 offset:4096
    ds_read_b128 v[108:111], v202 offset:8192
    v_mfma_f32_32x32x16_bf16 v[48:63], v[120:123], v[132:135], v[48:63]
    ds_read_b128 v[112:115], v202 offset:12288
    ds_read_b128 v[116:119], v202 offset:16384
    v_mfma_f32_32x32x16_bf16 v[64:79], v[120:123], v[136:139], v[64:79]
    v_mfma_f32_32x32x16_bf16 v[80:95], v[120:123], v[140:143], v[80:95]
    s_waitcnt lgkmcnt(6)
    v_mfma_f32_32x32x16_bf16 v[16:31], v[144:147], v[148:151], v[16:31]
    ds_read_b128 v[120:123], v195 offset:0
    ds_read_b128 v[124:127], v203 offset:0
    v_mfma_f32_32x32x16_bf16 v[32:47], v[144:147], v[152:155], v[32:47]
    ds_read_b128 v[128:131], v203 offset:4096
    ds_read_b128 v[132:135], v203 offset:8192
    v_mfma_f32_32x32x16_bf16 v[48:63], v[144:147], v[156:159], v[48:63]
    ds_read_b128 v[136:139], v203 offset:12288
    ds_read_b128 v[140:143], v203 offset:16384
    v_mfma_f32_32x32x16_bf16 v[64:79], v[144:147], v[160:163], v[64:79]
    v_mfma_f32_32x32x16_bf16 v[80:95], v[144:147], v[164:167], v[80:95]
    s_waitcnt lgkmcnt(0)
    s_barrier
    v_mfma_f32_32x32x16_bf16 v[16:31], v[96:99], v[100:103], v[16:31]
    ds_read_b128 v[144:147], v192 offset:36864
    ds_read_b128 v[148:151], v200 offset:36864
    v_mfma_f32_32x32x16_bf16 v[32:47], v[96:99], v[104:107], v[32:47]
    ds_read_b128 v[152:155], v200 offset:40960
    ds_read_b128 v[156:159], v200 offset:45056
    v_mfma_f32_32x32x16_bf16 v[48:63], v[96:99], v[108:111], v[48:63]
    ds_read_b128 v[160:163], v200 offset:49152
    ds_read_b128 v[164:167], v200 offset:53248
    v_mfma_f32_32x32x16_bf16 v[64:79], v[96:99], v[112:115], v[64:79]
    v_mfma_f32_32x32x16_bf16 v[80:95], v[96:99], v[116:119], v[80:95]
    s_waitcnt lgkmcnt(6)
    v_mfma_f32_32x32x16_bf16 v[16:31], v[120:123], v[124:127], v[16:31]
    ds_read_b128 v[96:99], v193 offset:36864
    ds_read_b128 v[100:103], v201 offset:36864
    v_mfma_f32_32x32x16_bf16 v[32:47], v[120:123], v[128:131], v[32:47]
    ds_read_b128 v[104:107], v201 offset:40960
    ds_read_b128 v[108:111], v201 offset:45056
    v_mfma_f32_32x32x16_bf16 v[48:63], v[120:123], v[132:135], v[48:63]
    ds_read_b128 v[112:115], v201 offset:49152
    ds_read_b128 v[116:119], v201 offset:53248
    v_mfma_f32_32x32x16_bf16 v[64:79], v[120:123], v[136:139], v[64:79]
    v_mfma_f32_32x32x16_bf16 v[80:95], v[120:123], v[140:143], v[80:95]
    s_waitcnt lgkmcnt(6)
    v_mfma_f32_32x32x16_bf16 v[16:31], v[144:147], v[148:151], v[16:31]
    ds_read_b128 v[120:123], v194 offset:36864
    ds_read_b128 v[124:127], v202 offset:36864
    v_mfma_f32_32x32x16_bf16 v[32:47], v[144:147], v[152:155], v[32:47]
    ds_read_b128 v[128:131], v202 offset:40960
    ds_read_b128 v[132:135], v202 offset:45056
    v_mfma_f32_32x32x16_bf16 v[48:63], v[144:147], v[156:159], v[48:63]
    ds_read_b128 v[136:139], v202 offset:49152
    ds_read_b128 v[140:143], v202 offset:53248
    v_mfma_f32_32x32x16_bf16 v[64:79], v[144:147], v[160:163], v[64:79]
    v_mfma_f32_32x32x16_bf16 v[80:95], v[144:147], v[164:167], v[80:95]
    s_waitcnt lgkmcnt(6)
    v_mfma_f32_32x32x16_bf16 v[16:31], v[96:99], v[100:103], v[16:31]
    ds_read_b128 v[144:147], v195 offset:36864
    ds_read_b128 v[148:151], v203 offset:36864
    v_mfma_f32_32x32x16_bf16 v[32:47], v[96:99], v[104:107], v[32:47]
    ds_read_b128 v[152:155], v203 offset:40960
    ds_read_b128 v[156:159], v203 offset:45056
    v_mfma_f32_32x32x16_bf16 v[48:63], v[96:99], v[108:111], v[48:63]
    ds_read_b128 v[160:163], v203 offset:49152
    ds_read_b128 v[164:167], v203 offset:53248
    v_mfma_f32_32x32x16_bf16 v[64:79], v[96:99], v[112:115], v[64:79]
    v_mfma_f32_32x32x16_bf16 v[80:95], v[96:99], v[116:119], v[80:95]
    s_waitcnt lgkmcnt(0)
    s_barrier
    v_mfma_f32_32x32x16_bf16 v[16:31], v[120:123], v[124:127], v[16:31]
    ds_read_b128 v[96:99], v196 offset:0
    ds_read_b128 v[100:103], v204 offset:0
    v_mfma_f32_32x32x16_bf16 v[32:47], v[120:123], v[128:131], v[32:47]
    ds_read_b128 v[104:107], v204 offset:4096
    ds_read_b128 v[108:111], v204 offset:8192
    v_mfma_f32_32x32x16_bf16 v[48:63], v[120:123], v[132:135], v[48:63]
    ds_read_b128 v[112:115], v204 offset:12288
    ds_read_b128 v[116:119], v204 offset:16384
    v_mfma_f32_32x32x16_bf16 v[64:79], v[120:123], v[136:139], v[64:79]
    v_mfma_f32_32x32x16_bf16 v[80:95], v[120:123], v[140:143], v[80:95]
    s_waitcnt lgkmcnt(6)
    v_mfma_f32_32x32x16_bf16 v[16:31], v[144:147], v[148:151], v[16:31]
    ds_read_b128 v[120:123], v197 offset:0
    ds_read_b128 v[124:127], v205 offset:0
    v_mfma_f32_32x32x16_bf16 v[32:47], v[144:147], v[152:155], v[32:47]
    ds_read_b128 v[128:131], v205 offset:4096
    ds_read_b128 v[132:135], v205 offset:8192
    v_mfma_f32_32x32x16_bf16 v[48:63], v[144:147], v[156:159], v[48:63]
    ds_read_b128 v[136:139], v205 offset:12288
    ds_read_b128 v[140:143], v205 offset:16384
    v_mfma_f32_32x32x16_bf16 v[64:79], v[144:147], v[160:163], v[64:79]
    v_mfma_f32_32x32x16_bf16 v[80:95], v[144:147], v[164:167], v[80:95]
    s_waitcnt lgkmcnt(6)
    v_mfma_f32_32x32x16_bf16 v[16:31], v[96:99], v[100:103], v[16:31]
    ds_read_b128 v[144:147], v198 offset:0
    ds_read_b128 v[148:151], v206 offset:0
    v_mfma_f32_32x32x16_bf16 v[32:47], v[96:99], v[104:107], v[32:47]
    ds_read_b128 v[152:155], v206 offset:4096
    ds_read_b128 v[156:159], v206 offset:8192
    v_mfma_f32_32x32x16_bf16 v[48:63], v[96:99], v[108:111], v[48:63]
    ds_read_b128 v[160:163], v206 offset:12288
    ds_read_b128 v[164:167], v206 offset:16384
    v_mfma_f32_32x32x16_bf16 v[64:79], v[96:99], v[112:115], v[64:79]
    v_mfma_f32_32x32x16_bf16 v[80:95], v[96:99], v[116:119], v[80:95]
    s_waitcnt lgkmcnt(6)
    v_mfma_f32_32x32x16_bf16 v[16:31], v[120:123], v[124:127], v[16:31]
    ds_read_b128 v[96:99], v199 offset:0
    ds_read_b128 v[100:103], v207 offset:0
    v_mfma_f32_32x32x16_bf16 v[32:47], v[120:123], v[128:131], v[32:47]
    ds_read_b128 v[104:107], v207 offset:4096
    ds_read_b128 v[108:111], v207 offset:8192
    v_mfma_f32_32x32x16_bf16 v[48:63], v[120:123], v[132:135], v[48:63]
    ds_read_b128 v[112:115], v207 offset:12288
    ds_read_b128 v[116:119], v207 offset:16384
    v_mfma_f32_32x32x16_bf16 v[64:79], v[120:123], v[136:139], v[64:79]
    v_mfma_f32_32x32x16_bf16 v[80:95], v[120:123], v[140:143], v[80:95]
    s_waitcnt lgkmcnt(0)
    s_barrier
    v_mfma_f32_32x32x16_bf16 v[16:31], v[144:147], v[148:151], v[16:31]
    ds_read_b128 v[120:123], v196 offset:36864
    ds_read_b128 v[124:127], v204 offset:36864
    v_mfma_f32_32x32x16_bf16 v[32:47], v[144:147], v[152:155], v[32:47]
    ds_read_b128 v[128:131], v204 offset:40960
    ds_read_b128 v[132:135], v204 offset:45056
    v_mfma_f32_32x32x16_bf16 v[48:63], v[144:147], v[156:159], v[48:63]
    ds_read_b128 v[136:139], v204 offset:49152
    ds_read_b128 v[140:143], v204 offset:53248
    v_mfma_f32_32x32x16_bf16 v[64:79], v[144:147], v[160:163], v[64:79]
    v_mfma_f32_32x32x16_bf16 v[80:95], v[144:147], v[164:167], v[80:95]
    s_waitcnt lgkmcnt(6)
    v_mfma_f32_32x32x16_bf16 v[16:31], v[96:99], v[100:103], v[16:31]
    ds_read_b128 v[144:147], v197 offset:36864
    ds_read_b128 v[148:151], v205 offset:36864
    v_mfma_f32_32x32x16_bf16 v[32:47], v[96:99], v[104:107], v[32:47]
    ds_read_b128 v[152:155], v205 offset:40960
    ds_read_b128 v[156:159], v205 offset:45056
    v_mfma_f32_32x32x16_bf16 v[48:63], v[96:99], v[108:111], v[48:63]
    ds_read_b128 v[160:163], v205 offset:49152
    ds_read_b128 v[164:167], v205 offset:53248
    v_mfma_f32_32x32x16_bf16 v[64:79], v[96:99], v[112:115], v[64:79]
    v_mfma_f32_32x32x16_bf16 v[80:95], v[96:99], v[116:119], v[80:95]
    s_waitcnt lgkmcnt(6)
    v_mfma_f32_32x32x16_bf16 v[16:31], v[120:123], v[124:127], v[16:31]
    ds_read_b128 v[96:99], v198 offset:36864
    ds_read_b128 v[100:103], v206 offset:36864
    v_mfma_f32_32x32x16_bf16 v[32:47], v[120:123], v[128:131], v[32:47]
    ds_read_b128 v[104:107], v206 offset:40960
    ds_read_b128 v[108:111], v206 offset:45056
    v_mfma_f32_32x32x16_bf16 v[48:63], v[120:123], v[132:135], v[48:63]
    ds_read_b128 v[112:115], v206 offset:49152
    ds_read_b128 v[116:119], v206 offset:53248
    v_mfma_f32_32x32x16_bf16 v[64:79], v[120:123], v[136:139], v[64:79]
    v_mfma_f32_32x32x16_bf16 v[80:95], v[120:123], v[140:143], v[80:95]
    s_waitcnt lgkmcnt(6)
    v_mfma_f32_32x32x16_bf16 v[16:31], v[144:147], v[148:151], v[16:31]
    ds_read_b128 v[120:123], v199 offset:36864
    ds_read_b128 v[124:127], v207 offset:36864
    v_mfma_f32_32x32x16_bf16 v[32:47], v[144:147], v[152:155], v[32:47]
    ds_read_b128 v[128:131], v207 offset:40960
    ds_read_b128 v[132:135], v207 offset:45056
    v_mfma_f32_32x32x16_bf16 v[48:63], v[144:147], v[156:159], v[48:63]
    ds_read_b128 v[136:139], v207 offset:49152
    ds_read_b128 v[140:143], v207 offset:53248
    v_mfma_f32_32x32x16_bf16 v[64:79], v[144:147], v[160:163], v[64:79]
    v_mfma_f32_32x32x16_bf16 v[80:95], v[144:147], v[164:167], v[80:95]
    s_waitcnt lgkmcnt(0)
    s_barrier
    v_mfma_f32_32x32x16_bf16 v[16:31], v[96:99], v[100:103], v[16:31]
    ds_read_b128 v[144:147], v192 offset:0
    ds_read_b128 v[148:151], v200 offset:0
    v_mfma_f32_32x32x16_bf16 v[32:47], v[96:99], v[104:107], v[32:47]
    ds_read_b128 v[152:155], v200 offset:4096
    ds_read_b128 v[156:159], v200 offset:8192
    v_mfma_f32_32x32x16_bf16 v[48:63], v[96:99], v[108:111], v[48:63]
    ds_read_b128 v[160:163], v200 offset:12288
    ds_read_b128 v[164:167], v200 offset:16384
    v_mfma_f32_32x32x16_bf16 v[64:79], v[96:99], v[112:115], v[64:79]
    v_mfma_f32_32x32x16_bf16 v[80:95], v[96:99], v[116:119], v[80:95]
    s_waitcnt lgkmcnt(6)
    v_mfma_f32_32x32x16_bf16 v[16:31], v[120:123], v[124:127], v[16:31]
    ds_read_b128 v[96:99], v193 offset:0
    ds_read_b128 v[100:103], v201 offset:0
    v_mfma_f32_32x32x16_bf16 v[32:47], v[120:123], v[128:131], v[32:47]
    ds_read_b128 v[104:107], v201 offset:4096
    ds_read_b128 v[108:111], v201 offset:8192
    v_mfma_f32_32x32x16_bf16 v[48:63], v[120:123], v[132:135], v[48:63]
    ds_read_b128 v[112:115], v201 offset:12288
    ds_read_b128 v[116:119], v201 offset:16384
    v_mfma_f32_32x32x16_bf16 v[64:79], v[120:123], v[136:139], v[64:79]
    v_mfma_f32_32x32x16_bf16 v[80:95], v[120:123], v[140:143], v[80:95]
    s_waitcnt lgkmcnt(6)
    v_mfma_f32_32x32x16_bf16 v[16:31], v[144:147], v[148:151], v[16:31]
    ds_read_b128 v[120:123], v194 offset:0
    ds_read_b128 v[124:127], v202 offset:0
    v_mfma_f32_32x32x16_bf16 v[32:47], v[144:147], v[152:155], v[32:47]
    ds_read_b128 v[128:131], v202 offset:4096
    ds_read_b128 v[132:135], v202 offset:8192
    v_mfma_f32_32x32x16_bf16 v[48:63], v[144:147], v[156:159], v[48:63]
    ds_read_b128 v[136:139], v202 offset:12288
    ds_read_b128 v[140:143], v202 offset:16384
    v_mfma_f32_32x32x16_bf16 v[64:79], v[144:147], v[160:163], v[64:79]
    v_mfma_f32_32x32x16_bf16 v[80:95], v[144:147], v[164:167], v[80:95]
    s_waitcnt lgkmcnt(6)
    v_mfma_f32_32x32x16_bf16 v[16:31], v[96:99], v[100:103], v[16:31]
    ds_read_b128 v[144:147], v195 offset:0
    ds_read_b128 v[148:151], v203 offset:0
    v_mfma_f32_32x32x16_bf16 v[32:47], v[96:99], v[104:107], v[32:47]
    ds_read_b128 v[152:155], v203 offset:4096
    ds_read_b128 v[156:159], v203 offset:8192
    v_mfma_f32_32x32x16_bf16 v[48:63], v[96:99], v[108:111], v[48:63]
    ds_read_b128 v[160:163], v203 offset:12288
    ds_read_b128 v[164:167], v203 offset:16384
    v_mfma_f32_32x32x16_bf16 v[64:79], v[96:99], v[112:115], v[64:79]
    v_mfma_f32_32x32x16_bf16 v[80:95], v[96:99], v[116:119], v[80:95]
    s_waitcnt lgkmcnt(0)
    s_barrier
    v_mfma_f32_32x32x16_bf16 v[16:31], v[120:123], v[124:127], v[16:31]
    ds_read_b128 v[96:99], v192 offset:36864
    ds_read_b128 v[100:103], v200 offset:36864
    v_mfma_f32_32x32x16_bf16 v[32:47], v[120:123], v[128:131], v[32:47]
    ds_read_b128 v[104:107], v200 offset:40960
    ds_read_b128 v[108:111], v200 offset:45056
    v_mfma_f32_32x32x16_bf16 v[48:63], v[120:123], v[132:135], v[48:63]
    ds_read_b128 v[112:115], v200 offset:49152
    ds_read_b128 v[116:119], v200 offset:53248
    v_mfma_f32_32x32x16_bf16 v[64:79], v[120:123], v[136:139], v[64:79]
    v_mfma_f32_32x32x16_bf16 v[80:95], v[120:123], v[140:143], v[80:95]
    s_waitcnt lgkmcnt(6)
    v_mfma_f32_32x32x16_bf16 v[16:31], v[144:147], v[148:151], v[16:31]
    ds_read_b128 v[120:123], v193 offset:36864
    ds_read_b128 v[124:127], v201 offset:36864
    v_mfma_f32_32x32x16_bf16 v[32:47], v[144:147], v[152:155], v[32:47]
    ds_read_b128 v[128:131], v201 offset:40960
    ds_read_b128 v[132:135], v201 offset:45056
    v_mfma_f32_32x32x16_bf16 v[48:63], v[144:147], v[156:159], v[48:63]
    ds_read_b128 v[136:139], v201 offset:49152
    ds_read_b128 v[140:143], v201 offset:53248
    v_mfma_f32_32x32x16_bf16 v[64:79], v[144:147], v[160:163], v[64:79]
    v_mfma_f32_32x32x16_bf16 v[80:95], v[144:147], v[164:167], v[80:95]
    s_waitcnt lgkmcnt(6)
    v_mfma_f32_32x32x16_bf16 v[16:31], v[96:99], v[100:103], v[16:31]
    ds_read_b128 v[144:147], v194 offset:36864
    ds_read_b128 v[148:151], v202 offset:36864
    v_mfma_f32_32x32x16_bf16 v[32:47], v[96:99], v[104:107], v[32:47]
    ds_read_b128 v[152:155], v202 offset:40960
    ds_read_b128 v[156:159], v202 offset:45056
    v_mfma_f32_32x32x16_bf16 v[48:63], v[96:99], v[108:111], v[48:63]
    ds_read_b128 v[160:163], v202 offset:49152
    ds_read_b128 v[164:167], v202 offset:53248
    v_mfma_f32_32x32x16_bf16 v[64:79], v[96:99], v[112:115], v[64:79]
    v_mfma_f32_32x32x16_bf16 v[80:95], v[96:99], v[116:119], v[80:95]
    s_waitcnt lgkmcnt(6)
    v_mfma_f32_32x32x16_bf16 v[16:31], v[120:123], v[124:127], v[16:31]
    ds_read_b128 v[96:99], v195 offset:36864
    ds_read_b128 v[100:103], v203 offset:36864
    v_mfma_f32_32x32x16_bf16 v[32:47], v[120:123], v[128:131], v[32:47]
    ds_read_b128 v[104:107], v203 offset:40960
    ds_read_b128 v[108:111], v203 offset:45056
    v_mfma_f32_32x32x16_bf16 v[48:63], v[120:123], v[132:135], v[48:63]
    ds_read_b128 v[112:115], v203 offset:49152
    ds_read_b128 v[116:119], v203 offset:53248
    v_mfma_f32_32x32x16_bf16 v[64:79], v[120:123], v[136:139], v[64:79]
    v_mfma_f32_32x32x16_bf16 v[80:95], v[120:123], v[140:143], v[80:95]
    s_waitcnt lgkmcnt(0)
    s_barrier
    v_mfma_f32_32x32x16_bf16 v[16:31], v[144:147], v[148:151], v[16:31]
    ds_read_b128 v[120:123], v196 offset:0
    ds_read_b128 v[124:127], v204 offset:0
    v_mfma_f32_32x32x16_bf16 v[32:47], v[144:147], v[152:155], v[32:47]
    ds_read_b128 v[128:131], v204 offset:4096
    ds_read_b128 v[132:135], v204 offset:8192
    v_mfma_f32_32x32x16_bf16 v[48:63], v[144:147], v[156:159], v[48:63]
    ds_read_b128 v[136:139], v204 offset:12288
    ds_read_b128 v[140:143], v204 offset:16384
    v_mfma_f32_32x32x16_bf16 v[64:79], v[144:147], v[160:163], v[64:79]
    v_mfma_f32_32x32x16_bf16 v[80:95], v[144:147], v[164:167], v[80:95]
    s_waitcnt lgkmcnt(6)
    v_mfma_f32_32x32x16_bf16 v[16:31], v[96:99], v[100:103], v[16:31]
    ds_read_b128 v[144:147], v197 offset:0
    ds_read_b128 v[148:151], v205 offset:0
    v_mfma_f32_32x32x16_bf16 v[32:47], v[96:99], v[104:107], v[32:47]
    ds_read_b128 v[152:155], v205 offset:4096
    ds_read_b128 v[156:159], v205 offset:8192
    v_mfma_f32_32x32x16_bf16 v[48:63], v[96:99], v[108:111], v[48:63]
    ds_read_b128 v[160:163], v205 offset:12288
    ds_read_b128 v[164:167], v205 offset:16384
    v_mfma_f32_32x32x16_bf16 v[64:79], v[96:99], v[112:115], v[64:79]
    v_mfma_f32_32x32x16_bf16 v[80:95], v[96:99], v[116:119], v[80:95]
    s_waitcnt lgkmcnt(6)
    v_mfma_f32_32x32x16_bf16 v[16:31], v[120:123], v[124:127], v[16:31]
    ds_read_b128 v[96:99], v198 offset:0
    ds_read_b128 v[100:103], v206 offset:0
    v_mfma_f32_32x32x16_bf16 v[32:47], v[120:123], v[128:131], v[32:47]
    ds_read_b128 v[104:107], v206 offset:4096
    ds_read_b128 v[108:111], v206 offset:8192
    v_mfma_f32_32x32x16_bf16 v[48:63], v[120:123], v[132:135], v[48:63]
    ds_read_b128 v[112:115], v206 offset:12288
    ds_read_b128 v[116:119], v206 offset:16384
    v_mfma_f32_32x32x16_bf16 v[64:79], v[120:123], v[136:139], v[64:79]
    v_mfma_f32_32x32x16_bf16 v[80:95], v[120:123], v[140:143], v[80:95]
    s_waitcnt lgkmcnt(6)
    v_mfma_f32_32x32x16_bf16 v[16:31], v[144:147], v[148:151], v[16:31]
    ds_read_b128 v[120:123], v199 offset:0
    ds_read_b128 v[124:127], v207 offset:0
    v_mfma_f32_32x32x16_bf16 v[32:47], v[144:147], v[152:155], v[32:47]
    ds_read_b128 v[128:131], v207 offset:4096
    ds_read_b128 v[132:135], v207 offset:8192
    v_mfma_f32_32x32x16_bf16 v[48:63], v[144:147], v[156:159], v[48:63]
    ds_read_b128 v[136:139], v207 offset:12288
    ds_read_b128 v[140:143], v207 offset:16384
    v_mfma_f32_32x32x16_bf16 v[64:79], v[144:147], v[160:163], v[64:79]
    v_mfma_f32_32x32x16_bf16 v[80:95], v[144:147], v[164:167], v[80:95]
    s_waitcnt lgkmcnt(0)
    s_barrier
    v_mfma_f32_32x32x16_bf16 v[16:31], v[96:99], v[100:103], v[16:31]
    ds_read_b128 v[144:147], v196 offset:36864
    ds_read_b128 v[148:151], v204 offset:36864
    v_mfma_f32_32x32x16_bf16 v[32:47], v[96:99], v[104:107], v[32:47]
    ds_read_b128 v[152:155], v204 offset:40960
    ds_read_b128 v[156:159], v204 offset:45056
    v_mfma_f32_32x32x16_bf16 v[48:63], v[96:99], v[108:111], v[48:63]
    ds_read_b128 v[160:163], v204 offset:49152
    ds_read_b128 v[164:167], v204 offset:53248
    v_mfma_f32_32x32x16_bf16 v[64:79], v[96:99], v[112:115], v[64:79]
    v_mfma_f32_32x32x16_bf16 v[80:95], v[96:99], v[116:119], v[80:95]
    s_waitcnt lgkmcnt(6)
    v_mfma_f32_32x32x16_bf16 v[16:31], v[120:123], v[124:127], v[16:31]
    ds_read_b128 v[96:99], v197 offset:36864
    ds_read_b128 v[100:103], v205 offset:36864
    v_mfma_f32_32x32x16_bf16 v[32:47], v[120:123], v[128:131], v[32:47]
    ds_read_b128 v[104:107], v205 offset:40960
    ds_read_b128 v[108:111], v205 offset:45056
    v_mfma_f32_32x32x16_bf16 v[48:63], v[120:123], v[132:135], v[48:63]
    ds_read_b128 v[112:115], v205 offset:49152
    ds_read_b128 v[116:119], v205 offset:53248
    v_mfma_f32_32x32x16_bf16 v[64:79], v[120:123], v[136:139], v[64:79]
    v_mfma_f32_32x32x16_bf16 v[80:95], v[120:123], v[140:143], v[80:95]
    s_waitcnt lgkmcnt(6)
    v_mfma_f32_32x32x16_bf16 v[16:31], v[144:147], v[148:151], v[16:31]
    ds_read_b128 v[120:123], v198 offset:36864
    ds_read_b128 v[124:127], v206 offset:36864
    v_mfma_f32_32x32x16_bf16 v[32:47], v[144:147], v[152:155], v[32:47]
    ds_read_b128 v[128:131], v206 offset:40960
    ds_read_b128 v[132:135], v206 offset:45056
    v_mfma_f32_32x32x16_bf16 v[48:63], v[144:147], v[156:159], v[48:63]
    ds_read_b128 v[136:139], v206 offset:49152
    ds_read_b128 v[140:143], v206 offset:53248
    v_mfma_f32_32x32x16_bf16 v[64:79], v[144:147], v[160:163], v[64:79]
    v_mfma_f32_32x32x16_bf16 v[80:95], v[144:147], v[164:167], v[80:95]
    s_waitcnt lgkmcnt(6)
    v_mfma_f32_32x32x16_bf16 v[16:31], v[96:99], v[100:103], v[16:31]
    ds_read_b128 v[144:147], v199 offset:36864
    ds_read_b128 v[148:151], v207 offset:36864
    v_mfma_f32_32x32x16_bf16 v[32:47], v[96:99], v[104:107], v[32:47]
    ds_read_b128 v[152:155], v207 offset:40960
    ds_read_b128 v[156:159], v207 offset:45056
    v_mfma_f32_32x32x16_bf16 v[48:63], v[96:99], v[108:111], v[48:63]
    ds_read_b128 v[160:163], v207 offset:49152
    ds_read_b128 v[164:167], v207 offset:53248
    v_mfma_f32_32x32x16_bf16 v[64:79], v[96:99], v[112:115], v[64:79]
    v_mfma_f32_32x32x16_bf16 v[80:95], v[96:99], v[116:119], v[80:95]
    s_waitcnt lgkmcnt(0)
    s_barrier
    v_mfma_f32_32x32x16_bf16 v[16:31], v[120:123], v[124:127], v[16:31]
    ds_read_b128 v[96:99], v192 offset:0
    ds_read_b128 v[100:103], v200 offset:0
    v_mfma_f32_32x32x16_bf16 v[32:47], v[120:123], v[128:131], v[32:47]
    ds_read_b128 v[104:107], v200 offset:4096
    ds_read_b128 v[108:111], v200 offset:8192
    v_mfma_f32_32x32x16_bf16 v[48:63], v[120:123], v[132:135], v[48:63]
    ds_read_b128 v[112:115], v200 offset:12288
    ds_read_b128 v[116:119], v200 offset:16384
    v_mfma_f32_32x32x16_bf16 v[64:79], v[120:123], v[136:139], v[64:79]
    v_mfma_f32_32x32x16_bf16 v[80:95], v[120:123], v[140:143], v[80:95]
    s_waitcnt lgkmcnt(6)
    v_mfma_f32_32x32x16_bf16 v[16:31], v[144:147], v[148:151], v[16:31]
    ds_read_b128 v[120:123], v193 offset:0
    ds_read_b128 v[124:127], v201 offset:0
    v_mfma_f32_32x32x16_bf16 v[32:47], v[144:147], v[152:155], v[32:47]
    ds_read_b128 v[128:131], v201 offset:4096
    ds_read_b128 v[132:135], v201 offset:8192
    v_mfma_f32_32x32x16_bf16 v[48:63], v[144:147], v[156:159], v[48:63]
    ds_read_b128 v[136:139], v201 offset:12288
    ds_read_b128 v[140:143], v201 offset:16384
    v_mfma_f32_32x32x16_bf16 v[64:79], v[144:147], v[160:163], v[64:79]
    v_mfma_f32_32x32x16_bf16 v[80:95], v[144:147], v[164:167], v[80:95]
    s_waitcnt lgkmcnt(6)
    v_mfma_f32_32x32x16_bf16 v[16:31], v[96:99], v[100:103], v[16:31]
    ds_read_b128 v[144:147], v194 offset:0
    ds_read_b128 v[148:151], v202 offset:0
    v_mfma_f32_32x32x16_bf16 v[32:47], v[96:99], v[104:107], v[32:47]
    ds_read_b128 v[152:155], v202 offset:4096
    ds_read_b128 v[156:159], v202 offset:8192
    v_mfma_f32_32x32x16_bf16 v[48:63], v[96:99], v[108:111], v[48:63]
    ds_read_b128 v[160:163], v202 offset:12288
    ds_read_b128 v[164:167], v202 offset:16384
    v_mfma_f32_32x32x16_bf16 v[64:79], v[96:99], v[112:115], v[64:79]
    v_mfma_f32_32x32x16_bf16 v[80:95], v[96:99], v[116:119], v[80:95]
    s_waitcnt lgkmcnt(6)
    v_mfma_f32_32x32x16_bf16 v[16:31], v[120:123], v[124:127], v[16:31]
    ds_read_b128 v[96:99], v195 offset:0
    ds_read_b128 v[100:103], v203 offset:0
    v_mfma_f32_32x32x16_bf16 v[32:47], v[120:123], v[128:131], v[32:47]
    ds_read_b128 v[104:107], v203 offset:4096
    ds_read_b128 v[108:111], v203 offset:8192
    v_mfma_f32_32x32x16_bf16 v[48:63], v[120:123], v[132:135], v[48:63]
    ds_read_b128 v[112:115], v203 offset:12288
    ds_read_b128 v[116:119], v203 offset:16384
    v_mfma_f32_32x32x16_bf16 v[64:79], v[120:123], v[136:139], v[64:79]
    v_mfma_f32_32x32x16_bf16 v[80:95], v[120:123], v[140:143], v[80:95]
    s_waitcnt lgkmcnt(0)
    s_barrier
    v_mfma_f32_32x32x16_bf16 v[16:31], v[144:147], v[148:151], v[16:31]
    ds_read_b128 v[120:123], v192 offset:36864
    ds_read_b128 v[124:127], v200 offset:36864
    v_mfma_f32_32x32x16_bf16 v[32:47], v[144:147], v[152:155], v[32:47]
    ds_read_b128 v[128:131], v200 offset:40960
    ds_read_b128 v[132:135], v200 offset:45056
    v_mfma_f32_32x32x16_bf16 v[48:63], v[144:147], v[156:159], v[48:63]
    ds_read_b128 v[136:139], v200 offset:49152
    ds_read_b128 v[140:143], v200 offset:53248
    v_mfma_f32_32x32x16_bf16 v[64:79], v[144:147], v[160:163], v[64:79]
    v_mfma_f32_32x32x16_bf16 v[80:95], v[144:147], v[164:167], v[80:95]
    s_waitcnt lgkmcnt(6)
    v_mfma_f32_32x32x16_bf16 v[16:31], v[96:99], v[100:103], v[16:31]
    ds_read_b128 v[144:147], v193 offset:36864
    ds_read_b128 v[148:151], v201 offset:36864
    v_mfma_f32_32x32x16_bf16 v[32:47], v[96:99], v[104:107], v[32:47]
    ds_read_b128 v[152:155], v201 offset:40960
    ds_read_b128 v[156:159], v201 offset:45056
    v_mfma_f32_32x32x16_bf16 v[48:63], v[96:99], v[108:111], v[48:63]
    ds_read_b128 v[160:163], v201 offset:49152
    ds_read_b128 v[164:167], v201 offset:53248
    v_mfma_f32_32x32x16_bf16 v[64:79], v[96:99], v[112:115], v[64:79]
    v_mfma_f32_32x32x16_bf16 v[80:95], v[96:99], v[116:119], v[80:95]
    s_waitcnt lgkmcnt(6)
    v_mfma_f32_32x32x16_bf16 v[16:31], v[120:123], v[124:127], v[16:31]
    ds_read_b128 v[96:99], v194 offset:36864
    ds_read_b128 v[100:103], v202 offset:36864
    v_mfma_f32_32x32x16_bf16 v[32:47], v[120:123], v[128:131], v[32:47]
    ds_read_b128 v[104:107], v202 offset:40960
    ds_read_b128 v[108:111], v202 offset:45056
    v_mfma_f32_32x32x16_bf16 v[48:63], v[120:123], v[132:135], v[48:63]
    ds_read_b128 v[112:115], v202 offset:49152
    ds_read_b128 v[116:119], v202 offset:53248
    v_mfma_f32_32x32x16_bf16 v[64:79], v[120:123], v[136:139], v[64:79]
    v_mfma_f32_32x32x16_bf16 v[80:95], v[120:123], v[140:143], v[80:95]
    s_waitcnt lgkmcnt(6)
    v_mfma_f32_32x32x16_bf16 v[16:31], v[144:147], v[148:151], v[16:31]
    ds_read_b128 v[120:123], v195 offset:36864
    ds_read_b128 v[124:127], v203 offset:36864
    v_mfma_f32_32x32x16_bf16 v[32:47], v[144:147], v[152:155], v[32:47]
    ds_read_b128 v[128:131], v203 offset:40960
    ds_read_b128 v[132:135], v203 offset:45056
    v_mfma_f32_32x32x16_bf16 v[48:63], v[144:147], v[156:159], v[48:63]
    ds_read_b128 v[136:139], v203 offset:49152
    ds_read_b128 v[140:143], v203 offset:53248
    v_mfma_f32_32x32x16_bf16 v[64:79], v[144:147], v[160:163], v[64:79]
    v_mfma_f32_32x32x16_bf16 v[80:95], v[144:147], v[164:167], v[80:95]
    s_waitcnt lgkmcnt(0)
    s_barrier
    v_mfma_f32_32x32x16_bf16 v[16:31], v[96:99], v[100:103], v[16:31]
    ds_read_b128 v[144:147], v196 offset:0
    ds_read_b128 v[148:151], v204 offset:0
    v_mfma_f32_32x32x16_bf16 v[32:47], v[96:99], v[104:107], v[32:47]
    ds_read_b128 v[152:155], v204 offset:4096
    ds_read_b128 v[156:159], v204 offset:8192
    v_mfma_f32_32x32x16_bf16 v[48:63], v[96:99], v[108:111], v[48:63]
    ds_read_b128 v[160:163], v204 offset:12288
    ds_read_b128 v[164:167], v204 offset:16384
    v_mfma_f32_32x32x16_bf16 v[64:79], v[96:99], v[112:115], v[64:79]
    v_mfma_f32_32x32x16_bf16 v[80:95], v[96:99], v[116:119], v[80:95]
    s_waitcnt lgkmcnt(6)
    v_mfma_f32_32x32x16_bf16 v[16:31], v[120:123], v[124:127], v[16:31]
    ds_read_b128 v[96:99], v197 offset:0
    ds_read_b128 v[100:103], v205 offset:0
    v_mfma_f32_32x32x16_bf16 v[32:47], v[120:123], v[128:131], v[32:47]
    ds_read_b128 v[104:107], v205 offset:4096
    ds_read_b128 v[108:111], v205 offset:8192
    v_mfma_f32_32x32x16_bf16 v[48:63], v[120:123], v[132:135], v[48:63]
    ds_read_b128 v[112:115], v205 offset:12288
    ds_read_b128 v[116:119], v205 offset:16384
    v_mfma_f32_32x32x16_bf16 v[64:79], v[120:123], v[136:139], v[64:79]
    v_mfma_f32_32x32x16_bf16 v[80:95], v[120:123], v[140:143], v[80:95]
    s_waitcnt lgkmcnt(6)
    v_mfma_f32_32x32x16_bf16 v[16:31], v[144:147], v[148:151], v[16:31]
    ds_read_b128 v[120:123], v198 offset:0
    ds_read_b128 v[124:127], v206 offset:0
    v_mfma_f32_32x32x16_bf16 v[32:47], v[144:147], v[152:155], v[32:47]
    ds_read_b128 v[128:131], v206 offset:4096
    ds_read_b128 v[132:135], v206 offset:8192
    v_mfma_f32_32x32x16_bf16 v[48:63], v[144:147], v[156:159], v[48:63]
    ds_read_b128 v[136:139], v206 offset:12288
    ds_read_b128 v[140:143], v206 offset:16384
    v_mfma_f32_32x32x16_bf16 v[64:79], v[144:147], v[160:163], v[64:79]
    v_mfma_f32_32x32x16_bf16 v[80:95], v[144:147], v[164:167], v[80:95]
    s_waitcnt lgkmcnt(6)
    v_mfma_f32_32x32x16_bf16 v[16:31], v[96:99], v[100:103], v[16:31]
    ds_read_b128 v[144:147], v199 offset:0
    ds_read_b128 v[148:151], v207 offset:0
    v_mfma_f32_32x32x16_bf16 v[32:47], v[96:99], v[104:107], v[32:47]
    ds_read_b128 v[152:155], v207 offset:4096
    ds_read_b128 v[156:159], v207 offset:8192
    v_mfma_f32_32x32x16_bf16 v[48:63], v[96:99], v[108:111], v[48:63]
    ds_read_b128 v[160:163], v207 offset:12288
    ds_read_b128 v[164:167], v207 offset:16384
    v_mfma_f32_32x32x16_bf16 v[64:79], v[96:99], v[112:115], v[64:79]
    v_mfma_f32_32x32x16_bf16 v[80:95], v[96:99], v[116:119], v[80:95]
    s_waitcnt lgkmcnt(0)
    s_barrier
    v_mfma_f32_32x32x16_bf16 v[16:31], v[120:123], v[124:127], v[16:31]
    ds_read_b128 v[96:99], v196 offset:36864
    ds_read_b128 v[100:103], v204 offset:36864
    v_mfma_f32_32x32x16_bf16 v[32:47], v[120:123], v[128:131], v[32:47]
    ds_read_b128 v[104:107], v204 offset:40960
    ds_read_b128 v[108:111], v204 offset:45056
    v_mfma_f32_32x32x16_bf16 v[48:63], v[120:123], v[132:135], v[48:63]
    ds_read_b128 v[112:115], v204 offset:49152
    ds_read_b128 v[116:119], v204 offset:53248
    v_mfma_f32_32x32x16_bf16 v[64:79], v[120:123], v[136:139], v[64:79]
    v_mfma_f32_32x32x16_bf16 v[80:95], v[120:123], v[140:143], v[80:95]
    s_waitcnt lgkmcnt(6)
    v_mfma_f32_32x32x16_bf16 v[16:31], v[144:147], v[148:151], v[16:31]
    ds_read_b128 v[120:123], v197 offset:36864
    ds_read_b128 v[124:127], v205 offset:36864
    v_mfma_f32_32x32x16_bf16 v[32:47], v[144:147], v[152:155], v[32:47]
    ds_read_b128 v[128:131], v205 offset:40960
    ds_read_b128 v[132:135], v205 offset:45056
    v_mfma_f32_32x32x16_bf16 v[48:63], v[144:147], v[156:159], v[48:63]
    ds_read_b128 v[136:139], v205 offset:49152
    ds_read_b128 v[140:143], v205 offset:53248
    v_mfma_f32_32x32x16_bf16 v[64:79], v[144:147], v[160:163], v[64:79]
    v_mfma_f32_32x32x16_bf16 v[80:95], v[144:147], v[164:167], v[80:95]
    s_waitcnt lgkmcnt(6)
    v_mfma_f32_32x32x16_bf16 v[16:31], v[96:99], v[100:103], v[16:31]
    ds_read_b128 v[144:147], v198 offset:36864
    ds_read_b128 v[148:151], v206 offset:36864
    v_mfma_f32_32x32x16_bf16 v[32:47], v[96:99], v[104:107], v[32:47]
    ds_read_b128 v[152:155], v206 offset:40960
    ds_read_b128 v[156:159], v206 offset:45056
    v_mfma_f32_32x32x16_bf16 v[48:63], v[96:99], v[108:111], v[48:63]
    ds_read_b128 v[160:163], v206 offset:49152
    ds_read_b128 v[164:167], v206 offset:53248
    v_mfma_f32_32x32x16_bf16 v[64:79], v[96:99], v[112:115], v[64:79]
    v_mfma_f32_32x32x16_bf16 v[80:95], v[96:99], v[116:119], v[80:95]
    s_waitcnt lgkmcnt(6)
    v_mfma_f32_32x32x16_bf16 v[16:31], v[120:123], v[124:127], v[16:31]
    ds_read_b128 v[96:99], v199 offset:36864
    ds_read_b128 v[100:103], v207 offset:36864
    v_mfma_f32_32x32x16_bf16 v[32:47], v[120:123], v[128:131], v[32:47]
    ds_read_b128 v[104:107], v207 offset:40960
    ds_read_b128 v[108:111], v207 offset:45056
    v_mfma_f32_32x32x16_bf16 v[48:63], v[120:123], v[132:135], v[48:63]
    ds_read_b128 v[112:115], v207 offset:49152
    ds_read_b128 v[116:119], v207 offset:53248
    v_mfma_f32_32x32x16_bf16 v[64:79], v[120:123], v[136:139], v[64:79]
    v_mfma_f32_32x32x16_bf16 v[80:95], v[120:123], v[140:143], v[80:95]
    s_waitcnt lgkmcnt(0)
    s_barrier
    v_mfma_f32_32x32x16_bf16 v[16:31], v[144:147], v[148:151], v[16:31]
    ds_read_b128 v[120:123], v192 offset:0
    ds_read_b128 v[124:127], v200 offset:0
    v_mfma_f32_32x32x16_bf16 v[32:47], v[144:147], v[152:155], v[32:47]
    ds_read_b128 v[128:131], v200 offset:4096
    ds_read_b128 v[132:135], v200 offset:8192
    v_mfma_f32_32x32x16_bf16 v[48:63], v[144:147], v[156:159], v[48:63]
    ds_read_b128 v[136:139], v200 offset:12288
    ds_read_b128 v[140:143], v200 offset:16384
    v_mfma_f32_32x32x16_bf16 v[64:79], v[144:147], v[160:163], v[64:79]
    v_mfma_f32_32x32x16_bf16 v[80:95], v[144:147], v[164:167], v[80:95]
    s_waitcnt lgkmcnt(6)
    v_mfma_f32_32x32x16_bf16 v[16:31], v[96:99], v[100:103], v[16:31]
    ds_read_b128 v[144:147], v193 offset:0
    ds_read_b128 v[148:151], v201 offset:0
    v_mfma_f32_32x32x16_bf16 v[32:47], v[96:99], v[104:107], v[32:47]
    ds_read_b128 v[152:155], v201 offset:4096
    ds_read_b128 v[156:159], v201 offset:8192
    v_mfma_f32_32x32x16_bf16 v[48:63], v[96:99], v[108:111], v[48:63]
    ds_read_b128 v[160:163], v201 offset:12288
    ds_read_b128 v[164:167], v201 offset:16384
    v_mfma_f32_32x32x16_bf16 v[64:79], v[96:99], v[112:115], v[64:79]
    v_mfma_f32_32x32x16_bf16 v[80:95], v[96:99], v[116:119], v[80:95]
    s_waitcnt lgkmcnt(6)
    v_mfma_f32_32x32x16_bf16 v[16:31], v[120:123], v[124:127], v[16:31]
    ds_read_b128 v[96:99], v194 offset:0
    ds_read_b128 v[100:103], v202 offset:0
    v_mfma_f32_32x32x16_bf16 v[32:47], v[120:123], v[128:131], v[32:47]
    ds_read_b128 v[104:107], v202 offset:4096
    ds_read_b128 v[108:111], v202 offset:8192
    v_mfma_f32_32x32x16_bf16 v[48:63], v[120:123], v[132:135], v[48:63]
    ds_read_b128 v[112:115], v202 offset:12288
    ds_read_b128 v[116:119], v202 offset:16384
    v_mfma_f32_32x32x16_bf16 v[64:79], v[120:123], v[136:139], v[64:79]
    v_mfma_f32_32x32x16_bf16 v[80:95], v[120:123], v[140:143], v[80:95]
    s_waitcnt lgkmcnt(6)
    v_mfma_f32_32x32x16_bf16 v[16:31], v[144:147], v[148:151], v[16:31]
    ds_read_b128 v[120:123], v195 offset:0
    ds_read_b128 v[124:127], v203 offset:0
    v_mfma_f32_32x32x16_bf16 v[32:47], v[144:147], v[152:155], v[32:47]
    ds_read_b128 v[128:131], v203 offset:4096
    ds_read_b128 v[132:135], v203 offset:8192
    v_mfma_f32_32x32x16_bf16 v[48:63], v[144:147], v[156:159], v[48:63]
    ds_read_b128 v[136:139], v203 offset:12288
    ds_read_b128 v[140:143], v203 offset:16384
    v_mfma_f32_32x32x16_bf16 v[64:79], v[144:147], v[160:163], v[64:79]
    v_mfma_f32_32x32x16_bf16 v[80:95], v[144:147], v[164:167], v[80:95]
    s_waitcnt lgkmcnt(0)
    s_barrier
    v_mfma_f32_32x32x16_bf16 v[16:31], v[96:99], v[100:103], v[16:31]
    ds_read_b128 v[144:147], v192 offset:36864
    ds_read_b128 v[148:151], v200 offset:36864
    v_mfma_f32_32x32x16_bf16 v[32:47], v[96:99], v[104:107], v[32:47]
    ds_read_b128 v[152:155], v200 offset:40960
    ds_read_b128 v[156:159], v200 offset:45056
    v_mfma_f32_32x32x16_bf16 v[48:63], v[96:99], v[108:111], v[48:63]
    ds_read_b128 v[160:163], v200 offset:49152
    ds_read_b128 v[164:167], v200 offset:53248
    v_mfma_f32_32x32x16_bf16 v[64:79], v[96:99], v[112:115], v[64:79]
    v_mfma_f32_32x32x16_bf16 v[80:95], v[96:99], v[116:119], v[80:95]
    s_waitcnt lgkmcnt(6)
    v_mfma_f32_32x32x16_bf16 v[16:31], v[120:123], v[124:127], v[16:31]
    ds_read_b128 v[96:99], v193 offset:36864
    ds_read_b128 v[100:103], v201 offset:36864
    v_mfma_f32_32x32x16_bf16 v[32:47], v[120:123], v[128:131], v[32:47]
    ds_read_b128 v[104:107], v201 offset:40960
    ds_read_b128 v[108:111], v201 offset:45056
    v_mfma_f32_32x32x16_bf16 v[48:63], v[120:123], v[132:135], v[48:63]
    ds_read_b128 v[112:115], v201 offset:49152
    ds_read_b128 v[116:119], v201 offset:53248
    v_mfma_f32_32x32x16_bf16 v[64:79], v[120:123], v[136:139], v[64:79]
    v_mfma_f32_32x32x16_bf16 v[80:95], v[120:123], v[140:143], v[80:95]
    s_waitcnt lgkmcnt(6)
    v_mfma_f32_32x32x16_bf16 v[16:31], v[144:147], v[148:151], v[16:31]
    ds_read_b128 v[120:123], v194 offset:36864
    ds_read_b128 v[124:127], v202 offset:36864
    v_mfma_f32_32x32x16_bf16 v[32:47], v[144:147], v[152:155], v[32:47]
    ds_read_b128 v[128:131], v202 offset:40960
    ds_read_b128 v[132:135], v202 offset:45056
    v_mfma_f32_32x32x16_bf16 v[48:63], v[144:147], v[156:159], v[48:63]
    ds_read_b128 v[136:139], v202 offset:49152
    ds_read_b128 v[140:143], v202 offset:53248
    v_mfma_f32_32x32x16_bf16 v[64:79], v[144:147], v[160:163], v[64:79]
    v_mfma_f32_32x32x16_bf16 v[80:95], v[144:147], v[164:167], v[80:95]
    s_waitcnt lgkmcnt(6)
    v_mfma_f32_32x32x16_bf16 v[16:31], v[96:99], v[100:103], v[16:31]
    ds_read_b128 v[144:147], v195 offset:36864
    ds_read_b128 v[148:151], v203 offset:36864
    v_mfma_f32_32x32x16_bf16 v[32:47], v[96:99], v[104:107], v[32:47]
    ds_read_b128 v[152:155], v203 offset:40960
    ds_read_b128 v[156:159], v203 offset:45056
    v_mfma_f32_32x32x16_bf16 v[48:63], v[96:99], v[108:111], v[48:63]
    ds_read_b128 v[160:163], v203 offset:49152
    ds_read_b128 v[164:167], v203 offset:53248
    v_mfma_f32_32x32x16_bf16 v[64:79], v[96:99], v[112:115], v[64:79]
    v_mfma_f32_32x32x16_bf16 v[80:95], v[96:99], v[116:119], v[80:95]
    s_waitcnt lgkmcnt(0)
    s_barrier
    v_mfma_f32_32x32x16_bf16 v[16:31], v[120:123], v[124:127], v[16:31]
    ds_read_b128 v[96:99], v196 offset:0
    ds_read_b128 v[100:103], v204 offset:0
    v_mfma_f32_32x32x16_bf16 v[32:47], v[120:123], v[128:131], v[32:47]
    ds_read_b128 v[104:107], v204 offset:4096
    ds_read_b128 v[108:111], v204 offset:8192
    v_mfma_f32_32x32x16_bf16 v[48:63], v[120:123], v[132:135], v[48:63]
    ds_read_b128 v[112:115], v204 offset:12288
    ds_read_b128 v[116:119], v204 offset:16384
    v_mfma_f32_32x32x16_bf16 v[64:79], v[120:123], v[136:139], v[64:79]
    v_mfma_f32_32x32x16_bf16 v[80:95], v[120:123], v[140:143], v[80:95]
    s_waitcnt lgkmcnt(6)
    v_mfma_f32_32x32x16_bf16 v[16:31], v[144:147], v[148:151], v[16:31]
    ds_read_b128 v[120:123], v197 offset:0
    ds_read_b128 v[124:127], v205 offset:0
    v_mfma_f32_32x32x16_bf16 v[32:47], v[144:147], v[152:155], v[32:47]
    ds_read_b128 v[128:131], v205 offset:4096
    ds_read_b128 v[132:135], v205 offset:8192
    v_mfma_f32_32x32x16_bf16 v[48:63], v[144:147], v[156:159], v[48:63]
    ds_read_b128 v[136:139], v205 offset:12288
    ds_read_b128 v[140:143], v205 offset:16384
    v_mfma_f32_32x32x16_bf16 v[64:79], v[144:147], v[160:163], v[64:79]
    v_mfma_f32_32x32x16_bf16 v[80:95], v[144:147], v[164:167], v[80:95]
    s_waitcnt lgkmcnt(6)
    v_mfma_f32_32x32x16_bf16 v[16:31], v[96:99], v[100:103], v[16:31]
    ds_read_b128 v[144:147], v198 offset:0
    ds_read_b128 v[148:151], v206 offset:0
    v_mfma_f32_32x32x16_bf16 v[32:47], v[96:99], v[104:107], v[32:47]
    ds_read_b128 v[152:155], v206 offset:4096
    ds_read_b128 v[156:159], v206 offset:8192
    v_mfma_f32_32x32x16_bf16 v[48:63], v[96:99], v[108:111], v[48:63]
    ds_read_b128 v[160:163], v206 offset:12288
    ds_read_b128 v[164:167], v206 offset:16384
    v_mfma_f32_32x32x16_bf16 v[64:79], v[96:99], v[112:115], v[64:79]
    v_mfma_f32_32x32x16_bf16 v[80:95], v[96:99], v[116:119], v[80:95]
    s_waitcnt lgkmcnt(6)
    v_mfma_f32_32x32x16_bf16 v[16:31], v[120:123], v[124:127], v[16:31]
    ds_read_b128 v[96:99], v199 offset:0
    ds_read_b128 v[100:103], v207 offset:0
    v_mfma_f32_32x32x16_bf16 v[32:47], v[120:123], v[128:131], v[32:47]
    ds_read_b128 v[104:107], v207 offset:4096
    ds_read_b128 v[108:111], v207 offset:8192
    v_mfma_f32_32x32x16_bf16 v[48:63], v[120:123], v[132:135], v[48:63]
    ds_read_b128 v[112:115], v207 offset:12288
    ds_read_b128 v[116:119], v207 offset:16384
    v_mfma_f32_32x32x16_bf16 v[64:79], v[120:123], v[136:139], v[64:79]
    v_mfma_f32_32x32x16_bf16 v[80:95], v[120:123], v[140:143], v[80:95]
    s_waitcnt lgkmcnt(0)
    s_barrier
    v_mfma_f32_32x32x16_bf16 v[16:31], v[144:147], v[148:151], v[16:31]
    ds_read_b128 v[120:123], v196 offset:36864
    ds_read_b128 v[124:127], v204 offset:36864
    v_mfma_f32_32x32x16_bf16 v[32:47], v[144:147], v[152:155], v[32:47]
    ds_read_b128 v[128:131], v204 offset:40960
    ds_read_b128 v[132:135], v204 offset:45056
    v_mfma_f32_32x32x16_bf16 v[48:63], v[144:147], v[156:159], v[48:63]
    ds_read_b128 v[136:139], v204 offset:49152
    ds_read_b128 v[140:143], v204 offset:53248
    v_mfma_f32_32x32x16_bf16 v[64:79], v[144:147], v[160:163], v[64:79]
    v_mfma_f32_32x32x16_bf16 v[80:95], v[144:147], v[164:167], v[80:95]
    s_waitcnt lgkmcnt(6)
    v_mfma_f32_32x32x16_bf16 v[16:31], v[96:99], v[100:103], v[16:31]
    ds_read_b128 v[144:147], v197 offset:36864
    ds_read_b128 v[148:151], v205 offset:36864
    v_mfma_f32_32x32x16_bf16 v[32:47], v[96:99], v[104:107], v[32:47]
    ds_read_b128 v[152:155], v205 offset:40960
    ds_read_b128 v[156:159], v205 offset:45056
    v_mfma_f32_32x32x16_bf16 v[48:63], v[96:99], v[108:111], v[48:63]
    ds_read_b128 v[160:163], v205 offset:49152
    ds_read_b128 v[164:167], v205 offset:53248
    v_mfma_f32_32x32x16_bf16 v[64:79], v[96:99], v[112:115], v[64:79]
    v_mfma_f32_32x32x16_bf16 v[80:95], v[96:99], v[116:119], v[80:95]
    s_waitcnt lgkmcnt(6)
    v_mfma_f32_32x32x16_bf16 v[16:31], v[120:123], v[124:127], v[16:31]
    ds_read_b128 v[96:99], v198 offset:36864
    ds_read_b128 v[100:103], v206 offset:36864
    v_mfma_f32_32x32x16_bf16 v[32:47], v[120:123], v[128:131], v[32:47]
    ds_read_b128 v[104:107], v206 offset:40960
    ds_read_b128 v[108:111], v206 offset:45056
    v_mfma_f32_32x32x16_bf16 v[48:63], v[120:123], v[132:135], v[48:63]
    ds_read_b128 v[112:115], v206 offset:49152
    ds_read_b128 v[116:119], v206 offset:53248
    v_mfma_f32_32x32x16_bf16 v[64:79], v[120:123], v[136:139], v[64:79]
    v_mfma_f32_32x32x16_bf16 v[80:95], v[120:123], v[140:143], v[80:95]
    s_waitcnt lgkmcnt(6)
    v_mfma_f32_32x32x16_bf16 v[16:31], v[144:147], v[148:151], v[16:31]
    ds_read_b128 v[120:123], v199 offset:36864
    ds_read_b128 v[124:127], v207 offset:36864
    v_mfma_f32_32x32x16_bf16 v[32:47], v[144:147], v[152:155], v[32:47]
    ds_read_b128 v[128:131], v207 offset:40960
    ds_read_b128 v[132:135], v207 offset:45056
    v_mfma_f32_32x32x16_bf16 v[48:63], v[144:147], v[156:159], v[48:63]
    ds_read_b128 v[136:139], v207 offset:49152
    ds_read_b128 v[140:143], v207 offset:53248
    v_mfma_f32_32x32x16_bf16 v[64:79], v[144:147], v[160:163], v[64:79]
    v_mfma_f32_32x32x16_bf16 v[80:95], v[144:147], v[164:167], v[80:95]
    s_waitcnt lgkmcnt(6)
    v_mfma_f32_32x32x16_bf16 v[16:31], v[96:99], v[100:103], v[16:31]
    v_mfma_f32_32x32x16_bf16 v[32:47], v[96:99], v[104:107], v[32:47]
    v_mfma_f32_32x32x16_bf16 v[48:63], v[96:99], v[108:111], v[48:63]
    v_mfma_f32_32x32x16_bf16 v[64:79], v[96:99], v[112:115], v[64:79]
    v_mfma_f32_32x32x16_bf16 v[80:95], v[96:99], v[116:119], v[80:95]
    s_waitcnt lgkmcnt(0)
    v_mfma_f32_32x32x16_bf16 v[16:31], v[120:123], v[124:127], v[16:31]
    v_mfma_f32_32x32x16_bf16 v[32:47], v[120:123], v[128:131], v[32:47]
    v_mfma_f32_32x32x16_bf16 v[48:63], v[120:123], v[132:135], v[48:63]
    v_mfma_f32_32x32x16_bf16 v[64:79], v[120:123], v[136:139], v[64:79]
    v_mfma_f32_32x32x16_bf16 v[80:95], v[120:123], v[140:143], v[80:95]
    s_nop 7
    buffer_store_dword v16, v210, s[48:51], s64 offen offset:0 sc1
    buffer_store_dword v17, v211, s[48:51], s64 offen offset:0 sc1
    buffer_store_dword v18, v212, s[48:51], s64 offen offset:0 sc1
    buffer_store_dword v19, v213, s[48:51], s64 offen offset:0 sc1
    buffer_store_dword v20, v210, s[48:51], s65 offen offset:0 sc1
    buffer_store_dword v21, v211, s[48:51], s65 offen offset:0 sc1
    buffer_store_dword v22, v212, s[48:51], s65 offen offset:0 sc1
    buffer_store_dword v23, v213, s[48:51], s65 offen offset:0 sc1
    buffer_store_dword v24, v210, s[48:51], s66 offen offset:0 sc1
    buffer_store_dword v25, v211, s[48:51], s66 offen offset:0 sc1
    buffer_store_dword v26, v212, s[48:51], s66 offen offset:0 sc1
    buffer_store_dword v27, v213, s[48:51], s66 offen offset:0 sc1
    buffer_store_dword v28, v210, s[48:51], s67 offen offset:0 sc1
    buffer_store_dword v29, v211, s[48:51], s67 offen offset:0 sc1
    buffer_store_dword v30, v212, s[48:51], s67 offen offset:0 sc1
    buffer_store_dword v31, v213, s[48:51], s67 offen offset:0 sc1
    buffer_store_dword v32, v210, s[48:51], s64 offen offset:128 sc1
    buffer_store_dword v33, v211, s[48:51], s64 offen offset:128 sc1
    buffer_store_dword v34, v212, s[48:51], s64 offen offset:128 sc1
    buffer_store_dword v35, v213, s[48:51], s64 offen offset:128 sc1
    buffer_store_dword v36, v210, s[48:51], s65 offen offset:128 sc1
    buffer_store_dword v37, v211, s[48:51], s65 offen offset:128 sc1
    buffer_store_dword v38, v212, s[48:51], s65 offen offset:128 sc1
    buffer_store_dword v39, v213, s[48:51], s65 offen offset:128 sc1
    buffer_store_dword v40, v210, s[48:51], s66 offen offset:128 sc1
    buffer_store_dword v41, v211, s[48:51], s66 offen offset:128 sc1
    buffer_store_dword v42, v212, s[48:51], s66 offen offset:128 sc1
    buffer_store_dword v43, v213, s[48:51], s66 offen offset:128 sc1
    buffer_store_dword v44, v210, s[48:51], s67 offen offset:128 sc1
    buffer_store_dword v45, v211, s[48:51], s67 offen offset:128 sc1
    buffer_store_dword v46, v212, s[48:51], s67 offen offset:128 sc1
    buffer_store_dword v47, v213, s[48:51], s67 offen offset:128 sc1
    buffer_store_dword v48, v210, s[48:51], s64 offen offset:256 sc1
    buffer_store_dword v49, v211, s[48:51], s64 offen offset:256 sc1
    buffer_store_dword v50, v212, s[48:51], s64 offen offset:256 sc1
    buffer_store_dword v51, v213, s[48:51], s64 offen offset:256 sc1
    buffer_store_dword v52, v210, s[48:51], s65 offen offset:256 sc1
    buffer_store_dword v53, v211, s[48:51], s65 offen offset:256 sc1
    buffer_store_dword v54, v212, s[48:51], s65 offen offset:256 sc1
    buffer_store_dword v55, v213, s[48:51], s65 offen offset:256 sc1
    buffer_store_dword v56, v210, s[48:51], s66 offen offset:256 sc1
    buffer_store_dword v57, v211, s[48:51], s66 offen offset:256 sc1
    buffer_store_dword v58, v212, s[48:51], s66 offen offset:256 sc1
    buffer_store_dword v59, v213, s[48:51], s66 offen offset:256 sc1
    buffer_store_dword v60, v210, s[48:51], s67 offen offset:256 sc1
    buffer_store_dword v61, v211, s[48:51], s67 offen offset:256 sc1
    buffer_store_dword v62, v212, s[48:51], s67 offen offset:256 sc1
    buffer_store_dword v63, v213, s[48:51], s67 offen offset:256 sc1
    buffer_store_dword v64, v210, s[48:51], s64 offen offset:384 sc1
    buffer_store_dword v65, v211, s[48:51], s64 offen offset:384 sc1
    buffer_store_dword v66, v212, s[48:51], s64 offen offset:384 sc1
    buffer_store_dword v67, v213, s[48:51], s64 offen offset:384 sc1
    buffer_store_dword v68, v210, s[48:51], s65 offen offset:384 sc1
    buffer_store_dword v69, v211, s[48:51], s65 offen offset:384 sc1
    buffer_store_dword v70, v212, s[48:51], s65 offen offset:384 sc1
    buffer_store_dword v71, v213, s[48:51], s65 offen offset:384 sc1
    buffer_store_dword v72, v210, s[48:51], s66 offen offset:384 sc1
    buffer_store_dword v73, v211, s[48:51], s66 offen offset:384 sc1
    buffer_store_dword v74, v212, s[48:51], s66 offen offset:384 sc1
    buffer_store_dword v75, v213, s[48:51], s66 offen offset:384 sc1
    buffer_store_dword v76, v210, s[48:51], s67 offen offset:384 sc1
    buffer_store_dword v77, v211, s[48:51], s67 offen offset:384 sc1
    buffer_store_dword v78, v212, s[48:51], s67 offen offset:384 sc1
    buffer_store_dword v79, v213, s[48:51], s67 offen offset:384 sc1
    buffer_store_dword v80, v210, s[48:51], s64 offen offset:512 sc1
    buffer_store_dword v81, v211, s[48:51], s64 offen offset:512 sc1
    buffer_store_dword v82, v212, s[48:51], s64 offen offset:512 sc1
    buffer_store_dword v83, v213, s[48:51], s64 offen offset:512 sc1
    buffer_store_dword v84, v210, s[48:51], s65 offen offset:512 sc1
    buffer_store_dword v85, v211, s[48:51], s65 offen offset:512 sc1
    buffer_store_dword v86, v212, s[48:51], s65 offen offset:512 sc1
    buffer_store_dword v87, v213, s[48:51], s65 offen offset:512 sc1
    buffer_store_dword v88, v210, s[48:51], s66 offen offset:512 sc1
    buffer_store_dword v89, v211, s[48:51], s66 offen offset:512 sc1
    buffer_store_dword v90, v212, s[48:51], s66 offen offset:512 sc1
    buffer_store_dword v91, v213, s[48:51], s66 offen offset:512 sc1
    buffer_store_dword v92, v210, s[48:51], s67 offen offset:512 sc1
    buffer_store_dword v93, v211, s[48:51], s67 offen offset:512 sc1
    buffer_store_dword v94, v212, s[48:51], s67 offen offset:512 sc1
    buffer_store_dword v95, v213, s[48:51], s67 offen offset:512 sc1
    s_branch m3_end
m3_g2_load:
    s_add_u32 s48, s40, 16240640
    s_addc_u32 s49, s41, 0
    s_mov_b32 s50, 5242880
    s_mov_b32 s51, 0x20000
    s_add_u32 s52, s40, 21483520
    s_addc_u32 s53, s41, 0
    s_mov_b32 s54, 1638400
    s_mov_b32 s55, 0x20000
    s_sub_u32 s4, s3, 4
    s_lshl_b32 s5, s4, 10
    s_mul_i32 s6, s44, 327680
    s_mul_i32 s7, s45, 409600
    v_lshrrev_b32 v10, 3, v1
    v_and_b32 v11, 7, v1
    v_lshrrev_b32 v12, 1, v10
    s_and_b32 s42, s4, 1
    s_lshl_b32 s42, s42, 2
    v_or_b32 v12, s42, v12
    v_xor_b32 v11, v11, v12
    s_lshl_b32 s42, s4, 3
    v_add_u32 v13, s42, v10
    v_mul_u32_u24 v13, 2560, v13
    v_lshl_add_u32 v3, v11, 4, v13
    v_mov_b32 v2, v3
    s_barrier
    s_add_u32 m0, s5, 16384
    s_nop 0
    buffer_load_dwordx4 v3, s[52:55], s7 offen lds
    s_add_u32 m0, s5, 20480
    s_add_u32 s43, s7, 81920
    buffer_load_dwordx4 v3, s[52:55], s43 offen lds
    s_add_u32 m0, s5, 24576
    s_add_u32 s43, s7, 163840
    buffer_load_dwordx4 v3, s[52:55], s43 offen lds
    s_add_u32 m0, s5, 28672
    s_add_u32 s43, s7, 245760
    buffer_load_dwordx4 v3, s[52:55], s43 offen lds
    s_add_u32 m0, s5, 32768
    s_add_u32 s43, s7, 327680
    buffer_load_dwordx4 v3, s[52:55], s43 offen lds
    s_add_u32 m0, s5, 53248
    s_add_u32 s43, s7, 128
    buffer_load_dwordx4 v3, s[52:55], s43 offen lds
    s_add_u32 m0, s5, 57344
    s_add_u32 s43, s7, 82048
    buffer_load_dwordx4 v3, s[52:55], s43 offen lds
    s_add_u32 m0, s5, 61440
    s_add_u32 s43, s7, 163968
    buffer_load_dwordx4 v3, s[52:55], s43 offen lds
    s_add_u32 m0, s5, 65536
    s_add_u32 s43, s7, 245888
    buffer_load_dwordx4 v3, s[52:55], s43 offen lds
    s_add_u32 m0, s5, 69632
    s_add_u32 s43, s7, 327808
    buffer_load_dwordx4 v3, s[52:55], s43 offen lds
    s_add_u32 m0, s5, 90112
    s_add_u32 s43, s7, 256
    buffer_load_dwordx4 v3, s[52:55], s43 offen lds
    s_add_u32 m0, s5, 94208
    s_add_u32 s43, s7, 82176
    buffer_load_dwordx4 v3, s[52:55], s43 offen lds
    s_add_u32 m0, s5, 98304
    s_add_u32 s43, s7, 164096
    buffer_load_dwordx4 v3, s[52:55], s43 offen lds
    s_add_u32 m0, s5, 102400
    s_add_u32 s43, s7, 246016
    buffer_load_dwordx4 v3, s[52:55], s43 offen lds
    s_add_u32 m0, s5, 106496
    s_add_u32 s43, s7, 327936
    buffer_load_dwordx4 v3, s[52:55], s43 offen lds
    s_add_u32 m0, s5, 126976
    s_add_u32 s43, s7, 384
    buffer_load_dwordx4 v3, s[52:55], s43 offen lds
    s_add_u32 m0, s5, 131072
    s_add_u32 s43, s7, 82304
    buffer_load_dwordx4 v3, s[52:55], s43 offen lds
    s_add_u32 m0, s5, 135168
    s_add_u32 s43, s7, 164224
    buffer_load_dwordx4 v3, s[52:55], s43 offen lds
    s_add_u32 m0, s5, 139264
    s_add_u32 s43, s7, 246144
    buffer_load_dwordx4 v3, s[52:55], s43 offen lds
    s_add_u32 m0, s5, 143360
    s_add_u32 s43, s7, 328064
    buffer_load_dwordx4 v3, s[52:55], s43 offen lds
    s_barrier
    s_add_u32 m0, s5, 0
    s_nop 0
    buffer_load_dwordx4 v2, s[48:51], s6 offen lds
    s_add_u32 m0, s5, 4096
    s_add_u32 s43, s6, 81920
    buffer_load_dwordx4 v2, s[48:51], s43 offen lds
    s_add_u32 m0, s5, 8192
    s_add_u32 s43, s6, 163840
    buffer_load_dwordx4 v2, s[48:51], s43 offen lds
    s_add_u32 m0, s5, 12288
    s_add_u32 s43, s6, 245760
    buffer_load_dwordx4 v2, s[48:51], s43 offen lds
    s_add_u32 m0, s5, 36864
    s_add_u32 s43, s6, 128
    buffer_load_dwordx4 v2, s[48:51], s43 offen lds
    s_add_u32 m0, s5, 40960
    s_add_u32 s43, s6, 82048
    buffer_load_dwordx4 v2, s[48:51], s43 offen lds
    s_add_u32 m0, s5, 45056
    s_add_u32 s43, s6, 163968
    buffer_load_dwordx4 v2, s[48:51], s43 offen lds
    s_add_u32 m0, s5, 49152
    s_add_u32 s43, s6, 245888
    buffer_load_dwordx4 v2, s[48:51], s43 offen lds
    s_waitcnt vmcnt(4)
    s_barrier
    s_add_u32 m0, s5, 73728
    s_add_u32 s43, s6, 256
    buffer_load_dwordx4 v2, s[48:51], s43 offen lds
    s_add_u32 m0, s5, 77824
    s_add_u32 s43, s6, 82176
    buffer_load_dwordx4 v2, s[48:51], s43 offen lds
    s_add_u32 m0, s5, 81920
    s_add_u32 s43, s6, 164096
    buffer_load_dwordx4 v2, s[48:51], s43 offen lds
    s_add_u32 m0, s5, 86016
    s_add_u32 s43, s6, 246016
    buffer_load_dwordx4 v2, s[48:51], s43 offen lds
    s_add_u32 m0, s5, 110592
    s_add_u32 s43, s6, 384
    buffer_load_dwordx4 v2, s[48:51], s43 offen lds
    s_add_u32 m0, s5, 114688
    s_add_u32 s43, s6, 82304
    buffer_load_dwordx4 v2, s[48:51], s43 offen lds
    s_add_u32 m0, s5, 118784
    s_add_u32 s43, s6, 164224
    buffer_load_dwordx4 v2, s[48:51], s43 offen lds
    s_add_u32 m0, s5, 122880
    s_add_u32 s43, s6, 246144
    buffer_load_dwordx4 v2, s[48:51], s43 offen lds
    s_waitcnt vmcnt(8)
    s_barrier
    s_add_u32 m0, s5, 0
    s_add_u32 s43, s6, 512
    buffer_load_dwordx4 v2, s[48:51], s43 offen lds
    s_add_u32 m0, s5, 4096
    s_add_u32 s43, s6, 82432
    buffer_load_dwordx4 v2, s[48:51], s43 offen lds
    s_add_u32 m0, s5, 8192
    s_add_u32 s43, s6, 164352
    buffer_load_dwordx4 v2, s[48:51], s43 offen lds
    s_add_u32 m0, s5, 12288
    s_add_u32 s43, s6, 246272
    buffer_load_dwordx4 v2, s[48:51], s43 offen lds
    s_add_u32 m0, s5, 16384
    s_add_u32 s43, s7, 512
    buffer_load_dwordx4 v3, s[52:55], s43 offen lds
    s_add_u32 m0, s5, 20480
    s_add_u32 s43, s7, 82432
    buffer_load_dwordx4 v3, s[52:55], s43 offen lds
    s_add_u32 m0, s5, 24576
    s_add_u32 s43, s7, 164352
    buffer_load_dwordx4 v3, s[52:55], s43 offen lds
    s_add_u32 m0, s5, 28672
    s_add_u32 s43, s7, 246272
    buffer_load_dwordx4 v3, s[52:55], s43 offen lds
    s_add_u32 m0, s5, 32768
    s_add_u32 s43, s7, 328192
    buffer_load_dwordx4 v3, s[52:55], s43 offen lds
    s_waitcnt vmcnt(13)
    s_barrier
    s_add_u32 m0, s5, 36864
    s_add_u32 s43, s6, 640
    buffer_load_dwordx4 v2, s[48:51], s43 offen lds
    s_add_u32 m0, s5, 40960
    s_add_u32 s43, s6, 82560
    buffer_load_dwordx4 v2, s[48:51], s43 offen lds
    s_add_u32 m0, s5, 45056
    s_add_u32 s43, s6, 164480
    buffer_load_dwordx4 v2, s[48:51], s43 offen lds
    s_add_u32 m0, s5, 49152
    s_add_u32 s43, s6, 246400
    buffer_load_dwordx4 v2, s[48:51], s43 offen lds
    s_add_u32 m0, s5, 53248
    s_add_u32 s43, s7, 640
    buffer_load_dwordx4 v3, s[52:55], s43 offen lds
    s_add_u32 m0, s5, 57344
    s_add_u32 s43, s7, 82560
    buffer_load_dwordx4 v3, s[52:55], s43 offen lds
    s_add_u32 m0, s5, 61440
    s_add_u32 s43, s7, 164480
    buffer_load_dwordx4 v3, s[52:55], s43 offen lds
    s_add_u32 m0, s5, 65536
    s_add_u32 s43, s7, 246400
    buffer_load_dwordx4 v3, s[52:55], s43 offen lds
    s_add_u32 m0, s5, 69632
    s_add_u32 s43, s7, 328320
    buffer_load_dwordx4 v3, s[52:55], s43 offen lds
    s_waitcnt vmcnt(18)
    s_barrier
    s_add_u32 m0, s5, 73728
    s_add_u32 s43, s6, 768
    buffer_load_dwordx4 v2, s[48:51], s43 offen lds
    s_add_u32 m0, s5, 77824
    s_add_u32 s43, s6, 82688
    buffer_load_dwordx4 v2, s[48:51], s43 offen lds
    s_add_u32 m0, s5, 81920
    s_add_u32 s43, s6, 164608
    buffer_load_dwordx4 v2, s[48:51], s43 offen lds
    s_add_u32 m0, s5, 86016
    s_add_u32 s43, s6, 246528
    buffer_load_dwordx4 v2, s[48:51], s43 offen lds
    s_add_u32 m0, s5, 90112
    s_add_u32 s43, s7, 768
    buffer_load_dwordx4 v3, s[52:55], s43 offen lds
    s_add_u32 m0, s5, 94208
    s_add_u32 s43, s7, 82688
    buffer_load_dwordx4 v3, s[52:55], s43 offen lds
    s_add_u32 m0, s5, 98304
    s_add_u32 s43, s7, 164608
    buffer_load_dwordx4 v3, s[52:55], s43 offen lds
    s_add_u32 m0, s5, 102400
    s_add_u32 s43, s7, 246528
    buffer_load_dwordx4 v3, s[52:55], s43 offen lds
    s_add_u32 m0, s5, 106496
    s_add_u32 s43, s7, 328448
    buffer_load_dwordx4 v3, s[52:55], s43 offen lds
    s_waitcnt vmcnt(18)
    s_barrier
    s_add_u32 m0, s5, 110592
    s_add_u32 s43, s6, 896
    buffer_load_dwordx4 v2, s[48:51], s43 offen lds
    s_add_u32 m0, s5, 114688
    s_add_u32 s43, s6, 82816
    buffer_load_dwordx4 v2, s[48:51], s43 offen lds
    s_add_u32 m0, s5, 118784
    s_add_u32 s43, s6, 164736
    buffer_load_dwordx4 v2, s[48:51], s43 offen lds
    s_add_u32 m0, s5, 122880
    s_add_u32 s43, s6, 246656
    buffer_load_dwordx4 v2, s[48:51], s43 offen lds
    s_add_u32 m0, s5, 126976
    s_add_u32 s43, s7, 896
    buffer_load_dwordx4 v3, s[52:55], s43 offen lds
    s_add_u32 m0, s5, 131072
    s_add_u32 s43, s7, 82816
    buffer_load_dwordx4 v3, s[52:55], s43 offen lds
    s_add_u32 m0, s5, 135168
    s_add_u32 s43, s7, 164736
    buffer_load_dwordx4 v3, s[52:55], s43 offen lds
    s_add_u32 m0, s5, 139264
    s_add_u32 s43, s7, 246656
    buffer_load_dwordx4 v3, s[52:55], s43 offen lds
    s_add_u32 m0, s5, 143360
    s_add_u32 s43, s7, 328576
    buffer_load_dwordx4 v3, s[52:55], s43 offen lds
    s_waitcnt vmcnt(18)
    s_barrier
    s_add_u32 m0, s5, 0
    s_add_u32 s43, s6, 1024
    buffer_load_dwordx4 v2, s[48:51], s43 offen lds
    s_add_u32 m0, s5, 4096
    s_add_u32 s43, s6, 82944
    buffer_load_dwordx4 v2, s[48:51], s43 offen lds
    s_add_u32 m0, s5, 8192
    s_add_u32 s43, s6, 164864
    buffer_load_dwordx4 v2, s[48:51], s43 offen lds
    s_add_u32 m0, s5, 12288
    s_add_u32 s43, s6, 246784
    buffer_load_dwordx4 v2, s[48:51], s43 offen lds
    s_add_u32 m0, s5, 16384
    s_add_u32 s43, s7, 1024
    buffer_load_dwordx4 v3, s[52:55], s43 offen lds
    s_add_u32 m0, s5, 20480
    s_add_u32 s43, s7, 82944
    buffer_load_dwordx4 v3, s[52:55], s43 offen lds
    s_add_u32 m0, s5, 24576
    s_add_u32 s43, s7, 164864
    buffer_load_dwordx4 v3, s[52:55], s43 offen lds
    s_add_u32 m0, s5, 28672
    s_add_u32 s43, s7, 246784
    buffer_load_dwordx4 v3, s[52:55], s43 offen lds
    s_add_u32 m0, s5, 32768
    s_add_u32 s43, s7, 328704
    buffer_load_dwordx4 v3, s[52:55], s43 offen lds
    s_waitcnt vmcnt(18)
    s_barrier
    s_add_u32 m0, s5, 36864
    s_add_u32 s43, s6, 1152
    buffer_load_dwordx4 v2, s[48:51], s43 offen lds
    s_add_u32 m0, s5, 40960
    s_add_u32 s43, s6, 83072
    buffer_load_dwordx4 v2, s[48:51], s43 offen lds
    s_add_u32 m0, s5, 45056
    s_add_u32 s43, s6, 164992
    buffer_load_dwordx4 v2, s[48:51], s43 offen lds
    s_add_u32 m0, s5, 49152
    s_add_u32 s43, s6, 246912
    buffer_load_dwordx4 v2, s[48:51], s43 offen lds
    s_add_u32 m0, s5, 53248
    s_add_u32 s43, s7, 1152
    buffer_load_dwordx4 v3, s[52:55], s43 offen lds
    s_add_u32 m0, s5, 57344
    s_add_u32 s43, s7, 83072
    buffer_load_dwordx4 v3, s[52:55], s43 offen lds
    s_add_u32 m0, s5, 61440
    s_add_u32 s43, s7, 164992
    buffer_load_dwordx4 v3, s[52:55], s43 offen lds
    s_add_u32 m0, s5, 65536
    s_add_u32 s43, s7, 246912
    buffer_load_dwordx4 v3, s[52:55], s43 offen lds
    s_add_u32 m0, s5, 69632
    s_add_u32 s43, s7, 328832
    buffer_load_dwordx4 v3, s[52:55], s43 offen lds
    s_waitcnt vmcnt(18)
    s_barrier
    s_add_u32 m0, s5, 73728
    s_add_u32 s43, s6, 1280
    buffer_load_dwordx4 v2, s[48:51], s43 offen lds
    s_add_u32 m0, s5, 77824
    s_add_u32 s43, s6, 83200
    buffer_load_dwordx4 v2, s[48:51], s43 offen lds
    s_add_u32 m0, s5, 81920
    s_add_u32 s43, s6, 165120
    buffer_load_dwordx4 v2, s[48:51], s43 offen lds
    s_add_u32 m0, s5, 86016
    s_add_u32 s43, s6, 247040
    buffer_load_dwordx4 v2, s[48:51], s43 offen lds
    s_add_u32 m0, s5, 90112
    s_add_u32 s43, s7, 1280
    buffer_load_dwordx4 v3, s[52:55], s43 offen lds
    s_add_u32 m0, s5, 94208
    s_add_u32 s43, s7, 83200
    buffer_load_dwordx4 v3, s[52:55], s43 offen lds
    s_add_u32 m0, s5, 98304
    s_add_u32 s43, s7, 165120
    buffer_load_dwordx4 v3, s[52:55], s43 offen lds
    s_add_u32 m0, s5, 102400
    s_add_u32 s43, s7, 247040
    buffer_load_dwordx4 v3, s[52:55], s43 offen lds
    s_add_u32 m0, s5, 106496
    s_add_u32 s43, s7, 328960
    buffer_load_dwordx4 v3, s[52:55], s43 offen lds
    s_waitcnt vmcnt(18)
    s_barrier
    s_add_u32 m0, s5, 110592
    s_add_u32 s43, s6, 1408
    buffer_load_dwordx4 v2, s[48:51], s43 offen lds
    s_add_u32 m0, s5, 114688
    s_add_u32 s43, s6, 83328
    buffer_load_dwordx4 v2, s[48:51], s43 offen lds
    s_add_u32 m0, s5, 118784
    s_add_u32 s43, s6, 165248
    buffer_load_dwordx4 v2, s[48:51], s43 offen lds
    s_add_u32 m0, s5, 122880
    s_add_u32 s43, s6, 247168
    buffer_load_dwordx4 v2, s[48:51], s43 offen lds
    s_add_u32 m0, s5, 126976
    s_add_u32 s43, s7, 1408
    buffer_load_dwordx4 v3, s[52:55], s43 offen lds
    s_add_u32 m0, s5, 131072
    s_add_u32 s43, s7, 83328
    buffer_load_dwordx4 v3, s[52:55], s43 offen lds
    s_add_u32 m0, s5, 135168
    s_add_u32 s43, s7, 165248
    buffer_load_dwordx4 v3, s[52:55], s43 offen lds
    s_add_u32 m0, s5, 139264
    s_add_u32 s43, s7, 247168
    buffer_load_dwordx4 v3, s[52:55], s43 offen lds
    s_add_u32 m0, s5, 143360
    s_add_u32 s43, s7, 329088
    buffer_load_dwordx4 v3, s[52:55], s43 offen lds
    s_waitcnt vmcnt(18)
    s_barrier
    s_add_u32 m0, s5, 0
    s_add_u32 s43, s6, 1536
    buffer_load_dwordx4 v2, s[48:51], s43 offen lds
    s_add_u32 m0, s5, 4096
    s_add_u32 s43, s6, 83456
    buffer_load_dwordx4 v2, s[48:51], s43 offen lds
    s_add_u32 m0, s5, 8192
    s_add_u32 s43, s6, 165376
    buffer_load_dwordx4 v2, s[48:51], s43 offen lds
    s_add_u32 m0, s5, 12288
    s_add_u32 s43, s6, 247296
    buffer_load_dwordx4 v2, s[48:51], s43 offen lds
    s_add_u32 m0, s5, 16384
    s_add_u32 s43, s7, 1536
    buffer_load_dwordx4 v3, s[52:55], s43 offen lds
    s_add_u32 m0, s5, 20480
    s_add_u32 s43, s7, 83456
    buffer_load_dwordx4 v3, s[52:55], s43 offen lds
    s_add_u32 m0, s5, 24576
    s_add_u32 s43, s7, 165376
    buffer_load_dwordx4 v3, s[52:55], s43 offen lds
    s_add_u32 m0, s5, 28672
    s_add_u32 s43, s7, 247296
    buffer_load_dwordx4 v3, s[52:55], s43 offen lds
    s_add_u32 m0, s5, 32768
    s_add_u32 s43, s7, 329216
    buffer_load_dwordx4 v3, s[52:55], s43 offen lds
    s_waitcnt vmcnt(18)
    s_barrier
    s_add_u32 m0, s5, 36864
    s_add_u32 s43, s6, 1664
    buffer_load_dwordx4 v2, s[48:51], s43 offen lds
    s_add_u32 m0, s5, 40960
    s_add_u32 s43, s6, 83584
    buffer_load_dwordx4 v2, s[48:51], s43 offen lds
    s_add_u32 m0, s5, 45056
    s_add_u32 s43, s6, 165504
    buffer_load_dwordx4 v2, s[48:51], s43 offen lds
    s_add_u32 m0, s5, 49152
    s_add_u32 s43, s6, 247424
    buffer_load_dwordx4 v2, s[48:51], s43 offen lds
    s_add_u32 m0, s5, 53248
    s_add_u32 s43, s7, 1664
    buffer_load_dwordx4 v3, s[52:55], s43 offen lds
    s_add_u32 m0, s5, 57344
    s_add_u32 s43, s7, 83584
    buffer_load_dwordx4 v3, s[52:55], s43 offen lds
    s_add_u32 m0, s5, 61440
    s_add_u32 s43, s7, 165504
    buffer_load_dwordx4 v3, s[52:55], s43 offen lds
    s_add_u32 m0, s5, 65536
    s_add_u32 s43, s7, 247424
    buffer_load_dwordx4 v3, s[52:55], s43 offen lds
    s_add_u32 m0, s5, 69632
    s_add_u32 s43, s7, 329344
    buffer_load_dwordx4 v3, s[52:55], s43 offen lds
    s_waitcnt vmcnt(18)
    s_barrier
    s_add_u32 m0, s5, 73728
    s_add_u32 s43, s6, 1792
    buffer_load_dwordx4 v2, s[48:51], s43 offen lds
    s_add_u32 m0, s5, 77824
    s_add_u32 s43, s6, 83712
    buffer_load_dwordx4 v2, s[48:51], s43 offen lds
    s_add_u32 m0, s5, 81920
    s_add_u32 s43, s6, 165632
    buffer_load_dwordx4 v2, s[48:51], s43 offen lds
    s_add_u32 m0, s5, 86016
    s_add_u32 s43, s6, 247552
    buffer_load_dwordx4 v2, s[48:51], s43 offen lds
    s_add_u32 m0, s5, 90112
    s_add_u32 s43, s7, 1792
    buffer_load_dwordx4 v3, s[52:55], s43 offen lds
    s_add_u32 m0, s5, 94208
    s_add_u32 s43, s7, 83712
    buffer_load_dwordx4 v3, s[52:55], s43 offen lds
    s_add_u32 m0, s5, 98304
    s_add_u32 s43, s7, 165632
    buffer_load_dwordx4 v3, s[52:55], s43 offen lds
    s_add_u32 m0, s5, 102400
    s_add_u32 s43, s7, 247552
    buffer_load_dwordx4 v3, s[52:55], s43 offen lds
    s_add_u32 m0, s5, 106496
    s_add_u32 s43, s7, 329472
    buffer_load_dwordx4 v3, s[52:55], s43 offen lds
    s_waitcnt vmcnt(18)
    s_barrier
    s_add_u32 m0, s5, 110592
    s_add_u32 s43, s6, 1920
    buffer_load_dwordx4 v2, s[48:51], s43 offen lds
    s_add_u32 m0, s5, 114688
    s_add_u32 s43, s6, 83840
    buffer_load_dwordx4 v2, s[48:51], s43 offen lds
    s_add_u32 m0, s5, 118784
    s_add_u32 s43, s6, 165760
    buffer_load_dwordx4 v2, s[48:51], s43 offen lds
    s_add_u32 m0, s5, 122880
    s_add_u32 s43, s6, 247680
    buffer_load_dwordx4 v2, s[48:51], s43 offen lds
    s_add_u32 m0, s5, 126976
    s_add_u32 s43, s7, 1920
    buffer_load_dwordx4 v3, s[52:55], s43 offen lds
    s_add_u32 m0, s5, 131072
    s_add_u32 s43, s7, 83840
    buffer_load_dwordx4 v3, s[52:55], s43 offen lds
    s_add_u32 m0, s5, 135168
    s_add_u32 s43, s7, 165760
    buffer_load_dwordx4 v3, s[52:55], s43 offen lds
    s_add_u32 m0, s5, 139264
    s_add_u32 s43, s7, 247680
    buffer_load_dwordx4 v3, s[52:55], s43 offen lds
    s_add_u32 m0, s5, 143360
    s_add_u32 s43, s7, 329600
    buffer_load_dwordx4 v3, s[52:55], s43 offen lds
    s_waitcnt vmcnt(18)
    s_barrier
    s_add_u32 m0, s5, 0
    s_add_u32 s43, s6, 2048
    buffer_load_dwordx4 v2, s[48:51], s43 offen lds
    s_add_u32 m0, s5, 4096
    s_add_u32 s43, s6, 83968
    buffer_load_dwordx4 v2, s[48:51], s43 offen lds
    s_add_u32 m0, s5, 8192
    s_add_u32 s43, s6, 165888
    buffer_load_dwordx4 v2, s[48:51], s43 offen lds
    s_add_u32 m0, s5, 12288
    s_add_u32 s43, s6, 247808
    buffer_load_dwordx4 v2, s[48:51], s43 offen lds
    s_add_u32 m0, s5, 16384
    s_add_u32 s43, s7, 2048
    buffer_load_dwordx4 v3, s[52:55], s43 offen lds
    s_add_u32 m0, s5, 20480
    s_add_u32 s43, s7, 83968
    buffer_load_dwordx4 v3, s[52:55], s43 offen lds
    s_add_u32 m0, s5, 24576
    s_add_u32 s43, s7, 165888
    buffer_load_dwordx4 v3, s[52:55], s43 offen lds
    s_add_u32 m0, s5, 28672
    s_add_u32 s43, s7, 247808
    buffer_load_dwordx4 v3, s[52:55], s43 offen lds
    s_add_u32 m0, s5, 32768
    s_add_u32 s43, s7, 329728
    buffer_load_dwordx4 v3, s[52:55], s43 offen lds
    s_waitcnt vmcnt(18)
    s_barrier
    s_add_u32 m0, s5, 36864
    s_add_u32 s43, s6, 2176
    buffer_load_dwordx4 v2, s[48:51], s43 offen lds
    s_add_u32 m0, s5, 40960
    s_add_u32 s43, s6, 84096
    buffer_load_dwordx4 v2, s[48:51], s43 offen lds
    s_add_u32 m0, s5, 45056
    s_add_u32 s43, s6, 166016
    buffer_load_dwordx4 v2, s[48:51], s43 offen lds
    s_add_u32 m0, s5, 49152
    s_add_u32 s43, s6, 247936
    buffer_load_dwordx4 v2, s[48:51], s43 offen lds
    s_add_u32 m0, s5, 53248
    s_add_u32 s43, s7, 2176
    buffer_load_dwordx4 v3, s[52:55], s43 offen lds
    s_add_u32 m0, s5, 57344
    s_add_u32 s43, s7, 84096
    buffer_load_dwordx4 v3, s[52:55], s43 offen lds
    s_add_u32 m0, s5, 61440
    s_add_u32 s43, s7, 166016
    buffer_load_dwordx4 v3, s[52:55], s43 offen lds
    s_add_u32 m0, s5, 65536
    s_add_u32 s43, s7, 247936
    buffer_load_dwordx4 v3, s[52:55], s43 offen lds
    s_add_u32 m0, s5, 69632
    s_add_u32 s43, s7, 329856
    buffer_load_dwordx4 v3, s[52:55], s43 offen lds
    s_waitcnt vmcnt(18)
    s_barrier
    s_add_u32 m0, s5, 73728
    s_add_u32 s43, s6, 2304
    buffer_load_dwordx4 v2, s[48:51], s43 offen lds
    s_add_u32 m0, s5, 77824
    s_add_u32 s43, s6, 84224
    buffer_load_dwordx4 v2, s[48:51], s43 offen lds
    s_add_u32 m0, s5, 81920
    s_add_u32 s43, s6, 166144
    buffer_load_dwordx4 v2, s[48:51], s43 offen lds
    s_add_u32 m0, s5, 86016
    s_add_u32 s43, s6, 248064
    buffer_load_dwordx4 v2, s[48:51], s43 offen lds
    s_add_u32 m0, s5, 90112
    s_add_u32 s43, s7, 2304
    buffer_load_dwordx4 v3, s[52:55], s43 offen lds
    s_add_u32 m0, s5, 94208
    s_add_u32 s43, s7, 84224
    buffer_load_dwordx4 v3, s[52:55], s43 offen lds
    s_add_u32 m0, s5, 98304
    s_add_u32 s43, s7, 166144
    buffer_load_dwordx4 v3, s[52:55], s43 offen lds
    s_add_u32 m0, s5, 102400
    s_add_u32 s43, s7, 248064
    buffer_load_dwordx4 v3, s[52:55], s43 offen lds
    s_add_u32 m0, s5, 106496
    s_add_u32 s43, s7, 329984
    buffer_load_dwordx4 v3, s[52:55], s43 offen lds
    s_waitcnt vmcnt(18)
    s_barrier
    s_add_u32 m0, s5, 110592
    s_add_u32 s43, s6, 2432
    buffer_load_dwordx4 v2, s[48:51], s43 offen lds
    s_add_u32 m0, s5, 114688
    s_add_u32 s43, s6, 84352
    buffer_load_dwordx4 v2, s[48:51], s43 offen lds
    s_add_u32 m0, s5, 118784
    s_add_u32 s43, s6, 166272
    buffer_load_dwordx4 v2, s[48:51], s43 offen lds
    s_add_u32 m0, s5, 122880
    s_add_u32 s43, s6, 248192
    buffer_load_dwordx4 v2, s[48:51], s43 offen lds
    s_add_u32 m0, s5, 126976
    s_add_u32 s43, s7, 2432
    buffer_load_dwordx4 v3, s[52:55], s43 offen lds
    s_add_u32 m0, s5, 131072
    s_add_u32 s43, s7, 84352
    buffer_load_dwordx4 v3, s[52:55], s43 offen lds
    s_add_u32 m0, s5, 135168
    s_add_u32 s43, s7, 166272
    buffer_load_dwordx4 v3, s[52:55], s43 offen lds
    s_add_u32 m0, s5, 139264
    s_add_u32 s43, s7, 248192
    buffer_load_dwordx4 v3, s[52:55], s43 offen lds
    s_add_u32 m0, s5, 143360
    s_add_u32 s43, s7, 330112
    buffer_load_dwordx4 v3, s[52:55], s43 offen lds
    s_waitcnt vmcnt(18)
    s_barrier
    s_waitcnt vmcnt(9)
    s_barrier
    s_waitcnt vmcnt(0)
    s_barrier
m3_end:
    s_add_u32 s84, s40, 34656256
    s_addc_u32 s85, s41, 0
    s_mov_b32 s86, 22528
    s_mov_b32 s87, 0x20000
    s_add_u32 s88, s96, 2000
    s_addc_u32 s89, s97, 0
    v_mov_b32 v22, s88
    v_mov_b32 v23, s89
    v_mov_b32 v20, s95
    s_waitcnt vmcnt(0) lgkmcnt(0)
    s_barrier
    s_cmp_lg_u32 s3, 0
    s_cbranch_scc1 pb32
    s_cmp_eq_u32 s95, -1
    s_cbranch_scc1 pb32
    s_mov_b64 s[90:91], exec
    s_mov_b64 exec, 1
    buffer_store_dwordx2 v[22:23], v20, s[84:87], 0 offen sc1
    s_mov_b64 exec, s[90:91]
pb32:
    s_and_b32 s4, s2, 7
    s_lshr_b32 s5, s2, 3
    s_lshl_b32 s6, s4, 2
    s_and_b32 s7, s5, 3
    s_add_u32 s44, s6, s7
    s_lshr_b32 s45, s5, 2
    s_cmp_ge_u32 s5, 20
    s_cbranch_scc1 m4_idle
    s_cmp_ge_u32 s3, 4
    s_cbranch_scc1 m4_load
    s_and_b32 s4, s3, 1
    s_lshr_b32 s5, s3, 1
    s_lshl_b32 s42, s5, 12
    v_and_b32 v10, 31, v1
    v_lshlrev_b32 v10, 7, v10
    v_lshrrev_b32 v11, 5, v1
    v_bfe_u32 v12, v1, 1, 3
    v_xor_b32 v11, v11, v12
    v_add_u32 v10, s42, v10
    v_xor_b32 v12, 0, v11
    v_lshl_add_u32 v208, v12, 4, v10
    v_xor_b32 v12, 2, v11
    v_lshl_add_u32 v209, v12, 4, v10
    v_xor_b32 v12, 4, v11
    v_lshl_add_u32 v210, v12, 4, v10
    v_xor_b32 v12, 6, v11
    v_lshl_add_u32 v211, v12, 4, v10
    v_lshrrev_b32 v10, 5, v1
    v_lshlrev_b32 v10, 3, v10
    v_bfe_u32 v11, v1, 2, 2
    v_add_u32 v10, v10, v11
    v_lshlrev_b32 v10, 7, v10
    v_bfe_u32 v11, v1, 3, 1
    v_lshlrev_b32 v11, 6, v11
    v_or_b32 v10, v10, v11
    v_bfe_u32 v11, v1, 4, 1
    v_lshlrev_b32 v11, 5, v11
    v_or_b32 v10, v10, v11
    v_bfe_u32 v11, v1, 1, 1
    v_lshlrev_b32 v11, 4, v11
    v_or_b32 v10, v10, v11
    v_and_b32 v11, 1, v1
    v_lshlrev_b32 v11, 3, v11
    v_or_b32 v224, v10, v11
    s_lshl_b32 s42, s4, 13
    s_add_u32 s42, s42, 8192
    v_add_u32 v224, s42, v224
    v_xor_b32 v225, 64, v224
    s_lshl_b32 s60, s5, 5
    s_lshl_b32 s62, s4, 3
    v_and_b32 v10, 31, v1
    v_add_u32 v10, s60, v10
    v_and_b32 v13, 15, v10
    v_mul_u32_u24 v12, 256, v10
    v_lshrrev_b32 v10, 5, v1
    v_lshl_add_u32 v12, v10, 3, v12
    v_add_u32 v12, 49152, v12
    s_add_u32 s42, s62, 0
    v_xor_b32 v14, s42, v13
    v_lshl_add_u32 v184, v14, 4, v12
    s_add_u32 s42, s62, 1
    v_xor_b32 v14, s42, v13
    v_lshl_add_u32 v185, v14, 4, v12
    s_add_u32 s42, s62, 2
    v_xor_b32 v14, s42, v13
    v_lshl_add_u32 v186, v14, 4, v12
    s_add_u32 s42, s62, 3
    v_xor_b32 v14, s42, v13
    v_lshl_add_u32 v187, v14, 4, v12
    s_add_u32 s42, s62, 4
    v_xor_b32 v14, s42, v13
    v_lshl_add_u32 v188, v14, 4, v12
    s_add_u32 s42, s62, 5
    v_xor_b32 v14, s42, v13
    v_lshl_add_u32 v189, v14, 4, v12
    s_add_u32 s42, s62, 6
    v_xor_b32 v14, s42, v13
    v_lshl_add_u32 v190, v14, 4, v12
    s_add_u32 s42, s62, 7
    v_xor_b32 v14, s42, v13
    v_lshl_add_u32 v191, v14, 4, v12
    s_cmp_lg_u32 s3, 0
    s_cbranch_scc1 dw33
    s_add_u32 s84, s40, 34656256
    s_addc_u32 s85, s41, 0
    s_mov_b32 s86, 22528
    s_mov_b32 s87, 0x20000
    s_lshr_b32 s90, s44, 1
    s_add_u32 s90, s90, 128
    s_lshl_b32 s90, s90, 7
    v_lshlrev_b32 v236, 3, v1
    v_add_u32 v236, s90, v236
    v_cmp_gt_u32 vcc, 12, v1
    v_cmp_ne_u32 s[92:93], 5, v1
    s_nop 1
    s_and_b64 vcc, vcc, s[92:93]
    v_cmp_ne_u32 s[92:93], 11, v1
    s_nop 1
    s_and_b64 vcc, vcc, s[92:93]
    s_and_saveexec_b64 s[88:89], vcc
    s_cbranch_execz pd35
    v_mov_b32 v240, s96
    v_mov_b32 v241, s97
    s_mov_b32 s90, 0
pl34:
    buffer_load_dwordx2 v[238:239], v236, s[84:87], 0 offen sc1
    s_waitcnt vmcnt(0)
    v_sub_co_u32 v238, vcc, v238, v240
    s_nop 1
    v_subb_co_u32 v239, vcc, v239, v241, vcc
    v_cmp_eq_u32 s[92:93], 0, v239
    s_mov_b32 s91, 16777216
    v_cmp_gt_u32 vcc, s91, v238
    s_nop 1
    s_and_b64 vcc, vcc, s[92:93]
    s_cmp_eq_u64 vcc, exec
    s_cbranch_scc1 pd35
    s_add_u32 s90, s90, 1
    s_cmp_lt_u32 s90, 262144
    s_cbranch_scc1 pl34
pd35:
    s_mov_b64 exec, s[88:89]
dw33:
    s_barrier
    v_add_u32 v212, 73728, v208
    v_add_u32 v213, 73728, v209
    v_add_u32 v214, 73728, v210
    v_add_u32 v215, 73728, v211
    v_add_u32 v226, 73728, v224
    v_add_u32 v227, 73728, v225
    s_barrier
    ds_read_b128 v[48:51], v208 offset:0
    ds_read_b64_tr_b16 v[52:53], v224 offset:0
    ds_read_b64_tr_b16 v[54:55], v224 offset:512
    ds_read_b64_tr_b16 v[56:57], v225 offset:0
    ds_read_b64_tr_b16 v[58:59], v225 offset:512
    ds_read_b128 v[60:63], v209 offset:0
    ds_read_b64_tr_b16 v[64:65], v224 offset:2048
    ds_read_b64_tr_b16 v[66:67], v224 offset:2560
    ds_read_b64_tr_b16 v[68:69], v225 offset:2048
    ds_read_b64_tr_b16 v[70:71], v225 offset:2560
    ds_read_b128 v[72:75], v210 offset:0
    ds_read_b64_tr_b16 v[76:77], v224 offset:4096
    ds_read_b64_tr_b16 v[78:79], v224 offset:4608
    ds_read_b64_tr_b16 v[80:81], v225 offset:4096
    ds_read_b64_tr_b16 v[82:83], v225 offset:4608
    s_waitcnt lgkmcnt(10)
    v_mfma_f32_32x32x16_bf16 v[16:31], v[52:55], v[48:51], 0
    ds_read_b128 v[84:87], v211 offset:0
    ds_read_b64_tr_b16 v[88:89], v224 offset:6144
    ds_read_b64_tr_b16 v[90:91], v224 offset:6656
    v_mfma_f32_32x32x16_bf16 v[32:47], v[56:59], v[48:51], 0
    ds_read_b64_tr_b16 v[92:93], v225 offset:6144
    ds_read_b64_tr_b16 v[94:95], v225 offset:6656
    s_waitcnt lgkmcnt(10)
    s_barrier
    v_mfma_f32_32x32x16_bf16 v[16:31], v[64:67], v[60:63], v[16:31]
    ds_read_b128 v[48:51], v208 offset:24576
    ds_read_b64_tr_b16 v[52:53], v224 offset:24576
    ds_read_b64_tr_b16 v[54:55], v224 offset:25088
    v_mfma_f32_32x32x16_bf16 v[32:47], v[68:71], v[60:63], v[32:47]
    ds_read_b64_tr_b16 v[56:57], v225 offset:24576
    ds_read_b64_tr_b16 v[58:59], v225 offset:25088
    s_waitcnt lgkmcnt(10)
    v_mfma_f32_32x32x16_bf16 v[16:31], v[76:79], v[72:75], v[16:31]
    ds_read_b128 v[60:63], v209 offset:24576
    ds_read_b64_tr_b16 v[64:65], v224 offset:26624
    ds_read_b64_tr_b16 v[66:67], v224 offset:27136
    v_mfma_f32_32x32x16_bf16 v[32:47], v[80:83], v[72:75], v[32:47]
    ds_read_b64_tr_b16 v[68:69], v225 offset:26624
    ds_read_b64_tr_b16 v[70:71], v225 offset:27136
    s_waitcnt lgkmcnt(10)
    v_mfma_f32_32x32x16_bf16 v[16:31], v[88:91], v[84:87], v[16:31]
    ds_read_b128 v[72:75], v210 offset:24576
    ds_read_b64_tr_b16 v[76:77], v224 offset:28672
    ds_read_b64_tr_b16 v[78:79], v224 offset:29184
    v_mfma_f32_32x32x16_bf16 v[32:47], v[92:95], v[84:87], v[32:47]
    ds_read_b64_tr_b16 v[80:81], v225 offset:28672
    ds_read_b64_tr_b16 v[82:83], v225 offset:29184
    s_waitcnt lgkmcnt(10)
    v_mfma_f32_32x32x16_bf16 v[16:31], v[52:55], v[48:51], v[16:31]
    ds_read_b128 v[84:87], v211 offset:24576
    ds_read_b64_tr_b16 v[88:89], v224 offset:30720
    ds_read_b64_tr_b16 v[90:91], v224 offset:31232
    v_mfma_f32_32x32x16_bf16 v[32:47], v[56:59], v[48:51], v[32:47]
    ds_read_b64_tr_b16 v[92:93], v225 offset:30720
    ds_read_b64_tr_b16 v[94:95], v225 offset:31232
    s_waitcnt lgkmcnt(10)
    s_barrier
    v_mfma_f32_32x32x16_bf16 v[16:31], v[64:67], v[60:63], v[16:31]
    ds_read_b128 v[48:51], v208 offset:49152
    ds_read_b64_tr_b16 v[52:53], v224 offset:49152
    ds_read_b64_tr_b16 v[54:55], v224 offset:49664
    v_mfma_f32_32x32x16_bf16 v[32:47], v[68:71], v[60:63], v[32:47]
    ds_read_b64_tr_b16 v[56:57], v225 offset:49152
    ds_read_b64_tr_b16 v[58:59], v225 offset:49664
    s_waitcnt lgkmcnt(10)
    v_mfma_f32_32x32x16_bf16 v[16:31], v[76:79], v[72:75], v[16:31]
    ds_read_b128 v[60:63], v209 offset:49152
    ds_read_b64_tr_b16 v[64:65], v224 offset:51200
    ds_read_b64_tr_b16 v[66:67], v224 offset:51712
    v_mfma_f32_32x32x16_bf16 v[32:47], v[80:83], v[72:75], v[32:47]
    ds_read_b64_tr_b16 v[68:69], v225 offset:51200
    ds_read_b64_tr_b16 v[70:71], v225 offset:51712
    s_waitcnt lgkmcnt(10)
    v_mfma_f32_32x32x16_bf16 v[16:31], v[88:91], v[84:87], v[16:31]
    ds_read_b128 v[72:75], v210 offset:49152
    ds_read_b64_tr_b16 v[76:77], v224 offset:53248
    ds_read_b64_tr_b16 v[78:79], v224 offset:53760
    v_mfma_f32_32x32x16_bf16 v[32:47], v[92:95], v[84:87], v[32:47]
    ds_read_b64_tr_b16 v[80:81], v225 offset:53248
    ds_read_b64_tr_b16 v[82:83], v225 offset:53760
    s_waitcnt lgkmcnt(10)
    v_mfma_f32_32x32x16_bf16 v[16:31], v[52:55], v[48:51], v[16:31]
    ds_read_b128 v[84:87], v211 offset:49152
    ds_read_b64_tr_b16 v[88:89], v224 offset:55296
    ds_read_b64_tr_b16 v[90:91], v224 offset:55808
    v_mfma_f32_32x32x16_bf16 v[32:47], v[56:59], v[48:51], v[32:47]
    ds_read_b64_tr_b16 v[92:93], v225 offset:55296
    ds_read_b64_tr_b16 v[94:95], v225 offset:55808
    s_waitcnt lgkmcnt(10)
    s_barrier
    v_mfma_f32_32x32x16_bf16 v[16:31], v[64:67], v[60:63], v[16:31]
    ds_read_b128 v[48:51], v212 offset:0
    ds_read_b64_tr_b16 v[52:53], v226 offset:0
    ds_read_b64_tr_b16 v[54:55], v226 offset:512
    v_mfma_f32_32x32x16_bf16 v[32:47], v[68:71], v[60:63], v[32:47]
    ds_read_b64_tr_b16 v[56:57], v227 offset:0
    ds_read_b64_tr_b16 v[58:59], v227 offset:512
    s_waitcnt lgkmcnt(10)
    v_mfma_f32_32x32x16_bf16 v[16:31], v[76:79], v[72:75], v[16:31]
    ds_read_b128 v[60:63], v213 offset:0
    ds_read_b64_tr_b16 v[64:65], v226 offset:2048
    ds_read_b64_tr_b16 v[66:67], v226 offset:2560
    v_mfma_f32_32x32x16_bf16 v[32:47], v[80:83], v[72:75], v[32:47]
    ds_read_b64_tr_b16 v[68:69], v227 offset:2048
    ds_read_b64_tr_b16 v[70:71], v227 offset:2560
    s_waitcnt lgkmcnt(10)
    v_mfma_f32_32x32x16_bf16 v[16:31], v[88:91], v[84:87], v[16:31]
    ds_read_b128 v[72:75], v214 offset:0
    ds_read_b64_tr_b16 v[76:77], v226 offset:4096
    ds_read_b64_tr_b16 v[78:79], v226 offset:4608
    v_mfma_f32_32x32x16_bf16 v[32:47], v[92:95], v[84:87], v[32:47]
    ds_read_b64_tr_b16 v[80:81], v227 offset:4096
    ds_read_b64_tr_b16 v[82:83], v227 offset:4608
    s_waitcnt lgkmcnt(10)
    v_mfma_f32_32x32x16_bf16 v[16:31], v[52:55], v[48:51], v[16:31]
    ds_read_b128 v[84:87], v215 offset:0
    ds_read_b64_tr_b16 v[88:89], v226 offset:6144
    ds_read_b64_tr_b16 v[90:91], v226 offset:6656
    v_mfma_f32_32x32x16_bf16 v[32:47], v[56:59], v[48:51], v[32:47]
    ds_read_b64_tr_b16 v[92:93], v227 offset:6144
    ds_read_b64_tr_b16 v[94:95], v227 offset:6656
    s_waitcnt lgkmcnt(10)
    s_barrier
    v_mfma_f32_32x32x16_bf16 v[16:31], v[64:67], v[60:63], v[16:31]
    ds_read_b128 v[48:51], v212 offset:24576
    ds_read_b64_tr_b16 v[52:53], v226 offset:24576
    ds_read_b64_tr_b16 v[54:55], v226 offset:25088
    v_mfma_f32_32x32x16_bf16 v[32:47], v[68:71], v[60:63], v[32:47]
    ds_read_b64_tr_b16 v[56:57], v227 offset:24576
    ds_read_b64_tr_b16 v[58:59], v227 offset:25088
    s_waitcnt lgkmcnt(10)
    v_mfma_f32_32x32x16_bf16 v[16:31], v[76:79], v[72:75], v[16:31]
    ds_read_b128 v[60:63], v213 offset:24576
    ds_read_b64_tr_b16 v[64:65], v226 offset:26624
    ds_read_b64_tr_b16 v[66:67], v226 offset:27136
    v_mfma_f32_32x32x16_bf16 v[32:47], v[80:83], v[72:75], v[32:47]
    ds_read_b64_tr_b16 v[68:69], v227 offset:26624
    ds_read_b64_tr_b16 v[70:71], v227 offset:27136
    s_waitcnt lgkmcnt(10)
    v_mfma_f32_32x32x16_bf16 v[16:31], v[88:91], v[84:87], v[16:31]
    ds_read_b128 v[72:75], v214 offset:24576
    ds_read_b64_tr_b16 v[76:77], v226 offset:28672
    ds_read_b64_tr_b16 v[78:79], v226 offset:29184
    v_mfma_f32_32x32x16_bf16 v[32:47], v[92:95], v[84:87], v[32:47]
    ds_read_b64_tr_b16 v[80:81], v227 offset:28672
    ds_read_b64_tr_b16 v[82:83], v227 offset:29184
    s_waitcnt lgkmcnt(10)
    v_mfma_f32_32x32x16_bf16 v[16:31], v[52:55], v[48:51], v[16:31]
    ds_read_b128 v[84:87], v215 offset:24576
    ds_read_b64_tr_b16 v[88:89], v226 offset:30720
    ds_read_b64_tr_b16 v[90:91], v226 offset:31232
    v_mfma_f32_32x32x16_bf16 v[32:47], v[56:59], v[48:51], v[32:47]
    ds_read_b64_tr_b16 v[92:93], v227 offset:30720
    ds_read_b64_tr_b16 v[94:95], v227 offset:31232
    s_waitcnt lgkmcnt(10)
    s_barrier
    v_mfma_f32_32x32x16_bf16 v[16:31], v[64:67], v[60:63], v[16:31]
    ds_read_b128 v[48:51], v212 offset:49152
    ds_read_b64_tr_b16 v[52:53], v226 offset:49152
    ds_read_b64_tr_b16 v[54:55], v226 offset:49664
    v_mfma_f32_32x32x16_bf16 v[32:47], v[68:71], v[60:63], v[32:47]
    ds_read_b64_tr_b16 v[56:57], v227 offset:49152
    ds_read_b64_tr_b16 v[58:59], v227 offset:49664
    s_waitcnt lgkmcnt(10)
    v_mfma_f32_32x32x16_bf16 v[16:31], v[76:79], v[72:75], v[16:31]
    ds_read_b128 v[60:63], v213 offset:49152
    ds_read_b64_tr_b16 v[64:65], v226 offset:51200
    ds_read_b64_tr_b16 v[66:67], v226 offset:51712
    v_mfma_f32_32x32x16_bf16 v[32:47], v[80:83], v[72:75], v[32:47]
    ds_read_b64_tr_b16 v[68:69], v227 offset:51200
    ds_read_b64_tr_b16 v[70:71], v227 offset:51712
    s_waitcnt lgkmcnt(10)
    v_mfma_f32_32x32x16_bf16 v[16:31], v[88:91], v[84:87], v[16:31]
    ds_read_b128 v[72:75], v214 offset:49152
    ds_read_b64_tr_b16 v[76:77], v226 offset:53248
    ds_read_b64_tr_b16 v[78:79], v226 offset:53760
    v_mfma_f32_32x32x16_bf16 v[32:47], v[92:95], v[84:87], v[32:47]
    ds_read_b64_tr_b16 v[80:81], v227 offset:53248
    ds_read_b64_tr_b16 v[82:83], v227 offset:53760
    s_waitcnt lgkmcnt(10)
    v_mfma_f32_32x32x16_bf16 v[16:31], v[52:55], v[48:51], v[16:31]
    ds_read_b128 v[84:87], v215 offset:49152
    ds_read_b64_tr_b16 v[88:89], v226 offset:55296
    ds_read_b64_tr_b16 v[90:91], v226 offset:55808
    v_mfma_f32_32x32x16_bf16 v[32:47], v[56:59], v[48:51], v[32:47]
    ds_read_b64_tr_b16 v[92:93], v227 offset:55296
    ds_read_b64_tr_b16 v[94:95], v227 offset:55808
    s_waitcnt lgkmcnt(10)
    s_barrier
    v_mfma_f32_32x32x16_bf16 v[16:31], v[64:67], v[60:63], v[16:31]
    ds_read_b128 v[48:51], v208 offset:0
    ds_read_b64_tr_b16 v[52:53], v224 offset:0
    ds_read_b64_tr_b16 v[54:55], v224 offset:512
    v_mfma_f32_32x32x16_bf16 v[32:47], v[68:71], v[60:63], v[32:47]
    ds_read_b64_tr_b16 v[56:57], v225 offset:0
    ds_read_b64_tr_b16 v[58:59], v225 offset:512
    s_waitcnt lgkmcnt(10)
    v_mfma_f32_32x32x16_bf16 v[16:31], v[76:79], v[72:75], v[16:31]
    ds_read_b128 v[60:63], v209 offset:0
    ds_read_b64_tr_b16 v[64:65], v224 offset:2048
    ds_read_b64_tr_b16 v[66:67], v224 offset:2560
    v_mfma_f32_32x32x16_bf16 v[32:47], v[80:83], v[72:75], v[32:47]
    ds_read_b64_tr_b16 v[68:69], v225 offset:2048
    ds_read_b64_tr_b16 v[70:71], v225 offset:2560
    s_waitcnt lgkmcnt(10)
    v_mfma_f32_32x32x16_bf16 v[16:31], v[88:91], v[84:87], v[16:31]
    ds_read_b128 v[72:75], v210 offset:0
    ds_read_b64_tr_b16 v[76:77], v224 offset:4096
    ds_read_b64_tr_b16 v[78:79], v224 offset:4608
    v_mfma_f32_32x32x16_bf16 v[32:47], v[92:95], v[84:87], v[32:47]
    ds_read_b64_tr_b16 v[80:81], v225 offset:4096
    ds_read_b64_tr_b16 v[82:83], v225 offset:4608
    s_waitcnt lgkmcnt(10)
    v_mfma_f32_32x32x16_bf16 v[16:31], v[52:55], v[48:51], v[16:31]
    ds_read_b128 v[84:87], v211 offset:0
    ds_read_b64_tr_b16 v[88:89], v224 offset:6144
    ds_read_b64_tr_b16 v[90:91], v224 offset:6656
    v_mfma_f32_32x32x16_bf16 v[32:47], v[56:59], v[48:51], v[32:47]
    ds_read_b64_tr_b16 v[92:93], v225 offset:6144
    ds_read_b64_tr_b16 v[94:95], v225 offset:6656
    s_waitcnt lgkmcnt(10)
    s_barrier
    v_mfma_f32_32x32x16_bf16 v[16:31], v[64:67], v[60:63], v[16:31]
    ds_read_b128 v[48:51], v208 offset:24576
    ds_read_b64_tr_b16 v[52:53], v224 offset:24576
    ds_read_b64_tr_b16 v[54:55], v224 offset:25088
    v_mfma_f32_32x32x16_bf16 v[32:47], v[68:71], v[60:63], v[32:47]
    ds_read_b64_tr_b16 v[56:57], v225 offset:24576
    ds_read_b64_tr_b16 v[58:59], v225 offset:25088
    s_waitcnt lgkmcnt(10)
    v_mfma_f32_32x32x16_bf16 v[16:31], v[76:79], v[72:75], v[16:31]
    ds_read_b128 v[60:63], v209 offset:24576
    ds_read_b64_tr_b16 v[64:65], v224 offset:26624
    ds_read_b64_tr_b16 v[66:67], v224 offset:27136
    v_mfma_f32_32x32x16_bf16 v[32:47], v[80:83], v[72:75], v[32:47]
    ds_read_b64_tr_b16 v[68:69], v225 offset:26624
    ds_read_b64_tr_b16 v[70:71], v225 offset:27136
    s_waitcnt lgkmcnt(10)
    v_mfma_f32_32x32x16_bf16 v[16:31], v[88:91], v[84:87], v[16:31]
    ds_read_b128 v[72:75], v210 offset:24576
    ds_read_b64_tr_b16 v[76:77], v224 offset:28672
    ds_read_b64_tr_b16 v[78:79], v224 offset:29184
    v_mfma_f32_32x32x16_bf16 v[32:47], v[92:95], v[84:87], v[32:47]
    ds_read_b64_tr_b16 v[80:81], v225 offset:28672
    ds_read_b64_tr_b16 v[82:83], v225 offset:29184
    s_waitcnt lgkmcnt(10)
    v_mfma_f32_32x32x16_bf16 v[16:31], v[52:55], v[48:51], v[16:31]
    ds_read_b128 v[84:87], v211 offset:24576
    ds_read_b64_tr_b16 v[88:89], v224 offset:30720
    ds_read_b64_tr_b16 v[90:91], v224 offset:31232
    v_mfma_f32_32x32x16_bf16 v[32:47], v[56:59], v[48:51], v[32:47]
    ds_read_b64_tr_b16 v[92:93], v225 offset:30720
    ds_read_b64_tr_b16 v[94:95], v225 offset:31232
    s_waitcnt lgkmcnt(10)
    s_barrier
    v_mfma_f32_32x32x16_bf16 v[16:31], v[64:67], v[60:63], v[16:31]
    ds_read_b128 v[48:51], v208 offset:49152
    ds_read_b64_tr_b16 v[52:53], v224 offset:49152
    ds_read_b64_tr_b16 v[54:55], v224 offset:49664
    v_mfma_f32_32x32x16_bf16 v[32:47], v[68:71], v[60:63], v[32:47]
    ds_read_b64_tr_b16 v[56:57], v225 offset:49152
    ds_read_b64_tr_b16 v[58:59], v225 offset:49664
    s_waitcnt lgkmcnt(10)
    v_mfma_f32_32x32x16_bf16 v[16:31], v[76:79], v[72:75], v[16:31]
    ds_read_b128 v[60:63], v209 offset:49152
    ds_read_b64_tr_b16 v[64:65], v224 offset:51200
    ds_read_b64_tr_b16 v[66:67], v224 offset:51712
    v_mfma_f32_32x32x16_bf16 v[32:47], v[80:83], v[72:75], v[32:47]
    ds_read_b64_tr_b16 v[68:69], v225 offset:51200
    ds_read_b64_tr_b16 v[70:71], v225 offset:51712
    s_waitcnt lgkmcnt(10)
    v_mfma_f32_32x32x16_bf16 v[16:31], v[88:91], v[84:87], v[16:31]
    ds_read_b128 v[72:75], v210 offset:49152
    ds_read_b64_tr_b16 v[76:77], v224 offset:53248
    ds_read_b64_tr_b16 v[78:79], v224 offset:53760
    v_mfma_f32_32x32x16_bf16 v[32:47], v[92:95], v[84:87], v[32:47]
    ds_read_b64_tr_b16 v[80:81], v225 offset:53248
    ds_read_b64_tr_b16 v[82:83], v225 offset:53760
    s_waitcnt lgkmcnt(10)
    v_mfma_f32_32x32x16_bf16 v[16:31], v[52:55], v[48:51], v[16:31]
    ds_read_b128 v[84:87], v211 offset:49152
    ds_read_b64_tr_b16 v[88:89], v224 offset:55296
    ds_read_b64_tr_b16 v[90:91], v224 offset:55808
    v_mfma_f32_32x32x16_bf16 v[32:47], v[56:59], v[48:51], v[32:47]
    ds_read_b64_tr_b16 v[92:93], v225 offset:55296
    ds_read_b64_tr_b16 v[94:95], v225 offset:55808
    s_waitcnt lgkmcnt(10)
    s_barrier
    v_mfma_f32_32x32x16_bf16 v[16:31], v[64:67], v[60:63], v[16:31]
    ds_read_b128 v[48:51], v212 offset:0
    ds_read_b64_tr_b16 v[52:53], v226 offset:0
    ds_read_b64_tr_b16 v[54:55], v226 offset:512
    v_mfma_f32_32x32x16_bf16 v[32:47], v[68:71], v[60:63], v[32:47]
    ds_read_b64_tr_b16 v[56:57], v227 offset:0
    ds_read_b64_tr_b16 v[58:59], v227 offset:512
    s_waitcnt lgkmcnt(10)
    v_mfma_f32_32x32x16_bf16 v[16:31], v[76:79], v[72:75], v[16:31]
    ds_read_b128 v[60:63], v213 offset:0
    ds_read_b64_tr_b16 v[64:65], v226 offset:2048
    ds_read_b64_tr_b16 v[66:67], v226 offset:2560
    v_mfma_f32_32x32x16_bf16 v[32:47], v[80:83], v[72:75], v[32:47]
    ds_read_b64_tr_b16 v[68:69], v227 offset:2048
    ds_read_b64_tr_b16 v[70:71], v227 offset:2560
    s_waitcnt lgkmcnt(10)
    v_mfma_f32_32x32x16_bf16 v[16:31], v[88:91], v[84:87], v[16:31]
    ds_read_b128 v[72:75], v214 offset:0
    ds_read_b64_tr_b16 v[76:77], v226 offset:4096
    ds_read_b64_tr_b16 v[78:79], v226 offset:4608
    v_mfma_f32_32x32x16_bf16 v[32:47], v[92:95], v[84:87], v[32:47]
    ds_read_b64_tr_b16 v[80:81], v227 offset:4096
    ds_read_b64_tr_b16 v[82:83], v227 offset:4608
    s_waitcnt lgkmcnt(10)
    v_mfma_f32_32x32x16_bf16 v[16:31], v[52:55], v[48:51], v[16:31]
    ds_read_b128 v[84:87], v215 offset:0
    ds_read_b64_tr_b16 v[88:89], v226 offset:6144
    ds_read_b64_tr_b16 v[90:91], v226 offset:6656
    v_mfma_f32_32x32x16_bf16 v[32:47], v[56:59], v[48:51], v[32:47]
    ds_read_b64_tr_b16 v[92:93], v227 offset:6144
    ds_read_b64_tr_b16 v[94:95], v227 offset:6656
    s_waitcnt lgkmcnt(10)
    s_barrier
    v_mfma_f32_32x32x16_bf16 v[16:31], v[64:67], v[60:63], v[16:31]
    ds_read_b128 v[48:51], v212 offset:24576
    ds_read_b64_tr_b16 v[52:53], v226 offset:24576
    ds_read_b64_tr_b16 v[54:55], v226 offset:25088
    v_mfma_f32_32x32x16_bf16 v[32:47], v[68:71], v[60:63], v[32:47]
    ds_read_b64_tr_b16 v[56:57], v227 offset:24576
    ds_read_b64_tr_b16 v[58:59], v227 offset:25088
    s_waitcnt lgkmcnt(10)
    v_mfma_f32_32x32x16_bf16 v[16:31], v[76:79], v[72:75], v[16:31]
    ds_read_b128 v[60:63], v213 offset:24576
    ds_read_b64_tr_b16 v[64:65], v226 offset:26624
    ds_read_b64_tr_b16 v[66:67], v226 offset:27136
    v_mfma_f32_32x32x16_bf16 v[32:47], v[80:83], v[72:75], v[32:47]
    ds_read_b64_tr_b16 v[68:69], v227 offset:26624
    ds_read_b64_tr_b16 v[70:71], v227 offset:27136
    s_waitcnt lgkmcnt(10)
    v_mfma_f32_32x32x16_bf16 v[16:31], v[88:91], v[84:87], v[16:31]
    ds_read_b128 v[72:75], v214 offset:24576
    ds_read_b64_tr_b16 v[76:77], v226 offset:28672
    ds_read_b64_tr_b16 v[78:79], v226 offset:29184
    v_mfma_f32_32x32x16_bf16 v[32:47], v[92:95], v[84:87], v[32:47]
    ds_read_b64_tr_b16 v[80:81], v227 offset:28672
    ds_read_b64_tr_b16 v[82:83], v227 offset:29184
    s_waitcnt lgkmcnt(10)
    v_mfma_f32_32x32x16_bf16 v[16:31], v[52:55], v[48:51], v[16:31]
    ds_read_b128 v[84:87], v215 offset:24576
    ds_read_b64_tr_b16 v[88:89], v226 offset:30720
    ds_read_b64_tr_b16 v[90:91], v226 offset:31232
    v_mfma_f32_32x32x16_bf16 v[32:47], v[56:59], v[48:51], v[32:47]
    ds_read_b64_tr_b16 v[92:93], v227 offset:30720
    ds_read_b64_tr_b16 v[94:95], v227 offset:31232
    s_waitcnt lgkmcnt(10)
    s_barrier
    v_mfma_f32_32x32x16_bf16 v[16:31], v[64:67], v[60:63], v[16:31]
    ds_read_b128 v[48:51], v212 offset:49152
    ds_read_b64_tr_b16 v[52:53], v226 offset:49152
    ds_read_b64_tr_b16 v[54:55], v226 offset:49664
    v_mfma_f32_32x32x16_bf16 v[32:47], v[68:71], v[60:63], v[32:47]
    ds_read_b64_tr_b16 v[56:57], v227 offset:49152
    ds_read_b64_tr_b16 v[58:59], v227 offset:49664
    s_waitcnt lgkmcnt(10)
    v_mfma_f32_32x32x16_bf16 v[16:31], v[76:79], v[72:75], v[16:31]
    ds_read_b128 v[60:63], v213 offset:49152
    ds_read_b64_tr_b16 v[64:65], v226 offset:51200
    ds_read_b64_tr_b16 v[66:67], v226 offset:51712
    v_mfma_f32_32x32x16_bf16 v[32:47], v[80:83], v[72:75], v[32:47]
    ds_read_b64_tr_b16 v[68:69], v227 offset:51200
    ds_read_b64_tr_b16 v[70:71], v227 offset:51712
    s_waitcnt lgkmcnt(10)
    v_mfma_f32_32x32x16_bf16 v[16:31], v[88:91], v[84:87], v[16:31]
    ds_read_b128 v[72:75], v214 offset:49152
    ds_read_b64_tr_b16 v[76:77], v226 offset:53248
    ds_read_b64_tr_b16 v[78:79], v226 offset:53760
    v_mfma_f32_32x32x16_bf16 v[32:47], v[92:95], v[84:87], v[32:47]
    ds_read_b64_tr_b16 v[80:81], v227 offset:53248
    ds_read_b64_tr_b16 v[82:83], v227 offset:53760
    s_waitcnt lgkmcnt(10)
    v_mfma_f32_32x32x16_bf16 v[16:31], v[52:55], v[48:51], v[16:31]
    ds_read_b128 v[84:87], v215 offset:49152
    ds_read_b64_tr_b16 v[88:89], v226 offset:55296
    ds_read_b64_tr_b16 v[90:91], v226 offset:55808
    v_mfma_f32_32x32x16_bf16 v[32:47], v[56:59], v[48:51], v[32:47]
    ds_read_b64_tr_b16 v[92:93], v227 offset:55296
    ds_read_b64_tr_b16 v[94:95], v227 offset:55808
    s_waitcnt lgkmcnt(10)
    s_barrier
    v_mfma_f32_32x32x16_bf16 v[16:31], v[64:67], v[60:63], v[16:31]
    ds_read_b128 v[48:51], v208 offset:0
    ds_read_b64_tr_b16 v[52:53], v224 offset:0
    ds_read_b64_tr_b16 v[54:55], v224 offset:512
    v_mfma_f32_32x32x16_bf16 v[32:47], v[68:71], v[60:63], v[32:47]
    ds_read_b64_tr_b16 v[56:57], v225 offset:0
    ds_read_b64_tr_b16 v[58:59], v225 offset:512
    s_waitcnt lgkmcnt(10)
    v_mfma_f32_32x32x16_bf16 v[16:31], v[76:79], v[72:75], v[16:31]
    ds_read_b128 v[60:63], v209 offset:0
    ds_read_b64_tr_b16 v[64:65], v224 offset:2048
    ds_read_b64_tr_b16 v[66:67], v224 offset:2560
    v_mfma_f32_32x32x16_bf16 v[32:47], v[80:83], v[72:75], v[32:47]
    ds_read_b64_tr_b16 v[68:69], v225 offset:2048
    ds_read_b64_tr_b16 v[70:71], v225 offset:2560
    s_waitcnt lgkmcnt(10)
    v_mfma_f32_32x32x16_bf16 v[16:31], v[88:91], v[84:87], v[16:31]
    ds_read_b128 v[72:75], v210 offset:0
    ds_read_b64_tr_b16 v[76:77], v224 offset:4096
    ds_read_b64_tr_b16 v[78:79], v224 offset:4608
    v_mfma_f32_32x32x16_bf16 v[32:47], v[92:95], v[84:87], v[32:47]
    ds_read_b64_tr_b16 v[80:81], v225 offset:4096
    ds_read_b64_tr_b16 v[82:83], v225 offset:4608
    s_waitcnt lgkmcnt(10)
    v_mfma_f32_32x32x16_bf16 v[16:31], v[52:55], v[48:51], v[16:31]
    ds_read_b128 v[84:87], v211 offset:0
    ds_read_b64_tr_b16 v[88:89], v224 offset:6144
    ds_read_b64_tr_b16 v[90:91], v224 offset:6656
    v_mfma_f32_32x32x16_bf16 v[32:47], v[56:59], v[48:51], v[32:47]
    ds_read_b64_tr_b16 v[92:93], v225 offset:6144
    ds_read_b64_tr_b16 v[94:95], v225 offset:6656
    s_waitcnt lgkmcnt(10)
    s_barrier
    v_mfma_f32_32x32x16_bf16 v[16:31], v[64:67], v[60:63], v[16:31]
    ds_read_b128 v[48:51], v208 offset:24576
    ds_read_b64_tr_b16 v[52:53], v224 offset:24576
    ds_read_b64_tr_b16 v[54:55], v224 offset:25088
    v_mfma_f32_32x32x16_bf16 v[32:47], v[68:71], v[60:63], v[32:47]
    ds_read_b64_tr_b16 v[56:57], v225 offset:24576
    ds_read_b64_tr_b16 v[58:59], v225 offset:25088
    s_waitcnt lgkmcnt(10)
    v_mfma_f32_32x32x16_bf16 v[16:31], v[76:79], v[72:75], v[16:31]
    ds_read_b128 v[60:63], v209 offset:24576
    ds_read_b64_tr_b16 v[64:65], v224 offset:26624
    ds_read_b64_tr_b16 v[66:67], v224 offset:27136
    v_mfma_f32_32x32x16_bf16 v[32:47], v[80:83], v[72:75], v[32:47]
    ds_read_b64_tr_b16 v[68:69], v225 offset:26624
    ds_read_b64_tr_b16 v[70:71], v225 offset:27136
    s_waitcnt lgkmcnt(10)
    v_mfma_f32_32x32x16_bf16 v[16:31], v[88:91], v[84:87], v[16:31]
    ds_read_b128 v[72:75], v210 offset:24576
    ds_read_b64_tr_b16 v[76:77], v224 offset:28672
    ds_read_b64_tr_b16 v[78:79], v224 offset:29184
    v_mfma_f32_32x32x16_bf16 v[32:47], v[92:95], v[84:87], v[32:47]
    ds_read_b64_tr_b16 v[80:81], v225 offset:28672
    ds_read_b64_tr_b16 v[82:83], v225 offset:29184
    s_waitcnt lgkmcnt(10)
    v_mfma_f32_32x32x16_bf16 v[16:31], v[52:55], v[48:51], v[16:31]
    ds_read_b128 v[84:87], v211 offset:24576
    ds_read_b64_tr_b16 v[88:89], v224 offset:30720
    ds_read_b64_tr_b16 v[90:91], v224 offset:31232
    v_mfma_f32_32x32x16_bf16 v[32:47], v[56:59], v[48:51], v[32:47]
    ds_read_b64_tr_b16 v[92:93], v225 offset:30720
    ds_read_b64_tr_b16 v[94:95], v225 offset:31232
    s_waitcnt lgkmcnt(10)
    s_barrier
    v_mfma_f32_32x32x16_bf16 v[16:31], v[64:67], v[60:63], v[16:31]
    ds_read_b128 v[48:51], v208 offset:49152
    ds_read_b64_tr_b16 v[52:53], v224 offset:49152
    ds_read_b64_tr_b16 v[54:55], v224 offset:49664
    v_mfma_f32_32x32x16_bf16 v[32:47], v[68:71], v[60:63], v[32:47]
    ds_read_b64_tr_b16 v[56:57], v225 offset:49152
    ds_read_b64_tr_b16 v[58:59], v225 offset:49664
    s_waitcnt lgkmcnt(10)
    v_mfma_f32_32x32x16_bf16 v[16:31], v[76:79], v[72:75], v[16:31]
    ds_read_b128 v[60:63], v209 offset:49152
    ds_read_b64_tr_b16 v[64:65], v224 offset:51200
    ds_read_b64_tr_b16 v[66:67], v224 offset:51712
    v_mfma_f32_32x32x16_bf16 v[32:47], v[80:83], v[72:75], v[32:47]
    ds_read_b64_tr_b16 v[68:69], v225 offset:51200
    ds_read_b64_tr_b16 v[70:71], v225 offset:51712
    s_waitcnt lgkmcnt(10)
    v_mfma_f32_32x32x16_bf16 v[16:31], v[88:91], v[84:87], v[16:31]
    ds_read_b128 v[72:75], v210 offset:49152
    ds_read_b64_tr_b16 v[76:77], v224 offset:53248
    ds_read_b64_tr_b16 v[78:79], v224 offset:53760
    v_mfma_f32_32x32x16_bf16 v[32:47], v[92:95], v[84:87], v[32:47]
    ds_read_b64_tr_b16 v[80:81], v225 offset:53248
    ds_read_b64_tr_b16 v[82:83], v225 offset:53760
    s_waitcnt lgkmcnt(10)
    v_mfma_f32_32x32x16_bf16 v[16:31], v[52:55], v[48:51], v[16:31]
    ds_read_b128 v[84:87], v211 offset:49152
    ds_read_b64_tr_b16 v[88:89], v224 offset:55296
    ds_read_b64_tr_b16 v[90:91], v224 offset:55808
    v_mfma_f32_32x32x16_bf16 v[32:47], v[56:59], v[48:51], v[32:47]
    ds_read_b64_tr_b16 v[92:93], v225 offset:55296
    ds_read_b64_tr_b16 v[94:95], v225 offset:55808
    s_waitcnt lgkmcnt(10)
    s_barrier
    v_mfma_f32_32x32x16_bf16 v[16:31], v[64:67], v[60:63], v[16:31]
    ds_read_b128 v[48:51], v212 offset:0
    ds_read_b64_tr_b16 v[52:53], v226 offset:0
    ds_read_b64_tr_b16 v[54:55], v226 offset:512
    v_mfma_f32_32x32x16_bf16 v[32:47], v[68:71], v[60:63], v[32:47]
    ds_read_b64_tr_b16 v[56:57], v227 offset:0
    ds_read_b64_tr_b16 v[58:59], v227 offset:512
    s_waitcnt lgkmcnt(10)
    v_mfma_f32_32x32x16_bf16 v[16:31], v[76:79], v[72:75], v[16:31]
    ds_read_b128 v[60:63], v213 offset:0
    ds_read_b64_tr_b16 v[64:65], v226 offset:2048
    ds_read_b64_tr_b16 v[66:67], v226 offset:2560
    v_mfma_f32_32x32x16_bf16 v[32:47], v[80:83], v[72:75], v[32:47]
    ds_read_b64_tr_b16 v[68:69], v227 offset:2048
    ds_read_b64_tr_b16 v[70:71], v227 offset:2560
    s_waitcnt lgkmcnt(10)
    v_mfma_f32_32x32x16_bf16 v[16:31], v[88:91], v[84:87], v[16:31]
    ds_read_b128 v[72:75], v214 offset:0
    ds_read_b64_tr_b16 v[76:77], v226 offset:4096
    ds_read_b64_tr_b16 v[78:79], v226 offset:4608
    v_mfma_f32_32x32x16_bf16 v[32:47], v[92:95], v[84:87], v[32:47]
    ds_read_b64_tr_b16 v[80:81], v227 offset:4096
    ds_read_b64_tr_b16 v[82:83], v227 offset:4608
    s_waitcnt lgkmcnt(10)
    s_cmp_lg_u32 s3, 0
    s_cbranch_scc1 dw36
    s_add_u32 s84, s40, 34656256
    s_addc_u32 s85, s41, 0
    s_mov_b32 s86, 22528
    s_mov_b32 s87, 0x20000
    s_lshr_b32 s90, s44, 1
    s_add_u32 s90, s90, 128
    s_lshl_b32 s90, s90, 7
    v_lshlrev_b32 v236, 3, v1
    v_add_u32 v236, s90, v236
    v_cmp_eq_u32 vcc, 5, v1
    s_nop 1
    s_and_saveexec_b64 s[88:89], vcc
    s_cbranch_execz pd38
    v_mov_b32 v240, s96
    v_mov_b32 v241, s97
    s_mov_b32 s90, 0
pl37:
    buffer_load_dwordx2 v[238:239], v236, s[84:87], 0 offen sc1
    s_waitcnt vmcnt(0)
    v_sub_co_u32 v238, vcc, v238, v240
    s_nop 1
    v_subb_co_u32 v239, vcc, v239, v241, vcc
    v_cmp_eq_u32 s[92:93], 0, v239
    s_mov_b32 s91, 16777216
    v_cmp_gt_u32 vcc, s91, v238
    s_nop 1
    s_and_b64 vcc, vcc, s[92:93]
    s_cmp_eq_u64 vcc, exec
    s_cbranch_scc1 pd38
    s_add_u32 s90, s90, 1
    s_cmp_lt_u32 s90, 262144
    s_cbranch_scc1 pl37
pd38:
    s_mov_b64 exec, s[88:89]
dw36:
    v_mfma_f32_32x32x16_bf16 v[16:31], v[52:55], v[48:51], v[16:31]
    ds_read_b128 v[84:87], v215 offset:0
    ds_read_b64_tr_b16 v[88:89], v226 offset:6144
    ds_read_b64_tr_b16 v[90:91], v226 offset:6656
    v_mfma_f32_32x32x16_bf16 v[32:47], v[56:59], v[48:51], v[32:47]
    ds_read_b64_tr_b16 v[92:93], v227 offset:6144
    ds_read_b64_tr_b16 v[94:95], v227 offset:6656
    s_waitcnt lgkmcnt(10)
    s_barrier
    v_mfma_f32_32x32x16_bf16 v[16:31], v[64:67], v[60:63], v[16:31]
    ds_read_b128 v[48:51], v212 offset:24576
    ds_read_b64_tr_b16 v[52:53], v226 offset:24576
    ds_read_b64_tr_b16 v[54:55], v226 offset:25088
    v_mfma_f32_32x32x16_bf16 v[32:47], v[68:71], v[60:63], v[32:47]
    ds_read_b64_tr_b16 v[56:57], v227 offset:24576
    ds_read_b64_tr_b16 v[58:59], v227 offset:25088
    s_waitcnt lgkmcnt(10)
    v_mfma_f32_32x32x16_bf16 v[16:31], v[76:79], v[72:75], v[16:31]
    ds_read_b128 v[60:63], v213 offset:24576
    ds_read_b64_tr_b16 v[64:65], v226 offset:26624
    ds_read_b64_tr_b16 v[66:67], v226 offset:27136
    v_mfma_f32_32x32x16_bf16 v[32:47], v[80:83], v[72:75], v[32:47]
    ds_read_b64_tr_b16 v[68:69], v227 offset:26624
    ds_read_b64_tr_b16 v[70:71], v227 offset:27136
    s_waitcnt lgkmcnt(10)
    v_mfma_f32_32x32x16_bf16 v[16:31], v[88:91], v[84:87], v[16:31]
    ds_read_b128 v[72:75], v214 offset:24576
    ds_read_b64_tr_b16 v[76:77], v226 offset:28672
    ds_read_b64_tr_b16 v[78:79], v226 offset:29184
    v_mfma_f32_32x32x16_bf16 v[32:47], v[92:95], v[84:87], v[32:47]
    ds_read_b64_tr_b16 v[80:81], v227 offset:28672
    ds_read_b64_tr_b16 v[82:83], v227 offset:29184
    s_waitcnt lgkmcnt(10)
    v_mfma_f32_32x32x16_bf16 v[16:31], v[52:55], v[48:51], v[16:31]
    ds_read_b128 v[84:87], v215 offset:24576
    ds_read_b64_tr_b16 v[88:89], v226 offset:30720
    ds_read_b64_tr_b16 v[90:91], v226 offset:31232
    v_mfma_f32_32x32x16_bf16 v[32:47], v[56:59], v[48:51], v[32:47]
    ds_read_b64_tr_b16 v[92:93], v227 offset:30720
    ds_read_b64_tr_b16 v[94:95], v227 offset:31232
    s_waitcnt lgkmcnt(10)
    s_barrier
    v_mfma_f32_32x32x16_bf16 v[16:31], v[64:67], v[60:63], v[16:31]
    ds_read_b128 v[48:51], v212 offset:49152
    ds_read_b64_tr_b16 v[52:53], v226 offset:49152
    ds_read_b64_tr_b16 v[54:55], v226 offset:49664
    v_mfma_f32_32x32x16_bf16 v[32:47], v[68:71], v[60:63], v[32:47]
    ds_read_b64_tr_b16 v[56:57], v227 offset:49152
    ds_read_b64_tr_b16 v[58:59], v227 offset:49664
    s_waitcnt lgkmcnt(10)
    v_mfma_f32_32x32x16_bf16 v[16:31], v[76:79], v[72:75], v[16:31]
    ds_read_b128 v[60:63], v213 offset:49152
    ds_read_b64_tr_b16 v[64:65], v226 offset:51200
    ds_read_b64_tr_b16 v[66:67], v226 offset:51712
    v_mfma_f32_32x32x16_bf16 v[32:47], v[80:83], v[72:75], v[32:47]
    ds_read_b64_tr_b16 v[68:69], v227 offset:51200
    ds_read_b64_tr_b16 v[70:71], v227 offset:51712
    s_waitcnt lgkmcnt(10)
    v_mfma_f32_32x32x16_bf16 v[16:31], v[88:91], v[84:87], v[16:31]
    ds_read_b128 v[72:75], v214 offset:49152
    ds_read_b64_tr_b16 v[76:77], v226 offset:53248
    ds_read_b64_tr_b16 v[78:79], v226 offset:53760
    v_mfma_f32_32x32x16_bf16 v[32:47], v[92:95], v[84:87], v[32:47]
    ds_read_b64_tr_b16 v[80:81], v227 offset:53248
    ds_read_b64_tr_b16 v[82:83], v227 offset:53760
    s_waitcnt lgkmcnt(10)
    s_cmp_lg_u32 s3, 0
    s_cbranch_scc1 dw39
    s_add_u32 s84, s40, 34656256
    s_addc_u32 s85, s41, 0
    s_mov_b32 s86, 22528
    s_mov_b32 s87, 0x20000
    s_lshr_b32 s90, s44, 1
    s_add_u32 s90, s90, 128
    s_lshl_b32 s90, s90, 7
    v_lshlrev_b32 v236, 3, v1
    v_add_u32 v236, s90, v236
    v_cmp_eq_u32 vcc, 11, v1
    s_nop 1
    s_and_saveexec_b64 s[88:89], vcc
    s_cbranch_execz pd41
    v_mov_b32 v240, s96
    v_mov_b32 v241, s97
    s_mov_b32 s90, 0
pl40:
    buffer_load_dwordx2 v[238:239], v236, s[84:87], 0 offen sc1
    s_waitcnt vmcnt(0)
    v_sub_co_u32 v238, vcc, v238, v240
    s_nop 1
    v_subb_co_u32 v239, vcc, v239, v241, vcc
    v_cmp_eq_u32 s[92:93], 0, v239
    s_mov_b32 s91, 16777216
    v_cmp_gt_u32 vcc, s91, v238
    s_nop 1
    s_and_b64 vcc, vcc, s[92:93]
    s_cmp_eq_u64 vcc, exec
    s_cbranch_scc1 pd41
    s_add_u32 s90, s90, 1
    s_cmp_lt_u32 s90, 262144
    s_cbranch_scc1 pl40
pd41:
    s_mov_b64 exec, s[88:89]
dw39:
    v_mfma_f32_32x32x16_bf16 v[16:31], v[52:55], v[48:51], v[16:31]
    ds_read_b128 v[84:87], v215 offset:49152
    ds_read_b64_tr_b16 v[88:89], v226 offset:55296
    ds_read_b64_tr_b16 v[90:91], v226 offset:55808
    v_mfma_f32_32x32x16_bf16 v[32:47], v[56:59], v[48:51], v[32:47]
    ds_read_b64_tr_b16 v[92:93], v227 offset:55296
    ds_read_b64_tr_b16 v[94:95], v227 offset:55808
    s_waitcnt lgkmcnt(10)
    s_barrier
    s_add_u32 s56, s40, 13443072
    s_addc_u32 s57, s41, 0
    s_mov_b32 s58, 2621440
    s_mov_b32 s59, 0x20000
    s_mov_b32 s60, s8
    s_mov_b32 s61, s9
    s_mov_b32 s62, 2621440
    s_mov_b32 s63, 0x20000
    s_mov_b32 s64, s40
    s_mov_b32 s65, s41
    s_mov_b32 s66, 2621440
    s_mov_b32 s67, 0x20000
    s_mov_b32 s72, s24
    s_mov_b32 s73, s25
    s_mov_b32 s74, 1280
    s_mov_b32 s75, 0x20000
    v_lshrrev_b32 v10, 5, v1
    s_lshl_b32 s76, s3, 3
    v_add_u32 v10, s76, v10
    v_and_b32 v11, 31, v1
    v_add_u32 v12, 0, v10
    v_mul_u32_u24 v13, 1280, v12
    v_lshl_add_u32 v100, v11, 3, v13
    v_mul_u32_u24 v13, 2560, v12
    v_lshl_add_u32 v104, v11, 4, v13
    v_lshrrev_b32 v13, 1, v11
    v_and_b32 v14, 15, v12
    v_xor_b32 v13, v13, v14
    v_lshlrev_b32 v13, 4, v13
    v_lshl_add_u32 v13, v12, 8, v13
    v_and_b32 v14, 1, v11
    v_lshl_add_u32 v13, v14, 3, v13
    v_add_u32 v108, 49152, v13
    v_add_u32 v12, 2, v10
    v_mul_u32_u24 v13, 1280, v12
    v_lshl_add_u32 v101, v11, 3, v13
    v_mul_u32_u24 v13, 2560, v12
    v_lshl_add_u32 v105, v11, 4, v13
    v_lshrrev_b32 v13, 1, v11
    v_and_b32 v14, 15, v12
    v_xor_b32 v13, v13, v14
    v_lshlrev_b32 v13, 4, v13
    v_lshl_add_u32 v13, v12, 8, v13
    v_and_b32 v14, 1, v11
    v_lshl_add_u32 v13, v14, 3, v13
    v_add_u32 v109, 49152, v13
    v_add_u32 v12, 4, v10
    v_mul_u32_u24 v13, 1280, v12
    v_lshl_add_u32 v102, v11, 3, v13
    v_mul_u32_u24 v13, 2560, v12
    v_lshl_add_u32 v106, v11, 4, v13
    v_lshrrev_b32 v13, 1, v11
    v_and_b32 v14, 15, v12
    v_xor_b32 v13, v13, v14
    v_lshlrev_b32 v13, 4, v13
    v_lshl_add_u32 v13, v12, 8, v13
    v_and_b32 v14, 1, v11
    v_lshl_add_u32 v13, v14, 3, v13
    v_add_u32 v110, 49152, v13
    v_add_u32 v12, 6, v10
    v_mul_u32_u24 v13, 1280, v12
    v_lshl_add_u32 v103, v11, 3, v13
    v_mul_u32_u24 v13, 2560, v12
    v_lshl_add_u32 v107, v11, 4, v13
    v_lshrrev_b32 v13, 1, v11
    v_and_b32 v14, 15, v12
    v_xor_b32 v13, v13, v14
    v_lshlrev_b32 v13, 4, v13
    v_lshl_add_u32 v13, v12, 8, v13
    v_and_b32 v14, 1, v11
    v_lshl_add_u32 v13, v14, 3, v13
    v_add_u32 v111, 49152, v13
    s_mul_i32 s80, s44, 81920
    s_lshl_b32 s77, s45, 8
    s_add_u32 s80, s80, s77
    s_lshl_b32 s81, s80, 1
    buffer_load_dwordx2 v[128:129], v100, s[56:59], s80 offen
    buffer_load_dwordx2 v[136:137], v100, s[60:63], s80 offen
    buffer_load_dwordx2 v[144:145], v100, s[64:67], s80 offen
    buffer_load_dwordx2 v[130:131], v101, s[56:59], s80 offen
    buffer_load_dwordx2 v[138:139], v101, s[60:63], s80 offen
    buffer_load_dwordx2 v[146:147], v101, s[64:67], s80 offen
    buffer_load_dwordx2 v[132:133], v102, s[56:59], s80 offen
    buffer_load_dwordx2 v[140:141], v102, s[60:63], s80 offen
    buffer_load_dwordx2 v[148:149], v102, s[64:67], s80 offen
    buffer_load_dwordx2 v[134:135], v103, s[56:59], s80 offen
    buffer_load_dwordx2 v[142:143], v103, s[60:63], s80 offen
    buffer_load_dwordx2 v[150:151], v103, s[64:67], s80 offen
    v_lshlrev_b32 v12, 3, v11
    buffer_load_dwordx2 v[168:169], v12, s[72:75], s77 offen
    v_mfma_f32_32x32x16_bf16 v[16:31], v[64:67], v[60:63], v[16:31]
    ds_read_b128 v[48:51], v208 offset:0
    ds_read_b64_tr_b16 v[52:53], v224 offset:0
    ds_read_b64_tr_b16 v[54:55], v224 offset:512
    v_mfma_f32_32x32x16_bf16 v[32:47], v[68:71], v[60:63], v[32:47]
    ds_read_b64_tr_b16 v[56:57], v225 offset:0
    ds_read_b64_tr_b16 v[58:59], v225 offset:512
    s_waitcnt lgkmcnt(10)
    v_mfma_f32_32x32x16_bf16 v[16:31], v[76:79], v[72:75], v[16:31]
    ds_read_b128 v[60:63], v209 offset:0
    ds_read_b64_tr_b16 v[64:65], v224 offset:2048
    ds_read_b64_tr_b16 v[66:67], v224 offset:2560
    v_mfma_f32_32x32x16_bf16 v[32:47], v[80:83], v[72:75], v[32:47]
    ds_read_b64_tr_b16 v[68:69], v225 offset:2048
    ds_read_b64_tr_b16 v[70:71], v225 offset:2560
    s_waitcnt lgkmcnt(10)
    v_mfma_f32_32x32x16_bf16 v[16:31], v[88:91], v[84:87], v[16:31]
    ds_read_b128 v[72:75], v210 offset:0
    ds_read_b64_tr_b16 v[76:77], v224 offset:4096
    ds_read_b64_tr_b16 v[78:79], v224 offset:4608
    v_mfma_f32_32x32x16_bf16 v[32:47], v[92:95], v[84:87], v[32:47]
    ds_read_b64_tr_b16 v[80:81], v225 offset:4096
    ds_read_b64_tr_b16 v[82:83], v225 offset:4608
    s_waitcnt lgkmcnt(10)
    v_mfma_f32_32x32x16_bf16 v[16:31], v[52:55], v[48:51], v[16:31]
    ds_read_b128 v[84:87], v211 offset:0
    ds_read_b64_tr_b16 v[88:89], v224 offset:6144
    ds_read_b64_tr_b16 v[90:91], v224 offset:6656
    v_mfma_f32_32x32x16_bf16 v[32:47], v[56:59], v[48:51], v[32:47]
    ds_read_b64_tr_b16 v[92:93], v225 offset:6144
    ds_read_b64_tr_b16 v[94:95], v225 offset:6656
    s_waitcnt lgkmcnt(10)
    s_barrier
    v_mfma_f32_32x32x16_bf16 v[16:31], v[64:67], v[60:63], v[16:31]
    ds_read_b128 v[48:51], v208 offset:24576
    ds_read_b64_tr_b16 v[52:53], v224 offset:24576
    ds_read_b64_tr_b16 v[54:55], v224 offset:25088
    v_mfma_f32_32x32x16_bf16 v[32:47], v[68:71], v[60:63], v[32:47]
    ds_read_b64_tr_b16 v[56:57], v225 offset:24576
    ds_read_b64_tr_b16 v[58:59], v225 offset:25088
    s_waitcnt lgkmcnt(10)
    v_mfma_f32_32x32x16_bf16 v[16:31], v[76:79], v[72:75], v[16:31]
    ds_read_b128 v[60:63], v209 offset:24576
    ds_read_b64_tr_b16 v[64:65], v224 offset:26624
    ds_read_b64_tr_b16 v[66:67], v224 offset:27136
    v_mfma_f32_32x32x16_bf16 v[32:47], v[80:83], v[72:75], v[32:47]
    ds_read_b64_tr_b16 v[68:69], v225 offset:26624
    ds_read_b64_tr_b16 v[70:71], v225 offset:27136
    s_waitcnt lgkmcnt(10)
    v_mfma_f32_32x32x16_bf16 v[16:31], v[88:91], v[84:87], v[16:31]
    ds_read_b128 v[72:75], v210 offset:24576
    ds_read_b64_tr_b16 v[76:77], v224 offset:28672
    ds_read_b64_tr_b16 v[78:79], v224 offset:29184
    v_mfma_f32_32x32x16_bf16 v[32:47], v[92:95], v[84:87], v[32:47]
    ds_read_b64_tr_b16 v[80:81], v225 offset:28672
    ds_read_b64_tr_b16 v[82:83], v225 offset:29184
    s_waitcnt lgkmcnt(10)
    v_mfma_f32_32x32x16_bf16 v[16:31], v[52:55], v[48:51], v[16:31]
    ds_read_b128 v[84:87], v211 offset:24576
    ds_read_b64_tr_b16 v[88:89], v224 offset:30720
    ds_read_b64_tr_b16 v[90:91], v224 offset:31232
    v_mfma_f32_32x32x16_bf16 v[32:47], v[56:59], v[48:51], v[32:47]
    ds_read_b64_tr_b16 v[92:93], v225 offset:30720
    ds_read_b64_tr_b16 v[94:95], v225 offset:31232
    s_waitcnt lgkmcnt(10)
    s_barrier
    v_mfma_f32_32x32x16_bf16 v[16:31], v[64:67], v[60:63], v[16:31]
    ds_read_b128 v[48:51], v208 offset:49152
    ds_read_b64_tr_b16 v[52:53], v224 offset:49152
    ds_read_b64_tr_b16 v[54:55], v224 offset:49664
    v_mfma_f32_32x32x16_bf16 v[32:47], v[68:71], v[60:63], v[32:47]
    ds_read_b64_tr_b16 v[56:57], v225 offset:49152
    ds_read_b64_tr_b16 v[58:59], v225 offset:49664
    s_waitcnt lgkmcnt(10)
    v_mfma_f32_32x32x16_bf16 v[16:31], v[76:79], v[72:75], v[16:31]
    ds_read_b128 v[60:63], v209 offset:49152
    ds_read_b64_tr_b16 v[64:65], v224 offset:51200
    ds_read_b64_tr_b16 v[66:67], v224 offset:51712
    v_mfma_f32_32x32x16_bf16 v[32:47], v[80:83], v[72:75], v[32:47]
    ds_read_b64_tr_b16 v[68:69], v225 offset:51200
    ds_read_b64_tr_b16 v[70:71], v225 offset:51712
    s_waitcnt lgkmcnt(10)
    v_mfma_f32_32x32x16_bf16 v[16:31], v[88:91], v[84:87], v[16:31]
    ds_read_b128 v[72:75], v210 offset:49152
    ds_read_b64_tr_b16 v[76:77], v224 offset:53248
    ds_read_b64_tr_b16 v[78:79], v224 offset:53760
    v_mfma_f32_32x32x16_bf16 v[32:47], v[92:95], v[84:87], v[32:47]
    ds_read_b64_tr_b16 v[80:81], v225 offset:53248
    ds_read_b64_tr_b16 v[82:83], v225 offset:53760
    s_waitcnt lgkmcnt(10)
    s_cmp_lg_u32 s3, 0
    s_cbranch_scc1 dw42
    s_add_u32 s84, s40, 34656256
    s_addc_u32 s85, s41, 0
    s_mov_b32 s86, 22528
    s_mov_b32 s87, 0x20000
    s_lshr_b32 s90, s44, 1
    s_add_u32 s90, s90, 146
    s_lshl_b32 s90, s90, 7
    v_lshlrev_b32 v236, 3, v1
    v_add_u32 v236, s90, v236
    v_cmp_gt_u32 vcc, 4, v1
    s_nop 1
    s_and_saveexec_b64 s[88:89], vcc
    s_cbranch_execz pd44
    v_mov_b32 v240, s96
    v_mov_b32 v241, s97
    s_mov_b32 s90, 0
pl43:
    buffer_load_dwordx2 v[238:239], v236, s[84:87], 0 offen sc1
    s_waitcnt vmcnt(0)
    v_sub_co_u32 v238, vcc, v238, v240
    s_nop 1
    v_subb_co_u32 v239, vcc, v239, v241, vcc
    v_cmp_eq_u32 s[92:93], 0, v239
    s_mov_b32 s91, 16777216
    v_cmp_gt_u32 vcc, s91, v238
    s_nop 1
    s_and_b64 vcc, vcc, s[92:93]
    s_cmp_eq_u64 vcc, exec
    s_cbranch_scc1 pd44
    s_add_u32 s90, s90, 1
    s_cmp_lt_u32 s90, 262144
    s_cbranch_scc1 pl43
pd44:
    s_mov_b64 exec, s[88:89]
dw42:
    v_mfma_f32_32x32x16_bf16 v[16:31], v[52:55], v[48:51], v[16:31]
    ds_read_b128 v[84:87], v211 offset:49152
    ds_read_b64_tr_b16 v[88:89], v224 offset:55296
    ds_read_b64_tr_b16 v[90:91], v224 offset:55808
    v_mfma_f32_32x32x16_bf16 v[32:47], v[56:59], v[48:51], v[32:47]
    ds_read_b64_tr_b16 v[92:93], v225 offset:55296
    ds_read_b64_tr_b16 v[94:95], v225 offset:55808
    s_waitcnt lgkmcnt(10)
    s_barrier
    v_mfma_f32_32x32x16_bf16 v[16:31], v[64:67], v[60:63], v[16:31]
    ds_read_b128 v[48:51], v212 offset:0
    ds_read_b64_tr_b16 v[52:53], v226 offset:0
    ds_read_b64_tr_b16 v[54:55], v226 offset:512
    v_mfma_f32_32x32x16_bf16 v[32:47], v[68:71], v[60:63], v[32:47]
    ds_read_b64_tr_b16 v[56:57], v227 offset:0
    ds_read_b64_tr_b16 v[58:59], v227 offset:512
    s_waitcnt lgkmcnt(10)
    v_mfma_f32_32x32x16_bf16 v[16:31], v[76:79], v[72:75], v[16:31]
    ds_read_b128 v[60:63], v213 offset:0
    ds_read_b64_tr_b16 v[64:65], v226 offset:2048
    ds_read_b64_tr_b16 v[66:67], v226 offset:2560
    v_mfma_f32_32x32x16_bf16 v[32:47], v[80:83], v[72:75], v[32:47]
    ds_read_b64_tr_b16 v[68:69], v227 offset:2048
    ds_read_b64_tr_b16 v[70:71], v227 offset:2560
    s_waitcnt lgkmcnt(10)
    v_mfma_f32_32x32x16_bf16 v[16:31], v[88:91], v[84:87], v[16:31]
    ds_read_b128 v[72:75], v214 offset:0
    ds_read_b64_tr_b16 v[76:77], v226 offset:4096
    ds_read_b64_tr_b16 v[78:79], v226 offset:4608
    v_mfma_f32_32x32x16_bf16 v[32:47], v[92:95], v[84:87], v[32:47]
    ds_read_b64_tr_b16 v[80:81], v227 offset:4096
    ds_read_b64_tr_b16 v[82:83], v227 offset:4608
    s_waitcnt lgkmcnt(10)
    s_add_u32 s68, s40, 29413376
    s_addc_u32 s69, s41, 0
    s_mov_b32 s70, 5242880
    s_mov_b32 s71, 0x20000
    buffer_load_dwordx4 v[152:155], v104, s[68:71], s81 offen
    buffer_load_dwordx4 v[156:159], v105, s[68:71], s81 offen
    buffer_load_dwordx4 v[160:163], v106, s[68:71], s81 offen
    buffer_load_dwordx4 v[164:167], v107, s[68:71], s81 offen
    v_mfma_f32_32x32x16_bf16 v[16:31], v[52:55], v[48:51], v[16:31]
    ds_read_b128 v[84:87], v215 offset:0
    ds_read_b64_tr_b16 v[88:89], v226 offset:6144
    ds_read_b64_tr_b16 v[90:91], v226 offset:6656
    v_mfma_f32_32x32x16_bf16 v[32:47], v[56:59], v[48:51], v[32:47]
    ds_read_b64_tr_b16 v[92:93], v227 offset:6144
    ds_read_b64_tr_b16 v[94:95], v227 offset:6656
    s_waitcnt lgkmcnt(10)
    s_barrier
    v_mfma_f32_32x32x16_bf16 v[16:31], v[64:67], v[60:63], v[16:31]
    ds_read_b128 v[48:51], v212 offset:24576
    ds_read_b64_tr_b16 v[52:53], v226 offset:24576
    ds_read_b64_tr_b16 v[54:55], v226 offset:25088
    v_mfma_f32_32x32x16_bf16 v[32:47], v[68:71], v[60:63], v[32:47]
    ds_read_b64_tr_b16 v[56:57], v227 offset:24576
    ds_read_b64_tr_b16 v[58:59], v227 offset:25088
    s_waitcnt lgkmcnt(10)
    v_mfma_f32_32x32x16_bf16 v[16:31], v[76:79], v[72:75], v[16:31]
    ds_read_b128 v[60:63], v213 offset:24576
    ds_read_b64_tr_b16 v[64:65], v226 offset:26624
    ds_read_b64_tr_b16 v[66:67], v226 offset:27136
    v_mfma_f32_32x32x16_bf16 v[32:47], v[80:83], v[72:75], v[32:47]
    ds_read_b64_tr_b16 v[68:69], v227 offset:26624
    ds_read_b64_tr_b16 v[70:71], v227 offset:27136
    s_waitcnt lgkmcnt(10)
    v_mfma_f32_32x32x16_bf16 v[16:31], v[88:91], v[84:87], v[16:31]
    ds_read_b128 v[72:75], v214 offset:24576
    ds_read_b64_tr_b16 v[76:77], v226 offset:28672
    ds_read_b64_tr_b16 v[78:79], v226 offset:29184
    v_mfma_f32_32x32x16_bf16 v[32:47], v[92:95], v[84:87], v[32:47]
    ds_read_b64_tr_b16 v[80:81], v227 offset:28672
    ds_read_b64_tr_b16 v[82:83], v227 offset:29184
    s_waitcnt lgkmcnt(10)
    v_mfma_f32_32x32x16_bf16 v[16:31], v[52:55], v[48:51], v[16:31]
    ds_read_b128 v[84:87], v215 offset:24576
    ds_read_b64_tr_b16 v[88:89], v226 offset:30720
    ds_read_b64_tr_b16 v[90:91], v226 offset:31232
    v_mfma_f32_32x32x16_bf16 v[32:47], v[56:59], v[48:51], v[32:47]
    ds_read_b64_tr_b16 v[92:93], v227 offset:30720
    ds_read_b64_tr_b16 v[94:95], v227 offset:31232
    s_waitcnt lgkmcnt(10)
    s_barrier
    v_mfma_f32_32x32x16_bf16 v[16:31], v[64:67], v[60:63], v[16:31]
    ds_read_b128 v[48:51], v212 offset:49152
    ds_read_b64_tr_b16 v[52:53], v226 offset:49152
    ds_read_b64_tr_b16 v[54:55], v226 offset:49664
    v_mfma_f32_32x32x16_bf16 v[32:47], v[68:71], v[60:63], v[32:47]
    ds_read_b64_tr_b16 v[56:57], v227 offset:49152
    ds_read_b64_tr_b16 v[58:59], v227 offset:49664
    s_waitcnt lgkmcnt(10)
    v_mfma_f32_32x32x16_bf16 v[16:31], v[76:79], v[72:75], v[16:31]
    ds_read_b128 v[60:63], v213 offset:49152
    ds_read_b64_tr_b16 v[64:65], v226 offset:51200
    ds_read_b64_tr_b16 v[66:67], v226 offset:51712
    v_mfma_f32_32x32x16_bf16 v[32:47], v[80:83], v[72:75], v[32:47]
    ds_read_b64_tr_b16 v[68:69], v227 offset:51200
    ds_read_b64_tr_b16 v[70:71], v227 offset:51712
    s_waitcnt lgkmcnt(10)
    v_mfma_f32_32x32x16_bf16 v[16:31], v[88:91], v[84:87], v[16:31]
    ds_read_b128 v[72:75], v214 offset:49152
    ds_read_b64_tr_b16 v[76:77], v226 offset:53248
    ds_read_b64_tr_b16 v[78:79], v226 offset:53760
    v_mfma_f32_32x32x16_bf16 v[32:47], v[92:95], v[84:87], v[32:47]
    ds_read_b64_tr_b16 v[80:81], v227 offset:53248
    ds_read_b64_tr_b16 v[82:83], v227 offset:53760
    s_waitcnt lgkmcnt(10)
    v_mfma_f32_32x32x16_bf16 v[16:31], v[52:55], v[48:51], v[16:31]
    ds_read_b128 v[84:87], v215 offset:49152
    ds_read_b64_tr_b16 v[88:89], v226 offset:55296
    ds_read_b64_tr_b16 v[90:91], v226 offset:55808
    v_mfma_f32_32x32x16_bf16 v[32:47], v[56:59], v[48:51], v[32:47]
    ds_read_b64_tr_b16 v[92:93], v227 offset:55296
    ds_read_b64_tr_b16 v[94:95], v227 offset:55808
    s_waitcnt lgkmcnt(10)
    v_mfma_f32_32x32x16_bf16 v[16:31], v[64:67], v[60:63], v[16:31]
    v_mfma_f32_32x32x16_bf16 v[32:47], v[68:71], v[60:63], v[32:47]
    s_waitcnt lgkmcnt(5)
    v_mfma_f32_32x32x16_bf16 v[16:31], v[76:79], v[72:75], v[16:31]
    v_mfma_f32_32x32x16_bf16 v[32:47], v[80:83], v[72:75], v[32:47]
    s_waitcnt lgkmcnt(0)
    v_mfma_f32_32x32x16_bf16 v[16:31], v[88:91], v[84:87], v[16:31]
    v_mfma_f32_32x32x16_bf16 v[32:47], v[92:95], v[84:87], v[32:47]
    s_nop 10
    v_cvt_pk_bf16_f32 v88, v16, v17
    v_cvt_pk_bf16_f32 v89, v18, v19
    ds_write_b64 v184, v[88:89]
    v_cvt_pk_bf16_f32 v90, v20, v21
    v_cvt_pk_bf16_f32 v91, v22, v23
    ds_write_b64 v185, v[90:91]
    v_cvt_pk_bf16_f32 v92, v24, v25
    v_cvt_pk_bf16_f32 v93, v26, v27
    ds_write_b64 v186, v[92:93]
    v_cvt_pk_bf16_f32 v94, v28, v29
    v_cvt_pk_bf16_f32 v95, v30, v31
    ds_write_b64 v187, v[94:95]
    v_cvt_pk_bf16_f32 v88, v32, v33
    v_cvt_pk_bf16_f32 v89, v34, v35
    ds_write_b64 v188, v[88:89]
    v_cvt_pk_bf16_f32 v90, v36, v37
    v_cvt_pk_bf16_f32 v91, v38, v39
    ds_write_b64 v189, v[90:91]
    v_cvt_pk_bf16_f32 v92, v40, v41
    v_cvt_pk_bf16_f32 v93, v42, v43
    ds_write_b64 v190, v[92:93]
    v_cvt_pk_bf16_f32 v94, v44, v45
    v_cvt_pk_bf16_f32 v95, v46, v47
    ds_write_b64 v191, v[94:95]
    s_waitcnt lgkmcnt(0)
    s_branch m4_p3
m4_load:
    s_add_u32 s48, s40, 23121920
    s_addc_u32 s49, s41, 0
    s_mov_b32 s50, 6291456
    s_mov_b32 s51, 0x20000
    s_mov_b32 s52, s34
    s_mov_b32 s53, s35
    s_mov_b32 s54, 1966080
    s_mov_b32 s55, 0x20000
    s_sub_u32 s4, s3, 4
    s_lshl_b32 s5, s4, 10
    s_mul_i32 s6, s44, 196608
    s_lshl_b32 s7, s45, 8
    v_lshrrev_b32 v10, 3, v1
    v_and_b32 v11, 7, v1
    v_bfe_u32 v12, v10, 1, 1
    v_lshlrev_b32 v12, 2, v12
    v_xor_b32 v11, v11, v12
    s_lshl_b32 s42, s4, 3
    v_add_u32 v13, s42, v10
    v_mul_u32_u24 v13, 1280, v13
    v_lshl_add_u32 v9, v11, 4, v13
    v_lshrrev_b32 v10, 3, v1
    v_and_b32 v11, 7, v1
    v_lshrrev_b32 v12, 1, v10
    s_and_b32 s42, s4, 1
    s_lshl_b32 s42, s42, 2
    v_or_b32 v12, s42, v12
    v_xor_b32 v11, v11, v12
    s_lshl_b32 s42, s4, 3
    v_add_u32 v13, s42, v10
    v_mul_u32_u24 v13, 3072, v13
    v_lshl_add_u32 v2, v11, 4, v13
    s_add_u32 m0, s5, 8192
    s_nop 0
    buffer_load_dwordx4 v9, s[52:55], s7 offen lds
    s_add_u32 m0, s5, 12288
    s_add_u32 s43, s7, 40960
    buffer_load_dwordx4 v9, s[52:55], s43 offen lds
    s_add_u32 m0, s5, 16384
    s_add_u32 s43, s7, 128
    buffer_load_dwordx4 v9, s[52:55], s43 offen lds
    s_add_u32 m0, s5, 20480
    s_add_u32 s43, s7, 41088
    buffer_load_dwordx4 v9, s[52:55], s43 offen lds
    s_add_u32 m0, s5, 32768
    s_add_u32 s43, s7, 81920
    buffer_load_dwordx4 v9, s[52:55], s43 offen lds
    s_add_u32 m0, s5, 36864
    s_add_u32 s43, s7, 122880
    buffer_load_dwordx4 v9, s[52:55], s43 offen lds
    s_add_u32 m0, s5, 40960
    s_add_u32 s43, s7, 82048
    buffer_load_dwordx4 v9, s[52:55], s43 offen lds
    s_add_u32 m0, s5, 45056
    s_add_u32 s43, s7, 123008
    buffer_load_dwordx4 v9, s[52:55], s43 offen lds
    s_add_u32 m0, s5, 57344
    s_add_u32 s43, s7, 163840
    buffer_load_dwordx4 v9, s[52:55], s43 offen lds
    s_add_u32 m0, s5, 61440
    s_add_u32 s43, s7, 204800
    buffer_load_dwordx4 v9, s[52:55], s43 offen lds
    s_add_u32 m0, s5, 65536
    s_add_u32 s43, s7, 163968
    buffer_load_dwordx4 v9, s[52:55], s43 offen lds
    s_add_u32 m0, s5, 69632
    s_add_u32 s43, s7, 204928
    buffer_load_dwordx4 v9, s[52:55], s43 offen lds
    s_add_u32 m0, s5, 81920
    s_add_u32 s43, s7, 245760
    buffer_load_dwordx4 v9, s[52:55], s43 offen lds
    s_add_u32 m0, s5, 86016
    s_add_u32 s43, s7, 286720
    buffer_load_dwordx4 v9, s[52:55], s43 offen lds
    s_add_u32 m0, s5, 90112
    s_add_u32 s43, s7, 245888
    buffer_load_dwordx4 v9, s[52:55], s43 offen lds
    s_add_u32 m0, s5, 94208
    s_add_u32 s43, s7, 286848
    buffer_load_dwordx4 v9, s[52:55], s43 offen lds
    s_add_u32 m0, s5, 106496
    s_add_u32 s43, s7, 327680
    buffer_load_dwordx4 v9, s[52:55], s43 offen lds
    s_add_u32 m0, s5, 110592
    s_add_u32 s43, s7, 368640
    buffer_load_dwordx4 v9, s[52:55], s43 offen lds
    s_add_u32 m0, s5, 114688
    s_add_u32 s43, s7, 327808
    buffer_load_dwordx4 v9, s[52:55], s43 offen lds
    s_add_u32 m0, s5, 118784
    s_add_u32 s43, s7, 368768
    buffer_load_dwordx4 v9, s[52:55], s43 offen lds
    s_add_u32 m0, s5, 131072
    s_add_u32 s43, s7, 409600
    buffer_load_dwordx4 v9, s[52:55], s43 offen lds
    s_add_u32 m0, s5, 135168
    s_add_u32 s43, s7, 450560
    buffer_load_dwordx4 v9, s[52:55], s43 offen lds
    s_add_u32 m0, s5, 139264
    s_add_u32 s43, s7, 409728
    buffer_load_dwordx4 v9, s[52:55], s43 offen lds
    s_add_u32 m0, s5, 143360
    s_add_u32 s43, s7, 450688
    buffer_load_dwordx4 v9, s[52:55], s43 offen lds
    s_barrier
    s_add_u32 m0, s5, 0
    s_nop 0
    buffer_load_dwordx4 v2, s[48:51], s6 offen lds
    s_add_u32 m0, s5, 4096
    s_add_u32 s43, s6, 98304
    buffer_load_dwordx4 v2, s[48:51], s43 offen lds
    s_add_u32 m0, s5, 24576
    s_add_u32 s43, s6, 128
    buffer_load_dwordx4 v2, s[48:51], s43 offen lds
    s_add_u32 m0, s5, 28672
    s_add_u32 s43, s6, 98432
    buffer_load_dwordx4 v2, s[48:51], s43 offen lds
    s_waitcnt vmcnt(2)
    s_barrier
    s_add_u32 m0, s5, 49152
    s_add_u32 s43, s6, 256
    buffer_load_dwordx4 v2, s[48:51], s43 offen lds
    s_add_u32 m0, s5, 53248
    s_add_u32 s43, s6, 98560
    buffer_load_dwordx4 v2, s[48:51], s43 offen lds
    s_add_u32 m0, s5, 73728
    s_add_u32 s43, s6, 384
    buffer_load_dwordx4 v2, s[48:51], s43 offen lds
    s_add_u32 m0, s5, 77824
    s_add_u32 s43, s6, 98688
    buffer_load_dwordx4 v2, s[48:51], s43 offen lds
    s_waitcnt vmcnt(4)
    s_barrier
    s_add_u32 m0, s5, 98304
    s_add_u32 s43, s6, 512
    buffer_load_dwordx4 v2, s[48:51], s43 offen lds
    s_add_u32 m0, s5, 102400
    s_add_u32 s43, s6, 98816
    buffer_load_dwordx4 v2, s[48:51], s43 offen lds
    s_add_u32 m0, s5, 122880
    s_add_u32 s43, s6, 640
    buffer_load_dwordx4 v2, s[48:51], s43 offen lds
    s_add_u32 m0, s5, 126976
    s_add_u32 s43, s6, 98944
    buffer_load_dwordx4 v2, s[48:51], s43 offen lds
    s_waitcnt vmcnt(6)
    s_barrier
    s_add_u32 m0, s5, 0
    s_add_u32 s43, s6, 768
    buffer_load_dwordx4 v2, s[48:51], s43 offen lds
    s_add_u32 m0, s5, 4096
    s_add_u32 s43, s6, 99072
    buffer_load_dwordx4 v2, s[48:51], s43 offen lds
    s_add_u32 m0, s5, 8192
    s_add_u32 s43, s7, 491520
    buffer_load_dwordx4 v9, s[52:55], s43 offen lds
    s_add_u32 m0, s5, 12288
    s_add_u32 s43, s7, 532480
    buffer_load_dwordx4 v9, s[52:55], s43 offen lds
    s_add_u32 m0, s5, 16384
    s_add_u32 s43, s7, 491648
    buffer_load_dwordx4 v9, s[52:55], s43 offen lds
    s_add_u32 m0, s5, 20480
    s_add_u32 s43, s7, 532608
    buffer_load_dwordx4 v9, s[52:55], s43 offen lds
    s_waitcnt vmcnt(10)
    s_barrier
    s_add_u32 m0, s5, 24576
    s_add_u32 s43, s6, 896
    buffer_load_dwordx4 v2, s[48:51], s43 offen lds
    s_add_u32 m0, s5, 28672
    s_add_u32 s43, s6, 99200
    buffer_load_dwordx4 v2, s[48:51], s43 offen lds
    s_add_u32 m0, s5, 32768
    s_add_u32 s43, s7, 573440
    buffer_load_dwordx4 v9, s[52:55], s43 offen lds
    s_add_u32 m0, s5, 36864
    s_add_u32 s43, s7, 614400
    buffer_load_dwordx4 v9, s[52:55], s43 offen lds
    s_add_u32 m0, s5, 40960
    s_add_u32 s43, s7, 573568
    buffer_load_dwordx4 v9, s[52:55], s43 offen lds
    s_add_u32 m0, s5, 45056
    s_add_u32 s43, s7, 614528
    buffer_load_dwordx4 v9, s[52:55], s43 offen lds
    s_waitcnt vmcnt(14)
    s_barrier
    s_add_u32 m0, s5, 49152
    s_add_u32 s43, s6, 1024
    buffer_load_dwordx4 v2, s[48:51], s43 offen lds
    s_add_u32 m0, s5, 53248
    s_add_u32 s43, s6, 99328
    buffer_load_dwordx4 v2, s[48:51], s43 offen lds
    s_add_u32 m0, s5, 57344
    s_add_u32 s43, s7, 655360
    buffer_load_dwordx4 v9, s[52:55], s43 offen lds
    s_add_u32 m0, s5, 61440
    s_add_u32 s43, s7, 696320
    buffer_load_dwordx4 v9, s[52:55], s43 offen lds
    s_add_u32 m0, s5, 65536
    s_add_u32 s43, s7, 655488
    buffer_load_dwordx4 v9, s[52:55], s43 offen lds
    s_add_u32 m0, s5, 69632
    s_add_u32 s43, s7, 696448
    buffer_load_dwordx4 v9, s[52:55], s43 offen lds
    s_waitcnt vmcnt(18)
    s_barrier
    s_add_u32 m0, s5, 73728
    s_add_u32 s43, s6, 1152
    buffer_load_dwordx4 v2, s[48:51], s43 offen lds
    s_add_u32 m0, s5, 77824
    s_add_u32 s43, s6, 99456
    buffer_load_dwordx4 v2, s[48:51], s43 offen lds
    s_add_u32 m0, s5, 81920
    s_add_u32 s43, s7, 737280
    buffer_load_dwordx4 v9, s[52:55], s43 offen lds
    s_add_u32 m0, s5, 86016
    s_add_u32 s43, s7, 778240
    buffer_load_dwordx4 v9, s[52:55], s43 offen lds
    s_add_u32 m0, s5, 90112
    s_add_u32 s43, s7, 737408
    buffer_load_dwordx4 v9, s[52:55], s43 offen lds
    s_add_u32 m0, s5, 94208
    s_add_u32 s43, s7, 778368
    buffer_load_dwordx4 v9, s[52:55], s43 offen lds
    s_waitcnt vmcnt(18)
    s_barrier
    s_add_u32 m0, s5, 98304
    s_add_u32 s43, s6, 1536
    buffer_load_dwordx4 v2, s[48:51], s43 offen lds
    s_add_u32 m0, s5, 102400
    s_add_u32 s43, s6, 99840
    buffer_load_dwordx4 v2, s[48:51], s43 offen lds
    s_add_u32 m0, s5, 106496
    s_add_u32 s43, s7, 983040
    buffer_load_dwordx4 v9, s[52:55], s43 offen lds
    s_add_u32 m0, s5, 110592
    s_add_u32 s43, s7, 1024000
    buffer_load_dwordx4 v9, s[52:55], s43 offen lds
    s_add_u32 m0, s5, 114688
    s_add_u32 s43, s7, 983168
    buffer_load_dwordx4 v9, s[52:55], s43 offen lds
    s_add_u32 m0, s5, 118784
    s_add_u32 s43, s7, 1024128
    buffer_load_dwordx4 v9, s[52:55], s43 offen lds
    s_waitcnt vmcnt(18)
    s_barrier
    s_add_u32 m0, s5, 122880
    s_add_u32 s43, s6, 1664
    buffer_load_dwordx4 v2, s[48:51], s43 offen lds
    s_add_u32 m0, s5, 126976
    s_add_u32 s43, s6, 99968
    buffer_load_dwordx4 v2, s[48:51], s43 offen lds
    s_add_u32 m0, s5, 131072
    s_add_u32 s43, s7, 1064960
    buffer_load_dwordx4 v9, s[52:55], s43 offen lds
    s_add_u32 m0, s5, 135168
    s_add_u32 s43, s7, 1105920
    buffer_load_dwordx4 v9, s[52:55], s43 offen lds
    s_add_u32 m0, s5, 139264
    s_add_u32 s43, s7, 1065088
    buffer_load_dwordx4 v9, s[52:55], s43 offen lds
    s_add_u32 m0, s5, 143360
    s_add_u32 s43, s7, 1106048
    buffer_load_dwordx4 v9, s[52:55], s43 offen lds
    s_waitcnt vmcnt(18)
    s_barrier
    s_add_u32 m0, s5, 0
    s_add_u32 s43, s6, 1792
    buffer_load_dwordx4 v2, s[48:51], s43 offen lds
    s_add_u32 m0, s5, 4096
    s_add_u32 s43, s6, 100096
    buffer_load_dwordx4 v2, s[48:51], s43 offen lds
    s_add_u32 m0, s5, 8192
    s_add_u32 s43, s7, 1146880
    buffer_load_dwordx4 v9, s[52:55], s43 offen lds
    s_add_u32 m0, s5, 12288
    s_add_u32 s43, s7, 1187840
    buffer_load_dwordx4 v9, s[52:55], s43 offen lds
    s_add_u32 m0, s5, 16384
    s_add_u32 s43, s7, 1147008
    buffer_load_dwordx4 v9, s[52:55], s43 offen lds
    s_add_u32 m0, s5, 20480
    s_add_u32 s43, s7, 1187968
    buffer_load_dwordx4 v9, s[52:55], s43 offen lds
    s_waitcnt vmcnt(18)
    s_barrier
    s_add_u32 m0, s5, 24576
    s_add_u32 s43, s6, 1920
    buffer_load_dwordx4 v2, s[48:51], s43 offen lds
    s_add_u32 m0, s5, 28672
    s_add_u32 s43, s6, 100224
    buffer_load_dwordx4 v2, s[48:51], s43 offen lds
    s_add_u32 m0, s5, 32768
    s_add_u32 s43, s7, 1228800
    buffer_load_dwordx4 v9, s[52:55], s43 offen lds
    s_add_u32 m0, s5, 36864
    s_add_u32 s43, s7, 1269760
    buffer_load_dwordx4 v9, s[52:55], s43 offen lds
    s_add_u32 m0, s5, 40960
    s_add_u32 s43, s7, 1228928
    buffer_load_dwordx4 v9, s[52:55], s43 offen lds
    s_add_u32 m0, s5, 45056
    s_add_u32 s43, s7, 1269888
    buffer_load_dwordx4 v9, s[52:55], s43 offen lds
    s_waitcnt vmcnt(18)
    s_barrier
    s_add_u32 m0, s5, 49152
    s_add_u32 s43, s6, 2048
    buffer_load_dwordx4 v2, s[48:51], s43 offen lds
    s_add_u32 m0, s5, 53248
    s_add_u32 s43, s6, 100352
    buffer_load_dwordx4 v2, s[48:51], s43 offen lds
    s_add_u32 m0, s5, 57344
    s_add_u32 s43, s7, 1310720
    buffer_load_dwordx4 v9, s[52:55], s43 offen lds
    s_add_u32 m0, s5, 61440
    s_add_u32 s43, s7, 1351680
    buffer_load_dwordx4 v9, s[52:55], s43 offen lds
    s_add_u32 m0, s5, 65536
    s_add_u32 s43, s7, 1310848
    buffer_load_dwordx4 v9, s[52:55], s43 offen lds
    s_add_u32 m0, s5, 69632
    s_add_u32 s43, s7, 1351808
    buffer_load_dwordx4 v9, s[52:55], s43 offen lds
    s_waitcnt vmcnt(18)
    s_barrier
    s_add_u32 m0, s5, 73728
    s_add_u32 s43, s6, 2176
    buffer_load_dwordx4 v2, s[48:51], s43 offen lds
    s_add_u32 m0, s5, 77824
    s_add_u32 s43, s6, 100480
    buffer_load_dwordx4 v2, s[48:51], s43 offen lds
    s_add_u32 m0, s5, 81920
    s_add_u32 s43, s7, 1392640
    buffer_load_dwordx4 v9, s[52:55], s43 offen lds
    s_add_u32 m0, s5, 86016
    s_add_u32 s43, s7, 1433600
    buffer_load_dwordx4 v9, s[52:55], s43 offen lds
    s_add_u32 m0, s5, 90112
    s_add_u32 s43, s7, 1392768
    buffer_load_dwordx4 v9, s[52:55], s43 offen lds
    s_add_u32 m0, s5, 94208
    s_add_u32 s43, s7, 1433728
    buffer_load_dwordx4 v9, s[52:55], s43 offen lds
    s_waitcnt vmcnt(18)
    s_barrier
    s_add_u32 m0, s5, 98304
    s_add_u32 s43, s6, 2304
    buffer_load_dwordx4 v2, s[48:51], s43 offen lds
    s_add_u32 m0, s5, 102400
    s_add_u32 s43, s6, 100608
    buffer_load_dwordx4 v2, s[48:51], s43 offen lds
    s_add_u32 m0, s5, 106496
    s_add_u32 s43, s7, 1474560
    buffer_load_dwordx4 v9, s[52:55], s43 offen lds
    s_add_u32 m0, s5, 110592
    s_add_u32 s43, s7, 1515520
    buffer_load_dwordx4 v9, s[52:55], s43 offen lds
    s_add_u32 m0, s5, 114688
    s_add_u32 s43, s7, 1474688
    buffer_load_dwordx4 v9, s[52:55], s43 offen lds
    s_add_u32 m0, s5, 118784
    s_add_u32 s43, s7, 1515648
    buffer_load_dwordx4 v9, s[52:55], s43 offen lds
    s_waitcnt vmcnt(18)
    s_barrier
    s_add_u32 m0, s5, 122880
    s_add_u32 s43, s6, 2432
    buffer_load_dwordx4 v2, s[48:51], s43 offen lds
    s_add_u32 m0, s5, 126976
    s_add_u32 s43, s6, 100736
    buffer_load_dwordx4 v2, s[48:51], s43 offen lds
    s_add_u32 m0, s5, 131072
    s_add_u32 s43, s7, 1556480
    buffer_load_dwordx4 v9, s[52:55], s43 offen lds
    s_add_u32 m0, s5, 135168
    s_add_u32 s43, s7, 1597440
    buffer_load_dwordx4 v9, s[52:55], s43 offen lds
    s_add_u32 m0, s5, 139264
    s_add_u32 s43, s7, 1556608
    buffer_load_dwordx4 v9, s[52:55], s43 offen lds
    s_add_u32 m0, s5, 143360
    s_add_u32 s43, s7, 1597568
    buffer_load_dwordx4 v9, s[52:55], s43 offen lds
    s_waitcnt vmcnt(18)
    s_barrier
    s_add_u32 m0, s5, 0
    s_add_u32 s43, s6, 2560
    buffer_load_dwordx4 v2, s[48:51], s43 offen lds
    s_add_u32 m0, s5, 4096
    s_add_u32 s43, s6, 100864
    buffer_load_dwordx4 v2, s[48:51], s43 offen lds
    s_add_u32 m0, s5, 8192
    s_add_u32 s43, s7, 1638400
    buffer_load_dwordx4 v9, s[52:55], s43 offen lds
    s_add_u32 m0, s5, 12288
    s_add_u32 s43, s7, 1679360
    buffer_load_dwordx4 v9, s[52:55], s43 offen lds
    s_add_u32 m0, s5, 16384
    s_add_u32 s43, s7, 1638528
    buffer_load_dwordx4 v9, s[52:55], s43 offen lds
    s_add_u32 m0, s5, 20480
    s_add_u32 s43, s7, 1679488
    buffer_load_dwordx4 v9, s[52:55], s43 offen lds
    s_waitcnt vmcnt(18)
    s_barrier
    s_add_u32 m0, s5, 24576
    s_add_u32 s43, s6, 2688
    buffer_load_dwordx4 v2, s[48:51], s43 offen lds
    s_add_u32 m0, s5, 28672
    s_add_u32 s43, s6, 100992
    buffer_load_dwordx4 v2, s[48:51], s43 offen lds
    s_add_u32 m0, s5, 32768
    s_add_u32 s43, s7, 1720320
    buffer_load_dwordx4 v9, s[52:55], s43 offen lds
    s_add_u32 m0, s5, 36864
    s_add_u32 s43, s7, 1761280
    buffer_load_dwordx4 v9, s[52:55], s43 offen lds
    s_add_u32 m0, s5, 40960
    s_add_u32 s43, s7, 1720448
    buffer_load_dwordx4 v9, s[52:55], s43 offen lds
    s_add_u32 m0, s5, 45056
    s_add_u32 s43, s7, 1761408
    buffer_load_dwordx4 v9, s[52:55], s43 offen lds
    s_waitcnt vmcnt(18)
    s_barrier
    s_add_u32 m0, s5, 49152
    s_add_u32 s43, s6, 1280
    buffer_load_dwordx4 v2, s[48:51], s43 offen lds
    s_add_u32 m0, s5, 53248
    s_add_u32 s43, s6, 99584
    buffer_load_dwordx4 v2, s[48:51], s43 offen lds
    s_add_u32 m0, s5, 57344
    s_add_u32 s43, s7, 819200
    buffer_load_dwordx4 v9, s[52:55], s43 offen lds
    s_add_u32 m0, s5, 61440
    s_add_u32 s43, s7, 860160
    buffer_load_dwordx4 v9, s[52:55], s43 offen lds
    s_add_u32 m0, s5, 65536
    s_add_u32 s43, s7, 819328
    buffer_load_dwordx4 v9, s[52:55], s43 offen lds
    s_add_u32 m0, s5, 69632
    s_add_u32 s43, s7, 860288
    buffer_load_dwordx4 v9, s[52:55], s43 offen lds
    s_waitcnt vmcnt(18)
    s_barrier
    s_add_u32 m0, s5, 73728
    s_add_u32 s43, s6, 1408
    buffer_load_dwordx4 v2, s[48:51], s43 offen lds
    s_add_u32 m0, s5, 77824
    s_add_u32 s43, s6, 99712
    buffer_load_dwordx4 v2, s[48:51], s43 offen lds
    s_add_u32 m0, s5, 81920
    s_add_u32 s43, s7, 901120
    buffer_load_dwordx4 v9, s[52:55], s43 offen lds
    s_add_u32 m0, s5, 86016
    s_add_u32 s43, s7, 942080
    buffer_load_dwordx4 v9, s[52:55], s43 offen lds
    s_add_u32 m0, s5, 90112
    s_add_u32 s43, s7, 901248
    buffer_load_dwordx4 v9, s[52:55], s43 offen lds
    s_add_u32 m0, s5, 94208
    s_add_u32 s43, s7, 942208
    buffer_load_dwordx4 v9, s[52:55], s43 offen lds
    s_add_u32 s56, s40, 13443072
    s_addc_u32 s57, s41, 0
    s_mov_b32 s58, 2621440
    s_mov_b32 s59, 0x20000
    s_mov_b32 s60, s8
    s_mov_b32 s61, s9
    s_mov_b32 s62, 2621440
    s_mov_b32 s63, 0x20000
    s_mov_b32 s64, s40
    s_mov_b32 s65, s41
    s_mov_b32 s66, 2621440
    s_mov_b32 s67, 0x20000
    s_mov_b32 s72, s24
    s_mov_b32 s73, s25
    s_mov_b32 s74, 1280
    s_mov_b32 s75, 0x20000
    v_lshrrev_b32 v10, 5, v1
    s_lshl_b32 s76, s3, 3
    v_add_u32 v10, s76, v10
    v_and_b32 v11, 31, v1
    v_add_u32 v12, 0, v10
    v_mul_u32_u24 v13, 1280, v12
    v_lshl_add_u32 v100, v11, 3, v13
    v_mul_u32_u24 v13, 2560, v12
    v_lshl_add_u32 v104, v11, 4, v13
    v_lshrrev_b32 v13, 1, v11
    v_and_b32 v14, 15, v12
    v_xor_b32 v13, v13, v14
    v_lshlrev_b32 v13, 4, v13
    v_lshl_add_u32 v13, v12, 8, v13
    v_and_b32 v14, 1, v11
    v_lshl_add_u32 v13, v14, 3, v13
    v_add_u32 v108, 49152, v13
    v_add_u32 v12, 2, v10
    v_mul_u32_u24 v13, 1280, v12
    v_lshl_add_u32 v101, v11, 3, v13
    v_mul_u32_u24 v13, 2560, v12
    v_lshl_add_u32 v105, v11, 4, v13
    v_lshrrev_b32 v13, 1, v11
    v_and_b32 v14, 15, v12
    v_xor_b32 v13, v13, v14
    v_lshlrev_b32 v13, 4, v13
    v_lshl_add_u32 v13, v12, 8, v13
    v_and_b32 v14, 1, v11
    v_lshl_add_u32 v13, v14, 3, v13
    v_add_u32 v109, 49152, v13
    v_add_u32 v12, 4, v10
    v_mul_u32_u24 v13, 1280, v12
    v_lshl_add_u32 v102, v11, 3, v13
    v_mul_u32_u24 v13, 2560, v12
    v_lshl_add_u32 v106, v11, 4, v13
    v_lshrrev_b32 v13, 1, v11
    v_and_b32 v14, 15, v12
    v_xor_b32 v13, v13, v14
    v_lshlrev_b32 v13, 4, v13
    v_lshl_add_u32 v13, v12, 8, v13
    v_and_b32 v14, 1, v11
    v_lshl_add_u32 v13, v14, 3, v13
    v_add_u32 v110, 49152, v13
    v_add_u32 v12, 6, v10
    v_mul_u32_u24 v13, 1280, v12
    v_lshl_add_u32 v103, v11, 3, v13
    v_mul_u32_u24 v13, 2560, v12
    v_lshl_add_u32 v107, v11, 4, v13
    v_lshrrev_b32 v13, 1, v11
    v_and_b32 v14, 15, v12
    v_xor_b32 v13, v13, v14
    v_lshlrev_b32 v13, 4, v13
    v_lshl_add_u32 v13, v12, 8, v13
    v_and_b32 v14, 1, v11
    v_lshl_add_u32 v13, v14, 3, v13
    v_add_u32 v111, 49152, v13
    s_mul_i32 s80, s44, 81920
    s_lshl_b32 s77, s45, 8
    s_add_u32 s80, s80, s77
    s_lshl_b32 s81, s80, 1
    buffer_load_dwordx2 v[128:129], v100, s[56:59], s80 offen
    buffer_load_dwordx2 v[136:137], v100, s[60:63], s80 offen
    buffer_load_dwordx2 v[144:145], v100, s[64:67], s80 offen
    buffer_load_dwordx2 v[130:131], v101, s[56:59], s80 offen
    buffer_load_dwordx2 v[138:139], v101, s[60:63], s80 offen
    buffer_load_dwordx2 v[146:147], v101, s[64:67], s80 offen
    buffer_load_dwordx2 v[132:133], v102, s[56:59], s80 offen
    buffer_load_dwordx2 v[140:141], v102, s[60:63], s80 offen
    buffer_load_dwordx2 v[148:149], v102, s[64:67], s80 offen
    buffer_load_dwordx2 v[134:135], v103, s[56:59], s80 offen
    buffer_load_dwordx2 v[142:143], v103, s[60:63], s80 offen
    buffer_load_dwordx2 v[150:151], v103, s[64:67], s80 offen
    v_lshlrev_b32 v12, 3, v11
    buffer_load_dwordx2 v[168:169], v12, s[72:75], s77 offen
    s_waitcnt vmcnt(31)
    s_barrier
    s_add_u32 m0, s5, 98304
    s_add_u32 s43, s6, 2816
    buffer_load_dwordx4 v2, s[48:51], s43 offen lds
    s_add_u32 m0, s5, 102400
    s_add_u32 s43, s6, 101120
    buffer_load_dwordx4 v2, s[48:51], s43 offen lds
    s_add_u32 m0, s5, 106496
    s_add_u32 s43, s7, 1802240
    buffer_load_dwordx4 v9, s[52:55], s43 offen lds
    s_add_u32 m0, s5, 110592
    s_add_u32 s43, s7, 1843200
    buffer_load_dwordx4 v9, s[52:55], s43 offen lds
    s_add_u32 m0, s5, 114688
    s_add_u32 s43, s7, 1802368
    buffer_load_dwordx4 v9, s[52:55], s43 offen lds
    s_add_u32 m0, s5, 118784
    s_add_u32 s43, s7, 1843328
    buffer_load_dwordx4 v9, s[52:55], s43 offen lds
    s_waitcnt vmcnt(31)
    s_barrier
    s_add_u32 m0, s5, 122880
    s_add_u32 s43, s6, 2944
    buffer_load_dwordx4 v2, s[48:51], s43 offen lds
    s_add_u32 m0, s5, 126976
    s_add_u32 s43, s6, 101248
    buffer_load_dwordx4 v2, s[48:51], s43 offen lds
    s_add_u32 m0, s5, 131072
    s_add_u32 s43, s7, 1884160
    buffer_load_dwordx4 v9, s[52:55], s43 offen lds
    s_add_u32 m0, s5, 135168
    s_add_u32 s43, s7, 1925120
    buffer_load_dwordx4 v9, s[52:55], s43 offen lds
    s_add_u32 m0, s5, 139264
    s_add_u32 s43, s7, 1884288
    buffer_load_dwordx4 v9, s[52:55], s43 offen lds
    s_add_u32 m0, s5, 143360
    s_add_u32 s43, s7, 1925248
    buffer_load_dwordx4 v9, s[52:55], s43 offen lds
    s_waitcnt vmcnt(31)
    s_barrier
    s_waitcnt vmcnt(25)
    s_barrier
    s_add_u32 s68, s40, 29413376
    s_addc_u32 s69, s41, 0
    s_mov_b32 s70, 5242880
    s_mov_b32 s71, 0x20000
    buffer_load_dwordx4 v[152:155], v104, s[68:71], s81 offen
    buffer_load_dwordx4 v[156:159], v105, s[68:71], s81 offen
    buffer_load_dwordx4 v[160:163], v106, s[68:71], s81 offen
    buffer_load_dwordx4 v[164:167], v107, s[68:71], s81 offen
    s_waitcnt vmcnt(10)
    s_barrier
    s_waitcnt vmcnt(4)
    s_barrier
m4_p3:
    s_mov_b32 s64, s36
    s_mov_b32 s65, s37
    s_mov_b32 s66, 5242880
    s_mov_b32 s67, 0x20000
    s_mov_b32 s72, 0xffff0000
    s_mov_b32 s68, 0xbfb8aa3b
    s_mov_b32 s69, 0xbfb8aa3b
    s_barrier
    ds_read_b64 v[16:17], v108
    ds_read_b64 v[18:19], v109
    ds_read_b64 v[20:21], v110
    ds_read_b64 v[22:23], v111
    s_waitcnt vmcnt(0)
    v_lshlrev_b32 v24, 16, v168
    v_and_b32 v25, s72, v168
    v_lshlrev_b32 v26, 16, v169
    v_and_b32 v27, s72, v169
    s_waitcnt lgkmcnt(3)
    v_lshlrev_b32 v32, 16, v16
    v_and_b32 v33, s72, v16
    v_lshlrev_b32 v34, 16, v128
    v_and_b32 v35, s72, v128
    v_pk_add_f32 v[32:33], v[32:33], v[34:35]
    v_cvt_pk_bf16_f32 v32, v32, v33
    v_lshlrev_b32 v34, 16, v32
    v_and_b32 v35, s72, v32
    v_pk_mul_f32 v[32:33], v[34:35], s[68:69]
    v_exp_f32 v32, v32
    v_exp_f32 v33, v33
    s_nop 0
    v_pk_add_f32 v[32:33], v[32:33], 1.0 op_sel_hi:[1,0]
    v_rcp_f32 v32, v32
    v_rcp_f32 v33, v33
    s_nop 0
    v_pk_mul_f32 v[32:33], v[32:33], v[34:35]
    v_cvt_pk_bf16_f32 v32, v32, v33
    v_lshlrev_b32 v34, 16, v32
    v_and_b32 v35, s72, v32
    v_lshlrev_b32 v36, 16, v144
    v_and_b32 v37, s72, v144
    v_pk_mul_f32 v[36:37], v[36:37], v[24:25]
    v_cvt_pk_bf16_f32 v36, v36, v37
    v_lshlrev_b32 v32, 16, v36
    v_and_b32 v33, s72, v36
    v_pk_add_f32 v[32:33], v[32:33], v[152:153]
    v_lshlrev_b32 v36, 16, v136
    v_and_b32 v37, s72, v136
    v_pk_fma_f32 v[60:61], v[32:33], v[34:35], v[36:37]
    v_lshlrev_b32 v40, 16, v17
    v_and_b32 v41, s72, v17
    v_lshlrev_b32 v42, 16, v129
    v_and_b32 v43, s72, v129
    v_pk_add_f32 v[40:41], v[40:41], v[42:43]
    v_cvt_pk_bf16_f32 v40, v40, v41
    v_lshlrev_b32 v42, 16, v40
    v_and_b32 v43, s72, v40
    v_pk_mul_f32 v[40:41], v[42:43], s[68:69]
    v_exp_f32 v40, v40
    v_exp_f32 v41, v41
    s_nop 0
    v_pk_add_f32 v[40:41], v[40:41], 1.0 op_sel_hi:[1,0]
    v_rcp_f32 v40, v40
    v_rcp_f32 v41, v41
    s_nop 0
    v_pk_mul_f32 v[40:41], v[40:41], v[42:43]
    v_cvt_pk_bf16_f32 v40, v40, v41
    v_lshlrev_b32 v42, 16, v40
    v_and_b32 v43, s72, v40
    v_lshlrev_b32 v44, 16, v145
    v_and_b32 v45, s72, v145
    v_pk_mul_f32 v[44:45], v[44:45], v[26:27]
    v_cvt_pk_bf16_f32 v44, v44, v45
    v_lshlrev_b32 v40, 16, v44
    v_and_b32 v41, s72, v44
    v_pk_add_f32 v[40:41], v[40:41], v[154:155]
    v_lshlrev_b32 v44, 16, v137
    v_and_b32 v45, s72, v137
    v_pk_fma_f32 v[62:63], v[40:41], v[42:43], v[44:45]
    buffer_store_dwordx4 v[60:63], v104, s[64:67], s81 offen sc1
    s_waitcnt lgkmcnt(2)
    v_lshlrev_b32 v32, 16, v18
    v_and_b32 v33, s72, v18
    v_lshlrev_b32 v34, 16, v130
    v_and_b32 v35, s72, v130
    v_pk_add_f32 v[32:33], v[32:33], v[34:35]
    v_cvt_pk_bf16_f32 v32, v32, v33
    v_lshlrev_b32 v34, 16, v32
    v_and_b32 v35, s72, v32
    v_pk_mul_f32 v[32:33], v[34:35], s[68:69]
    v_exp_f32 v32, v32
    v_exp_f32 v33, v33
    s_nop 0
    v_pk_add_f32 v[32:33], v[32:33], 1.0 op_sel_hi:[1,0]
    v_rcp_f32 v32, v32
    v_rcp_f32 v33, v33
    s_nop 0
    v_pk_mul_f32 v[32:33], v[32:33], v[34:35]
    v_cvt_pk_bf16_f32 v32, v32, v33
    v_lshlrev_b32 v34, 16, v32
    v_and_b32 v35, s72, v32
    v_lshlrev_b32 v36, 16, v146
    v_and_b32 v37, s72, v146
    v_pk_mul_f32 v[36:37], v[36:37], v[24:25]
    v_cvt_pk_bf16_f32 v36, v36, v37
    v_lshlrev_b32 v32, 16, v36
    v_and_b32 v33, s72, v36
    v_pk_add_f32 v[32:33], v[32:33], v[156:157]
    v_lshlrev_b32 v36, 16, v138
    v_and_b32 v37, s72, v138
    v_pk_fma_f32 v[64:65], v[32:33], v[34:35], v[36:37]
    v_lshlrev_b32 v40, 16, v19
    v_and_b32 v41, s72, v19
    v_lshlrev_b32 v42, 16, v131
    v_and_b32 v43, s72, v131
    v_pk_add_f32 v[40:41], v[40:41], v[42:43]
    v_cvt_pk_bf16_f32 v40, v40, v41
    v_lshlrev_b32 v42, 16, v40
    v_and_b32 v43, s72, v40
    v_pk_mul_f32 v[40:41], v[42:43], s[68:69]
    v_exp_f32 v40, v40
    v_exp_f32 v41, v41
    s_nop 0
    v_pk_add_f32 v[40:41], v[40:41], 1.0 op_sel_hi:[1,0]
    v_rcp_f32 v40, v40
    v_rcp_f32 v41, v41
    s_nop 0
    v_pk_mul_f32 v[40:41], v[40:41], v[42:43]
    v_cvt_pk_bf16_f32 v40, v40, v41
    v_lshlrev_b32 v42, 16, v40
    v_and_b32 v43, s72, v40
    v_lshlrev_b32 v44, 16, v147
    v_and_b32 v45, s72, v147
    v_pk_mul_f32 v[44:45], v[44:45], v[26:27]
    v_cvt_pk_bf16_f32 v44, v44, v45
    v_lshlrev_b32 v40, 16, v44
    v_and_b32 v41, s72, v44
    v_pk_add_f32 v[40:41], v[40:41], v[158:159]
    v_lshlrev_b32 v44, 16, v139
    v_and_b32 v45, s72, v139
    v_pk_fma_f32 v[66:67], v[40:41], v[42:43], v[44:45]
    buffer_store_dwordx4 v[64:67], v105, s[64:67], s81 offen sc1
    s_waitcnt lgkmcnt(1)
    v_lshlrev_b32 v32, 16, v20
    v_and_b32 v33, s72, v20
    v_lshlrev_b32 v34, 16, v132
    v_and_b32 v35, s72, v132
    v_pk_add_f32 v[32:33], v[32:33], v[34:35]
    v_cvt_pk_bf16_f32 v32, v32, v33
    v_lshlrev_b32 v34, 16, v32
    v_and_b32 v35, s72, v32
    v_pk_mul_f32 v[32:33], v[34:35], s[68:69]
    v_exp_f32 v32, v32
    v_exp_f32 v33, v33
    s_nop 0
    v_pk_add_f32 v[32:33], v[32:33], 1.0 op_sel_hi:[1,0]
    v_rcp_f32 v32, v32
    v_rcp_f32 v33, v33
    s_nop 0
    v_pk_mul_f32 v[32:33], v[32:33], v[34:35]
    v_cvt_pk_bf16_f32 v32, v32, v33
    v_lshlrev_b32 v34, 16, v32
    v_and_b32 v35, s72, v32
    v_lshlrev_b32 v36, 16, v148
    v_and_b32 v37, s72, v148
    v_pk_mul_f32 v[36:37], v[36:37], v[24:25]
    v_cvt_pk_bf16_f32 v36, v36, v37
    v_lshlrev_b32 v32, 16, v36
    v_and_b32 v33, s72, v36
    v_pk_add_f32 v[32:33], v[32:33], v[160:161]
    v_lshlrev_b32 v36, 16, v140
    v_and_b32 v37, s72, v140
    v_pk_fma_f32 v[68:69], v[32:33], v[34:35], v[36:37]
    v_lshlrev_b32 v40, 16, v21
    v_and_b32 v41, s72, v21
    v_lshlrev_b32 v42, 16, v133
    v_and_b32 v43, s72, v133
    v_pk_add_f32 v[40:41], v[40:41], v[42:43]
    v_cvt_pk_bf16_f32 v40, v40, v41
    v_lshlrev_b32 v42, 16, v40
    v_and_b32 v43, s72, v40
    v_pk_mul_f32 v[40:41], v[42:43], s[68:69]
    v_exp_f32 v40, v40
    v_exp_f32 v41, v41
    s_nop 0
    v_pk_add_f32 v[40:41], v[40:41], 1.0 op_sel_hi:[1,0]
    v_rcp_f32 v40, v40
    v_rcp_f32 v41, v41
    s_nop 0
    v_pk_mul_f32 v[40:41], v[40:41], v[42:43]
    v_cvt_pk_bf16_f32 v40, v40, v41
    v_lshlrev_b32 v42, 16, v40
    v_and_b32 v43, s72, v40
    v_lshlrev_b32 v44, 16, v149
    v_and_b32 v45, s72, v149
    v_pk_mul_f32 v[44:45], v[44:45], v[26:27]
    v_cvt_pk_bf16_f32 v44, v44, v45
    v_lshlrev_b32 v40, 16, v44
    v_and_b32 v41, s72, v44
    v_pk_add_f32 v[40:41], v[40:41], v[162:163]
    v_lshlrev_b32 v44, 16, v141
    v_and_b32 v45, s72, v141
    v_pk_fma_f32 v[70:71], v[40:41], v[42:43], v[44:45]
    buffer_store_dwordx4 v[68:71], v106, s[64:67], s81 offen sc1
    s_waitcnt lgkmcnt(0)
    v_lshlrev_b32 v32, 16, v22
    v_and_b32 v33, s72, v22
    v_lshlrev_b32 v34, 16, v134
    v_and_b32 v35, s72, v134
    v_pk_add_f32 v[32:33], v[32:33], v[34:35]
    v_cvt_pk_bf16_f32 v32, v32, v33
    v_lshlrev_b32 v34, 16, v32
    v_and_b32 v35, s72, v32
    v_pk_mul_f32 v[32:33], v[34:35], s[68:69]
    v_exp_f32 v32, v32
    v_exp_f32 v33, v33
    s_nop 0
    v_pk_add_f32 v[32:33], v[32:33], 1.0 op_sel_hi:[1,0]
    v_rcp_f32 v32, v32
    v_rcp_f32 v33, v33
    s_nop 0
    v_pk_mul_f32 v[32:33], v[32:33], v[34:35]
    v_cvt_pk_bf16_f32 v32, v32, v33
    v_lshlrev_b32 v34, 16, v32
    v_and_b32 v35, s72, v32
    v_lshlrev_b32 v36, 16, v150
    v_and_b32 v37, s72, v150
    v_pk_mul_f32 v[36:37], v[36:37], v[24:25]
    v_cvt_pk_bf16_f32 v36, v36, v37
    v_lshlrev_b32 v32, 16, v36
    v_and_b32 v33, s72, v36
    v_pk_add_f32 v[32:33], v[32:33], v[164:165]
    v_lshlrev_b32 v36, 16, v142
    v_and_b32 v37, s72, v142
    v_pk_fma_f32 v[72:73], v[32:33], v[34:35], v[36:37]
    v_lshlrev_b32 v40, 16, v23
    v_and_b32 v41, s72, v23
    v_lshlrev_b32 v42, 16, v135
    v_and_b32 v43, s72, v135
    v_pk_add_f32 v[40:41], v[40:41], v[42:43]
    v_cvt_pk_bf16_f32 v40, v40, v41
    v_lshlrev_b32 v42, 16, v40
    v_and_b32 v43, s72, v40
    v_pk_mul_f32 v[40:41], v[42:43], s[68:69]
    v_exp_f32 v40, v40
    v_exp_f32 v41, v41
    s_nop 0
    v_pk_add_f32 v[40:41], v[40:41], 1.0 op_sel_hi:[1,0]
    v_rcp_f32 v40, v40
    v_rcp_f32 v41, v41
    s_nop 0
    v_pk_mul_f32 v[40:41], v[40:41], v[42:43]
    v_cvt_pk_bf16_f32 v40, v40, v41
    v_lshlrev_b32 v42, 16, v40
    v_and_b32 v43, s72, v40
    v_lshlrev_b32 v44, 16, v151
    v_and_b32 v45, s72, v151
    v_pk_mul_f32 v[44:45], v[44:45], v[26:27]
    v_cvt_pk_bf16_f32 v44, v44, v45
    v_lshlrev_b32 v40, 16, v44
    v_and_b32 v41, s72, v44
    v_pk_add_f32 v[40:41], v[40:41], v[166:167]
    v_lshlrev_b32 v44, 16, v143
    v_and_b32 v45, s72, v143
    v_pk_fma_f32 v[74:75], v[40:41], v[42:43], v[44:45]
    buffer_store_dwordx4 v[72:75], v107, s[64:67], s81 offen sc1
    s_branch m4_end
m4_idle:
    s_cmp_lt_u32 s5, 28
    s_cbranch_scc1 m4_end
    s_mov_b32 s64, s34
    s_mov_b32 s65, s35
    s_mov_b32 s66, 1966080
    s_mov_b32 s67, 0x20000
    s_sub_u32 s78, s5, 28
    s_lshl_b32 s78, s78, 3
    s_add_u32 s78, s78, s3
    s_lshl_b32 s78, s78, 13
    s_add_u32 s78, s78, 655360
    v_lshlrev_b32 v60, 7, v1
    s_add_u32 s79, s78, 0
    buffer_load_dword v61, v60, s[64:67], s79 offen
    s_add_u32 s79, s78, 262144
    buffer_load_dword v62, v60, s[64:67], s79 offen
    s_add_u32 s79, s78, 524288
    buffer_load_dword v63, v60, s[64:67], s79 offen
    s_add_u32 s79, s78, 786432
    buffer_load_dword v64, v60, s[64:67], s79 offen
    s_add_u32 s79, s78, 1048576
    buffer_load_dword v65, v60, s[64:67], s79 offen
m4_end:
recurrent_scan__ssm_conv_s5__mixer_s_mlp__prompt_kernel_done:
    s_endpgm
recurrent_scan__ssm_conv_s5__mixer_s_mlp__prompt_kernel_end:
.section .rodata,"a"
.p2align 6
.amdhsa_kernel recurrent_scan__ssm_conv_s5__mixer_s_mlp__prompt_kernel
  .amdhsa_next_free_vgpr 256
  .amdhsa_next_free_sgpr 102
  .amdhsa_accum_offset 256
  .amdhsa_group_segment_fixed_size 0
  .amdhsa_kernarg_size 136
  .amdhsa_user_sgpr_count 2
  .amdhsa_user_sgpr_kernarg_segment_ptr 1
  .amdhsa_system_sgpr_workgroup_id_x 1
.end_amdhsa_kernel
```
